```python
import torch

def _softmax(x, axis=-1):
    return torch.softmax(x, dim=axis)
def _gelu(x):
    return torch.nn.functional.gelu(x, approximate="tanh")
def _silu(x):
    return torch.nn.functional.silu(x)
def _sigmoid(x):
    return torch.sigmoid(x)
def _layernorm(x, axis=-1, eps=1e-5):
    m = x.mean(dim=axis, keepdim=True)
    v = x.var(dim=axis, keepdim=True, unbiased=False)
    return (x - m) / torch.sqrt(v + eps)
def _scatter_add(tgt, idx, src, axis=0):
    return tgt.clone().index_add_(axis, idx, src)
def _segment_sum(src, seg, n):
    out = torch.zeros((n,) + src.shape[1:], dtype=src.dtype)
    return out.index_add_(0, seg, src)
def _pad(x, pw):
    flat = tuple(v for pair in reversed(pw) for v in pair)
    return torch.nn.functional.pad(x, flat)

kernel_name = 'interleave_layers__sliding_local_dilated__moe_arch_mod__prompt'

def setup_inputs():

    _w = (lambda a: (lambda t: t.to(torch.bfloat16) if t.is_floating_point() else t)(torch.as_tensor(a)))
    def _A_setup():
        B, S, D = 1, 2048, 576
        return {
            "x": _w((lambda *s: torch.randn(*s, dtype=torch.bfloat16) * 0.05)(B, S, D)),
            "wqkv": _w((lambda *s: torch.randn(*s, dtype=torch.bfloat16) * 0.05)(D, 3 * D)),
            "wo": _w((lambda *s: torch.randn(*s, dtype=torch.bfloat16) * 0.05)(D, D)),
        }
    _A_in = _A_setup()

    def _B_setup():
        B, S, D, F, C = 1, 2048, 576, 4608, 1
        return {
            "x": _w((lambda *s: torch.randn(*s, dtype=torch.bfloat16) * 0.05)(B, S, D)),
            "w_r": _w((lambda *s: torch.randn(*s, dtype=torch.bfloat16) * 0.05)(D)),
            "w_gate": _w((lambda *s: torch.randn(*s, dtype=torch.bfloat16) * 0.05)(D, F)),
            "w_up": _w((lambda *s: torch.randn(*s, dtype=torch.bfloat16) * 0.05)(D, F)),
            "w_down": _w((lambda *s: torch.randn(*s, dtype=torch.bfloat16) * 0.05)(F, D)),
        }
    _B_in = _B_setup()

    return {
        "A_x": _A_in["x"],
        "A_wqkv": _A_in["wqkv"],
        "A_wo": _A_in["wo"],
        "B_x": _B_in["x"],
        "B_w_r": _B_in["w_r"],
        "B_w_gate": _B_in["w_gate"],
        "B_w_up": _B_in["w_up"],
        "B_w_down": _B_in["w_down"],
    }

def reference(A_x, A_wqkv, A_wo, B_x, B_w_r, B_w_gate, B_w_up, B_w_down):
    def _A_ref(x, wqkv, wo):
        B, S, D = x.shape
        H = 32; Dh = D // H
        W, dil = 8, 2
        qkv = (lambda x, *d: x.permute(*d))((x @ wqkv).reshape(B, S, 3, H, Dh), 2, 0, 3, 1, 4)
        q, k, v = qkv[0], qkv[1], qkv[2]
        scale = Dh ** -0.5
        pos = torch.arange(S)
        off = torch.arange(W) * dil
        idx = pos[:, None] - off[None, :]
        mask = idx >= 0
        idx_c = torch.where(mask, idx, 0).reshape(-1)
        kg = k[:, :, idx_c, :].reshape(B, H, S, W, Dh)
        vg = v[:, :, idx_c, :].reshape(B, H, S, W, Dh)
        logits = torch.einsum("bhsd,bhswd->bhsw", q, kg) * scale
        logits = torch.where(mask[None, None, :, :], logits, -1e9)
        attn = _softmax(logits, axis=-1)
        o = torch.einsum("bhsw,bhswd->bhsd", attn, vg)
        return (lambda x, *d: x.permute(*d))(o, 0, 2, 1, 3).reshape(B, S, D) @ wo

    def _B_ref(x, w_r, w_gate, w_up, w_down):
        B, S, D = x.shape
        C = 1
        r = x @ w_r
        idx = torch.argsort(-r, axis=-1)[:, :C]
        idx_e = (lambda x, n, axis: torch.repeat_interleave(x, n, dim=axis))(idx.reshape(B, C, 1), D, axis=2)
        x_sel = (lambda x, i, axis: torch.take_along_dim(x, i, dim=axis))(x, idx_e, axis=1)
        g = _silu(x_sel @ w_gate)
        u = x_sel @ w_up
        y = (g * u) @ w_down
        r_sel = _sigmoid((lambda x, i, axis: torch.take_along_dim(x, i, dim=axis))(r, idx, axis=1))
        y = y * r_sel.reshape(B, C, 1)
        b_off = (torch.arange(B) * S).reshape(B, 1)
        flat_idx = (idx + b_off).reshape(B * C)
        zero = (x * 0.0).reshape(B * S, D)
        upd = _scatter_add(zero, flat_idx, y.reshape(B * C, D), axis=0)
        return x + upd.reshape(B, S, D)

    x = A_x
    x = x + _A_ref(_layernorm(x, axis=-1), A_wqkv, A_wo)
    x = x + _B_ref(_layernorm(x, axis=-1), B_w_r, B_w_gate, B_w_up, B_w_down)
    x = x + _A_ref(_layernorm(x, axis=-1), A_wqkv, A_wo)
    x = x + _B_ref(_layernorm(x, axis=-1), B_w_r, B_w_gate, B_w_up, B_w_down)
    return x
```

```asm
; @launch grid=(256,1,1) block=(256,1,1) lds=163840
.amdgcn_target "amdgcn-amd-amdhsa--gfx950"
.text
.globl interleave_layers__sliding_local_dilated__moe_arch_mod__prompt_kernel
.p2align 8
.type interleave_layers__sliding_local_dilated__moe_arch_mod__prompt_kernel,@function
interleave_layers__sliding_local_dilated__moe_arch_mod__prompt_kernel:
    s_cmp_ge_u32 s2, 256
    s_cbranch_scc1 L_end
    s_getpc_b64 s[74:75]
    s_lshr_b32 s76, s2, 3
    v_lshrrev_b32 v8, 4, v0
    v_lshl_add_u32 v8, s76, 4, v8
    v_lshlrev_b32_e64 v8, 7, v8
    global_load_dword v71, v8, s[74:75]
    s_load_dwordx2 s[4:5], s[0:1], 0
    s_load_dwordx2 s[8:9], s[0:1], 8
    s_load_dwordx2 s[16:17], s[0:1], 80
    s_load_dwordx2 s[24:25], s[0:1], 32
    s_load_dwordx2 s[28:29], s[0:1], 40
    s_load_dwordx2 s[32:33], s[0:1], 48
    s_load_dwordx2 s[36:37], s[0:1], 56
    s_load_dwordx2 s[12:13], s[0:1], 16
    s_load_dwordx2 s[20:21], s[0:1], 64
    v_lshrrev_b32 v1, 6, v0
    s_and_b32 s45, s2, 7
    s_lshr_b32 s76, s2, 3
    v_readfirstlane_b32 s40, v1
    s_mul_i32 s77, s76, 29
    s_lshr_b32 s77, s77, 8
    s_mul_i32 s78, s77, 9
    s_sub_u32 s41, s76, s78
    v_lshrrev_b32 v4, 3, v0
    v_and_b32 v5, 7, v0
    v_and_b32 v6, 2, v4
    v_lshrrev_b32 v7, 1, v4
    v_and_b32 v7, 4, v7
    v_or_b32 v6, v6, v7
    v_xor_b32 v6, v5, v6
    v_lshlrev_b32 v6, 4, v6
    v_and_b32 v1, 63, v0
    v_lshlrev_b32 v46, 4, v1
    v_and_b32 v2, 15, v0
    v_bfe_u32 v3, v0, 4, 2
    s_lshl_b32 s51, s40, 10
    s_cmp_eq_u32 s77, 3
    s_cbranch_scc1 L_ffn
    s_mov_b32 s6, 2359296
    s_mov_b32 s7, 0x20000
    s_mov_b32 s10, 1990656
    s_mov_b32 s11, 0x20000
    s_mov_b32 s26, 1152
    s_mov_b32 s27, 0x20000
    s_mov_b32 s44, s77
    s_mul_i32 s42, s45, 3
    s_add_u32 s42, s42, s77
    s_and_b32 s78, s45, 3
    s_or_b32 s43, s78, s77
    s_lshl_b32 s78, s78, 9
    s_mul_i32 s86, s77, 176
    s_add_u32 s86, s86, s78
    s_cmp_lt_u32 s45, 4
    s_subb_u32 s86, s86, 31
    s_mul_i32 s48, s86, 1152
    s_and_b32 s52, s40, 1
    s_lshr_b32 s53, s40, 1
    s_lshl_b32 s79, s41, 7
    s_mov_b32 s49, 1969496848
    s_cmp_eq_u32 s77, 1
    s_cmov_b32 s49, 2252681249
    s_cmp_eq_u32 s77, 2
    s_cmov_b32 s49, 1733509378
    s_mul_i32 s78, s45, 0x11111111
    s_add_u32 s49, s49, s78
    v_bfe_u32 v7, v4, 1, 3
    v_xor_b32 v7, v5, v7
    v_mul_u32_u24 v138, 2304, v4
    v_lshl_add_u32 v138, v7, 4, v138
    v_add_u32_e64 v138, s48, v138
    v_add_u32 v139, 73728, v138
    v_add_u32 v140, 147456, v138
    v_max_i32_e64 v138, 0, v138
    v_mul_u32_u24 v136, 3456, v4
    v_add3_u32 v136, v136, v6, s79
    v_add_u32 v137, 110592, v136
    s_lshl_b32 s78, s52, 6
    s_add_u32 s80, s79, s78
    s_bfe_u32 s78, s49, 262144
    s_sub_u32 s77, s78, 9
    s_min_u32 s78, s78, s77
    s_lshl_b32 s77, s78, 7
    s_mul_i32 s76, s77, 1728
    s_and_b32 s3, s44, 1
    s_lshl_b32 s94, s3, 12
    s_add_u32 s94, s94, s51
    s_mul_i32 s95, s3, 110592
    s_add_u32 s95, s95, s76
    s_cmp_eq_u32 s40, 0
    s_cselect_b32 s83, 0xffffff00, -1
    s_waitcnt lgkmcnt(0)
    s_load_dword s46, s[16:17], 0
    s_add_u32 m0, s51, 24576
    s_mov_b32 exec_lo, s83
    buffer_load_dwordx4 v138, s[4:7], s77 offen  lds
    s_mov_b32 exec_lo, -1
    s_add_u32 m0, s51, 36864
    s_nop 0
    buffer_load_dwordx4 v136, s[8:11], s76 offen offset:0 lds
    s_add_u32 m0, s51, 28672
    s_nop 0
    buffer_load_dwordx4 v139, s[4:7], s77 offen  lds
    s_add_u32 m0, s51, 40960
    s_nop 0
    buffer_load_dwordx4 v137, s[8:11], s76 offen offset:0 lds
    s_add_u32 m0, s51, 32768
    s_nop 0
    buffer_load_dwordx4 v140, s[4:7], s77 offen  lds
    s_add_u32 m0, s51, 43904
    s_nop 0
    buffer_load_dwordx4 v136, s[8:11], s76 offen offset:1152 lds
    s_add_u32 m0, s51, 48000
    s_nop 0
    buffer_load_dwordx4 v137, s[8:11], s76 offen offset:1152 lds
    s_add_u32 m0, s94, 50944
    s_nop 0
    buffer_load_dwordx4 v136, s[8:11], s95 offen offset:2304 lds
    s_mov_b32 s18, 268435456
    s_mov_b32 s19, 0x20000
    s_mov_b32 s14, 663552
    s_mov_b32 s15, 0x20000
    s_mov_b32 s22, 2359296
    s_mov_b32 s23, 0x20000
    v_bfe_u32 v7, v0, 2, 2
    v_lshl_add_u32 v8, v3, 3, v7
    v_lshlrev_b32 v8, 7, v8
    v_and_b32 v9, 2, v7
    v_and_b32_e64 v10, 1, v3
    v_lshl_or_b32 v9, v10, 2, v9
    v_bfe_u32 v10, v0, 1, 1
    v_lshl_or_b32 v10, s40, 1, v10
    v_xor_b32_e64 v9, v9, v10
    v_lshl_add_u32 v8, v9, 4, v8
    v_and_b32_e64 v9, 1, v0
    v_lshl_add_u32 v8, v9, 3, v8
    v_mov_b32 v10, 1073741824
    v_mov_b32 v141, v8
    v_add_u32 v142, 73728, v8
    v_bfe_u32 v7, v2, 1, 3
    v_xor_b32 v7, v3, v7
    v_lshlrev_b32 v7, 4, v7
    v_lshl_add_u32 v7, v2, 7, v7
    v_add_u32 v143, 24576, v7
    v_xor_b32_e64 v144, 64, v143
    v_add_u32 v145, 73728, v143
    v_add_u32 v146, 73728, v144
    s_lshl_b32 s81, s52, 6
    s_lshl_b32 s82, s53, 11
    v_xor_b32 v7, s81, v7
    v_add_u32 v151, s82, v7
    v_add_u32 v147, 24576, v151
    v_add_u32 v148, 73728, v147
    v_and_b32 v7, 3, v0
    v_cmp_eq_u32 vcc, 1, v7
    v_lshlrev_b32 v9, 4, v3
    s_nop 0
    v_cndmask_b32 v252, v10, v9, vcc
    s_lshl_b32 s47, s42, 18
    s_add_u32 s47, s47, 1048576
    s_sub_u32 s86, 2047, s86
    s_mul_i32 s87, s40, 3072
    v_mov_b32 v248, 0x3f803f80
    v_mov_b32 v249, 0x3f803f80
    v_mov_b32 v250, 0x3f803f80
    v_mov_b32 v251, 0x3f803f80
    v_mul_u32_u24 v7, 36864, v3
    v_lshl_add_u32 v7, v2, 3, v7
    ds_write_b64 v7, v[248:249] offset:24576
    s_mul_i32 s81, s53, 36864
    s_add_u32 s81, s81, s80
    s_add_u32 s81, s81, s48
    v_mul_u32_u24 v62, 2304, v2
    v_lshl_add_u32 v62, v3, 4, v62
    v_add_u32_e64 v62, s81, v62
    v_bfe_u32 v7, v0, 3, 3
    v_and_b32 v9, 2, v7
    v_lshlrev_b32 v9, 1, v9
    v_xor_b32_e64 v9, v5, v9
    v_lshl_add_u32 v9, v9, 4, s79
    s_mul_i32 s81, s53, 18
    s_lshl3_add_u32 s81, s52, s81
    v_add_u32_e64 v11, s81, v7
    v_mul_u32_u24 v11, 1152, v11
    v_add_u32 v149, v11, v9
    v_lshrrev_b32 v11, 1, v7
    v_lshl_add_u32 v11, s40, 2, v11
    v_mul_u32_u24 v11, 18, v11
    v_and_b32 v7, 1, v7
    v_add3_u32 v11, v11, v7, 16
    v_mul_u32_u24 v11, 1152, v11
    v_add_u32 v150, v11, v9
    v_and_b32 v7, 1, v2
    v_cmp_ne_u32 s[60:61], 0, v7
    v_and_b32_e64 v7, 2, v2
    v_cmp_ne_u32 s[62:63], 0, v7
    v_lshrrev_b32_e64 v7, 2, v2
    v_cmp_eq_u32 s[64:65], v7, v3
    s_mov_b32 s84, 0xf149f2ca
    s_mov_b32 s85, 0x3eae1a93
    v_mov_b32_e64 v9, s84
    v_lshl_add_u32 v7, v3, 2, 0
    v_sub_u32_e64 v7, v2, v7
    v_cmp_le_i32 s[66:67], 0, v7
    v_bfe_i32 v7, v7, 3, 1
    v_and_b32_e64 v40, v7, v9
    v_lshl_add_u32 v7, v3, 2, 1
    v_sub_u32_e64 v7, v2, v7
    v_cmp_le_i32 s[68:69], 0, v7
    v_bfe_i32 v7, v7, 3, 1
    v_and_b32_e64 v41, v7, v9
    v_lshl_add_u32 v7, v3, 2, 2
    v_sub_u32_e64 v7, v2, v7
    v_cmp_le_i32 s[70:71], 0, v7
    v_bfe_i32 v7, v7, 3, 1
    v_and_b32_e64 v42, v7, v9
    v_lshl_add_u32 v7, v3, 2, 3
    v_sub_u32_e64 v7, v2, v7
    v_cmp_le_i32 s[72:73], 0, v7
    v_bfe_i32 v7, v7, 3, 1
    v_and_b32_e64 v43, v7, v9
    v_mov_b32 v7, 0xffff
    v_mov_b32 v8, 0xffff0000
    v_cndmask_b32 v9, 0, v7, s[66:67]
    v_cndmask_b32 v11, 0, v8, s[68:69]
    v_or_b32_e64 v44, v9, v11
    v_cndmask_b32 v9, 0, v7, s[70:71]
    v_cndmask_b32 v11, 0, v8, s[72:73]
    v_or_b32 v45, v9, v11
    s_lshl_b32 s81, s40, 5
    s_add_u32 s81, s81, 110608
    v_mul_u32_u24 v7, 168, v2
    v_lshl_add_u32 v9, v3, 3, v7
    v_add_u32_e64 v47, s81, v9
    s_mul_i32 s81, s40, 3328
    s_add_u32 s81, s81, 144512
    v_mul_u32_u24 v11, 208, v2
    v_mad_u32_u24 v11, v3, 48, v11
    v_add_u32_e64 v48, s81, v11
    s_mov_b32 s81, 159744
    v_lshl_add_u32 v49, v2, 2, s81
    v_lshl_add_u32 v50, v3, 4, s81
    s_mul_i32 s81, s41, 7
    s_add_u32 s81, s81, 1
    s_lshr_b32 s81, s81, 1
    s_add_u32 s81, s81, s40
    s_and_b32 s55, s52, s53
    s_and_b32 s55, s55, s41
    s_sub_u32 s81, s81, s55
    s_lshl_b32 s55, s55, 30
    s_mul_i32 s82, s81, 18
    s_lshl_b32 s54, s41, 6
    s_sub_u32 s82, s82, s54
    s_add_u32 s82, s82, 8
    s_and_b32 s54, s81, 1
    s_lshl_b32 s94, s82, 1
    s_add_u32 s94, s94, 110592
    s_lshl2_add_u32 s95, s54, s94
    v_add_u32 v51, s95, v9
    s_cmp_eq_u32 s54, 0
    s_cselect_b32 s95, 32, 0
    s_add_u32 s95, s95, s94
    v_mov_b32 v52, s95
    v_mov_b32 v9, 110752
    v_cmp_eq_u32 vcc, 0, v3
    s_nop 1
    v_cndmask_b32 v52, v9, v52, vcc
    v_add_u32 v52, v52, v7
    s_mul_i32 s94, s82, 208
    s_add_u32 s94, s94, 142848
    v_add_u32_e64 v53, s94, v11
    s_add_u32 s94, s94, 3328
    v_and_b32_e64 v7, 1, v2
    v_mul_u32_u24 v7, 208, v7
    v_add_u32_e64 v7, s94, v7
    v_mov_b32 v9, 159488
    v_cndmask_b32 v7, v7, v9, s[62:63]
    v_mad_u32_u24 v54, v3, 48, v7
    s_mul_i32 s94, s81, 43
    s_lshr_b32 s94, s94, 9
    s_mul_i32 s94, s94, 6144
    s_lshl_b32 s95, s81, 9
    s_add_u32 s94, s94, s95
    s_add_u32 s94, s94, s55
    v_lshrrev_b32 v7, 1, v3
    v_lshl_add_u32 v7, v7, 4, v2
    v_lshl_add_u32 v7, v7, 4, s94
    v_and_b32 v9, 1, v3
    v_lshl_add_u32 v55, v9, 3, v7
    s_lshr_b32 s94, s81, 2
    s_lshl_b32 s94, s94, 8
    s_and_b32 s95, s81, 3
    s_lshl2_add_u32 s94, s95, s94
    s_add_u32 s94, s94, 28672
    s_add_u32 s94, s94, s55
    v_lshl_add_u32 v7, v2, 4, s94
    v_mul_u32_u24 v9, 6144, v3
    v_add_u32 v7, v7, v9
    v_cmp_gt_u32 vcc, 2, v3
    s_nop 1
    v_cndmask_b32 v56, v10, v7, vcc
    s_mov_b32 s90, 1969496848
    s_cmp_eq_u32 s44, 1
    s_cmov_b32 s90, 2252681474
    s_cselect_b32 s91, 7, 8
    s_cmp_eq_u32 s44, 2
    s_cmov_b32 s90, 1733509153
    s_sub_u32 s81, s41, s45
    s_add_u32 s82, s81, 9
    s_min_u32 s81, s81, s82
    s_lshl_b32 s81, s81, 2
    s_lshr_b64 s[74:75], s[90:91], s81
    s_and_b32 s81, s74, 15
    s_lshl1_add_u32 s81, s81, s52
    s_mul_i32 s82, s81, 43
    s_lshr_b32 s82, s82, 8
    s_mul_i32 s82, s82, 6144
    s_lshl_b32 s81, s81, 10
    s_add_u32 s56, s81, s82
    s_mul_i32 s81, s53, 6144
    s_add_u32 s56, s56, s81
    s_add_u32 s56, s56, s47
    s_add_u32 s94, s44, 1
    s_mov_b32 s92, 1969496848
    s_cmp_eq_u32 s94, 1
    s_cmov_b32 s92, 2252681474
    s_cselect_b32 s93, 7, 8
    s_cmp_eq_u32 s94, 2
    s_cmov_b32 s92, 1733509153
    s_sub_u32 s81, s41, s45
    s_add_u32 s82, s81, 9
    s_min_u32 s81, s81, s82
    s_lshl_b32 s81, s81, 2
    s_lshr_b64 s[74:75], s[92:93], s81
    s_and_b32 s81, s74, 15
    s_lshl1_add_u32 s81, s81, s52
    s_mul_i32 s82, s81, 43
    s_lshr_b32 s82, s82, 8
    s_mul_i32 s82, s82, 6144
    s_lshl_b32 s81, s81, 10
    s_add_u32 s57, s81, s82
    s_add_u32 s57, s57, s47
    s_add_u32 s57, s57, 442240
    s_cmp_lt_u32 s44, 2
    s_cselect_b32 s81, s53, 0
    s_cmp_eq_u32 s81, 0
    s_cselect_b32 s57, 1073741824, s57
    s_lshl2_add_u32 s81, s41, s40
    s_lshl_b32 s81, s81, 2
    v_mov_b32 v7, s81
    v_cmp_eq_u32 vcc, 0, v1
    s_nop 1
    v_cndmask_b32 v57, v10, v7, vcc
    v_min_u32 v7, 35, v1
    v_lshlrev_b32 v59, 2, v7
    v_cmp_eq_u32 vcc, 7, v5
    s_nop 1
    v_subb_co_u32 v7, vcc, v7, 0, vcc
    v_lshlrev_b32 v58, 2, v7
    s_add_u32 s81, s41, s52
    s_sub_u32 s81, s81, 1
    s_mul_i32 s59, s81, 6144
    s_add_u32 s59, s59, s47
    s_add_u32 s59, s59, 2048
    s_and_b32 s82, s41, 1
    s_sub_u32 s58, 2, s82
    s_cmp_gt_u32 s81, 7
    s_cselect_b32 s58, 0, s58
    s_cmp_eq_u32 s52, s53
    s_cselect_b32 s58, s58, 0
    s_add_u32 s32, s59, 4096
    s_sub_u32 s28, 0, s52
    s_mov_b32 s29, s28
    s_xor_b32 s30, s28, 0xff00ff00
    s_mov_b64 exec, 0
    s_cmp_eq_u32 s40, 1
    s_cbranch_scc1 Lw1
    s_cmp_eq_u32 s40, 2
    s_cbranch_scc1 Lw2
    s_cmp_eq_u32 s40, 3
    s_cbranch_scc1 Lw3
    s_branch Lw0
Lwx:
    s_mov_b64 exec, -1
    s_xor_b32 s3, s3, 1
    s_lshl_b32 s50, s3, 12
    s_add_u32 s50, s50, s51
    s_mul_i32 s78, s3, 110592
    s_add_u32 s78, s78, s76
    s_add_u32 m0, s50, 50944
    s_nop 0
    buffer_load_dwordx4 v136, s[8:11], s78 offen offset:2304 lds
    s_mov_b32 s31, s30
    s_xor_b32 s81, s52, 1
    v_lshrrev_b32_e64 v7, 5, v1
    v_mul_u32_u24 v7, 16128, v7
    v_mul_u32_u24 v9, 168, v2
    s_mul_i32 s82, s52, 144
    s_add_u32 s82, s82, 110592
    v_add3_u32 v7, v7, v9, s82
    v_and_b32_e64 v9, 1, v3
    v_lshl_add_u32 v63, v9, 3, v7
    s_bfe_u32 s78, s49, 262148
    s_sub_u32 s77, s78, 9
    s_min_u32 s78, s78, s77
    s_lshl_b32 s77, s78, 7
    s_mul_i32 s76, s77, 1728
    s_add_u32 m0, s51, 73728
    s_nop 0
    buffer_load_dwordx4 v136, s[8:11], s76 offen offset:0 lds
    v_lshrrev_b32 v7, 3, v2
    v_xor_b32 v7, s81, v7
    s_mul_i32 s82, s52, 14976
    s_add_u32 s82, s82, 142848
    v_lshl_add_u32 v7, v7, 2, s82
    v_mul_u32_u24 v9, 208, v5
    v_mad_u32_u24 v9, v3, 48, v9
    v_add_u32_e64 v64, v7, v9
    s_lshl1_add_u32 s81, s41, s52
    s_mul_i32 s81, s81, 1536
    s_add_u32 m0, s51, 77824
    s_nop 0
    buffer_load_dwordx4 v137, s[8:11], s76 offen offset:0 lds
    s_lshl_b32 s82, s53, 8
    s_add_u32 s81, s81, s82
    v_lshl_add_u32 v7, v2, 4, s81
    v_cndmask_b32 v60, v10, v7, s[64:65]
    v_lshrrev_b32_e64 v7, 3, v1
    v_mul_u32_u24 v7, 1536, v7
    v_lshl_add_u32 v7, v5, 4, v7
    v_lshl_add_u32 v61, s40, 7, v7
    v_cmp_gt_u32 vcc, 16, v1
    s_nop 1
    v_cndmask_b32 v69, v10, v61, vcc
    s_add_u32 m0, s51, 80768
    s_nop 0
    buffer_load_dwordx4 v136, s[8:11], s76 offen offset:1152 lds
    v_lshlrev_b32_e64 v7, 3, v3
    v_mov_b32 v9, 0x00200040
    v_bfe_u32 v7, v9, v7, 8
    v_lshl_add_u32 v9, s40, 3, v5
    v_add_u32_e64 v7, v7, v9
    s_mov_b32 s81, 159744
    v_lshl_add_u32 v66, v7, 2, s81
    v_lshlrev_b32_e64 v9, 1, v7
    v_sub_u32 v67, s86, v9
    s_cmp_eq_u32 s44, 0
    s_cselect_b32 s81, 16, 8
    s_add_u32 m0, s51, 84864
    s_nop 0
    buffer_load_dwordx4 v137, s[8:11], s76 offen offset:1152 lds
    v_cmp_le_u32 s[88:89], s81, v7
    v_lshlrev_b32_e64 v65, 5, v3
    v_mul_u32_u24 v7, 168, v0
    v_add_u32 v7, 110752, v7
    v_cmp_gt_u32 vcc, 192, v0
    v_mov_b32 v9, 162816
    s_nop 0
    v_cndmask_b32 v253, v9, v7, vcc
    v_and_b32 v7, 31, v0
    v_min_u32 v7, 25, v7
    v_lshlrev_b32 v7, 3, v7
    s_add_u32 m0, s51, 87808
    s_nop 0
    buffer_load_dwordx4 v136, s[8:11], s76 offen offset:2304 lds
    v_add_u32 v7, 159488, v7
    ds_write_b64 v7, v[248:249]
    v_min_u32 v151, 26, v1
    v_lshlrev_b32 v151, 2, v151
    s_mul_i32 s81, s52, 768
    s_lshl_b32 s82, s53, 7
    s_add_u32 s81, s81, s82
    s_add_u32 s81, s81, 161280
    v_lshl_add_u32 v7, v2, 3, s81
    v_cndmask_b32 v24, v10, v7, s[64:65]
    s_add_u32 m0, s51, 91904
    s_nop 0
    buffer_load_dwordx4 v137, s[8:11], s76 offen offset:2304 lds
    s_lshl_b32 s81, s52, 5
    v_add_u32_e64 v7, s81, v1
    s_mov_b32 s81, 161280
    v_lshl_add_u32 v25, v7, 3, s81
    s_mov_b32 s81, 159744
    v_lshl_add_u32 v26, v7, 2, s81
    v_bfe_u32 v7, v1, 2, 2
    v_lshl_add_u32 v9, v3, 3, v7
    v_lshlrev_b32 v9, 7, v9
    v_lshrrev_b32 v7, 1, v7
    s_add_u32 m0, s51, 135168
    s_mov_b32 exec_lo, s83
    buffer_load_dwordx4 v138, s[4:7], s77 offen  lds
    s_mov_b32 exec_lo, -1
    v_xor_b32 v7, s52, v7
    v_and_b32 v11, 3, v1
    v_lshl_or_b32 v7, v7, 2, v11
    v_lshl_add_u32 v7, v7, 4, v9
    v_add_u32 v33, 36864, v7
    v_add_u32 v34, 73728, v7
    v_mov_b32 v254, 0
    v_mov_b32 v255, 0
    v_and_b32_e64 v7, 3, v0
    v_cmp_eq_u32 vcc, 0, v7
    s_add_u32 m0, s51, 139264
    s_nop 0
    buffer_load_dwordx4 v139, s[4:7], s77 offen  lds
    s_add_u32 m0, s51, 143360
    s_nop 0
    buffer_load_dwordx4 v140, s[4:7], s77 offen  lds
    buffer_load_dwordx4 v[12:15], v46, s[24:27], 0 offen offset:0
    buffer_load_dwordx4 v[16:19], v46, s[24:27], 0 offen offset:1024
    buffer_load_dwordx4 v[36:39], v252, s[24:27], s80 offen
    s_branch Lhot
.p2align 12
Lhot:
    Lw0: s_cbranch_execz Lw4
    s_waitcnt vmcnt(12) lgkmcnt(0)
    s_barrier
    s_nop 0
    ds_read_b128 v[112:115], v147 offset:0
    ds_read_b128 v[116:119], v147 offset:4096
    ds_read_b128 v[120:123], v147 offset:8192
    ds_read_b64_tr_b16 a[0:1], v141 offset:36864
    ds_read_b64_tr_b16 a[2:3], v141 offset:37376
    ds_read_b64_tr_b16 a[4:5], v141 offset:45056
    ds_read_b64_tr_b16 a[6:7], v141 offset:45568
    ds_read_b64_tr_b16 a[8:9], v141 offset:53248
    ds_read_b64_tr_b16 a[10:11], v141 offset:53760
    s_waitcnt lgkmcnt(8)
    v_mfma_f32_16x16x32_bf16 v[224:227], v[112:115], v[112:115], 0
    s_bfe_u32 s78, s49, 262152
    ds_read_b128 v[76:79], v143 offset:0
    s_sub_u32 s76, s78, 9
    v_mfma_f32_16x16x32_bf16 v[228:231], v[248:251], v[112:115], 0
    s_waitcnt lgkmcnt(8)
    ds_read_b128 v[80:83], v143 offset:2048
    s_min_u32 s78, s78, s76
    v_mfma_f32_16x16x32_bf16 v[232:235], v[116:119], v[116:119], 0
    s_mul_i32 s76, s78, 221184
    ds_read_b128 v[84:87], v143 offset:4096
    s_add_u32 m0, s51, 0
    v_mfma_f32_16x16x32_bf16 v[236:239], v[248:251], v[116:119], 0
    s_waitcnt lgkmcnt(9)
    ds_read_b128 v[88:91], v143 offset:6144
    s_mul_i32 s46, s46, 1664525
    v_mfma_f32_16x16x32_bf16 v[240:243], v[120:123], v[120:123], 0
    buffer_load_dwordx4 v136, s[8:11], s76 offen offset:0 lds
    ds_read_b128 v[92:95], v143 offset:8192
    v_mfma_f32_16x16x32_bf16 v[244:247], v[248:251], v[120:123], 0
    s_waitcnt lgkmcnt(4)
    ds_read_b128 v[96:99], v143 offset:10240
    s_add_u32 m0, s51, 4096
    v_mfma_f32_16x16x32_bf16 v[152:155], a[0:3], v[76:79], 0
    buffer_load_dwordx4 v137, s[8:11], s76 offen offset:0 lds
    ds_read_b64_tr_b16 a[12:13], v141 offset:40960
    v_mfma_f32_16x16x32_bf16 v[156:159], a[4:7], v[76:79], 0
    s_add_u32 m0, s51, 7040
    ds_read_b64_tr_b16 a[14:15], v141 offset:41472
    s_add_u32 s46, s46, 1013904223
    v_mfma_f32_16x16x32_bf16 v[160:163], v[76:79], a[8:11], 0
    s_waitcnt lgkmcnt(6)
    ds_read_b64_tr_b16 a[16:17], v141 offset:49152
    s_andn2_b32 s46, s46, 15
    v_mfma_f32_16x16x32_bf16 v[164:167], a[0:3], v[80:83], 0
    buffer_load_dwordx4 v136, s[8:11], s76 offen offset:1152 lds
    ds_read_b64_tr_b16 a[18:19], v141 offset:49664
    v_mfma_f32_16x16x32_bf16 v[168:171], a[4:7], v[80:83], 0
    s_add_u32 m0, s51, 11136
    ds_read_b64_tr_b16 a[20:21], v141 offset:57344
    v_mov_b32 v68, s46
    v_mfma_f32_16x16x32_bf16 v[172:175], v[80:83], a[8:11], 0
    s_waitcnt lgkmcnt(8)
    ds_read_b64_tr_b16 a[22:23], v141 offset:57856
    s_or_b32 s33, s46, 2
    v_mfma_f32_16x16x32_bf16 v[176:179], a[0:3], v[84:87], 0
    buffer_load_dwordx4 v137, s[8:11], s76 offen offset:1152 lds
    ds_read_b128 v[100:103], v144 offset:0
    v_mfma_f32_16x16x32_bf16 v[180:183], a[4:7], v[84:87], 0
    s_add_u32 m0, s51, 14080
    ds_read_b128 v[104:107], v144 offset:2048
    s_getreg_b32 s81, hwreg(HW_REG_XCC_ID, 0, 4)
    v_mfma_f32_16x16x32_bf16 v[184:187], v[84:87], a[8:11], 0
    s_waitcnt lgkmcnt(10)
    buffer_load_dwordx4 v136, s[8:11], s76 offen offset:2304 lds
    v_mfma_f32_16x16x32_bf16 v[188:191], a[0:3], v[88:91], 0
    s_add_u32 m0, s51, 18176
    ds_read_b128 v[108:111], v144 offset:4096
    s_or_b32 s54, s81, s46
    v_mfma_f32_16x16x32_bf16 v[192:195], a[4:7], v[88:91], 0
    buffer_load_dwordx4 v137, s[8:11], s76 offen offset:2304 lds
    ds_read_b128 v[112:115], v144 offset:6144
    v_mfma_f32_16x16x32_bf16 v[196:199], v[88:91], a[8:11], 0
    s_waitcnt lgkmcnt(11)
    s_bfe_u32 s78, s49, 262152
    s_sub_u32 s77, s78, 9
    v_mfma_f32_16x16x32_bf16 v[200:203], a[0:3], v[92:95], 0
    s_min_u32 s78, s78, s77
    ds_read_b128 v[116:119], v144 offset:8192
    s_lshl_b32 s77, s78, 7
    v_mfma_f32_16x16x32_bf16 v[204:207], a[4:7], v[92:95], 0
    s_add_u32 m0, s51, 61440
    ds_read_b128 v[120:123], v144 offset:10240
    v_mov_b32_e64 v73, s54
    v_mfma_f32_16x16x32_bf16 v[208:211], v[92:95], a[8:11], 0
    s_waitcnt lgkmcnt(12)
    s_mul_i32 s55, s45, 786432
    s_add_u32 s55, s55, 1294336
    v_mfma_f32_16x16x32_bf16 v[212:215], a[0:3], v[96:99], 0
    s_mov_b32 exec_lo, s83
    buffer_load_dwordx4 v138, s[4:7], s77 offen  lds
    s_mov_b32 exec_lo, -1
    v_mfma_f32_16x16x32_bf16 v[216:219], a[4:7], v[96:99], 0
    s_add_u32 m0, s51, 65536
    s_lshr_b32 s81, s2, 3
    s_lshl2_add_u32 s81, s81, s55
    v_mfma_f32_16x16x32_bf16 v[220:223], v[96:99], a[8:11], 0
    s_waitcnt lgkmcnt(5)
    buffer_load_dwordx4 v139, s[4:7], s77 offen  lds
    v_mfma_f32_16x16x32_bf16 v[152:155], a[12:15], v[100:103], v[152:155]
    s_add_u32 m0, s51, 69632
    s_cmp_eq_u32 s40, 0
    s_cselect_b32 s81, s81, 1073741824
    v_mfma_f32_16x16x32_bf16 v[156:159], a[16:19], v[100:103], v[156:159]
    buffer_load_dwordx4 v140, s[4:7], s77 offen  lds
    v_mfma_f32_16x16x32_bf16 v[160:163], v[100:103], a[20:23], v[160:163]
    s_waitcnt lgkmcnt(4)
    v_mfma_f32_16x16x32_bf16 v[164:167], a[12:15], v[104:107], v[164:167]
    s_mov_b64 exec, 1
    buffer_store_dword v73, v46, s[16:19], s81 offen sc1
    s_mov_b64 exec, -1
    v_mfma_f32_16x16x32_bf16 v[168:171], a[16:19], v[104:107], v[168:171]
    v_mfma_f32_16x16x32_bf16 v[172:175], v[104:107], a[20:23], v[172:175]
    s_waitcnt vmcnt(13) lgkmcnt(0)
    s_barrier
    v_mfma_f32_16x16x32_bf16 v[176:179], a[12:15], v[108:111], v[176:179]
    s_bfe_u32 s78, s49, 262156
    ds_read_b64_tr_b16 a[24:25], v142 offset:0
    s_sub_u32 s76, s78, 9
    v_mfma_f32_16x16x32_bf16 v[180:183], a[16:19], v[108:111], v[180:183]
    s_min_u32 s78, s78, s76
    ds_read_b64_tr_b16 a[26:27], v142 offset:512
    s_mul_i32 s76, s78, 221184
    v_mfma_f32_16x16x32_bf16 v[184:187], v[108:111], a[20:23], v[184:187]
    ds_read_b64_tr_b16 a[28:29], v142 offset:8192
    s_add_u32 m0, s51, 36864
    v_mfma_f32_16x16x32_bf16 v[188:191], a[12:15], v[112:115], v[188:191]
    buffer_load_dwordx4 v136, s[8:11], s76 offen offset:0 lds
    ds_read_b64_tr_b16 a[30:31], v142 offset:8704
    v_mfma_f32_16x16x32_bf16 v[192:195], a[16:19], v[112:115], v[192:195]
    ds_read_b64_tr_b16 a[32:33], v142 offset:16384
    s_add_u32 m0, s51, 40960
    v_mfma_f32_16x16x32_bf16 v[196:199], v[112:115], a[20:23], v[196:199]
    buffer_load_dwordx4 v137, s[8:11], s76 offen offset:0 lds
    ds_read_b64_tr_b16 a[34:35], v142 offset:16896
    v_mfma_f32_16x16x32_bf16 v[200:203], a[12:15], v[116:119], v[200:203]
    ds_read_b128 v[76:79], v145 offset:36864
    s_add_u32 m0, s51, 43904
    v_mfma_f32_16x16x32_bf16 v[204:207], a[16:19], v[116:119], v[204:207]
    buffer_load_dwordx4 v136, s[8:11], s76 offen offset:1152 lds
    ds_read_b128 v[80:83], v145 offset:38912
    v_mfma_f32_16x16x32_bf16 v[208:211], v[116:119], a[20:23], v[208:211]
    ds_read_b128 v[84:87], v145 offset:40960
    s_add_u32 m0, s51, 48000
    v_mfma_f32_16x16x32_bf16 v[212:215], a[12:15], v[120:123], v[212:215]
    ds_read_b128 v[88:91], v145 offset:43008
    v_mfma_f32_16x16x32_bf16 v[216:219], a[16:19], v[120:123], v[216:219]
    buffer_load_dwordx4 v137, s[8:11], s76 offen offset:1152 lds
    ds_read_b128 v[92:95], v145 offset:45056
    v_mfma_f32_16x16x32_bf16 v[220:223], v[120:123], a[20:23], v[220:223]
    s_waitcnt lgkmcnt(4)
    ds_read_b128 v[96:99], v145 offset:47104
    s_add_u32 m0, s51, 50944
    v_mfma_f32_16x16x32_bf16 v[152:155], a[24:27], v[76:79], v[152:155]
    ds_read_b128 v[124:127], v148 offset:36864
    v_mfma_f32_16x16x32_bf16 v[156:159], a[28:31], v[76:79], v[156:159]
    buffer_load_dwordx4 v136, s[8:11], s76 offen offset:2304 lds
    ds_read_b128 v[128:131], v148 offset:40960
    v_mfma_f32_16x16x32_bf16 v[160:163], v[76:79], a[32:35], v[160:163]
    s_waitcnt lgkmcnt(6)
    s_add_u32 m0, s51, 55040
    v_mfma_f32_16x16x32_bf16 v[164:167], a[24:27], v[80:83], v[164:167]
    ds_read_b128 v[132:135], v148 offset:45056
    v_mfma_f32_16x16x32_bf16 v[168:171], a[28:31], v[80:83], v[168:171]
    buffer_load_dwordx4 v137, s[8:11], s76 offen offset:2304 lds
    ds_read_b64_tr_b16 a[36:37], v142 offset:4096
    v_mfma_f32_16x16x32_bf16 v[172:175], v[80:83], a[32:35], v[172:175]
    s_waitcnt lgkmcnt(7)
    ds_read_b64_tr_b16 a[38:39], v142 offset:4608
    s_bfe_u32 s78, s49, 262156
    v_mfma_f32_16x16x32_bf16 v[176:179], a[24:27], v[84:87], v[176:179]
    s_sub_u32 s77, s78, 9
    ds_read_b64_tr_b16 a[40:41], v142 offset:12288
    s_min_u32 s78, s78, s77
    v_mfma_f32_16x16x32_bf16 v[180:183], a[28:31], v[84:87], v[180:183]
    s_lshl_b32 s77, s78, 7
    ds_read_b64_tr_b16 a[42:43], v142 offset:12800
    s_add_u32 m0, s51, 98304
    v_mfma_f32_16x16x32_bf16 v[184:187], v[84:87], a[32:35], v[184:187]
    s_waitcnt lgkmcnt(9)
    ds_read_b64_tr_b16 a[44:45], v142 offset:20480
    v_mfma_f32_16x16x32_bf16 v[188:191], a[24:27], v[88:91], v[188:191]
    ds_read_b64_tr_b16 a[46:47], v142 offset:20992
    v_mfma_f32_16x16x32_bf16 v[192:195], a[28:31], v[88:91], v[192:195]
    ds_read_b128 v[100:103], v146 offset:36864
    v_mfma_f32_16x16x32_bf16 v[196:199], v[88:91], a[32:35], v[196:199]
    s_waitcnt lgkmcnt(11)
    v_mfma_f32_16x16x32_bf16 v[200:203], a[24:27], v[92:95], v[200:203]
    ds_read_b128 v[104:107], v146 offset:38912
    v_mfma_f32_16x16x32_bf16 v[204:207], a[28:31], v[92:95], v[204:207]
    ds_read_b128 v[108:111], v146 offset:40960
    v_mfma_f32_16x16x32_bf16 v[208:211], v[92:95], a[32:35], v[208:211]
    s_waitcnt lgkmcnt(12)
    v_mfma_f32_16x16x32_bf16 v[212:215], a[24:27], v[96:99], v[212:215]
    s_nop 0
    ds_read_b128 v[112:115], v146 offset:43008
    v_mfma_f32_16x16x32_bf16 v[216:219], a[28:31], v[96:99], v[216:219]
    ds_read_b128 v[116:119], v146 offset:45056
    v_mfma_f32_16x16x32_bf16 v[220:223], v[96:99], a[32:35], v[220:223]
    s_waitcnt lgkmcnt(13)
    v_mfma_f32_16x16x32_bf16 v[224:227], v[124:127], v[124:127], v[224:227]
    ds_read_b128 v[120:123], v146 offset:47104
    v_mfma_f32_16x16x32_bf16 v[228:231], v[248:251], v[124:127], v[228:231]
    s_waitcnt lgkmcnt(13)
    v_mfma_f32_16x16x32_bf16 v[232:235], v[128:131], v[128:131], v[232:235]
    s_mov_b32 exec_lo, s83
    buffer_load_dwordx4 v138, s[4:7], s77 offen  lds
    s_mov_b32 exec_lo, -1
    v_mfma_f32_16x16x32_bf16 v[236:239], v[248:251], v[128:131], v[236:239]
    s_waitcnt lgkmcnt(12)
    s_add_u32 m0, s51, 102400
    v_mfma_f32_16x16x32_bf16 v[240:243], v[132:135], v[132:135], v[240:243]
    buffer_load_dwordx4 v139, s[4:7], s77 offen  lds
    s_add_u32 m0, s51, 106496
    v_mfma_f32_16x16x32_bf16 v[244:247], v[248:251], v[132:135], v[244:247]
    s_waitcnt lgkmcnt(5)
    buffer_load_dwordx4 v140, s[4:7], s77 offen  lds
    v_mfma_f32_16x16x32_bf16 v[152:155], a[36:39], v[100:103], v[152:155]
    s_bfe_u32 s78, s49, 262160
    s_sub_u32 s77, s78, 9
    s_min_u32 s78, s78, s77
    v_mfma_f32_16x16x32_bf16 v[156:159], a[40:43], v[100:103], v[156:159]
    s_lshl_b32 s77, s78, 7
    s_add_u32 m0, s51, 24576
    v_mfma_f32_16x16x32_bf16 v[160:163], v[100:103], a[44:47], v[160:163]
    s_waitcnt lgkmcnt(4)
    v_mfma_f32_16x16x32_bf16 v[164:167], a[36:39], v[104:107], v[164:167]
    s_mov_b32 exec_lo, s83
    buffer_load_dwordx4 v138, s[4:7], s77 offen  lds
    s_mov_b32 exec_lo, -1
    v_mfma_f32_16x16x32_bf16 v[168:171], a[40:43], v[104:107], v[168:171]
    v_mfma_f32_16x16x32_bf16 v[172:175], v[104:107], a[44:47], v[172:175]
    s_waitcnt vmcnt(11) lgkmcnt(0)
    s_barrier
    v_mfma_f32_16x16x32_bf16 v[176:179], a[36:39], v[108:111], v[176:179]
    v_mfma_f32_16x16x32_bf16 v[20:23], v[248:251], v[12:15], 0
    ds_read_b64_tr_b16 a[48:49], v141 offset:0
    ds_read_b64_tr_b16 a[50:51], v141 offset:512
    ds_read_b64_tr_b16 a[52:53], v141 offset:8192
    ds_read_b64_tr_b16 a[54:55], v141 offset:8704
    ds_read_b64_tr_b16 a[56:57], v141 offset:16384
    ds_read_b64_tr_b16 a[58:59], v141 offset:16896
    v_mfma_f32_16x16x32_bf16 v[180:183], a[40:43], v[108:111], v[180:183]
    v_mfma_f32_16x16x32_bf16 v[20:23], v[248:251], v[16:19], v[20:23]
    ds_read_b128 v[76:79], v143 offset:36864
    ds_read_b128 v[80:83], v143 offset:38912
    ds_read_b128 v[84:87], v143 offset:40960
    ds_read_b128 v[88:91], v143 offset:43008
    ds_read_b128 v[92:95], v143 offset:45056
    ds_read_b128 v[96:99], v143 offset:47104
    v_mfma_f32_16x16x32_bf16 v[184:187], v[108:111], a[44:47], v[184:187]
    s_bfe_u32 s78, s49, 262160
    s_sub_u32 s76, s78, 9
    s_min_u32 s78, s78, s76
    v_mfma_f32_16x16x32_bf16 v[188:191], a[36:39], v[112:115], v[188:191]
    s_mul_i32 s76, s78, 221184
    s_add_u32 m0, s51, 73728
    v_mfma_f32_16x16x32_bf16 v[192:195], a[40:43], v[112:115], v[192:195]
    buffer_load_dwordx4 v136, s[8:11], s76 offen offset:0 lds
    s_add_u32 m0, s51, 77824
    v_mfma_f32_16x16x32_bf16 v[196:199], v[112:115], a[44:47], v[196:199]
    buffer_load_dwordx4 v137, s[8:11], s76 offen offset:0 lds
    s_add_u32 m0, s51, 80768
    v_mfma_f32_16x16x32_bf16 v[200:203], a[36:39], v[116:119], v[200:203]
    v_cndmask_b32 v36, v36, v248, vcc
    v_cndmask_b32 v37, v37, v248, vcc
    v_mfma_f32_16x16x32_bf16 v[204:207], a[40:43], v[116:119], v[204:207]
    buffer_load_dwordx4 v136, s[8:11], s76 offen offset:1152 lds
    s_add_u32 m0, s51, 84864
    v_mfma_f32_16x16x32_bf16 v[208:211], v[116:119], a[44:47], v[208:211]
    v_cndmask_b32 v38, v38, v248, vcc
    v_cndmask_b32 v39, v39, v248, vcc
    v_mfma_f32_16x16x32_bf16 v[212:215], a[36:39], v[120:123], v[212:215]
    v_add_f32_dpp v20, v20, v20 row_ror:1 row_mask:0xf bank_mask:0xf
    v_mfma_f32_16x16x32_bf16 v[216:219], a[40:43], v[120:123], v[216:219]
    buffer_load_dwordx4 v137, s[8:11], s76 offen offset:1152 lds
    s_add_u32 m0, s51, 87808
    v_mfma_f32_16x16x32_bf16 v[220:223], v[120:123], a[44:47], v[220:223]
    s_waitcnt lgkmcnt(5)
    v_add_f32_dpp v20, v20, v20 row_ror:2 row_mask:0xf bank_mask:0xf
    v_mfma_f32_16x16x32_bf16 v[152:155], a[48:51], v[76:79], v[152:155]
    s_nop 0
    ds_read_b128 v[124:127], v147 offset:36864
    v_add_f32_dpp v20, v20, v20 row_ror:4 row_mask:0xf bank_mask:0xf
    v_mfma_f32_16x16x32_bf16 v[156:159], a[52:55], v[76:79], v[156:159]
    buffer_load_dwordx4 v136, s[8:11], s76 offen offset:2304 lds
    ds_read_b128 v[128:131], v147 offset:40960
    v_mfma_f32_16x16x32_bf16 v[160:163], v[76:79], a[56:59], v[160:163]
    s_waitcnt lgkmcnt(6)
    s_add_u32 m0, s51, 91904
    v_add_f32_dpp v20, v20, v20 row_ror:8 row_mask:0xf bank_mask:0xf
    v_mfma_f32_16x16x32_bf16 v[164:167], a[48:51], v[80:83], v[164:167]
    ds_read_b128 v[132:135], v147 offset:45056
    v_readfirstlane_b32 s50, v20
    v_mfma_f32_16x16x32_bf16 v[168:171], a[52:55], v[80:83], v[168:171]
    buffer_load_dwordx4 v137, s[8:11], s76 offen offset:2304 lds
    ds_read_b64_tr_b16 a[60:61], v141 offset:4096
    v_mfma_f32_16x16x32_bf16 v[172:175], v[80:83], a[56:59], v[172:175]
    s_waitcnt lgkmcnt(7)
    ds_read_b64_tr_b16 a[62:63], v141 offset:4608
    s_add_u32 m0, s51, 28672
    v_mfma_f32_16x16x32_bf16 v[176:179], a[48:51], v[84:87], v[176:179]
    ds_read_b64_tr_b16 a[64:65], v141 offset:12288
    v_mfma_f32_16x16x32_bf16 v[180:183], a[52:55], v[84:87], v[180:183]
    buffer_load_dwordx4 v139, s[4:7], s77 offen  lds
    ds_read_b64_tr_b16 a[66:67], v141 offset:12800
    v_mfma_f32_16x16x32_bf16 v[184:187], v[84:87], a[56:59], v[184:187]
    s_waitcnt lgkmcnt(9)
    ds_read_b64_tr_b16 a[68:69], v141 offset:20480
    s_add_u32 m0, s51, 32768
    v_mfma_f32_16x16x32_bf16 v[188:191], a[48:51], v[88:91], v[188:191]
    ds_read_b64_tr_b16 a[70:71], v141 offset:20992
    v_mfma_f32_16x16x32_bf16 v[192:195], a[52:55], v[88:91], v[192:195]
    buffer_load_dwordx4 v140, s[4:7], s77 offen  lds
    ds_read_b128 v[100:103], v144 offset:36864
    v_mfma_f32_16x16x32_bf16 v[196:199], v[88:91], a[56:59], v[196:199]
    s_waitcnt lgkmcnt(11)
    s_bfe_u32 s78, s49, 262164
    s_sub_u32 s77, s78, 9
    v_mfma_f32_16x16x32_bf16 v[200:203], a[48:51], v[92:95], v[200:203]
    s_min_u32 s78, s78, s77
    ds_read_b128 v[104:107], v144 offset:38912
    s_lshl_b32 s77, s78, 7
    v_mfma_f32_16x16x32_bf16 v[204:207], a[52:55], v[92:95], v[204:207]
    ds_read_b128 v[108:111], v144 offset:40960
    s_add_u32 m0, s51, 135168
    v_mfma_f32_16x16x32_bf16 v[208:211], v[92:95], a[56:59], v[208:211]
    s_waitcnt lgkmcnt(12)
    v_mfma_f32_16x16x32_bf16 v[212:215], a[48:51], v[96:99], v[212:215]
    ds_read_b128 v[112:115], v144 offset:43008
    v_mfma_f32_16x16x32_bf16 v[216:219], a[52:55], v[96:99], v[216:219]
    ds_read_b128 v[116:119], v144 offset:45056
    v_mfma_f32_16x16x32_bf16 v[220:223], v[96:99], a[56:59], v[220:223]
    s_waitcnt lgkmcnt(13)
    v_mfma_f32_16x16x32_bf16 v[224:227], v[124:127], v[124:127], v[224:227]
    ds_read_b128 v[120:123], v144 offset:47104
    v_mfma_f32_16x16x32_bf16 v[228:231], v[248:251], v[124:127], v[228:231]
    s_waitcnt lgkmcnt(13)
    v_mfma_f32_16x16x32_bf16 v[232:235], v[128:131], v[128:131], v[232:235]
    s_mov_b32 exec_lo, s83
    buffer_load_dwordx4 v138, s[4:7], s77 offen  lds
    s_mov_b32 exec_lo, -1
    v_mfma_f32_16x16x32_bf16 v[236:239], v[248:251], v[128:131], v[236:239]
    s_waitcnt lgkmcnt(12)
    s_add_u32 m0, s51, 139264
    v_mfma_f32_16x16x32_bf16 v[240:243], v[132:135], v[132:135], v[240:243]
    buffer_load_dwordx4 v139, s[4:7], s77 offen  lds
    v_mfma_f32_16x16x32_bf16 v[244:247], v[248:251], v[132:135], v[244:247]
    s_waitcnt lgkmcnt(5)
    v_mfma_f32_16x16x32_bf16 v[152:155], a[60:63], v[100:103], v[152:155]
    v_mfma_f32_16x16x32_bf16 v[156:159], a[64:67], v[100:103], v[156:159]
    v_mfma_f32_16x16x32_bf16 v[160:163], v[100:103], a[68:71], v[160:163]
    s_waitcnt lgkmcnt(4)
    v_mfma_f32_16x16x32_bf16 v[164:167], a[60:63], v[104:107], v[164:167]
    v_mfma_f32_16x16x32_bf16 v[168:171], a[64:67], v[104:107], v[168:171]
    v_mfma_f32_16x16x32_bf16 v[172:175], v[104:107], a[68:71], v[172:175]
    s_waitcnt vmcnt(11) lgkmcnt(0)
    s_barrier
    v_mfma_f32_16x16x32_bf16 v[176:179], a[60:63], v[108:111], v[176:179]
    s_bfe_u32 s78, s49, 262164
    ds_read_b64_tr_b16 a[72:73], v141 offset:36864
    s_sub_u32 s76, s78, 9
    v_mfma_f32_16x16x32_bf16 v[180:183], a[64:67], v[108:111], v[180:183]
    s_min_u32 s78, s78, s76
    ds_read_b64_tr_b16 a[74:75], v141 offset:37376
    s_mul_i32 s76, s78, 221184
    v_mfma_f32_16x16x32_bf16 v[184:187], v[108:111], a[68:71], v[184:187]
    ds_read_b64_tr_b16 a[76:77], v141 offset:45056
    s_add_u32 m0, s51, 0
    v_mfma_f32_16x16x32_bf16 v[188:191], a[60:63], v[112:115], v[188:191]
    buffer_load_dwordx4 v136, s[8:11], s76 offen offset:0 lds
    ds_read_b64_tr_b16 a[78:79], v141 offset:45568
    v_mfma_f32_16x16x32_bf16 v[192:195], a[64:67], v[112:115], v[192:195]
    s_nop 0
    ds_read_b64_tr_b16 a[80:81], v141 offset:53248
    s_add_u32 m0, s51, 4096
    v_mfma_f32_16x16x32_bf16 v[196:199], v[112:115], a[68:71], v[196:199]
    buffer_load_dwordx4 v137, s[8:11], s76 offen offset:0 lds
    ds_read_b64_tr_b16 a[82:83], v141 offset:53760
    v_mfma_f32_16x16x32_bf16 v[200:203], a[60:63], v[116:119], v[200:203]
    ds_read_b128 v[76:79], v145 offset:0
    s_add_u32 m0, s51, 7040
    v_mfma_f32_16x16x32_bf16 v[204:207], a[64:67], v[116:119], v[204:207]
    buffer_load_dwordx4 v136, s[8:11], s76 offen offset:1152 lds
    ds_read_b128 v[80:83], v145 offset:2048
    v_mfma_f32_16x16x32_bf16 v[208:211], v[116:119], a[68:71], v[208:211]
    ds_read_b128 v[84:87], v145 offset:4096
    s_add_u32 m0, s51, 11136
    v_mfma_f32_16x16x32_bf16 v[212:215], a[60:63], v[120:123], v[212:215]
    ds_read_b128 v[88:91], v145 offset:6144
    v_mfma_f32_16x16x32_bf16 v[216:219], a[64:67], v[120:123], v[216:219]
    buffer_load_dwordx4 v137, s[8:11], s76 offen offset:1152 lds
    ds_read_b128 v[92:95], v145 offset:8192
    v_mfma_f32_16x16x32_bf16 v[220:223], v[120:123], a[68:71], v[220:223]
    s_waitcnt lgkmcnt(4)
    ds_read_b128 v[96:99], v145 offset:10240
    s_add_u32 m0, s51, 14080
    v_mfma_f32_16x16x32_bf16 v[152:155], a[72:75], v[76:79], v[152:155]
    ds_read_b128 v[124:127], v148 offset:0
    v_mfma_f32_16x16x32_bf16 v[156:159], a[76:79], v[76:79], v[156:159]
    buffer_load_dwordx4 v136, s[8:11], s76 offen offset:2304 lds
    ds_read_b128 v[128:131], v148 offset:4096
    v_mfma_f32_16x16x32_bf16 v[160:163], v[76:79], a[80:83], v[160:163]
    s_waitcnt lgkmcnt(6)
    s_add_u32 m0, s51, 18176
    v_mfma_f32_16x16x32_bf16 v[164:167], a[72:75], v[80:83], v[164:167]
    ds_read_b128 v[132:135], v148 offset:8192
    v_mfma_f32_16x16x32_bf16 v[168:171], a[76:79], v[80:83], v[168:171]
    buffer_load_dwordx4 v137, s[8:11], s76 offen offset:2304 lds
    ds_read_b64_tr_b16 a[84:85], v141 offset:40960
    v_mfma_f32_16x16x32_bf16 v[172:175], v[80:83], a[80:83], v[172:175]
    s_waitcnt lgkmcnt(7)
    ds_read_b64_tr_b16 a[86:87], v141 offset:41472
    s_add_u32 m0, s51, 143360
    v_mfma_f32_16x16x32_bf16 v[176:179], a[72:75], v[84:87], v[176:179]
    ds_read_b64_tr_b16 a[88:89], v141 offset:49152
    v_mfma_f32_16x16x32_bf16 v[180:183], a[76:79], v[84:87], v[180:183]
    buffer_load_dwordx4 v140, s[4:7], s77 offen  lds
    ds_read_b64_tr_b16 a[90:91], v141 offset:49664
    v_mfma_f32_16x16x32_bf16 v[184:187], v[84:87], a[80:83], v[184:187]
    s_waitcnt lgkmcnt(9)
    ds_read_b64_tr_b16 a[92:93], v141 offset:57344
    s_bfe_u32 s78, s49, 262168
    v_mfma_f32_16x16x32_bf16 v[188:191], a[72:75], v[88:91], v[188:191]
    s_sub_u32 s77, s78, 9
    ds_read_b64_tr_b16 a[94:95], v141 offset:57856
    s_min_u32 s78, s78, s77
    v_mfma_f32_16x16x32_bf16 v[192:195], a[76:79], v[88:91], v[192:195]
    s_lshl_b32 s77, s78, 7
    ds_read_b128 v[100:103], v146 offset:0
    s_add_u32 m0, s51, 61440
    v_mfma_f32_16x16x32_bf16 v[196:199], v[88:91], a[80:83], v[196:199]
    s_waitcnt lgkmcnt(11)
    v_mfma_f32_16x16x32_bf16 v[200:203], a[72:75], v[92:95], v[200:203]
    ds_read_b128 v[104:107], v146 offset:2048
    v_mfma_f32_16x16x32_bf16 v[204:207], a[76:79], v[92:95], v[204:207]
    ds_read_b128 v[108:111], v146 offset:4096
    v_mfma_f32_16x16x32_bf16 v[208:211], v[92:95], a[80:83], v[208:211]
    s_waitcnt lgkmcnt(12)
    v_mfma_f32_16x16x32_bf16 v[212:215], a[72:75], v[96:99], v[212:215]
    ds_read_b128 v[112:115], v146 offset:6144
    v_mfma_f32_16x16x32_bf16 v[216:219], a[76:79], v[96:99], v[216:219]
    ds_read_b128 v[116:119], v146 offset:8192
    v_mfma_f32_16x16x32_bf16 v[220:223], v[96:99], a[80:83], v[220:223]
    s_waitcnt lgkmcnt(13)
    v_mfma_f32_16x16x32_bf16 v[224:227], v[124:127], v[124:127], v[224:227]
    ds_read_b128 v[120:123], v146 offset:10240
    v_mfma_f32_16x16x32_bf16 v[228:231], v[248:251], v[124:127], v[228:231]
    s_waitcnt lgkmcnt(13)
    v_mfma_f32_16x16x32_bf16 v[232:235], v[128:131], v[128:131], v[232:235]
    s_mov_b32 exec_lo, s83
    buffer_load_dwordx4 v138, s[4:7], s77 offen  lds
    s_mov_b32 exec_lo, -1
    v_mfma_f32_16x16x32_bf16 v[236:239], v[248:251], v[128:131], v[236:239]
    s_waitcnt lgkmcnt(12)
    s_add_u32 m0, s51, 65536
    v_mfma_f32_16x16x32_bf16 v[240:243], v[132:135], v[132:135], v[240:243]
    buffer_load_dwordx4 v139, s[4:7], s77 offen  lds
    s_add_u32 m0, s51, 69632
    v_mfma_f32_16x16x32_bf16 v[244:247], v[248:251], v[132:135], v[244:247]
    s_waitcnt lgkmcnt(5)
    buffer_load_dwordx4 v140, s[4:7], s77 offen  lds
    v_mfma_f32_16x16x32_bf16 v[152:155], a[84:87], v[100:103], v[152:155]
    s_add_u32 m0, s51, 110592
    v_mfma_f32_16x16x32_bf16 v[156:159], a[88:91], v[100:103], v[156:159]
    buffer_load_dwordx4 v138, s[4:7], s79 offen  lds
    v_mfma_f32_16x16x32_bf16 v[160:163], v[100:103], a[92:95], v[160:163]
    s_waitcnt lgkmcnt(4)
    v_mfma_f32_16x16x32_bf16 v[164:167], a[84:87], v[104:107], v[164:167]
    v_mfma_f32_16x16x32_bf16 v[168:171], a[88:91], v[104:107], v[168:171]
    v_mfma_f32_16x16x32_bf16 v[172:175], v[104:107], a[92:95], v[172:175]
    s_waitcnt vmcnt(13) lgkmcnt(0)
    s_barrier
    v_mfma_f32_16x16x32_bf16 v[176:179], a[84:87], v[108:111], v[176:179]
    s_bfe_u32 s78, s49, 262168
    ds_read_b64_tr_b16 a[96:97], v142 offset:0
    s_sub_u32 s76, s78, 9
    v_mfma_f32_16x16x32_bf16 v[180:183], a[88:91], v[108:111], v[180:183]
    s_min_u32 s78, s78, s76
    ds_read_b64_tr_b16 a[98:99], v142 offset:512
    s_mul_i32 s76, s78, 221184
    v_mfma_f32_16x16x32_bf16 v[184:187], v[108:111], a[92:95], v[184:187]
    ds_read_b64_tr_b16 a[100:101], v142 offset:8192
    s_add_u32 m0, s51, 36864
    v_mfma_f32_16x16x32_bf16 v[188:191], a[84:87], v[112:115], v[188:191]
    buffer_load_dwordx4 v136, s[8:11], s76 offen offset:0 lds
    ds_read_b64_tr_b16 a[102:103], v142 offset:8704
    v_mfma_f32_16x16x32_bf16 v[192:195], a[88:91], v[112:115], v[192:195]
    ds_read_b64_tr_b16 a[104:105], v142 offset:16384
    s_add_u32 m0, s51, 40960
    v_mfma_f32_16x16x32_bf16 v[196:199], v[112:115], a[92:95], v[196:199]
    buffer_load_dwordx4 v137, s[8:11], s76 offen offset:0 lds
    ds_read_b64_tr_b16 a[106:107], v142 offset:16896
    v_mfma_f32_16x16x32_bf16 v[200:203], a[84:87], v[116:119], v[200:203]
    ds_read_b128 v[76:79], v143 offset:0
    s_add_u32 m0, s51, 43904
    v_mfma_f32_16x16x32_bf16 v[204:207], a[88:91], v[116:119], v[204:207]
    buffer_load_dwordx4 v136, s[8:11], s76 offen offset:1152 lds
    ds_read_b128 v[80:83], v143 offset:2048
    v_mfma_f32_16x16x32_bf16 v[208:211], v[116:119], a[92:95], v[208:211]
    ds_read_b128 v[84:87], v143 offset:4096
    s_add_u32 m0, s51, 48000
    v_mfma_f32_16x16x32_bf16 v[212:215], a[84:87], v[120:123], v[212:215]
    ds_read_b128 v[88:91], v143 offset:6144
    v_mfma_f32_16x16x32_bf16 v[216:219], a[88:91], v[120:123], v[216:219]
    buffer_load_dwordx4 v137, s[8:11], s76 offen offset:1152 lds
    ds_read_b128 v[92:95], v143 offset:8192
    v_mfma_f32_16x16x32_bf16 v[220:223], v[120:123], a[92:95], v[220:223]
    s_waitcnt lgkmcnt(4)
    ds_read_b128 v[96:99], v143 offset:10240
    s_add_u32 m0, s51, 50944
    v_mfma_f32_16x16x32_bf16 v[152:155], a[96:99], v[76:79], v[152:155]
    ds_read_b128 v[124:127], v147 offset:0
    v_mfma_f32_16x16x32_bf16 v[156:159], a[100:103], v[76:79], v[156:159]
    buffer_load_dwordx4 v136, s[8:11], s76 offen offset:2304 lds
    ds_read_b128 v[128:131], v147 offset:4096
    v_mfma_f32_16x16x32_bf16 v[160:163], v[76:79], a[104:107], v[160:163]
    s_waitcnt lgkmcnt(6)
    s_add_u32 m0, s51, 55040
    v_mfma_f32_16x16x32_bf16 v[164:167], a[96:99], v[80:83], v[164:167]
    ds_read_b128 v[132:135], v147 offset:8192
    v_mfma_f32_16x16x32_bf16 v[168:171], a[100:103], v[80:83], v[168:171]
    buffer_load_dwordx4 v137, s[8:11], s76 offen offset:2304 lds
    ds_read_b64_tr_b16 a[108:109], v142 offset:4096
    v_mfma_f32_16x16x32_bf16 v[172:175], v[80:83], a[104:107], v[172:175]
    s_waitcnt lgkmcnt(7)
    ds_read_b64_tr_b16 a[110:111], v142 offset:4608
    s_add_u32 m0, s51, 114688
    v_mfma_f32_16x16x32_bf16 v[176:179], a[96:99], v[84:87], v[176:179]
    ds_read_b64_tr_b16 a[112:113], v142 offset:12288
    v_mfma_f32_16x16x32_bf16 v[180:183], a[100:103], v[84:87], v[180:183]
    buffer_load_dwordx4 v139, s[4:7], s79 offen  lds
    ds_read_b64_tr_b16 a[114:115], v142 offset:12800
    v_mfma_f32_16x16x32_bf16 v[184:187], v[84:87], a[104:107], v[184:187]
    s_waitcnt lgkmcnt(9)
    ds_read_b64_tr_b16 a[116:117], v142 offset:20480
    s_add_u32 m0, s51, 118784
    v_mfma_f32_16x16x32_bf16 v[188:191], a[96:99], v[88:91], v[188:191]
    ds_read_b64_tr_b16 a[118:119], v142 offset:20992
    v_mfma_f32_16x16x32_bf16 v[192:195], a[100:103], v[88:91], v[192:195]
    buffer_load_dwordx4 v140, s[4:7], s79 offen  lds
    ds_read_b128 v[100:103], v144 offset:0
    v_mfma_f32_16x16x32_bf16 v[196:199], v[88:91], a[104:107], v[196:199]
    s_waitcnt lgkmcnt(11)
    s_bfe_u32 s78, s49, 262172
    s_sub_u32 s77, s78, 9
    v_mfma_f32_16x16x32_bf16 v[200:203], a[96:99], v[92:95], v[200:203]
    s_min_u32 s78, s78, s77
    ds_read_b128 v[104:107], v144 offset:2048
    s_lshl_b32 s77, s78, 7
    v_mfma_f32_16x16x32_bf16 v[204:207], a[100:103], v[92:95], v[204:207]
    ds_read_b128 v[108:111], v144 offset:4096
    s_add_u32 m0, s51, 98304
    v_mfma_f32_16x16x32_bf16 v[208:211], v[92:95], a[104:107], v[208:211]
    s_waitcnt lgkmcnt(12)
    v_mfma_f32_16x16x32_bf16 v[212:215], a[96:99], v[96:99], v[212:215]
    ds_read_b128 v[112:115], v144 offset:6144
    v_mfma_f32_16x16x32_bf16 v[216:219], a[100:103], v[96:99], v[216:219]
    ds_read_b128 v[116:119], v144 offset:8192
    v_mfma_f32_16x16x32_bf16 v[220:223], v[96:99], a[104:107], v[220:223]
    s_waitcnt lgkmcnt(13)
    v_mfma_f32_16x16x32_bf16 v[224:227], v[124:127], v[124:127], v[224:227]
    ds_read_b128 v[120:123], v144 offset:10240
    v_mfma_f32_16x16x32_bf16 v[228:231], v[248:251], v[124:127], v[228:231]
    s_waitcnt lgkmcnt(13)
    v_mfma_f32_16x16x32_bf16 v[232:235], v[128:131], v[128:131], v[232:235]
    s_mov_b32 exec_lo, s83
    buffer_load_dwordx4 v138, s[4:7], s77 offen  lds
    s_mov_b32 exec_lo, -1
    v_mfma_f32_16x16x32_bf16 v[236:239], v[248:251], v[128:131], v[236:239]
    s_waitcnt lgkmcnt(12)
    Lw1: s_cbranch_execz Lw5
    s_add_u32 m0, s51, 102400
    v_mfma_f32_16x16x32_bf16 v[240:243], v[132:135], v[132:135], v[240:243]
    buffer_load_dwordx4 v139, s[4:7], s77 offen  lds
    s_add_u32 m0, s51, 106496
    v_mfma_f32_16x16x32_bf16 v[244:247], v[248:251], v[132:135], v[244:247]
    s_waitcnt lgkmcnt(5)
    buffer_load_dwordx4 v140, s[4:7], s77 offen  lds
    v_mfma_f32_16x16x32_bf16 v[152:155], a[108:111], v[100:103], v[152:155]
    v_mfma_f32_16x16x32_bf16 v[156:159], a[112:115], v[100:103], v[156:159]
    v_mfma_f32_16x16x32_bf16 v[160:163], v[100:103], a[116:119], v[160:163]
    s_waitcnt lgkmcnt(4)
    v_mfma_f32_16x16x32_bf16 v[164:167], a[108:111], v[104:107], v[164:167]
    v_mfma_f32_16x16x32_bf16 v[168:171], a[112:115], v[104:107], v[168:171]
    v_mfma_f32_16x16x32_bf16 v[172:175], v[104:107], a[116:119], v[172:175]
    s_waitcnt vmcnt(12) lgkmcnt(0)
    s_barrier
    v_mfma_f32_16x16x32_bf16 v[176:179], a[108:111], v[108:111], v[176:179]
    s_bfe_u32 s78, s49, 262172
    ds_read_b64_tr_b16 a[120:121], v141 offset:0
    s_sub_u32 s76, s78, 9
    v_mfma_f32_16x16x32_bf16 v[180:183], a[112:115], v[108:111], v[180:183]
    s_min_u32 s78, s78, s76
    ds_read_b64_tr_b16 a[122:123], v141 offset:512
    s_mul_i32 s76, s78, 221184
    v_mfma_f32_16x16x32_bf16 v[184:187], v[108:111], a[116:119], v[184:187]
    s_add_u32 m0, s51, 73728
    ds_read_b64_tr_b16 a[124:125], v141 offset:8192
    s_lshl2_add_u32 s94, s41, s40
    v_mfma_f32_16x16x32_bf16 v[188:191], a[108:111], v[112:115], v[188:191]
    buffer_load_dwordx4 v136, s[8:11], s76 offen offset:0 lds
    ds_read_b64_tr_b16 a[126:127], v141 offset:8704
    v_mfma_f32_16x16x32_bf16 v[192:195], a[112:115], v[112:115], v[192:195]
    s_add_u32 m0, s51, 77824
    ds_read_b64_tr_b16 a[128:129], v141 offset:16384
    s_mul_i32 s94, s94, 1536
    v_mfma_f32_16x16x32_bf16 v[196:199], v[112:115], a[116:119], v[196:199]
    s_add_u32 s94, s94, s47
    ds_read_b64_tr_b16 a[130:131], v141 offset:16896
    s_add_u32 s94, s94, 0
    v_mfma_f32_16x16x32_bf16 v[200:203], a[108:111], v[116:119], v[200:203]
    buffer_load_dwordx4 v137, s[8:11], s76 offen offset:0 lds
    ds_read_b128 v[76:79], v145 offset:36864
    v_mfma_f32_16x16x32_bf16 v[204:207], a[112:115], v[116:119], v[204:207]
    s_add_u32 m0, s51, 80768
    ds_read_b128 v[80:83], v145 offset:38912
    v_lshlrev_b32_e64 v74, 3, v46
    v_mfma_f32_16x16x32_bf16 v[208:211], v[116:119], a[116:119], v[208:211]
    ds_read_b128 v[84:87], v145 offset:40960
    v_min_u32 v74, 1408, v74
    v_mfma_f32_16x16x32_bf16 v[212:215], a[108:111], v[120:123], v[212:215]
    s_lshl1_add_u32 s81, s41, s53
    ds_read_b128 v[88:91], v145 offset:43008
    s_sub_u32 s95, s47, s94
    v_mfma_f32_16x16x32_bf16 v[216:219], a[112:115], v[120:123], v[216:219]
    s_add_u32 s82, s95, 217088
    ds_read_b128 v[92:95], v145 offset:45056
    v_writelane_b32 v74, s82, 61
    v_mfma_f32_16x16x32_bf16 v[220:223], v[120:123], a[116:119], v[220:223]
    s_waitcnt lgkmcnt(4)
    ds_read_b128 v[96:99], v145 offset:47104
    s_mul_i32 s82, s81, 43
    v_mfma_f32_16x16x32_bf16 v[152:155], a[120:123], v[76:79], v[152:155]
    buffer_load_dwordx4 v136, s[8:11], s76 offen offset:1152 lds
    ds_read_b128 v[124:127], v148 offset:36864
    v_mfma_f32_16x16x32_bf16 v[156:159], a[124:127], v[76:79], v[156:159]
    s_add_u32 m0, s51, 84864
    ds_read_b128 v[128:131], v148 offset:40960
    s_lshr_b32 s82, s82, 8
    v_mfma_f32_16x16x32_bf16 v[160:163], v[76:79], a[128:131], v[160:163]
    s_waitcnt lgkmcnt(6)
    s_mul_i32 s82, s82, 6
    s_add_u32 s81, s81, s82
    v_mfma_f32_16x16x32_bf16 v[164:167], a[120:123], v[80:83], v[164:167]
    s_lshl1_add_u32 s81, s81, s52
    ds_read_b128 v[132:135], v148 offset:45056
    s_lshl_b32 s81, s81, 9
    v_mfma_f32_16x16x32_bf16 v[168:171], a[124:127], v[80:83], v[168:171]
    buffer_load_dwordx4 v137, s[8:11], s76 offen offset:1152 lds
    ds_read_b64_tr_b16 a[132:133], v141 offset:4096
    v_mfma_f32_16x16x32_bf16 v[172:175], v[80:83], a[128:131], v[172:175]
    s_waitcnt lgkmcnt(7)
    ds_read_b64_tr_b16 a[134:135], v141 offset:4608
    s_add_u32 m0, s51, 87808
    v_mfma_f32_16x16x32_bf16 v[176:179], a[120:123], v[84:87], v[176:179]
    s_add_u32 s81, s81, s95
    ds_read_b64_tr_b16 a[136:137], v141 offset:12288
    s_add_u32 s81, s81, 180224
    v_mfma_f32_16x16x32_bf16 v[180:183], a[124:127], v[84:87], v[180:183]
    ds_read_b64_tr_b16 a[138:139], v141 offset:12800
    v_writelane_b32 v74, s81, 62
    v_mfma_f32_16x16x32_bf16 v[184:187], v[84:87], a[128:131], v[184:187]
    s_waitcnt lgkmcnt(6)
    ds_read_b64_tr_b16 a[140:141], v141 offset:20480
    s_add_u32 s81, s81, 256
    v_mfma_f32_16x16x32_bf16 v[224:227], v[124:127], v[124:127], v[224:227]
    buffer_load_dwordx4 v136, s[8:11], s76 offen offset:2304 lds
    ds_read_b64_tr_b16 a[142:143], v141 offset:20992
    v_mfma_f32_16x16x32_bf16 v[228:231], v[248:251], v[124:127], v[228:231]
    s_waitcnt lgkmcnt(7)
    ds_read_b128 v[100:103], v146 offset:36864
    s_add_u32 m0, s51, 91904
    v_mfma_f32_16x16x32_bf16 v[232:235], v[128:131], v[128:131], v[232:235]
    v_writelane_b32 v74, s81, 63
    v_mfma_f32_16x16x32_bf16 v[236:239], v[248:251], v[128:131], v[236:239]
    s_waitcnt lgkmcnt(7)
    ds_read_b128 v[104:107], v146 offset:38912
    v_mfma_f32_16x16x32_bf16 v[240:243], v[132:135], v[132:135], v[240:243]
    v_mfma_f32_16x16x32_bf16 v[244:247], v[248:251], v[132:135], v[244:247]
    buffer_load_dwordx4 v137, s[8:11], s76 offen offset:2304 lds
    v_mfma_f32_16x16x32_bf16 v[188:191], a[120:123], v[88:91], v[188:191]
    s_bitcmp0_b32 s44, 0
    s_addc_u32 s78, s45, 7
    ds_read_b128 v[124:127], v147 offset:36864
    v_mfma_f32_16x16x32_bf16 v[192:195], a[124:127], v[88:91], v[192:195]
    s_sub_u32 s77, s78, 9
    ds_read_b128 v[128:131], v147 offset:40960
    s_min_u32 s78, s78, s77
    v_mfma_f32_16x16x32_bf16 v[196:199], v[88:91], a[128:131], v[196:199]
    s_lshl_b32 s77, s78, 7
    s_add_u32 m0, s51, 24576
    v_mfma_f32_16x16x32_bf16 v[200:203], a[120:123], v[92:95], v[200:203]
    ds_read_b128 v[132:135], v147 offset:45056
    v_mfma_f32_16x16x32_bf16 v[204:207], a[124:127], v[92:95], v[204:207]
    ds_read_b128 v[108:111], v146 offset:40960
    v_mfma_f32_16x16x32_bf16 v[208:211], v[92:95], a[128:131], v[208:211]
    s_mov_b32 exec_lo, s83
    buffer_load_dwordx4 v138, s[4:7], s77 offen  lds
    s_mov_b32 exec_lo, -1
    v_mfma_f32_16x16x32_bf16 v[212:215], a[120:123], v[96:99], v[212:215]
    ds_read_b128 v[112:115], v146 offset:43008
    s_add_u32 m0, s51, 28672
    v_mfma_f32_16x16x32_bf16 v[216:219], a[124:127], v[96:99], v[216:219]
    ds_read_b128 v[116:119], v146 offset:45056
    v_mfma_f32_16x16x32_bf16 v[220:223], v[96:99], a[128:131], v[220:223]
    s_waitcnt lgkmcnt(7)
    v_mfma_f32_16x16x32_bf16 v[152:155], a[132:135], v[100:103], v[152:155]
    buffer_load_dwordx4 v139, s[4:7], s77 offen  lds
    ds_read_b128 v[120:123], v146 offset:47104
    v_mfma_f32_16x16x32_bf16 v[156:159], a[136:139], v[100:103], v[156:159]
    s_add_u32 m0, s51, 32768
    v_mfma_f32_16x16x32_bf16 v[160:163], v[100:103], a[140:143], v[160:163]
    s_waitcnt lgkmcnt(7)
    buffer_load_dword v71, v74, s[16:19], s94 offen nt
    v_mfma_f32_16x16x32_bf16 v[164:167], a[132:135], v[104:107], v[164:167]
    v_mfma_f32_16x16x32_bf16 v[168:171], a[136:139], v[104:107], v[168:171]
    buffer_load_dword v71, v74, s[16:19], s94 offen sc1
    buffer_load_dword v75, v151, s[16:19], s55 offen sc1
    v_mfma_f32_16x16x32_bf16 v[172:175], v[104:107], a[140:143], v[172:175]
    s_waitcnt lgkmcnt(6)
    buffer_load_dwordx4 v140, s[4:7], s77 offen  lds
    v_mfma_f32_16x16x32_bf16 v[224:227], v[124:127], v[124:127], v[224:227]
    v_mfma_f32_16x16x32_bf16 v[228:231], v[248:251], v[124:127], v[228:231]
    s_waitcnt lgkmcnt(5)
    v_mfma_f32_16x16x32_bf16 v[232:235], v[128:131], v[128:131], v[232:235]
    v_mfma_f32_16x16x32_bf16 v[236:239], v[248:251], v[128:131], v[236:239]
    s_waitcnt lgkmcnt(4)
    v_mfma_f32_16x16x32_bf16 v[240:243], v[132:135], v[132:135], v[240:243]
    v_mfma_f32_16x16x32_bf16 v[244:247], v[248:251], v[132:135], v[244:247]
    s_waitcnt vmcnt(12) lgkmcnt(0)
    s_barrier
    v_mfma_f32_16x16x32_bf16 v[176:179], a[132:135], v[108:111], v[176:179]
    s_bitcmp0_b32 s44, 0
    s_addc_u32 s78, s45, 7
    ds_read_b64_tr_b16 a[144:145], v141 offset:36864
    v_mfma_f32_16x16x32_bf16 v[180:183], a[136:139], v[108:111], v[180:183]
    s_sub_u32 s76, s78, 9
    ds_read_b64_tr_b16 a[146:147], v141 offset:37376
    s_min_u32 s78, s78, s76
    v_mfma_f32_16x16x32_bf16 v[184:187], v[108:111], a[140:143], v[184:187]
    s_mul_i32 s76, s78, 221184
    ds_read_b64_tr_b16 a[148:149], v141 offset:45056
    s_add_u32 m0, s51, 0
    v_mfma_f32_16x16x32_bf16 v[188:191], a[132:135], v[112:115], v[188:191]
    buffer_load_dwordx4 v136, s[8:11], s76 offen offset:0 lds
    ds_read_b64_tr_b16 a[150:151], v141 offset:45568
    v_mfma_f32_16x16x32_bf16 v[192:195], a[136:139], v[112:115], v[192:195]
    ds_read_b64_tr_b16 a[152:153], v141 offset:53248
    s_add_u32 m0, s51, 4096
    v_mfma_f32_16x16x32_bf16 v[196:199], v[112:115], a[140:143], v[196:199]
    ds_read_b64_tr_b16 a[154:155], v141 offset:53760
    v_mfma_f32_16x16x32_bf16 v[200:203], a[132:135], v[116:119], v[200:203]
    buffer_load_dwordx4 v137, s[8:11], s76 offen offset:0 lds
    ds_read_b128 v[76:79], v143 offset:36864
    v_mfma_f32_16x16x32_bf16 v[204:207], a[136:139], v[116:119], v[204:207]
    ds_read_b128 v[80:83], v143 offset:38912
    s_add_u32 m0, s51, 7040
    v_mfma_f32_16x16x32_bf16 v[208:211], v[116:119], a[140:143], v[208:211]
    ds_read_b128 v[84:87], v143 offset:40960
    v_mfma_f32_16x16x32_bf16 v[212:215], a[132:135], v[120:123], v[212:215]
    ds_read_b128 v[88:91], v143 offset:43008
    v_mfma_f32_16x16x32_bf16 v[216:219], a[136:139], v[120:123], v[216:219]
    ds_read_b128 v[92:95], v143 offset:45056
    v_mfma_f32_16x16x32_bf16 v[220:223], v[120:123], a[140:143], v[220:223]
    s_waitcnt lgkmcnt(4)
    ds_read_b128 v[96:99], v143 offset:47104
    v_mfma_f32_16x16x32_bf16 v[152:155], a[144:147], v[76:79], v[152:155]
    buffer_load_dwordx4 v136, s[8:11], s76 offen offset:1152 lds
    ds_read_b128 v[124:127], v148 offset:0
    v_mfma_f32_16x16x32_bf16 v[156:159], a[148:151], v[76:79], v[156:159]
    ds_read_b128 v[128:131], v148 offset:4096
    s_add_u32 m0, s51, 11136
    v_mfma_f32_16x16x32_bf16 v[160:163], v[76:79], a[152:155], v[160:163]
    s_waitcnt lgkmcnt(6)
    ds_read_b128 v[12:15], v148 offset:20480
    v_mfma_f32_16x16x32_bf16 v[164:167], a[144:147], v[80:83], v[164:167]
    ds_read_b128 v[132:135], v148 offset:8192
    v_mfma_f32_16x16x32_bf16 v[168:171], a[148:151], v[80:83], v[168:171]
    buffer_load_dwordx4 v137, s[8:11], s76 offen offset:1152 lds
    ds_read_b64_tr_b16 a[156:157], v141 offset:40960
    v_mfma_f32_16x16x32_bf16 v[172:175], v[80:83], a[152:155], v[172:175]
    s_waitcnt lgkmcnt(8)
    ds_read_b64_tr_b16 a[158:159], v141 offset:41472
    s_add_u32 m0, s51, 14080
    v_mfma_f32_16x16x32_bf16 v[176:179], a[144:147], v[84:87], v[176:179]
    ds_read_b64_tr_b16 a[160:161], v141 offset:49152
    v_mfma_f32_16x16x32_bf16 v[180:183], a[148:151], v[84:87], v[180:183]
    ds_read_b64_tr_b16 a[162:163], v141 offset:49664
    v_mfma_f32_16x16x32_bf16 v[184:187], v[84:87], a[152:155], v[184:187]
    s_waitcnt lgkmcnt(10)
    ds_read_b64_tr_b16 a[164:165], v141 offset:57344
    v_mfma_f32_16x16x32_bf16 v[188:191], a[144:147], v[88:91], v[188:191]
    buffer_load_dwordx4 v136, s[8:11], s76 offen offset:2304 lds
    ds_read_b64_tr_b16 a[166:167], v141 offset:57856
    v_mfma_f32_16x16x32_bf16 v[192:195], a[148:151], v[88:91], v[192:195]
    ds_read_b128 v[100:103], v144 offset:36864
    s_add_u32 m0, s51, 18176
    v_mfma_f32_16x16x32_bf16 v[196:199], v[88:91], a[152:155], v[196:199]
    s_waitcnt lgkmcnt(12)
    ds_read_b128 v[16:19], v148 offset:16384
    v_mfma_f32_16x16x32_bf16 v[200:203], a[144:147], v[92:95], v[200:203]
    ds_read_b128 v[104:107], v144 offset:38912
    v_mfma_f32_16x16x32_bf16 v[204:207], a[148:151], v[92:95], v[204:207]
    ds_read_b128 v[108:111], v144 offset:40960
    v_mfma_f32_16x16x32_bf16 v[208:211], v[92:95], a[152:155], v[208:211]
    s_waitcnt lgkmcnt(14)
    buffer_load_dwordx4 v137, s[8:11], s76 offen offset:2304 lds
    v_mfma_f32_16x16x32_bf16 v[212:215], a[144:147], v[96:99], v[212:215]
    ds_read_b128 v[112:115], v144 offset:43008
    v_mfma_f32_16x16x32_bf16 v[216:219], a[148:151], v[96:99], v[216:219]
    ds_read_b128 v[116:119], v144 offset:45056
    v_mfma_f32_16x16x32_bf16 v[220:223], v[96:99], a[152:155], v[220:223]
    s_waitcnt lgkmcnt(13)
    ds_read_b128 v[20:23], v148 offset:12288
    v_lshlrev_b32 v0, 16, v12
    v_mfma_f32_16x16x32_bf16 v[224:227], v[124:127], v[124:127], v[224:227]
    ds_read_b128 v[120:123], v144 offset:47104
    v_and_b32 v1, 0xffff0000, v12
    v_mfma_f32_16x16x32_bf16 v[228:231], v[248:251], v[124:127], v[228:231]
    v_lshlrev_b32 v2, 16, v13
    v_and_b32 v3, 0xffff0000, v13
    v_mfma_f32_16x16x32_bf16 v[232:235], v[128:131], v[128:131], v[232:235]
    v_lshlrev_b32 v4, 16, v14
    v_and_b32 v5, 0xffff0000, v14
    v_mfma_f32_16x16x32_bf16 v[236:239], v[248:251], v[128:131], v[236:239]
    s_waitcnt lgkmcnt(14)
    v_lshlrev_b32 v6, 16, v15
    v_and_b32 v7, 0xffff0000, v15
    v_mfma_f32_16x16x32_bf16 v[240:243], v[132:135], v[132:135], v[240:243]
    s_waitcnt lgkmcnt(6)
    v_lshlrev_b32 v8, 16, v16
    v_and_b32 v9, 0xffff0000, v16
    v_mfma_f32_16x16x32_bf16 v[244:247], v[248:251], v[132:135], v[244:247]
    v_lshlrev_b32 v10, 16, v17
    v_and_b32 v11, 0xffff0000, v17
    v_mfma_f32_16x16x32_bf16 v[152:155], a[156:159], v[100:103], v[152:155]
    v_lshlrev_b32 v12, 16, v18
    v_and_b32 v13, 0xffff0000, v18
    v_mfma_f32_16x16x32_bf16 v[156:159], a[160:163], v[100:103], v[156:159]
    v_lshlrev_b32_e64 v14, 16, v19
    v_and_b32 v15, 0xffff0000, v19
    v_mfma_f32_16x16x32_bf16 v[160:163], v[100:103], a[164:167], v[160:163]
    s_waitcnt lgkmcnt(1)
    v_lshlrev_b32 v16, 16, v20
    v_and_b32 v17, 0xffff0000, v20
    v_mfma_f32_16x16x32_bf16 v[164:167], a[156:159], v[104:107], v[164:167]
    v_lshlrev_b32 v18, 16, v21
    v_and_b32 v19, 0xffff0000, v21
    v_mfma_f32_16x16x32_bf16 v[168:171], a[160:163], v[104:107], v[168:171]
    v_lshlrev_b32 v20, 16, v22
    v_and_b32 v21, 0xffff0000, v22
    v_mfma_f32_16x16x32_bf16 v[172:175], v[104:107], a[164:167], v[172:175]
    v_lshlrev_b32 v22, 16, v23
    v_and_b32 v23, 0xffff0000, v23
    s_waitcnt vmcnt(6) lgkmcnt(0)
    s_barrier
    v_mfma_f32_16x16x32_bf16 v[176:179], a[156:159], v[108:111], v[176:179]
    s_add_u32 m0, s51, 36864
    ds_read_b128 v[124:127], v147 offset:0
    s_mov_b32 s76, 0
    v_mfma_f32_16x16x32_bf16 v[180:183], a[160:163], v[108:111], v[180:183]
    buffer_load_dwordx4 v149, s[12:15], s76 offen lds
    ds_read_b128 v[128:131], v147 offset:4096
    v_mfma_f32_16x16x32_bf16 v[184:187], v[108:111], a[164:167], v[184:187]
    s_add_u32 m0, s51, 40960
    ds_read_b128 v[132:135], v147 offset:8192
    s_mov_b32 s76, 41472
    v_mfma_f32_16x16x32_bf16 v[188:191], a[156:159], v[112:115], v[188:191]
    ds_read_b64_tr_b16 a[168:169], v142 offset:0
    v_xor_b32 v73, s54, v75
    v_mfma_f32_16x16x32_bf16 v[192:195], a[160:163], v[112:115], v[192:195]
    ds_read_b64_tr_b16 a[170:171], v142 offset:512
    v_cmp_lt_u32 vcc, 15, v73
    v_mfma_f32_16x16x32_bf16 v[196:199], v[112:115], a[164:167], v[196:199]
    buffer_load_dwordx4 v149, s[12:15], s76 offen lds
    ds_read_b64_tr_b16 a[172:173], v142 offset:8192
    v_mfma_f32_16x16x32_bf16 v[200:203], a[156:159], v[116:119], v[200:203]
    s_add_u32 m0, s51, 45056
    ds_read_b64_tr_b16 a[174:175], v142 offset:8704
    s_mov_b32 s76, 82944
    v_mfma_f32_16x16x32_bf16 v[204:207], a[160:163], v[116:119], v[204:207]
    s_cmp_lg_u64 vcc, 0
    s_cbranch_scc1 Lre3
Lok1:
    ds_read_b64_tr_b16 a[176:177], v142 offset:16384
    v_mfma_f32_16x16x32_bf16 v[208:211], v[116:119], a[164:167], v[208:211]
    ds_read_b64_tr_b16 a[178:179], v142 offset:16896
    v_cmp_ne_u32_e64 vcc, 0, v73
    v_mfma_f32_16x16x32_bf16 v[212:215], a[156:159], v[120:123], v[212:215]
    buffer_load_dwordx4 v149, s[12:15], s76 offen lds
    ds_read_b128 v[76:79], v145 offset:0
    v_mfma_f32_16x16x32_bf16 v[216:219], a[160:163], v[120:123], v[216:219]
    s_add_u32 m0, s51, 49152
    ds_read_b128 v[80:83], v145 offset:2048
    s_mov_b32 s76, 124416
    v_mfma_f32_16x16x32_bf16 v[220:223], v[120:123], a[164:167], v[220:223]
    s_waitcnt lgkmcnt(10)
    ds_read_b128 v[84:87], v145 offset:4096
    v_mfma_f32_16x16x32_bf16 v[224:227], v[124:127], v[124:127], v[224:227]
    ds_read_b128 v[88:91], v145 offset:6144
    v_mfma_f32_16x16x32_bf16 v[228:231], v[248:251], v[124:127], v[228:231]
    s_waitcnt lgkmcnt(11)
    ds_read_b128 v[92:95], v145 offset:8192
    v_mfma_f32_16x16x32_bf16 v[232:235], v[128:131], v[128:131], v[232:235]
    v_cndmask_b32 v224, v224, v225, s[60:61]
    v_cndmask_b32 v226, v226, v227, s[60:61]
    v_mfma_f32_16x16x32_bf16 v[236:239], v[248:251], v[128:131], v[236:239]
    s_waitcnt lgkmcnt(11)
    ds_read_b128 v[96:99], v145 offset:10240
    v_cndmask_b32 v229, v224, v226, s[62:63]
    v_mfma_f32_16x16x32_bf16 v[240:243], v[132:135], v[132:135], v[240:243]
    ds_write_b64 v24, v[228:229] offset:0
    v_cndmask_b32 v232, v232, v233, s[60:61]
    v_mfma_f32_16x16x32_bf16 v[244:247], v[248:251], v[132:135], v[244:247]
    s_waitcnt lgkmcnt(6)
    v_cndmask_b32 v234, v234, v235, s[60:61]
    v_cndmask_b32 v237, v232, v234, s[62:63]
    v_mfma_f32_16x16x32_bf16 v[152:155], a[168:171], v[76:79], v[152:155]
    ds_write_b64 v24, v[236:237] offset:256
    v_cndmask_b32 v240, v240, v241, s[60:61]
    v_mfma_f32_16x16x32_bf16 v[156:159], a[172:175], v[76:79], v[156:159]
    v_cndmask_b32 v242, v242, v243, s[60:61]
    v_cndmask_b32 v245, v240, v242, s[62:63]
    v_mfma_f32_16x16x32_bf16 v[160:163], v[76:79], a[176:179], v[160:163]
    s_waitcnt lgkmcnt(6)
    ds_write_b64 v24, v[244:245] offset:512
    v_mfma_f32_16x16x32_bf16 v[164:167], a[168:171], v[80:83], v[164:167]
    buffer_load_dwordx4 v149, s[12:15], s76 offen lds
    ds_read_b64_tr_b16 a[180:181], v142 offset:4096
    v_mfma_f32_16x16x32_bf16 v[168:171], a[172:175], v[80:83], v[168:171]
    s_add_u32 m0, s51, 53248
    ds_read_b64_tr_b16 a[182:183], v142 offset:4608
    s_mov_b32 s76, 165888
    v_mfma_f32_16x16x32_bf16 v[172:175], v[80:83], a[176:179], v[172:175]
    s_waitcnt lgkmcnt(8)
    ds_read_b64_tr_b16 a[184:185], v142 offset:12288
    v_mfma_f32_16x16x32_bf16 v[176:179], a[168:171], v[84:87], v[176:179]
    s_waitcnt lgkmcnt(3)
    s_barrier
    ds_read2_b64 v[124:127], v25 offset1:96
    v_mfma_f32_16x16x32_bf16 v[180:183], a[172:175], v[84:87], v[180:183]
    buffer_load_dwordx4 v149, s[12:15], s76 offen lds
    ds_read_b64_tr_b16 a[186:187], v142 offset:12800
    v_mfma_f32_16x16x32_bf16 v[184:187], v[84:87], a[176:179], v[184:187]
    ds_read_b64_tr_b16 a[188:189], v142 offset:20480
    s_add_u32 m0, s51, 57344
    v_mfma_f32_16x16x32_bf16 v[188:191], a[168:171], v[88:91], v[188:191]
    ds_read_b64_tr_b16 a[190:191], v142 offset:20992
    s_mov_b32 s76, 207360
    v_mfma_f32_16x16x32_bf16 v[192:195], a[172:175], v[88:91], v[192:195]
    buffer_load_dwordx4 v149, s[12:15], s76 offen lds
    ds_read_b128 v[100:103], v146 offset:0
    v_mfma_f32_16x16x32_bf16 v[196:199], v[88:91], a[176:179], v[196:199]
    s_waitcnt lgkmcnt(4)
    v_add_f32 v124, v124, v126
    v_add_f32_e64 v125, v125, v127
    v_mfma_f32_16x16x32_bf16 v[200:203], a[168:171], v[92:95], v[200:203]
    s_add_u32 m0, s51, 61440
    v_mul_f32 v124, 0xbae38e39, v124
    v_mul_f32 v125, 0x3ae38e39, v125
    v_mfma_f32_16x16x32_bf16 v[204:207], a[172:175], v[92:95], v[204:207]
    s_mov_b32 s76, 248832
    v_fma_f32 v125, -v124, v124, v125
    v_max_f32_e64 v125, 0, v125
    v_mfma_f32_16x16x32_bf16 v[208:211], v[92:95], a[176:179], v[208:211]
    ds_read_b128 v[104:107], v146 offset:2048
    v_add_f32 v125, 0x3727c5ac, v125
    v_mfma_f32_16x16x32_bf16 v[212:215], a[168:171], v[96:99], v[212:215]
    v_rsq_f32_e64 v125, v125
    v_mfma_f32_16x16x32_bf16 v[216:219], a[172:175], v[96:99], v[216:219]
    ds_write2_b32 v26, v125, v124 offset1:96
    v_mfma_f32_16x16x32_bf16 v[220:223], v[96:99], a[176:179], v[220:223]
    s_waitcnt lgkmcnt(2)
    ds_read_b128 v[108:111], v146 offset:4096
    v_mfma_f32_16x16x32_bf16 v[152:155], a[180:183], v[100:103], v[152:155]
    buffer_load_dwordx4 v149, s[12:15], s76 offen lds
    ds_read_b128 v[112:115], v146 offset:6144
    v_mfma_f32_16x16x32_bf16 v[156:159], a[184:187], v[100:103], v[156:159]
    s_add_u32 m0, s51, 65536
    ds_read_b128 v[116:119], v146 offset:8192
    s_mov_b32 s76, 290304
    v_mfma_f32_16x16x32_bf16 v[160:163], v[100:103], a[188:191], v[160:163]
    s_waitcnt lgkmcnt(4)
    ds_read_b128 v[120:123], v146 offset:10240
    v_mfma_f32_16x16x32_bf16 v[164:167], a[180:183], v[104:107], v[164:167]
    buffer_load_dwordx4 v149, s[12:15], s76 offen lds
    s_add_u32 m0, s51, 69632
    v_mfma_f32_16x16x32_bf16 v[168:171], a[184:187], v[104:107], v[168:171]
    s_mov_b32 s76, 331776
    buffer_load_dwordx4 v149, s[12:15], s76 offen lds
    v_mfma_f32_16x16x32_bf16 v[172:175], v[104:107], a[188:191], v[172:175]
    s_cmp_lg_u64 vcc, 0
    s_waitcnt vmcnt(9) lgkmcnt(0)
    s_barrier
    s_cbranch_scc1 L_slow
    v_mfma_f32_16x16x32_bf16 v[176:179], a[180:183], v[108:111], v[176:179]
    s_add_u32 m0, s51, 73728
    ds_read_b64_tr_b16 a[192:193], v141 offset:0
    s_mov_b32 s76, 373248
    v_mfma_f32_16x16x32_bf16 v[180:183], a[184:187], v[108:111], v[180:183]
    s_lshl2_add_u32 s94, s41, s40
    ds_read_b64_tr_b16 a[194:195], v141 offset:512
    s_mul_i32 s94, s94, 3456
    v_mfma_f32_16x16x32_bf16 v[184:187], v[108:111], a[188:191], v[184:187]
    s_add_u32 s94, s94, s47
    ds_read_b64_tr_b16 a[196:197], v141 offset:8192
    s_add_u32 s94, s94, 54528
    v_mfma_f32_16x16x32_bf16 v[188:191], a[180:183], v[112:115], v[188:191]
    ds_read_b64_tr_b16 a[198:199], v141 offset:8704
    v_lshlrev_b32_e64 v32, 3, v46
    v_mfma_f32_16x16x32_bf16 v[192:195], a[184:187], v[112:115], v[192:195]
    buffer_load_dwordx4 v149, s[12:15], s76 offen lds
    ds_read_b64_tr_b16 a[200:201], v141 offset:16384
    v_mfma_f32_16x16x32_bf16 v[196:199], v[112:115], a[188:191], v[196:199]
    s_add_u32 m0, s51, 77824
    ds_read_b64_tr_b16 a[202:203], v141 offset:16896
    s_mov_b32 s76, 414720
    v_mfma_f32_16x16x32_bf16 v[200:203], a[180:183], v[116:119], v[200:203]
    ds_read_b128 v[76:79], v143 offset:0
    v_min_u32 v32, 3328, v32
    v_mfma_f32_16x16x32_bf16 v[204:207], a[184:187], v[116:119], v[204:207]
    ds_read_b128 v[80:83], v143 offset:6144
    v_mfma_f32_16x16x32_bf16 v[208:211], v[116:119], a[188:191], v[208:211]
    ds_read_b64_tr_b16 a[204:205], v141 offset:4096
    v_mfma_f32_16x16x32_bf16 v[212:215], a[180:183], v[120:123], v[212:215]
    buffer_load_dwordx4 v149, s[12:15], s76 offen lds
    ds_read_b64_tr_b16 a[206:207], v141 offset:4608
    v_mfma_f32_16x16x32_bf16 v[216:219], a[184:187], v[120:123], v[216:219]
    s_add_u32 m0, s51, 81920
    ds_read_b64_tr_b16 a[208:209], v141 offset:12288
    s_mov_b32 s76, 456192
    v_mfma_f32_16x16x32_bf16 v[220:223], v[120:123], a[188:191], v[220:223]
    s_waitcnt lgkmcnt(4)
    ds_read_b64_tr_b16 a[210:211], v141 offset:12800
    v_mfma_f32_16x16x32_bf16 v[152:155], a[192:195], v[76:79], v[152:155]
    ds_read_b64_tr_b16 a[212:213], v141 offset:20480
    v_mfma_f32_16x16x32_bf16 v[156:159], a[196:199], v[76:79], v[156:159]
    ds_read_b64_tr_b16 a[214:215], v141 offset:20992
    v_mfma_f32_16x16x32_bf16 v[160:163], v[76:79], a[200:203], v[160:163]
    s_waitcnt lgkmcnt(6)
    ds_read_b128 v[100:103], v144 offset:0
    v_mfma_f32_16x16x32_bf16 v[188:191], a[192:195], v[80:83], v[188:191]
    buffer_load_dwordx4 v149, s[12:15], s76 offen lds
    ds_read_b128 v[104:107], v144 offset:6144
    v_mfma_f32_16x16x32_bf16 v[192:195], a[196:199], v[80:83], v[192:195]
    s_add_u32 m0, s51, 86016
    ds_read_b128 v[84:87], v143 offset:8192
    s_mov_b32 s76, 497664
    v_mfma_f32_16x16x32_bf16 v[196:199], v[80:83], a[200:203], v[196:199]
    s_waitcnt lgkmcnt(2)
    ds_read_b128 v[108:111], v144 offset:8192
    v_mfma_f32_16x16x32_bf16 v[152:155], a[204:207], v[100:103], v[152:155]
    ds_read_b128 v[88:91], v143 offset:10240
    v_mfma_f32_16x16x32_bf16 v[156:159], a[208:211], v[100:103], v[156:159]
    buffer_load_dwordx4 v149, s[12:15], s76 offen lds
    ds_read_b128 v[112:115], v144 offset:10240
    v_mfma_f32_16x16x32_bf16 v[160:163], v[100:103], a[212:215], v[160:163]
    s_waitcnt lgkmcnt(4)
    ds_read2_b32 v[224:225], v49 offset0:48 offset1:144
    s_add_u32 m0, s51, 90112
    v_mfma_f32_16x16x32_bf16 v[188:191], a[204:207], v[104:107], v[188:191]
    s_mov_b32 s76, 539136
    ds_read_b128 v[226:229], v50 offset:192
    v_mov_b32_dpp v24, v152 row_newbcast:0 row_mask:0xf bank_mask:0xf
    v_mfma_f32_16x16x32_bf16 v[192:195], a[208:211], v[104:107], v[192:195]
    ds_read_b128 v[230:233], v50 offset:576
    v_mov_b32_dpp v25, v153 row_newbcast:0 row_mask:0xf bank_mask:0xf
    v_mfma_f32_16x16x32_bf16 v[196:199], v[104:107], a[212:215], v[196:199]
    s_waitcnt lgkmcnt(6)
    ds_read_b128 v[92:95], v143 offset:4096
    v_mov_b32_dpp v26, v154 row_newbcast:0 row_mask:0xf bank_mask:0xf
    v_mfma_f32_16x16x32_bf16 v[200:203], a[192:195], v[84:87], v[200:203]
    buffer_load_dwordx4 v149, s[12:15], s76 offen lds
    ds_read_b128 v[116:119], v144 offset:4096
    v_mfma_f32_16x16x32_bf16 v[204:207], a[196:199], v[84:87], v[204:207]
    s_add_u32 m0, s51, 94208
    ds_read_b128 v[96:99], v143 offset:2048
    s_mov_b32 s76, 580608
    v_mfma_f32_16x16x32_bf16 v[208:211], v[84:87], a[200:203], v[208:211]
    s_waitcnt lgkmcnt(8)
    ds_read_b128 v[120:123], v144 offset:2048
    v_mov_b32_dpp v27, v155 row_newbcast:0 row_mask:0xf bank_mask:0xf
    v_mfma_f32_16x16x32_bf16 v[200:203], a[204:207], v[108:111], v[200:203]
    buffer_load_dword v71, v32, s[16:19], s94 offen nt
    ds_read2_b32 v[234:235], v49 offset0:64 offset1:160
    v_mfma_f32_16x16x32_bf16 v[204:207], a[208:211], v[108:111], v[204:207]
    buffer_load_dword v71, v32, s[16:19], s94 offen sc1
    ds_read_b128 v[236:239], v50 offset:256
    v_mfma_f32_16x16x32_bf16 v[208:211], v[108:111], a[212:215], v[208:211]
    s_waitcnt lgkmcnt(10)
    ds_read_b128 v[240:243], v50 offset:640
    v_mov_b32_dpp v28, v156 row_newbcast:0 row_mask:0xf bank_mask:0xf
    v_mfma_f32_16x16x32_bf16 v[212:215], a[192:195], v[88:91], v[212:215]
    buffer_load_dwordx4 v149, s[12:15], s76 offen lds
    ds_read2_b32 v[124:125], v49 offset0:80 offset1:176
    v_mfma_f32_16x16x32_bf16 v[216:219], a[196:199], v[88:91], v[216:219]
    s_add_u32 m0, s51, 98304
    ds_read_b128 v[126:129], v50 offset:320
    s_mov_b32 s76, 622080
    v_mfma_f32_16x16x32_bf16 v[220:223], v[88:91], a[200:203], v[220:223]
    s_waitcnt lgkmcnt(12)
    ds_read_b128 v[130:133], v50 offset:704
    v_mov_b32_dpp v29, v157 row_newbcast:0 row_mask:0xf bank_mask:0xf
    v_mfma_f32_16x16x32_bf16 v[212:215], a[204:207], v[112:115], v[212:215]
    ds_write_b64 v253, v[254:255]
    v_mov_b32_dpp v30, v158 row_newbcast:0 row_mask:0xf bank_mask:0xf
    v_mfma_f32_16x16x32_bf16 v[216:219], a[208:211], v[112:115], v[216:219]
    buffer_load_dwordx4 v149, s[12:15], s76 offen lds
    s_add_u32 m0, s51, 102400
    v_mfma_f32_16x16x32_bf16 v[220:223], v[112:115], a[212:215], v[220:223]
    s_waitcnt lgkmcnt(10)
    s_mov_b32 s76, 0
    v_mov_b32_dpp v31, v159 row_newbcast:0 row_mask:0xf bank_mask:0xf
    v_mfma_f32_16x16x32_bf16 v[176:179], a[192:195], v[92:95], v[176:179]
    v_mov_b32 v35, v160
    v_mov_b32 v72, v160
    v_mfma_f32_16x16x32_bf16 v[180:183], a[196:199], v[92:95], v[180:183]
    v_fmac_f32 v188, v225, v24
    v_fmac_f32 v189, v225, v25
    v_mfma_f32_16x16x32_bf16 v[184:187], v[92:95], a[200:203], v[184:187]
    s_waitcnt lgkmcnt(9)
    v_permlane16_swap_b32 v35, v72
    v_mfma_f32_16x16x32_bf16 v[176:179], a[204:207], v[116:119], v[176:179]
    buffer_load_dwordx4 v150, s[12:15], s76 offen lds
    s_add_u32 m0, s51, 106496
    v_mfma_f32_16x16x32_bf16 v[180:183], a[208:211], v[116:119], v[180:183]
    s_mov_b32 s76, 331776
    v_mov_b32 v72, v35
    v_fmac_f32 v190, v225, v26
    v_mfma_f32_16x16x32_bf16 v[184:187], v[116:119], a[212:215], v[184:187]
    s_waitcnt lgkmcnt(8)
    v_fmac_f32 v191, v225, v27
    v_mfma_f32_16x16x32_bf16 v[164:167], a[192:195], v[96:99], v[164:167]
    v_permlane32_swap_b32 v35, v72
    v_mfma_f32_16x16x32_bf16 v[168:171], a[196:199], v[96:99], v[168:171]
    v_mul_f32 v188, v224, v188
    v_mul_f32 v189, v224, v189
    v_mfma_f32_16x16x32_bf16 v[172:175], v[96:99], a[200:203], v[172:175]
    s_waitcnt lgkmcnt(7)
    buffer_load_dwordx4 v150, s[12:15], s76 offen lds
    v_mfma_f32_16x16x32_bf16 v[164:167], a[204:207], v[120:123], v[164:167]
    Lw2: s_cbranch_execz Lw6
    v_mul_f32 v190, v224, v190
    v_mul_f32_e64 v191, v224, v191
    v_mfma_f32_16x16x32_bf16 v[168:171], a[208:211], v[120:123], v[168:171]
    v_cvt_pk_bf16_f32 v80, v188, v189
    v_cvt_pk_bf16_f32 v81, v190, v191
    v_mfma_f32_16x16x32_bf16 v[172:175], v[120:123], a[212:215], v[172:175]
    ds_write_b64 v47, v[80:81] offset:8064
    v_pk_fma_f32 v[192:193], v[224:225], v[28:29], v[192:193] op_sel:[1,0,0] op_sel_hi:[1,1,1]
    v_pk_fma_f32 v[194:195], v[224:225], v[30:31], v[194:195] op_sel:[1,0,0] op_sel_hi:[1,1,1]
    v_pk_mul_f32 v[192:193], v[224:225], v[192:193] op_sel_hi:[0,1]
    v_pk_mul_f32 v[194:195], v[224:225], v[194:195] op_sel_hi:[0,1]
    v_cvt_pk_bf16_f32 v82, v192, v193
    v_cvt_pk_bf16_f32 v83, v194, v195
    ds_write_b64 v47, v[82:83] offset:24192
    v_pk_fma_f32 v[196:197], v[230:231], v[34:35], v[196:197] op_sel:[0,1,0]
    v_pk_fma_f32 v[198:199], v[232:233], v[34:35], v[198:199] op_sel:[0,1,0]
    v_pk_mul_f32 v[196:197], v[226:227], v[196:197]
    v_pk_mul_f32 v[198:199], v[228:229], v[198:199]
    v_cvt_pk_bf16_f32 v104, v196, v197
    v_cvt_pk_bf16_f32 v105, v198, v199
    ds_write_b64 v48, v[104:105] offset:24
    ds_read2_b32 v[224:225], v49 offset0:32 offset1:128
    ds_read_b128 v[226:229], v50 offset:128
    ds_read_b128 v[230:233], v50 offset:512
    v_permlane32_swap_b32 v80, v82
    v_permlane32_swap_b32 v81, v83
    v_mov_b32_dpp v105, v105 row_ror:8 row_mask:0xf bank_mask:0xf
    v_cndmask_b32 v80, v80, v82, s[28:29]
    v_cndmask_b32 v81, v81, v83, s[28:29]
    v_cndmask_b32 v82, v104, v105, s[30:31]
    v_mov_b32 v83, s46
    s_bitcmp1_b32 s58, 0
    s_cbranch_scc0 Lnx4
    buffer_store_dwordx4 v[80:83], v46, s[16:19], s59 offen offset:3072
Lnx4:
    s_waitcnt lgkmcnt(12)
    v_pk_fma_f32 v[200:201], v[234:235], v[24:25], v[200:201] op_sel:[1,0,0] op_sel_hi:[1,1,1]
    v_pk_fma_f32 v[202:203], v[234:235], v[26:27], v[202:203] op_sel:[1,0,0] op_sel_hi:[1,1,1]
    v_pk_mul_f32 v[200:201], v[234:235], v[200:201] op_sel_hi:[0,1]
    v_pk_mul_f32 v[202:203], v[234:235], v[202:203] op_sel_hi:[0,1]
    v_cvt_pk_bf16_f32 v84, v200, v201
    v_cvt_pk_bf16_f32 v85, v202, v203
    ds_write_b64 v47, v[84:85] offset:10752
    v_pk_fma_f32 v[204:205], v[234:235], v[28:29], v[204:205] op_sel:[1,0,0] op_sel_hi:[1,1,1]
    v_pk_fma_f32 v[206:207], v[234:235], v[30:31], v[206:207] op_sel:[1,0,0] op_sel_hi:[1,1,1]
    v_pk_mul_f32 v[204:205], v[234:235], v[204:205] op_sel_hi:[0,1]
    v_pk_mul_f32 v[206:207], v[234:235], v[206:207] op_sel_hi:[0,1]
    v_cvt_pk_bf16_f32 v86, v204, v205
    v_cvt_pk_bf16_f32 v87, v206, v207
    ds_write_b64 v47, v[86:87] offset:26880
    s_waitcnt lgkmcnt(12)
    s_nop 0
    v_pk_fma_f32 v[208:209], v[240:241], v[34:35], v[208:209] op_sel:[0,1,0]
    v_pk_fma_f32 v[210:211], v[242:243], v[34:35], v[210:211] op_sel:[0,1,0]
    v_pk_mul_f32 v[208:209], v[236:237], v[208:209]
    v_pk_mul_f32 v[210:211], v[238:239], v[210:211]
    v_cvt_pk_bf16_f32 v108, v208, v209
    v_cvt_pk_bf16_f32 v109, v210, v211
    ds_write_b64 v48, v[108:109] offset:32
    ds_read2_b32 v[234:235], v49 offset0:16 offset1:112
    ds_read_b128 v[236:239], v50 offset:64
    ds_read_b128 v[240:243], v50 offset:448
    v_permlane32_swap_b32 v84, v86
    v_permlane32_swap_b32 v85, v87
    v_mov_b32_dpp v109, v109 row_ror:8 row_mask:0xf bank_mask:0xf
    v_cndmask_b32 v84, v84, v86, s[28:29]
    v_cndmask_b32 v85, v85, v87, s[28:29]
    v_cndmask_b32 v86, v108, v109, s[30:31]
    v_mov_b32 v87, s46
    s_bitcmp1_b32 s58, 0
    s_cbranch_scc0 Lnx5
    buffer_store_dwordx4 v[84:87], v46, s[16:19], s32 offen offset:0
Lnx5:
    s_waitcnt lgkmcnt(15)
    v_pk_fma_f32 v[212:213], v[124:125], v[24:25], v[212:213] op_sel:[1,0,0] op_sel_hi:[1,1,1]
    v_pk_fma_f32 v[214:215], v[124:125], v[26:27], v[214:215] op_sel:[1,0,0] op_sel_hi:[1,1,1]
    v_pk_mul_f32 v[212:213], v[124:125], v[212:213] op_sel_hi:[0,1]
    v_pk_mul_f32 v[214:215], v[124:125], v[214:215] op_sel_hi:[0,1]
    v_cvt_pk_bf16_f32 v88, v212, v213
    v_cvt_pk_bf16_f32 v89, v214, v215
    ds_write_b64 v47, v[88:89] offset:13440
    v_pk_fma_f32 v[216:217], v[124:125], v[28:29], v[216:217] op_sel:[1,0,0] op_sel_hi:[1,1,1]
    v_pk_fma_f32 v[218:219], v[124:125], v[30:31], v[218:219] op_sel:[1,0,0] op_sel_hi:[1,1,1]
    v_pk_mul_f32 v[216:217], v[124:125], v[216:217] op_sel_hi:[0,1]
    v_pk_mul_f32 v[218:219], v[124:125], v[218:219] op_sel_hi:[0,1]
    v_cvt_pk_bf16_f32 v90, v216, v217
    v_cvt_pk_bf16_f32 v91, v218, v219
    ds_write_b64 v47, v[90:91] offset:29568
    s_waitcnt lgkmcnt(15)
    s_nop 0
    v_pk_fma_f32 v[220:221], v[130:131], v[34:35], v[220:221] op_sel:[0,1,0]
    v_pk_fma_f32 v[222:223], v[132:133], v[34:35], v[222:223] op_sel:[0,1,0]
    v_pk_mul_f32 v[220:221], v[126:127], v[220:221]
    v_pk_mul_f32 v[222:223], v[128:129], v[222:223]
    v_cvt_pk_bf16_f32 v112, v220, v221
    v_cvt_pk_bf16_f32 v113, v222, v223
    ds_write_b64 v48, v[112:113] offset:40
    ds_read2_b32 v[124:125], v49 offset0:0 offset1:96
    ds_read_b128 v[126:129], v50 offset:0
    ds_read_b128 v[130:133], v50 offset:384
    v_permlane32_swap_b32 v88, v90
    v_permlane32_swap_b32 v89, v91
    v_mov_b32_dpp v113, v113 row_ror:8 row_mask:0xf bank_mask:0xf
    v_cndmask_b32 v88, v88, v90, s[28:29]
    v_cndmask_b32 v89, v89, v91, s[28:29]
    v_cndmask_b32 v90, v112, v113, s[30:31]
    v_mov_b32 v91, s46
    s_bitcmp1_b32 s58, 0
    s_cbranch_scc0 Lnx6
    buffer_store_dwordx4 v[88:91], v46, s[16:19], s32 offen offset:1024
Lnx6:
    s_waitcnt lgkmcnt(14)
    v_pk_fma_f32 v[176:177], v[224:225], v[24:25], v[176:177] op_sel:[1,0,0] op_sel_hi:[1,1,1]
    v_pk_fma_f32 v[178:179], v[224:225], v[26:27], v[178:179] op_sel:[1,0,0] op_sel_hi:[1,1,1]
    v_pk_mul_f32 v[176:177], v[224:225], v[176:177] op_sel_hi:[0,1]
    v_pk_mul_f32 v[178:179], v[224:225], v[178:179] op_sel_hi:[0,1]
    v_cvt_pk_bf16_f32 v92, v176, v177
    v_cvt_pk_bf16_f32 v93, v178, v179
    ds_write_b64 v47, v[92:93] offset:5376
    v_pk_fma_f32 v[180:181], v[224:225], v[28:29], v[180:181] op_sel:[1,0,0] op_sel_hi:[1,1,1]
    v_pk_fma_f32 v[182:183], v[224:225], v[30:31], v[182:183] op_sel:[1,0,0] op_sel_hi:[1,1,1]
    v_pk_mul_f32 v[180:181], v[224:225], v[180:181] op_sel_hi:[0,1]
    v_pk_mul_f32 v[182:183], v[224:225], v[182:183] op_sel_hi:[0,1]
    v_cvt_pk_bf16_f32 v94, v180, v181
    v_cvt_pk_bf16_f32 v95, v182, v183
    ds_write_b64 v47, v[94:95] offset:21504
    s_waitcnt lgkmcnt(14)
    s_nop 0
    v_pk_fma_f32 v[184:185], v[230:231], v[34:35], v[184:185] op_sel:[0,1,0]
    v_pk_fma_f32 v[186:187], v[232:233], v[34:35], v[186:187] op_sel:[0,1,0]
    v_pk_mul_f32 v[184:185], v[226:227], v[184:185]
    v_pk_mul_f32 v[186:187], v[228:229], v[186:187]
    v_cvt_pk_bf16_f32 v116, v184, v185
    v_cvt_pk_bf16_f32 v117, v186, v187
    ds_write_b64 v48, v[116:117] offset:16
    v_permlane32_swap_b32 v92, v94
    v_permlane32_swap_b32 v93, v95
    v_mov_b32_dpp v117, v117 row_ror:8 row_mask:0xf bank_mask:0xf
    v_cndmask_b32 v92, v92, v94, s[28:29]
    v_cndmask_b32 v93, v93, v95, s[28:29]
    v_cndmask_b32 v94, v116, v117, s[30:31]
    v_mov_b32 v95, s46
    s_bitcmp1_b32 s58, 0
    s_cbranch_scc0 Lnx7
    buffer_store_dwordx4 v[92:95], v46, s[16:19], s59 offen offset:2048
Lnx7:
    s_waitcnt lgkmcnt(11)
    v_pk_fma_f32 v[164:165], v[234:235], v[24:25], v[164:165] op_sel:[1,0,0] op_sel_hi:[1,1,1]
    v_pk_fma_f32 v[166:167], v[234:235], v[26:27], v[166:167] op_sel:[1,0,0] op_sel_hi:[1,1,1]
    v_pk_mul_f32 v[164:165], v[234:235], v[164:165] op_sel_hi:[0,1]
    v_pk_mul_f32 v[166:167], v[234:235], v[166:167] op_sel_hi:[0,1]
    v_cvt_pk_bf16_f32 v96, v164, v165
    v_cvt_pk_bf16_f32 v97, v166, v167
    ds_write_b64 v47, v[96:97] offset:2688
    v_pk_fma_f32 v[168:169], v[234:235], v[28:29], v[168:169] op_sel:[1,0,0] op_sel_hi:[1,1,1]
    v_pk_fma_f32 v[170:171], v[234:235], v[30:31], v[170:171] op_sel:[1,0,0] op_sel_hi:[1,1,1]
    v_pk_mul_f32 v[168:169], v[234:235], v[168:169] op_sel_hi:[0,1]
    v_pk_mul_f32 v[170:171], v[234:235], v[170:171] op_sel_hi:[0,1]
    v_cvt_pk_bf16_f32 v98, v168, v169
    v_cvt_pk_bf16_f32 v99, v170, v171
    ds_write_b64 v47, v[98:99] offset:18816
    s_waitcnt lgkmcnt(11)
    s_nop 0
    v_pk_fma_f32 v[172:173], v[240:241], v[34:35], v[172:173] op_sel:[0,1,0]
    v_pk_fma_f32 v[174:175], v[242:243], v[34:35], v[174:175] op_sel:[0,1,0]
    v_pk_mul_f32 v[172:173], v[236:237], v[172:173]
    v_pk_mul_f32 v[174:175], v[238:239], v[174:175]
    v_cvt_pk_bf16_f32 v120, v172, v173
    v_cvt_pk_bf16_f32 v121, v174, v175
    ds_write_b64 v48, v[120:121] offset:8
    v_permlane32_swap_b32 v96, v98
    v_permlane32_swap_b32 v97, v99
    v_mov_b32_dpp v121, v121 row_ror:8 row_mask:0xf bank_mask:0xf
    v_cndmask_b32 v96, v96, v98, s[28:29]
    v_cndmask_b32 v97, v97, v99, s[28:29]
    v_cndmask_b32 v98, v120, v121, s[30:31]
    v_mov_b32 v99, s46
    s_bitcmp1_b32 s58, 0
    s_cbranch_scc0 Lnx8
    buffer_store_dwordx4 v[96:99], v46, s[16:19], s59 offen offset:1024
Lnx8:
    s_bitcmp1_b32 s58, 1
    s_cbranch_scc0 Lni9
    buffer_load_dwordx4 v[224:227], v46, s[16:19], s59 offen offset:3072 sc1
    buffer_load_dwordx4 v[228:231], v46, s[16:19], s32 offen offset:0 sc1
    buffer_load_dwordx4 v[232:235], v46, s[16:19], s32 offen offset:1024 sc1
Lni9:
    s_waitcnt lgkmcnt(8)
    v_pk_fma_f32 v[152:153], v[124:125], v[24:25], v[152:153] op_sel:[1,0,0] op_sel_hi:[1,1,1]
    v_pk_fma_f32 v[154:155], v[124:125], v[26:27], v[154:155] op_sel:[1,0,0] op_sel_hi:[1,1,1]
    v_pk_mul_f32 v[152:153], v[124:125], v[152:153] op_sel_hi:[0,1]
    v_pk_mul_f32 v[154:155], v[124:125], v[154:155] op_sel_hi:[0,1]
    v_cvt_pk_bf16_f32 v76, v152, v153
    v_cvt_pk_bf16_f32 v77, v154, v155
    ds_write_b64 v47, v[76:77] offset:0
    v_pk_fma_f32 v[156:157], v[124:125], v[28:29], v[156:157] op_sel:[1,0,0] op_sel_hi:[1,1,1]
    v_pk_fma_f32 v[158:159], v[124:125], v[30:31], v[158:159] op_sel:[1,0,0] op_sel_hi:[1,1,1]
    v_pk_mul_f32 v[156:157], v[124:125], v[156:157] op_sel_hi:[0,1]
    v_pk_mul_f32 v[158:159], v[124:125], v[158:159] op_sel_hi:[0,1]
    v_cvt_pk_bf16_f32 v78, v156, v157
    v_cvt_pk_bf16_f32 v79, v158, v159
    ds_write_b64 v47, v[78:79] offset:16128
    s_waitcnt lgkmcnt(8)
    s_nop 0
    v_pk_fma_f32 v[160:161], v[130:131], v[34:35], v[160:161] op_sel:[0,1,0]
    v_pk_fma_f32 v[162:163], v[132:133], v[34:35], v[162:163] op_sel:[0,1,0]
    v_pk_mul_f32 v[160:161], v[126:127], v[160:161]
    v_pk_mul_f32 v[162:163], v[128:129], v[162:163]
    v_cvt_pk_bf16_f32 v100, v160, v161
    v_cvt_pk_bf16_f32 v101, v162, v163
    ds_write_b64 v48, v[100:101] offset:0
    v_permlane32_swap_b32 v76, v78
    v_permlane32_swap_b32 v77, v79
    v_mov_b32_dpp v101, v101 row_ror:8 row_mask:0xf bank_mask:0xf
    v_cndmask_b32 v76, v76, v78, s[28:29]
    v_cndmask_b32 v77, v77, v79, s[28:29]
    v_cndmask_b32 v78, v100, v101, s[30:31]
    v_mov_b32_e64 v79, s46
    s_bitcmp1_b32 s58, 0
    s_cbranch_scc0 Lnx10
    buffer_store_dwordx4 v[76:79], v46, s[16:19], s59 offen offset:0
Lnx10:
    s_waitcnt vmcnt(11) lgkmcnt(0)
    s_barrier
    s_bitcmp1_b32 s58, 1
    s_cbranch_scc0 Lnp11
    s_waitcnt vmcnt(2)
    v_xor_b32 v227, s46, v227
    s_waitcnt vmcnt(1)
    v_xor_b32 v231, s46, v231
    s_waitcnt vmcnt(0)
    v_xor_b32 v235, s46, v235
    v_or3_b32 v227, v227, v231, v235
    v_cmp_lt_u32_e64 vcc, 0, v227
    ds_write_b64 v63, v[224:225] offset:8064
    ds_write_b32 v64, v226 offset:24
    ds_write_b64 v63, v[228:229] offset:10752
    ds_write_b32 v64, v230 offset:32
    ds_write_b64 v63, v[232:233] offset:13440
    ds_write_b32 v64, v234 offset:40
    s_cmp_lg_u64 vcc, 0
    s_cbranch_scc1 Lre14
Lok12:
Lnp11:
    ds_read_b64 v[92:93], v51 offset:29568
    ds_read_b32 v94, v52 offset:29568
    ds_read_b64 v[100:101], v51 offset:13440
    ds_read_b32 v102, v52 offset:13440
    ds_read_b64 v[88:89], v51 offset:26880
    ds_read_b32 v90, v52 offset:26880
    ds_read_b64 v[96:97], v51 offset:10752
    ds_read_b32 v98, v52 offset:10752
    ds_read_b64 v[84:85], v51 offset:24192
    ds_read_b32 v86, v52 offset:24192
    v_mov_b32 v87, 0
    v_mov_b32 v91, 0
    v_mov_b32 v95, 0
    v_mov_b32 v99, 0
    v_mov_b32 v103, 0
    s_waitcnt lgkmcnt(6)
    s_nop 0
    v_mfma_f32_16x16x32_bf16 v[108:111], v[92:95], v[100:103], v[40:43]
    s_waitcnt lgkmcnt(4)
    ds_read_b64 v[78:79], v54 offset:24
    v_mfma_f32_16x16x32_bf16 v[116:119], v[88:91], v[100:103], v[40:43]
    s_waitcnt lgkmcnt(3)
    ds_read_b128 v[80:83], v54 offset:32
    v_mfma_f32_16x16x32_bf16 v[104:107], v[88:91], v[96:99], v[40:43]
    s_waitcnt lgkmcnt(2)
    ds_read_b64 v[72:73], v53 offset:24
    v_mfma_f32_16x16x32_bf16 v[112:115], v[84:87], v[96:99], v[40:43]
    ds_read_b128 v[74:77], v53 offset:32
    s_bitcmp1_b32 s58, 1
    s_cbranch_scc0 Lni15
    buffer_load_dwordx4 v[184:187], v46, s[16:19], s59 offen offset:2048 sc1
    buffer_load_dwordx4 v[188:191], v46, s[16:19], s59 offen offset:1024 sc1
    buffer_load_dwordx4 v[192:195], v46, s[16:19], s59 offen offset:0 sc1
Lni15:
    v_cndmask_b32 v108, v116, v108, s[66:67]
    v_cndmask_b32 v109, v117, v109, s[68:69]
    v_cndmask_b32 v110, v118, v110, s[70:71]
    v_cndmask_b32 v111, v119, v111, s[72:73]
    s_nop 0
    s_nop 0
    v_cndmask_b32 v104, v112, v104, s[66:67]
    v_cndmask_b32 v105, v113, v105, s[68:69]
    v_cndmask_b32 v106, v114, v106, s[70:71]
    v_cndmask_b32 v107, v115, v107, s[72:73]
    v_max3_f32 v145, v108, v109, v110
    v_max3_f32 v144, v104, v105, v106
    v_max_f32 v145, v145, v111
    v_max_f32 v144, v144, v107
    s_nop 1
    v_permlane32_swap_b32 v144, v145
    v_max_f32 v144, v144, v145
    v_mov_b32 v145, v144
    s_nop 1
    v_permlane16_swap_b32 v144, v145
    v_max_f32 v144, v144, v145
    v_mul_f32 v145, s85, v144
    v_mul_f32 v144, s85, v144
    s_nop 1
    v_permlane32_swap_b32_e64 v144, v145
    v_pk_fma_f32 v[104:105], v[104:105], s[84:85], v[144:145] op_sel:[0,1,0] op_sel_hi:[1,1,0] neg_lo:[0,0,1] neg_hi:[0,0,1]
    v_pk_fma_f32 v[106:107], v[106:107], s[84:85], v[144:145] op_sel:[0,1,0] op_sel_hi:[1,1,0] neg_lo:[0,0,1] neg_hi:[0,0,1]
    v_pk_fma_f32 v[108:109], v[108:109], s[84:85], v[144:145] op_sel:[0,1,1] op_sel_hi:[1,1,1] neg_lo:[0,0,1] neg_hi:[0,0,1]
    v_pk_fma_f32 v[110:111], v[110:111], s[84:85], v[144:145] op_sel:[0,1,1] op_sel_hi:[1,1,1] neg_lo:[0,0,1] neg_hi:[0,0,1]
    s_bitcmp1_b32 s58, 1
    s_cbranch_scc0 Lnp16
    s_waitcnt vmcnt(2)
    v_xor_b32 v187, s46, v187
    s_waitcnt vmcnt(1)
    v_xor_b32 v191, s46, v191
    s_waitcnt vmcnt(0)
    v_xor_b32 v195, s46, v195
    v_or3_b32 v187, v187, v191, v195
    v_cmp_lt_u32_e64 vcc, 0, v187
    ds_write_b64 v63, v[184:185] offset:5376
    ds_write_b32 v64, v186 offset:16
    ds_write_b64 v63, v[188:189] offset:2688
    ds_write_b32 v64, v190 offset:8
    ds_write_b64 v63, v[192:193] offset:0
    ds_write_b32 v64, v194 offset:0
    s_cmp_lg_u64 vcc, 0
    s_cbranch_scc1 Lre19
Lok17:
Lnp16:
    ds_read_b64 v[100:101], v51 offset:8064
    ds_read_b32 v102, v52 offset:8064
    ds_read_b64 v[92:93], v51 offset:21504
    ds_read_b32 v94, v52 offset:21504
    ds_read_b64 v[96:97], v51 offset:5376
    ds_read_b32 v98, v52 offset:5376
    ds_read_b64 v[88:89], v51 offset:18816
    ds_read_b32 v90, v52 offset:18816
    v_exp_f32 v104, v104
    v_exp_f32 v105, v105
    v_exp_f32 v106, v106
    v_exp_f32 v107, v107
    v_exp_f32 v108, v108
    v_exp_f32 v109, v109
    v_exp_f32 v110, v110
    v_exp_f32 v111, v111
    s_waitcnt lgkmcnt(6)
    v_mfma_f32_16x16x32_bf16 v[124:127], v[84:87], v[100:103], v[40:43]
    s_waitcnt lgkmcnt(4)
    v_cvt_pk_bf16_f32 v138, v104, v105
    v_cvt_pk_bf16_f32 v139, v106, v107
    v_mfma_f32_16x16x32_bf16 v[132:135], v[92:95], v[100:103], v[40:43]
    s_waitcnt lgkmcnt(2)
    v_bfi_b32 v136, v44, 0, v138
    v_bfi_b32 v137, v45, 0, v139
    v_mfma_f32_16x16x32_bf16 v[120:123], v[92:95], v[96:99], v[40:43]
    s_waitcnt lgkmcnt(0)
    v_and_b32 v138, v44, v138
    v_and_b32 v139, v45, v139
    v_mfma_f32_16x16x32_bf16 v[128:131], v[88:91], v[96:99], v[40:43]
    s_add_u32 s76, s47, 66560
    v_cvt_pk_bf16_f32 v142, v108, v109
    v_cvt_pk_bf16_f32 v143, v110, v111
    v_mfma_f32_16x16x32_bf16 v[112:115], v[78:81], v[136:139], 0
    s_add_u32 s77, s47, 72704
    v_bfi_b32 v140, v44, 0, v142
    v_bfi_b32 v141, v45, 0, v143
    v_mfma_f32_16x16x32_bf16 v[104:107], v[72:75], v[136:139], 0
    v_and_b32_e64 v142, v44, v142
    v_and_b32 v143, v45, v143
    s_nop 1
    v_mfma_f32_16x16x32_bf16 v[116:119], v[80:83], v[140:143], 0
    v_cndmask_b32 v124, v132, v124, s[66:67]
    v_cndmask_b32 v125, v133, v125, s[68:69]
    v_mfma_f32_16x16x32_bf16 v[108:111], v[74:77], v[140:143], 0
    v_cndmask_b32 v126, v134, v126, s[70:71]
    v_cndmask_b32 v127, v135, v127, s[72:73]
    v_cndmask_b32 v120, v128, v120, s[66:67]
    v_cndmask_b32 v121, v129, v121, s[68:69]
    v_cndmask_b32 v122, v130, v122, s[70:71]
    v_cndmask_b32 v123, v131, v123, s[72:73]
    v_rcp_f32 v114, v114
    v_rcp_f32 v118, v118
    v_pk_mul_f32 v[104:105], v[104:105], v[114:115] op_sel_hi:[1,0]
    v_pk_mul_f32 v[106:107], v[106:107], v[114:115] op_sel_hi:[1,0]
    v_pk_mul_f32 v[112:113], v[112:113], v[114:115] op_sel_hi:[1,0]
    v_cvt_pk_bf16_f32 v104, v104, v105
    v_cvt_pk_bf16_f32 v105, v106, v107
    v_cvt_pk_bf16_f32 v112, v112, v113
    v_pk_mul_f32 v[108:109], v[108:109], v[118:119] op_sel_hi:[1,0]
    v_pk_mul_f32 v[110:111], v[110:111], v[118:119] op_sel_hi:[1,0]
    v_pk_mul_f32 v[116:117], v[116:117], v[118:119] op_sel_hi:[1,0]
    v_cvt_pk_bf16_f32 v108, v108, v109
    v_cvt_pk_bf16_f32 v109, v110, v111
    v_cvt_pk_bf16_f32 v116, v116, v117
    buffer_store_dwordx2 v[104:105], v55, s[16:19], s76 offen
    buffer_store_dwordx2 v[108:109], v55, s[16:19], s77 offen
    v_mov_b32_dpp v112, v116 quad_perm:[0,1,2,3] row_mask:0x2 bank_mask:0xf
    buffer_store_dword v112, v56, s[16:19], s76 offen
    v_max3_f32 v145, v124, v125, v126
    v_max3_f32 v144, v120, v121, v122
    v_max_f32 v145, v145, v127
    v_max_f32 v144, v144, v123
    ds_read_b64 v[78:79], v54 offset:8
    ds_read_b128 v[80:83], v54 offset:16
    v_permlane32_swap_b32 v144, v145
    v_max_f32 v144, v144, v145
    v_mov_b32_e64 v145, v144
    ds_read_b64 v[72:73], v53 offset:8
    ds_read_b128 v[74:77], v53 offset:16
    v_permlane16_swap_b32 v144, v145
    v_max_f32 v144, v144, v145
    v_mul_f32 v145, s85, v144
    v_mul_f32 v144, s85, v144
    s_cmp_eq_u32 s43, 0
    s_cselect_b32 s81, s84, 0
    v_permlane32_swap_b32 v144, v145
    v_min_f32 v116, s81, v40
    v_min_f32 v117, s81, v41
    v_min_f32 v118, s81, v42
    v_min_f32 v119, s81, v43
    v_mov_b32 v112, s84
    v_mov_b32 v113, s84
    v_mov_b32 v114, s84
    v_mov_b32_e64 v115, s84
    v_pk_fma_f32 v[120:121], v[120:121], s[84:85], v[144:145] op_sel:[0,1,0] op_sel_hi:[1,1,0] neg_lo:[0,0,1] neg_hi:[0,0,1]
    v_pk_fma_f32 v[122:123], v[122:123], s[84:85], v[144:145] op_sel:[0,1,0] op_sel_hi:[1,1,0] neg_lo:[0,0,1] neg_hi:[0,0,1]
    v_pk_fma_f32 v[124:125], v[124:125], s[84:85], v[144:145] op_sel:[0,1,1] op_sel_hi:[1,1,1] neg_lo:[0,0,1] neg_hi:[0,0,1]
    v_pk_fma_f32 v[126:127], v[126:127], s[84:85], v[144:145] op_sel:[0,1,1] op_sel_hi:[1,1,1] neg_lo:[0,0,1] neg_hi:[0,0,1]
    ds_read_b64 v[100:101], v51 offset:2688
    ds_read_b32 v102, v52 offset:2688
    ds_read_b64 v[84:85], v51 offset:16128
    ds_read_b32 v86, v52 offset:16128
    ds_read_b64 v[96:97], v51 offset:0
    ds_read_b32 v98, v52 offset:0
    v_exp_f32 v120, v120
    v_exp_f32 v121, v121
    v_exp_f32 v122, v122
    v_exp_f32 v123, v123
    v_exp_f32 v124, v124
    v_exp_f32 v125, v125
    v_exp_f32_e64 v126, v126
    v_exp_f32 v127, v127
    s_waitcnt vmcnt(0)
    buffer_store_dword v68, v57, s[16:19], s47 offen offset:0
    s_waitcnt lgkmcnt(4)
    v_mfma_f32_16x16x32_bf16 v[108:111], v[88:91], v[100:103], v[40:43]
    s_waitcnt lgkmcnt(2)
    v_cvt_pk_bf16_f32 v138, v120, v121
    v_cvt_pk_bf16_f32 v139, v122, v123
    v_mfma_f32_16x16x32_bf16 v[116:119], v[84:87], v[100:103], v[116:119]
    s_waitcnt lgkmcnt(0)
    v_bfi_b32 v136, v44, 0, v138
    v_bfi_b32 v137, v45, 0, v139
    v_mfma_f32_16x16x32_bf16 v[104:107], v[84:87], v[96:99], v[40:43]
    s_add_u32 s76, s47, 103424
    s_add_u32 s77, s47, 109568
    v_and_b32 v138, v44, v138
    v_and_b32 v139, v45, v139
    s_nop 1
    v_mfma_f32_16x16x32_bf16 v[128:131], v[78:81], v[136:139], 0
    v_cvt_pk_bf16_f32 v142, v124, v125
    v_cvt_pk_bf16_f32 v143, v126, v127
    v_mfma_f32_16x16x32_bf16 v[120:123], v[72:75], v[136:139], 0
    v_bfi_b32 v140, v44, 0, v142
    v_bfi_b32 v141, v45, 0, v143
    v_and_b32_e64 v142, v44, v142
    v_and_b32 v143, v45, v143
    s_nop 1
    v_mfma_f32_16x16x32_bf16 v[132:135], v[80:83], v[140:143], 0
    v_cndmask_b32 v108, v116, v108, s[66:67]
    v_cndmask_b32 v109, v117, v109, s[68:69]
    v_mfma_f32_16x16x32_bf16 v[124:127], v[74:77], v[140:143], 0
    v_cndmask_b32 v110, v118, v110, s[70:71]
    v_cndmask_b32 v111, v119, v111, s[72:73]
    v_cndmask_b32 v104, v112, v104, s[66:67]
    v_cndmask_b32 v105, v113, v105, s[68:69]
    v_cndmask_b32 v106, v114, v106, s[70:71]
    v_cndmask_b32 v107, v115, v107, s[72:73]
    v_rcp_f32 v130, v130
    v_rcp_f32 v134, v134
    v_pk_mul_f32 v[120:121], v[120:121], v[130:131] op_sel_hi:[1,0]
    v_pk_mul_f32 v[122:123], v[122:123], v[130:131] op_sel_hi:[1,0]
    v_pk_mul_f32 v[128:129], v[128:129], v[130:131] op_sel_hi:[1,0]
    v_cvt_pk_bf16_f32 v120, v120, v121
    v_cvt_pk_bf16_f32 v121, v122, v123
    v_cvt_pk_bf16_f32 v128, v128, v129
    v_pk_mul_f32 v[124:125], v[124:125], v[134:135] op_sel_hi:[1,0]
    v_pk_mul_f32 v[126:127], v[126:127], v[134:135] op_sel_hi:[1,0]
    v_pk_mul_f32 v[132:133], v[132:133], v[134:135] op_sel_hi:[1,0]
    v_cvt_pk_bf16_f32 v124, v124, v125
    v_cvt_pk_bf16_f32 v125, v126, v127
    v_cvt_pk_bf16_f32 v132, v132, v133
    buffer_store_dwordx2 v[120:121], v55, s[16:19], s76 offen
    buffer_store_dwordx2 v[124:125], v55, s[16:19], s77 offen
    v_mov_b32_dpp v128, v132 quad_perm:[0,1,2,3] row_mask:0x2 bank_mask:0xf
    buffer_store_dword v128, v56, s[16:19], s76 offen
    buffer_load_dword v146, v58, s[16:19], s47 offen offset:0 sc1
    v_max3_f32 v145, v108, v109, v110
    v_max3_f32 v144, v104, v105, v106
    v_max_f32 v145, v145, v111
    v_max_f32 v144, v144, v107
    ds_read_b128 v[80:83], v54 offset:0
    ds_read_b128 v[74:77], v53 offset:0
    v_permlane32_swap_b32 v144, v145
    v_max_f32 v144, v144, v145
    v_mov_b32 v145, v144
    v_mov_b32 v78, 0
    v_mov_b32 v79, 0
    v_permlane16_swap_b32 v144, v145
    v_max_f32 v144, v144, v145
    v_mul_f32 v145, s85, v144
    v_mul_f32 v144, s85, v144
    v_mov_b32 v72, 0
    v_mov_b32 v73, 0
    v_permlane32_swap_b32 v144, v145
    v_pk_fma_f32 v[104:105], v[104:105], s[84:85], v[144:145] op_sel:[0,1,0] op_sel_hi:[1,1,0] neg_lo:[0,0,1] neg_hi:[0,0,1]
    v_pk_fma_f32 v[106:107], v[106:107], s[84:85], v[144:145] op_sel:[0,1,0] op_sel_hi:[1,1,0] neg_lo:[0,0,1] neg_hi:[0,0,1]
    v_pk_fma_f32 v[108:109], v[108:109], s[84:85], v[144:145] op_sel:[0,1,1] op_sel_hi:[1,1,1] neg_lo:[0,0,1] neg_hi:[0,0,1]
    v_pk_fma_f32 v[110:111], v[110:111], s[84:85], v[144:145] op_sel:[0,1,1] op_sel_hi:[1,1,1] neg_lo:[0,0,1] neg_hi:[0,0,1]
    v_exp_f32 v104, v104
    v_exp_f32 v105, v105
    v_exp_f32 v106, v106
    v_exp_f32 v107, v107
    v_exp_f32 v108, v108
    v_exp_f32 v109, v109
    v_exp_f32_e64 v110, v110
    v_exp_f32 v111, v111
    s_waitcnt vmcnt(0)
    v_cmp_ne_u32 s[34:35], s46, v146
    buffer_store_dword v68, v57, s[16:19], s47 offen offset:160
    s_add_u32 s78, s87, s47
    s_add_u32 m0, s87, 0
    s_add_u32 s78, s78, 66560
    s_cmp_lg_u64 s[34:35], 0
    s_cbranch_scc1 Lre22
Lok20:
    buffer_load_dwordx4 v46, s[16:19], s78 offen offset:0 sc1 lds
    buffer_load_dwordx4 v46, s[16:19], s78 offen offset:1024 sc1 lds
    v_cvt_pk_bf16_f32 v138, v104, v105
    v_cvt_pk_bf16_f32 v139, v106, v107
    v_bfi_b32 v136, v44, 0, v138
    v_bfi_b32 v137, v45, 0, v139
    v_and_b32_e64 v138, v44, v138
    v_and_b32 v139, v45, v139
    s_waitcnt lgkmcnt(1)
    s_nop 0
    v_mfma_f32_16x16x32_bf16 v[112:115], v[78:81], v[136:139], 0
    s_waitcnt lgkmcnt(0)
    v_cvt_pk_bf16_f32 v142, v108, v109
    v_cvt_pk_bf16_f32 v143, v110, v111
    v_mfma_f32_16x16x32_bf16 v[104:107], v[72:75], v[136:139], 0
    s_add_u32 s76, s47, 140288
    s_add_u32 s77, s47, 146432
    v_bfi_b32 v140, v44, 0, v142
    v_bfi_b32 v141, v45, 0, v143
    v_and_b32_e64 v142, v44, v142
    v_and_b32 v143, v45, v143
    s_nop 1
    v_mfma_f32_16x16x32_bf16 v[116:119], v[80:83], v[140:143], 0
    v_rcp_f32 v114, v114
    v_mfma_f32_16x16x32_bf16 v[108:111], v[74:77], v[140:143], 0
    buffer_load_dwordx4 v46, s[16:19], s78 offen offset:2048 sc1 lds
    s_add_u32 s78, s87, s47
    s_add_u32 m0, s87, 12288
    s_add_u32 s78, s78, 78848
    buffer_load_dwordx4 v46, s[16:19], s78 offen offset:0 sc1 lds
    v_rcp_f32_e64 v118, v118
    v_pk_mul_f32 v[104:105], v[104:105], v[114:115] op_sel_hi:[1,0]
    v_pk_mul_f32 v[106:107], v[106:107], v[114:115] op_sel_hi:[1,0]
    v_pk_mul_f32 v[112:113], v[112:113], v[114:115] op_sel_hi:[1,0]
    v_cvt_pk_bf16_f32 v104, v104, v105
    v_cvt_pk_bf16_f32 v105, v106, v107
    v_cvt_pk_bf16_f32 v112, v112, v113
    v_pk_mul_f32 v[108:109], v[108:109], v[118:119] op_sel_hi:[1,0]
    v_pk_mul_f32 v[110:111], v[110:111], v[118:119] op_sel_hi:[1,0]
    v_pk_mul_f32 v[116:117], v[116:117], v[118:119] op_sel_hi:[1,0]
    v_cvt_pk_bf16_f32 v108, v108, v109
    v_cvt_pk_bf16_f32 v109, v110, v111
    v_cvt_pk_bf16_f32 v116, v116, v117
    buffer_store_dwordx2 v[104:105], v55, s[16:19], s76 offen
    buffer_store_dwordx2 v[108:109], v55, s[16:19], s77 offen
    v_mov_b32_dpp v112, v116 quad_perm:[0,1,2,3] row_mask:0x2 bank_mask:0xf
    buffer_store_dword v112, v56, s[16:19], s76 offen
    buffer_load_dword v146, v58, s[16:19], s47 offen offset:160 sc1
    s_mul_i32 s81, s53, 6144
    v_add_u32_e64 v96, s81, v46
    v_add_u32 v97, 36864, v96
    ds_read_b64_tr_b16 a[216:217], v33 offset:0
    ds_read_b64_tr_b16 a[218:219], v33 offset:512
    ds_read_b64_tr_b16 a[220:221], v33 offset:8
    ds_read_b64_tr_b16 a[222:223], v33 offset:520
    ds_read_b64_tr_b16 a[224:225], v33 offset:4096
    ds_read_b64_tr_b16 a[226:227], v33 offset:4608
    ds_read_b64_tr_b16 a[228:229], v33 offset:4104
    buffer_load_dwordx4 v46, s[16:19], s78 offen offset:1024 sc1 lds
    ds_read_b64_tr_b16 a[230:231], v33 offset:4616
    ds_read_b64_tr_b16 a[232:233], v33 offset:8192
    ds_read_b64_tr_b16 a[234:235], v33 offset:8704
    ds_read_b64_tr_b16 a[236:237], v33 offset:8200
    ds_read_b64_tr_b16 a[238:239], v33 offset:8712
    ds_read_b64_tr_b16 a[240:241], v33 offset:12288
    ds_read_b64_tr_b16 a[242:243], v33 offset:12800
    buffer_load_dwordx4 v46, s[16:19], s78 offen offset:2048 sc1 lds
    ds_read_b64_tr_b16 a[244:245], v33 offset:12296
    ds_read_b64_tr_b16 a[246:247], v33 offset:12808
    ds_read_b64_tr_b16 a[248:249], v33 offset:16384
    ds_read_b64_tr_b16 a[250:251], v33 offset:16896
    ds_read_b64_tr_b16 a[252:253], v33 offset:16392
    ds_read_b64_tr_b16 a[254:255], v33 offset:16904
    ds_read_b64_tr_b16 v[152:153], v33 offset:20480
    s_add_u32 s78, s87, s47
    s_nop 0
    s_add_u32 m0, s87, 24576
    s_add_u32 s78, s78, 91136
    buffer_load_dwordx4 v46, s[16:19], s78 offen offset:0 sc1 lds
    ds_read_b64_tr_b16 v[154:155], v33 offset:20992
    ds_read_b64_tr_b16 v[156:157], v33 offset:20488
    ds_read_b64_tr_b16 v[158:159], v33 offset:21000
    Lw3: s_cbranch_execz Lw7
    s_nop 0
    ds_read_b64_tr_b16 v[160:161], v33 offset:24576
    ds_read_b64_tr_b16 v[162:163], v33 offset:25088
    ds_read_b64_tr_b16 v[164:165], v33 offset:24584
    ds_read_b64_tr_b16 v[166:167], v33 offset:25096
    buffer_load_dwordx4 v46, s[16:19], s78 offen offset:1024 sc1 lds
    ds_read_b64_tr_b16 v[168:169], v33 offset:28672
    ds_read_b64_tr_b16 v[170:171], v33 offset:29184
    ds_read_b64_tr_b16 v[172:173], v33 offset:28680
    ds_read_b64_tr_b16 v[174:175], v33 offset:29192
    ds_read_b64_tr_b16 v[176:177], v33 offset:32768
    ds_read_b64_tr_b16 v[178:179], v33 offset:33280
    ds_read_b64_tr_b16 v[180:181], v33 offset:32776
    buffer_load_dwordx4 v46, s[16:19], s78 offen offset:2048 sc1 lds
    ds_read_b64_tr_b16 v[182:183], v33 offset:33288
    s_waitcnt vmcnt(10) lgkmcnt(0)
    s_barrier
    ds_read_b128 v[72:75], v96 offset:0
    ds_read_b128 v[76:79], v96 offset:1024
    ds_read_b128 v[80:83], v96 offset:2048
    ds_read_b128 v[84:87], v96 offset:3072
    ds_read_b128 v[88:91], v96 offset:4096
    ds_read_b128 v[92:95], v96 offset:5120
    s_waitcnt lgkmcnt(5)
    v_mfma_f32_16x16x32_bf16 v[0:3], a[216:219], v[72:75], v[0:3]
    s_waitcnt vmcnt(5)
    ds_read_b64_tr_b16 v[184:185], v34 offset:0
    ds_read_b64_tr_b16 v[186:187], v34 offset:512
    v_cmp_ne_u32 s[34:35], s46, v146
    v_mfma_f32_16x16x32_bf16 v[4:7], a[220:223], v[72:75], v[4:7]
    s_waitcnt lgkmcnt(6)
    ds_read_b64_tr_b16 v[188:189], v34 offset:8
    ds_read_b64_tr_b16 v[190:191], v34 offset:520
    v_mfma_f32_16x16x32_bf16 v[0:3], a[224:227], v[76:79], v[0:3]
    ds_read_b64_tr_b16 v[192:193], v34 offset:4096
    ds_read_b64_tr_b16 v[194:195], v34 offset:4608
    v_mfma_f32_16x16x32_bf16 v[4:7], a[228:231], v[76:79], v[4:7]
    s_waitcnt lgkmcnt(9)
    ds_read_b64_tr_b16 v[196:197], v34 offset:4104
    s_cmp_lg_u64 s[34:35], 0
    s_cbranch_scc1 Lre25
Lok23:
    ds_read_b64_tr_b16 v[198:199], v34 offset:4616
    v_mfma_f32_16x16x32_bf16 v[0:3], a[232:235], v[80:83], v[0:3]
    buffer_store_dword v68, v57, s[16:19], s47 offen offset:320
    s_add_u32 s78, s87, s47
    ds_read_b64_tr_b16 v[200:201], v34 offset:8192
    v_mfma_f32_16x16x32_bf16 v[4:7], a[236:239], v[80:83], v[4:7]
    s_waitcnt lgkmcnt(11)
    s_add_u32 m0, s87, 36864
    s_add_u32 s78, s78, 103424
    buffer_load_dwordx4 v46, s[16:19], s78 offen offset:0 sc1 lds
    v_mfma_f32_16x16x32_bf16 v[0:3], a[240:243], v[84:87], v[0:3]
    s_waitcnt vmcnt(5)
    s_barrier
    ds_read_b64_tr_b16 v[202:203], v34 offset:8704
    ds_read_b64_tr_b16 v[204:205], v34 offset:8200
    v_mfma_f32_16x16x32_bf16 v[4:7], a[244:247], v[84:87], v[4:7]
    s_waitcnt lgkmcnt(12)
    ds_read_b128 v[72:75], v96 offset:12288
    buffer_load_dwordx4 v46, s[16:19], s78 offen offset:1024 sc1 lds
    ds_read_b128 v[76:79], v96 offset:13312
    v_mfma_f32_16x16x32_bf16 v[0:3], a[248:251], v[88:91], v[0:3]
    s_nop 0
    ds_read_b128 v[80:83], v96 offset:14336
    ds_read_b128 v[84:87], v96 offset:15360
    v_mfma_f32_16x16x32_bf16 v[4:7], a[252:255], v[88:91], v[4:7]
    s_waitcnt lgkmcnt(15)
    ds_read_b128 v[88:91], v96 offset:16384
    buffer_load_dwordx4 v46, s[16:19], s78 offen offset:2048 sc1 lds
    ds_read_b64_tr_b16 v[206:207], v34 offset:8712
    v_mfma_f32_16x16x32_bf16 v[0:3], v[152:155], v[92:95], v[0:3]
    s_add_u32 s78, s87, s47
    ds_read_b64_tr_b16 v[208:209], v34 offset:12288
    s_add_u32 m0, s87, 49152
    s_add_u32 s78, s78, 115712
    ds_read_b64_tr_b16 v[210:211], v34 offset:12800
    v_mfma_f32_16x16x32_bf16 v[4:7], v[156:159], v[92:95], v[4:7]
    s_waitcnt lgkmcnt(7)
    ds_read_b128 v[92:95], v96 offset:17408
    ds_read_b64_tr_b16 v[212:213], v34 offset:12296
    v_mfma_f32_16x16x32_bf16 v[0:3], v[160:163], v[72:75], v[0:3]
    buffer_load_dwordx4 v46, s[16:19], s78 offen offset:0 sc1 lds
    ds_read_b64_tr_b16 v[214:215], v34 offset:12808
    ds_read_b64_tr_b16 v[216:217], v34 offset:16384
    v_mfma_f32_16x16x32_bf16 v[4:7], v[164:167], v[72:75], v[4:7]
    s_waitcnt lgkmcnt(10)
    ds_read_b64_tr_b16 v[218:219], v34 offset:16896
    ds_read_b64_tr_b16 v[220:221], v34 offset:16392
    v_mfma_f32_16x16x32_bf16 v[0:3], v[168:171], v[76:79], v[0:3]
    ds_read_b64_tr_b16 v[222:223], v34 offset:16904
    ds_read_b64_tr_b16 v[224:225], v34 offset:20480
    v_mfma_f32_16x16x32_bf16 v[4:7], v[172:175], v[76:79], v[4:7]
    s_waitcnt lgkmcnt(13)
    ds_read_b64_tr_b16 v[226:227], v34 offset:20992
    buffer_load_dwordx4 v46, s[16:19], s78 offen offset:1024 sc1 lds
    ds_read_b64_tr_b16 v[228:229], v34 offset:20488
    v_mfma_f32_16x16x32_bf16 v[0:3], v[176:179], v[80:83], v[0:3]
    ds_read_b64_tr_b16 v[230:231], v34 offset:21000
    ds_read_b64_tr_b16 v[232:233], v34 offset:24576
    v_mfma_f32_16x16x32_bf16 v[4:7], v[180:183], v[80:83], v[4:7]
    s_waitcnt lgkmcnt(15)
    ds_read_b64_tr_b16 v[234:235], v34 offset:25088
    buffer_load_dword v98, v58, s[16:19], s47 offen offset:320 sc1
    ds_read_b64_tr_b16 v[236:237], v34 offset:24584
    v_mfma_f32_16x16x32_bf16 v[0:3], v[184:187], v[84:87], v[0:3]
    s_waitcnt vmcnt(7)
    s_barrier
    ds_read_b64_tr_b16 v[238:239], v34 offset:25096
    ds_read_b64_tr_b16 v[240:241], v34 offset:28672
    v_mfma_f32_16x16x32_bf16 v[4:7], v[188:191], v[84:87], v[4:7]
    ds_read_b128 v[72:75], v96 offset:24576
    buffer_load_dwordx4 v46, s[16:19], s78 offen offset:2048 sc1 lds
    ds_read_b128 v[76:79], v96 offset:25600
    v_mfma_f32_16x16x32_bf16 v[0:3], v[192:195], v[88:91], v[0:3]
    s_add_u32 s78, s87, s47
    ds_read_b128 v[80:83], v96 offset:26624
    s_add_u32 m0, s87, 61440
    s_add_u32 s78, s78, 128000
    ds_read_b128 v[84:87], v96 offset:27648
    v_mfma_f32_16x16x32_bf16 v[4:7], v[196:199], v[88:91], v[4:7]
    s_waitcnt lgkmcnt(15)
    ds_read_b128 v[88:91], v96 offset:28672
    ds_read_b64_tr_b16 v[242:243], v34 offset:29184
    v_mfma_f32_16x16x32_bf16 v[0:3], v[200:203], v[92:95], v[0:3]
    buffer_load_dwordx4 v46, s[16:19], s78 offen offset:0 sc1 lds
    ds_read_b64_tr_b16 v[244:245], v34 offset:28680
    ds_read_b64_tr_b16 v[246:247], v34 offset:29192
    v_mfma_f32_16x16x32_bf16 v[4:7], v[204:207], v[92:95], v[4:7]
    s_waitcnt lgkmcnt(7)
    ds_read_b128 v[92:95], v96 offset:29696
    ds_read_b64_tr_b16 v[248:249], v34 offset:32768
    v_mfma_f32_16x16x32_bf16 v[0:3], v[208:211], v[72:75], v[0:3]
    ds_read_b64_tr_b16 v[250:251], v34 offset:33280
    ds_read_b64_tr_b16 v[252:253], v34 offset:32776
    v_mfma_f32_16x16x32_bf16 v[4:7], v[212:215], v[72:75], v[4:7]
    s_waitcnt lgkmcnt(10)
    buffer_load_dwordx4 v46, s[16:19], s78 offen offset:1024 sc1 lds
    ds_read_b64_tr_b16 v[254:255], v34 offset:33288
    v_mfma_f32_16x16x32_bf16 v[0:3], v[216:219], v[76:79], v[0:3]
    v_mfma_f32_16x16x32_bf16 v[4:7], v[220:223], v[76:79], v[4:7]
    s_waitcnt lgkmcnt(10)
    v_mfma_f32_16x16x32_bf16 v[0:3], v[224:227], v[80:83], v[0:3]
    buffer_load_dwordx4 v46, s[16:19], s78 offen offset:2048 sc1 lds
    v_mfma_f32_16x16x32_bf16 v[4:7], v[228:231], v[80:83], v[4:7]
    s_waitcnt vmcnt(4) lgkmcnt(9)
    v_cmp_ne_u32 s[34:35], s46, v98
    v_mfma_f32_16x16x32_bf16 v[0:3], v[232:235], v[84:87], v[0:3]
    s_waitcnt lgkmcnt(0)
    s_barrier
    v_mfma_f32_16x16x32_bf16 v[4:7], v[236:239], v[84:87], v[4:7]
    ds_read_b128 v[72:75], v97 offset:0
    v_mfma_f32_16x16x32_bf16 v[0:3], v[240:243], v[88:91], v[0:3]
    ds_read_b128 v[76:79], v97 offset:1024
    v_mfma_f32_16x16x32_bf16 v[4:7], v[244:247], v[88:91], v[4:7]
    ds_read_b128 v[80:83], v97 offset:2048
    v_mfma_f32_16x16x32_bf16 v[0:3], v[248:251], v[92:95], v[0:3]
    ds_read_b128 v[84:87], v97 offset:3072
    v_mfma_f32_16x16x32_bf16 v[4:7], v[252:255], v[92:95], v[4:7]
    s_waitcnt lgkmcnt(3)
    ds_read_b128 v[88:91], v97 offset:4096
    v_mfma_f32_16x16x32_bf16 v[8:11], a[216:219], v[72:75], v[8:11]
    s_cmp_lg_u64 s[34:35], 0
    s_cbranch_scc1 Lre29
Lok27:
    ds_read_b128 v[92:95], v97 offset:5120
    v_mfma_f32_16x16x32_bf16 v[12:15], a[220:223], v[72:75], v[12:15]
    s_waitcnt lgkmcnt(4)
    v_cvt_pk_bf16_f32 v140, v0, v1
    v_cvt_pk_bf16_f32 v141, v2, v3
    v_mfma_f32_16x16x32_bf16 v[8:11], a[224:227], v[76:79], v[8:11]
    s_add_u32 s78, s87, s47
    v_cvt_pk_bf16_f32 v142, v4, v5
    v_cvt_pk_bf16_f32 v143, v6, v7
    v_mfma_f32_16x16x32_bf16 v[12:15], a[228:231], v[76:79], v[12:15]
    s_waitcnt lgkmcnt(3)
    s_add_u32 s80, s56, 29696
    v_mfma_f32_16x16x32_bf16 v[8:11], a[232:235], v[80:83], v[8:11]
    buffer_store_dwordx4 v[140:143], v46, s[16:19], s80 offen
    s_add_u32 m0, s87, 73728
    s_add_u32 s78, s78, 140288
    v_mfma_f32_16x16x32_bf16 v[12:15], a[236:239], v[80:83], v[12:15]
    s_waitcnt lgkmcnt(2)
    s_or_b32 s79, s46, 4
    v_mfma_f32_16x16x32_bf16 v[100:103], v[140:143], v[140:143], 0
    v_mfma_f32_16x16x32_bf16 v[146:149], v[36:39], v[140:143], 0
    s_nop 3
    v_cndmask_b32 v100, v100, v101, s[60:61]
    v_cndmask_b32 v102, v102, v103, s[60:61]
    s_nop 1
    v_mov_b32_e64 v149, s79
    v_cndmask_b32 v148, v100, v102, s[62:63]
    v_mfma_f32_16x16x32_bf16 v[8:11], a[240:243], v[84:87], v[8:11]
    s_waitcnt vmcnt(4)
    s_barrier
    v_mfma_f32_16x16x32_bf16 v[12:15], a[244:247], v[84:87], v[12:15]
    s_waitcnt lgkmcnt(1)
    ds_read_b128 v[72:75], v97 offset:12288
    v_mfma_f32_16x16x32_bf16 v[8:11], a[248:251], v[88:91], v[8:11]
    buffer_load_dwordx4 v46, s[16:19], s78 offen offset:0 sc1 lds
    ds_read_b128 v[76:79], v97 offset:13312
    v_mfma_f32_16x16x32_bf16 v[12:15], a[252:255], v[88:91], v[12:15]
    s_waitcnt lgkmcnt(2)
    ds_read_b128 v[80:83], v97 offset:14336
    v_mfma_f32_16x16x32_bf16 v[8:11], v[152:155], v[92:95], v[8:11]
    ds_read_b128 v[84:87], v97 offset:15360
    v_mfma_f32_16x16x32_bf16 v[12:15], v[156:159], v[92:95], v[12:15]
    s_waitcnt lgkmcnt(3)
    ds_read_b128 v[88:91], v97 offset:16384
    v_mfma_f32_16x16x32_bf16 v[8:11], v[160:163], v[72:75], v[8:11]
    buffer_load_dwordx4 v46, s[16:19], s78 offen offset:1024 sc1 lds
    ds_read_b128 v[92:95], v97 offset:17408
    v_mfma_f32_16x16x32_bf16 v[12:15], v[164:167], v[72:75], v[12:15]
    s_waitcnt lgkmcnt(4)
    v_mfma_f32_16x16x32_bf16 v[8:11], v[168:171], v[76:79], v[8:11]
    buffer_load_dwordx4 v46, s[16:19], s78 offen offset:2048 sc1 lds
    v_mfma_f32_16x16x32_bf16 v[12:15], v[172:175], v[76:79], v[12:15]
    s_waitcnt lgkmcnt(3)
    s_add_u32 s78, s87, s47
    v_mfma_f32_16x16x32_bf16 v[8:11], v[176:179], v[80:83], v[8:11]
    s_add_u32 m0, s87, 86016
    s_add_u32 s78, s78, 152576
    v_mfma_f32_16x16x32_bf16 v[12:15], v[180:183], v[80:83], v[12:15]
    s_waitcnt lgkmcnt(2)
    v_mfma_f32_16x16x32_bf16 v[8:11], v[184:187], v[84:87], v[8:11]
    s_waitcnt vmcnt(4)
    s_barrier
    v_mfma_f32_16x16x32_bf16 v[12:15], v[188:191], v[84:87], v[12:15]
    s_waitcnt lgkmcnt(1)
    ds_read_b128 v[72:75], v97 offset:24576
    v_mfma_f32_16x16x32_bf16 v[8:11], v[192:195], v[88:91], v[8:11]
    buffer_load_dwordx4 v46, s[16:19], s78 offen offset:0 sc1 lds
    ds_read_b128 v[76:79], v97 offset:25600
    v_mfma_f32_16x16x32_bf16 v[12:15], v[196:199], v[88:91], v[12:15]
    s_waitcnt lgkmcnt(2)
    ds_read_b128 v[80:83], v97 offset:26624
    v_mfma_f32_16x16x32_bf16 v[8:11], v[200:203], v[92:95], v[8:11]
    s_waitcnt vmcnt(4)
    buffer_store_dword v68, v57, s[16:19], s47 offen offset:960
    ds_read_b128 v[84:87], v97 offset:27648
    v_mfma_f32_16x16x32_bf16 v[12:15], v[204:207], v[92:95], v[12:15]
    s_waitcnt lgkmcnt(3)
    ds_read_b128 v[88:91], v97 offset:28672
    v_mfma_f32_16x16x32_bf16 v[8:11], v[208:211], v[72:75], v[8:11]
    buffer_load_dwordx4 v46, s[16:19], s78 offen offset:1024 sc1 lds
    ds_read_b128 v[92:95], v97 offset:29696
    v_mfma_f32_16x16x32_bf16 v[12:15], v[212:215], v[72:75], v[12:15]
    s_waitcnt lgkmcnt(4)
    v_mfma_f32_16x16x32_bf16 v[8:11], v[216:219], v[76:79], v[8:11]
    buffer_load_dwordx4 v46, s[16:19], s78 offen offset:2048 sc1 lds
    v_mfma_f32_16x16x32_bf16 v[12:15], v[220:223], v[76:79], v[12:15]
    s_waitcnt lgkmcnt(3)
    s_add_u32 s78, s87, s47
    v_mfma_f32_16x16x32_bf16 v[8:11], v[224:227], v[80:83], v[8:11]
    s_add_u32 m0, s87, 98304
    s_add_u32 s78, s78, 164864
    v_mfma_f32_16x16x32_bf16 v[12:15], v[228:231], v[80:83], v[12:15]
    s_waitcnt lgkmcnt(2)
    v_mfma_f32_16x16x32_bf16 v[8:11], v[232:235], v[84:87], v[8:11]
    s_waitcnt vmcnt(4)
    s_barrier
    v_mfma_f32_16x16x32_bf16 v[12:15], v[236:239], v[84:87], v[12:15]
    s_waitcnt lgkmcnt(1)
    v_add_u32 v96, 73728, v96
    v_mfma_f32_16x16x32_bf16 v[8:11], v[240:243], v[88:91], v[8:11]
    buffer_load_dwordx4 v46, s[16:19], s78 offen offset:0 sc1 lds
    ds_read_b128 v[72:75], v96 offset:0
    v_mfma_f32_16x16x32_bf16 v[12:15], v[244:247], v[88:91], v[12:15]
    s_waitcnt lgkmcnt(1)
    ds_read_b128 v[76:79], v96 offset:1024
    v_mfma_f32_16x16x32_bf16 v[8:11], v[248:251], v[92:95], v[8:11]
    ds_read_b128 v[80:83], v96 offset:2048
    v_mfma_f32_16x16x32_bf16 v[12:15], v[252:255], v[92:95], v[12:15]
    s_waitcnt lgkmcnt(2)
    ds_read_b128 v[84:87], v96 offset:3072
    v_mfma_f32_16x16x32_bf16 v[16:19], a[216:219], v[72:75], v[16:19]
    buffer_load_dwordx4 v46, s[16:19], s78 offen offset:1024 sc1 lds
    ds_read_b128 v[88:91], v96 offset:4096
    v_mfma_f32_16x16x32_bf16 v[20:23], a[220:223], v[72:75], v[20:23]
    s_waitcnt lgkmcnt(3)
    ds_read_b128 v[92:95], v96 offset:5120
    v_mfma_f32_16x16x32_bf16 v[16:19], a[224:227], v[76:79], v[16:19]
    buffer_load_dwordx4 v46, s[16:19], s78 offen offset:2048 sc1 lds
    v_mfma_f32_16x16x32_bf16 v[20:23], a[228:231], v[76:79], v[20:23]
    s_waitcnt lgkmcnt(3)
    buffer_load_dword v98, v59, s[16:19], s47 offen offset:960 sc1
    v_mfma_f32_16x16x32_bf16 v[16:19], a[232:235], v[80:83], v[16:19]
    v_mfma_f32_16x16x32_bf16 v[20:23], a[236:239], v[80:83], v[20:23]
    s_waitcnt lgkmcnt(2)
    v_mfma_f32_16x16x32_bf16 v[16:19], a[240:243], v[84:87], v[16:19]
    s_waitcnt vmcnt(4)
    s_barrier
    v_mfma_f32_16x16x32_bf16 v[20:23], a[244:247], v[84:87], v[20:23]
    s_waitcnt lgkmcnt(1)
    ds_read_b128 v[72:75], v96 offset:12288
    v_mfma_f32_16x16x32_bf16 v[16:19], a[248:251], v[88:91], v[16:19]
    buffer_store_dwordx4 v[146:149], v60, s[16:19], s47 offen offset:3072
    ds_read_b128 v[76:79], v96 offset:13312
    ds_read_b128 v[80:83], v96 offset:14336
    ds_read_b128 v[84:87], v96 offset:15360
    v_mfma_f32_16x16x32_bf16 v[20:23], a[252:255], v[88:91], v[20:23]
    s_waitcnt lgkmcnt(4)
    ds_read_b128 v[88:91], v96 offset:16384
    v_mfma_f32_16x16x32_bf16 v[16:19], v[152:155], v[92:95], v[16:19]
    s_mov_b32 exec_lo, 0xff00ff00
    s_mov_b32 exec_hi, 0xff00ff00
    buffer_store_dwordx4 v[140:143], v46, s[16:19], s57 offen
    s_mov_b64 exec, -1
    v_cvt_pk_bf16_f32 v116, v8, v9
    v_cvt_pk_bf16_f32 v117, v10, v11
    v_cvt_pk_bf16_f32 v118, v12, v13
    v_cvt_pk_bf16_f32 v119, v14, v15
    v_mfma_f32_16x16x32_bf16 v[20:23], v[156:159], v[92:95], v[20:23]
    s_waitcnt lgkmcnt(4)
    s_or_b32 s79, s46, 4
    v_mfma_f32_16x16x32_bf16 v[100:103], v[116:119], v[116:119], 0
    ds_read_b128 v[92:95], v96 offset:17408
    v_mfma_f32_16x16x32_bf16 v[104:107], v[36:39], v[116:119], 0
    s_nop 3
    v_cndmask_b32 v100, v100, v101, s[60:61]
    v_cndmask_b32 v102, v102, v103, s[60:61]
    s_nop 1
    v_mov_b32 v107, s79
    v_mfma_f32_16x16x32_bf16 v[16:19], v[160:163], v[72:75], v[16:19]
    v_mfma_f32_16x16x32_bf16 v[20:23], v[164:167], v[72:75], v[20:23]
    s_waitcnt vmcnt(2) lgkmcnt(4)
    v_cmp_ne_u32 s[34:35], s46, v98
    v_cndmask_b32 v106, v100, v102, s[62:63]
    v_mfma_f32_16x16x32_bf16 v[16:19], v[168:171], v[76:79], v[16:19]
    buffer_store_dwordx4 v[104:107], v60, s[16:19], s47 offen offset:2560
    v_mfma_f32_16x16x32_bf16 v[20:23], v[172:175], v[76:79], v[20:23]
    s_waitcnt lgkmcnt(3)
    v_mfma_f32_16x16x32_bf16 v[16:19], v[176:179], v[80:83], v[16:19]
    s_cmp_lg_u64 s[34:35], 0
    s_cbranch_scc1 Lre36
Lok34:
    v_mfma_f32_16x16x32_bf16 v[20:23], v[180:183], v[80:83], v[20:23]
    s_waitcnt lgkmcnt(2)
    s_add_u32 s78, s87, s47
    v_mfma_f32_16x16x32_bf16 v[16:19], v[184:187], v[84:87], v[16:19]
    s_barrier
    v_mfma_f32_16x16x32_bf16 v[20:23], v[188:191], v[84:87], v[20:23]
    s_waitcnt lgkmcnt(1)
    ds_read_b128 v[72:75], v96 offset:24576
    v_mfma_f32_16x16x32_bf16 v[16:19], v[192:195], v[88:91], v[16:19]
    s_add_u32 m0, s87, 0
    s_add_u32 s78, s78, 29696
    ds_read_b128 v[76:79], v96 offset:25600
    v_mfma_f32_16x16x32_bf16 v[20:23], v[196:199], v[88:91], v[20:23]
    s_waitcnt lgkmcnt(2)
    ds_read_b128 v[80:83], v96 offset:26624
    v_mfma_f32_16x16x32_bf16 v[16:19], v[200:203], v[92:95], v[16:19]
    buffer_load_dwordx4 v46, s[16:19], s78 offen offset:0 sc1 lds
    ds_read_b128 v[84:87], v96 offset:27648
    v_mfma_f32_16x16x32_bf16 v[20:23], v[204:207], v[92:95], v[20:23]
    s_waitcnt lgkmcnt(3)
    ds_read_b128 v[88:91], v96 offset:28672
    v_mfma_f32_16x16x32_bf16 v[16:19], v[208:211], v[72:75], v[16:19]
    buffer_load_dwordx4 v46, s[16:19], s78 offen offset:1024 sc1 lds
    ds_read_b128 v[92:95], v96 offset:29696
    v_mfma_f32_16x16x32_bf16 v[20:23], v[212:215], v[72:75], v[20:23]
    s_waitcnt lgkmcnt(4)
    v_mfma_f32_16x16x32_bf16 v[16:19], v[216:219], v[76:79], v[16:19]
    v_mfma_f32_16x16x32_bf16 v[20:23], v[220:223], v[76:79], v[20:23]
    s_waitcnt lgkmcnt(3)
    v_mfma_f32_16x16x32_bf16 v[16:19], v[224:227], v[80:83], v[16:19]
    buffer_load_dwordx4 v46, s[16:19], s78 offen offset:2048 sc1 lds
    s_add_u32 s78, s87, s47
    v_mfma_f32_16x16x32_bf16 v[20:23], v[228:231], v[80:83], v[20:23]
    s_waitcnt lgkmcnt(2)
    s_add_u32 m0, s87, 12288
    s_add_u32 s78, s78, 41984
    v_mfma_f32_16x16x32_bf16 v[16:19], v[232:235], v[84:87], v[16:19]
    v_mfma_f32_16x16x32_bf16 v[20:23], v[236:239], v[84:87], v[20:23]
    s_waitcnt lgkmcnt(1)
    v_mfma_f32_16x16x32_bf16 v[16:19], v[240:243], v[88:91], v[16:19]
    buffer_load_dwordx4 v46, s[16:19], s78 offen offset:0 sc1 lds
    v_mfma_f32_16x16x32_bf16 v[20:23], v[244:247], v[88:91], v[20:23]
    s_waitcnt lgkmcnt(0)
    v_mfma_f32_16x16x32_bf16 v[16:19], v[248:251], v[92:95], v[16:19]
    v_mfma_f32_16x16x32_bf16 v[20:23], v[252:255], v[92:95], v[20:23]
    buffer_load_dwordx4 v46, s[16:19], s78 offen offset:1024 sc1 lds
    buffer_load_dwordx4 v46, s[16:19], s78 offen offset:2048 sc1 lds
    buffer_load_dwordx4 v[128:131], v61, s[16:19], s47 offen offset:3072 sc1
    s_add_u32 s81, s47, 12288
    buffer_load_dwordx4 v[132:135], v61, s[16:19], s81 offen offset:3072 sc1
    s_add_u32 s81, s47, 24576
    buffer_load_dwordx4 v[136:139], v69, s[16:19], s81 offen offset:3072 sc1
    s_add_u32 s78, s87, s47
    s_nop 0
    s_add_u32 m0, s87, 24576
    s_add_u32 s78, s78, 54272
    buffer_load_dwordx4 v46, s[16:19], s78 offen offset:0 sc1 lds
    v_cvt_pk_bf16_f32 v112, v16, v17
    v_cvt_pk_bf16_f32 v113, v18, v19
    v_cvt_pk_bf16_f32 v114, v20, v21
    v_cvt_pk_bf16_f32 v115, v22, v23
    s_or_b32 s79, s46, 4
    s_nop 0
    v_mfma_f32_16x16x32_bf16 v[100:103], v[112:115], v[112:115], 0
    v_mfma_f32_16x16x32_bf16 v[120:123], v[36:39], v[112:115], 0
    buffer_load_dwordx4 v46, s[16:19], s78 offen offset:1024 sc1 lds
    s_nop 2
    v_cndmask_b32 v100, v100, v101, s[60:61]
    v_cndmask_b32 v102, v102, v103, s[60:61]
    s_nop 1
    v_mov_b32_e64 v123, s79
    v_cndmask_b32 v122, v100, v102, s[62:63]
    buffer_load_dwordx4 v46, s[16:19], s78 offen offset:2048 sc1 lds
    v_add_u32 v96, 36864, v46
    v_add_u32 v97, 73728, v46
    buffer_store_dwordx4 v[120:123], v60, s[16:19], s47 offen offset:2048
    s_waitcnt vmcnt(10)
    s_barrier
    ds_read_b128 v[72:75], v46 offset:0
    ds_read_b128 v[76:79], v46 offset:1024
    ds_read_b128 v[80:83], v46 offset:2048
    ds_read_b128 v[84:87], v46 offset:3072
    ds_read_b128 v[88:91], v46 offset:4096
    ds_read_b128 v[92:95], v46 offset:5120
    s_waitcnt lgkmcnt(5)
    v_mfma_f32_16x16x32_bf16 v[100:103], a[0:3], v[72:75], 0
    s_add_u32 s80, s56, 66560
    v_mfma_f32_16x16x32_bf16 v[104:107], a[4:7], v[72:75], 0
    v_mfma_f32_16x16x32_bf16 v[108:111], v[72:75], a[8:11], 0
    s_waitcnt lgkmcnt(4)
    v_mfma_f32_16x16x32_bf16 v[100:103], a[12:15], v[76:79], v[100:103]
    buffer_store_dwordx4 v[116:119], v46, s[16:19], s80 offen
    v_mfma_f32_16x16x32_bf16 v[104:107], a[16:19], v[76:79], v[104:107]
    v_mfma_f32_16x16x32_bf16 v[108:111], v[76:79], a[20:23], v[108:111]
    s_waitcnt lgkmcnt(3)
    v_mfma_f32_16x16x32_bf16 v[100:103], a[24:27], v[80:83], v[100:103]
    v_mfma_f32_16x16x32_bf16 v[104:107], a[28:31], v[80:83], v[104:107]
    v_mfma_f32_16x16x32_bf16 v[108:111], v[80:83], a[32:35], v[108:111]
    s_waitcnt lgkmcnt(2)
    v_mfma_f32_16x16x32_bf16 v[100:103], a[36:39], v[84:87], v[100:103]
    s_waitcnt vmcnt(8)
    s_barrier
    ds_read_b128 v[72:75], v46 offset:12288
    v_mfma_f32_16x16x32_bf16 v[104:107], a[40:43], v[84:87], v[104:107]
    buffer_load_dwordx4 v[140:143], v61, s[16:19], s47 offen offset:2560 sc1
    ds_read_b128 v[76:79], v46 offset:13312
    v_mfma_f32_16x16x32_bf16 v[108:111], v[84:87], a[44:47], v[108:111]
    s_waitcnt lgkmcnt(3)
    ds_read_b128 v[80:83], v46 offset:14336
    v_mfma_f32_16x16x32_bf16 v[100:103], a[48:51], v[88:91], v[100:103]
    ds_read_b128 v[84:87], v46 offset:15360
    v_mfma_f32_16x16x32_bf16 v[104:107], a[52:55], v[88:91], v[104:107]
    v_mfma_f32_16x16x32_bf16 v[108:111], v[88:91], a[56:59], v[108:111]
    s_waitcnt lgkmcnt(4)
    ds_read_b128 v[88:91], v46 offset:16384
    v_mfma_f32_16x16x32_bf16 v[100:103], a[60:63], v[92:95], v[100:103]
    s_add_u32 s81, s47, 12288
    buffer_load_dwordx4 v[144:147], v61, s[16:19], s81 offen offset:2560 sc1
    v_mfma_f32_16x16x32_bf16 v[104:107], a[64:67], v[92:95], v[104:107]
    v_mfma_f32_16x16x32_bf16 v[108:111], v[92:95], a[68:71], v[108:111]
    s_waitcnt lgkmcnt(4)
    ds_read_b128 v[92:95], v46 offset:17408
    v_mfma_f32_16x16x32_bf16 v[100:103], a[72:75], v[72:75], v[100:103]
    s_add_u32 s81, s47, 24576
    buffer_load_dwordx4 v[148:151], v69, s[16:19], s81 offen offset:2560 sc1
    v_mfma_f32_16x16x32_bf16 v[104:107], a[76:79], v[72:75], v[104:107]
    s_waitcnt vmcnt(9)
    v_cmp_ne_u32 s[74:75], s79, v131
    v_cmp_ne_u32 s[92:93], s79, v135
    v_mfma_f32_16x16x32_bf16 v[108:111], v[72:75], a[80:83], v[108:111]
    s_waitcnt vmcnt(8) lgkmcnt(4)
    v_cmp_ne_u32 vcc, s79, v139
    s_or_b64 s[74:75], s[74:75], s[92:93]
    v_mfma_f32_16x16x32_bf16 v[100:103], a[84:87], v[76:79], v[100:103]
    s_and_b32 s92, vcc_lo, 0xffff
    s_or_b32 s74, s74, s75
    v_mfma_f32_16x16x32_bf16 v[104:107], a[88:91], v[76:79], v[104:107]
    s_or_b32 s74, s74, s92
    s_cbranch_scc1 Lre58
Lok56:
    v_add_f32 v128, v128, v132
    v_mfma_f32_16x16x32_bf16 v[108:111], v[76:79], a[92:95], v[108:111]
    s_waitcnt lgkmcnt(3)
    v_add_f32 v129, v129, v133
    v_add_f32 v130, v130, v134
    v_mfma_f32_16x16x32_bf16 v[100:103], a[96:99], v[80:83], v[100:103]
    v_add_f32 v124, v128, v136
    v_add_f32 v125, v129, v137
    v_mfma_f32_16x16x32_bf16 v[104:107], a[100:103], v[80:83], v[104:107]
    v_add_f32 v126, v130, v138
    v_mfma_f32_16x16x32_bf16 v[108:111], v[80:83], a[104:107], v[108:111]
    s_waitcnt lgkmcnt(2)
    buffer_load_dwordx4 v[128:131], v61, s[16:19], s47 offen offset:2048 sc1
    v_mfma_f32_16x16x32_bf16 v[100:103], a[108:111], v[84:87], v[100:103]
    s_waitcnt vmcnt(6)
    s_barrier
    ds_read_b128 v[72:75], v46 offset:24576
    v_mfma_f32_16x16x32_bf16 v[104:107], a[112:115], v[84:87], v[104:107]
    s_waitcnt vmcnt(4)
    buffer_store_dword v68, v57, s[16:19], s47 offen offset:1120
    ds_read_b128 v[76:79], v46 offset:25600
    v_mfma_f32_16x16x32_bf16 v[108:111], v[84:87], a[116:119], v[108:111]
    s_waitcnt lgkmcnt(3)
    ds_read_b128 v[80:83], v46 offset:26624
    v_mfma_f32_16x16x32_bf16 v[100:103], a[120:123], v[88:91], v[100:103]
    ds_read_b128 v[84:87], v46 offset:27648
    v_mfma_f32_16x16x32_bf16 v[104:107], a[124:127], v[88:91], v[104:107]
    s_add_u32 s81, s47, 12288
    buffer_load_dwordx4 v[132:135], v61, s[16:19], s81 offen offset:2048 sc1
    v_mfma_f32_16x16x32_bf16 v[108:111], v[88:91], a[128:131], v[108:111]
    s_waitcnt lgkmcnt(4)
    ds_read_b128 v[88:91], v46 offset:28672
    v_mfma_f32_16x16x32_bf16 v[100:103], a[132:135], v[92:95], v[100:103]
    s_add_u32 s81, s47, 24576
    buffer_load_dwordx4 v[136:139], v69, s[16:19], s81 offen offset:2048 sc1
    v_mfma_f32_16x16x32_bf16 v[104:107], a[136:139], v[92:95], v[104:107]
    s_add_u32 s80, s56, 103424
    v_mfma_f32_16x16x32_bf16 v[108:111], v[92:95], a[140:143], v[108:111]
    s_waitcnt lgkmcnt(4)
    ds_read_b128 v[92:95], v46 offset:29696
    v_mfma_f32_16x16x32_bf16 v[100:103], a[144:147], v[72:75], v[100:103]
    buffer_store_dwordx4 v[112:115], v46, s[16:19], s80 offen
    v_mfma_f32_16x16x32_bf16 v[104:107], a[148:151], v[72:75], v[104:107]
    s_waitcnt vmcnt(6)
    v_cmp_ne_u32 s[74:75], s79, v143
    v_cmp_ne_u32 s[92:93], s79, v147
    v_mfma_f32_16x16x32_bf16 v[108:111], v[72:75], a[152:155], v[108:111]
    s_waitcnt vmcnt(5) lgkmcnt(4)
    ds_read_b128 v[72:75], v46 offset:6144
    v_cmp_ne_u32 vcc, s79, v151
    v_mfma_f32_16x16x32_bf16 v[100:103], a[156:159], v[76:79], v[100:103]
    s_or_b64 s[74:75], s[74:75], s[92:93]
    s_and_b32 s92, vcc_lo, 0xffff
    s_or_b32 s74, s74, s75
    v_mfma_f32_16x16x32_bf16 v[104:107], a[160:163], v[76:79], v[104:107]
    s_or_b32 s74, s74, s92
    s_cbranch_scc1 Lre61
Lok59:
    v_add_f32 v140, v140, v144
    v_mfma_f32_16x16x32_bf16 v[108:111], v[76:79], a[164:167], v[108:111]
    s_waitcnt lgkmcnt(4)
    ds_read_b128 v[76:79], v46 offset:7168
    v_add_f32 v141, v141, v145
    v_mfma_f32_16x16x32_bf16 v[100:103], a[168:171], v[80:83], v[100:103]
    buffer_load_dword v33, v59, s[16:19], s47 offen offset:1120 sc1
    v_add_f32 v142, v142, v146
    v_mfma_f32_16x16x32_bf16 v[104:107], a[172:175], v[80:83], v[104:107]
    v_add_f32 v140, v140, v148
    v_add_f32 v141, v141, v149
    v_mfma_f32_16x16x32_bf16 v[108:111], v[80:83], a[176:179], v[108:111]
    s_waitcnt lgkmcnt(4)
    ds_read_b128 v[80:83], v46 offset:8192
    v_add_f32 v142, v142, v150
    v_mfma_f32_16x16x32_bf16 v[100:103], a[180:183], v[84:87], v[100:103]
    v_permlane32_swap_b32 v124, v140
    v_mfma_f32_16x16x32_bf16 v[104:107], a[184:187], v[84:87], v[104:107]
    v_permlane32_swap_b32 v125, v141
    v_mfma_f32_16x16x32_bf16 v[108:111], v[84:87], a[188:191], v[108:111]
    s_waitcnt lgkmcnt(4)
    ds_read_b128 v[84:87], v46 offset:9216
    v_mfma_f32_16x16x32_bf16 v[100:103], a[192:195], v[88:91], v[100:103]
    v_permlane32_swap_b32 v126, v142
    v_mfma_f32_16x16x32_bf16 v[104:107], a[196:199], v[88:91], v[104:107]
    v_add_f32 v124, v124, v140
    v_add_f32 v125, v125, v141
    v_mfma_f32_16x16x32_bf16 v[108:111], v[88:91], a[200:203], v[108:111]
    s_waitcnt lgkmcnt(4)
    ds_read_b128 v[88:91], v46 offset:10240
    v_add_f32 v126, v126, v142
    v_mfma_f32_16x16x32_bf16 v[100:103], a[204:207], v[92:95], v[100:103]
    s_waitcnt vmcnt(2)
    v_cmp_ne_u32 s[74:75], s79, v131
    v_cmp_ne_u32 s[92:93], s79, v135
    v_cmp_ne_u32 vcc, s79, v139
    v_mfma_f32_16x16x32_bf16 v[104:107], a[208:211], v[92:95], v[104:107]
    s_or_b64 s[74:75], s[74:75], s[92:93]
    s_and_b32 s92, vcc_lo, 0xffff
    s_or_b32 s74, s74, s75
    s_or_b32 s74, s74, s92
    s_cbranch_scc1 Lre64
Lok62:
    v_mfma_f32_16x16x32_bf16 v[108:111], v[92:95], a[212:215], v[108:111]
    s_waitcnt lgkmcnt(4)
    ds_read_b128 v[92:95], v46 offset:11264
    v_add_f32 v128, v128, v132
    v_add_f32 v129, v129, v133
    v_add_f32_e64 v130, v130, v134
    v_mfma_f32_16x16x32_bf16 v[112:115], a[0:3], v[72:75], 0
    v_add_f32 v128, v128, v136
    v_add_f32 v129, v129, v137
    v_add_f32 v130, v130, v138
    v_mov_b32 v132, v128
    v_mfma_f32_16x16x32_bf16 v[116:119], a[4:7], v[72:75], 0
    v_mov_b32 v133, v129
    v_mov_b32 v134, v130
    v_permlane32_swap_b32 v128, v132
    v_mfma_f32_16x16x32_bf16 v[120:123], v[72:75], a[8:11], 0
    s_waitcnt vmcnt(0) lgkmcnt(4)
    ds_read_b128 v[72:75], v46 offset:18432
    v_cmp_ne_u32 s[34:35], s46, v33
    v_permlane32_swap_b32 v129, v133
    v_mfma_f32_16x16x32_bf16 v[112:115], a[12:15], v[76:79], v[112:115]
    v_permlane32_swap_b32 v130, v134
    v_add_f32 v128, v128, v132
    v_add_f32 v129, v129, v133
    v_mfma_f32_16x16x32_bf16 v[116:119], a[16:19], v[76:79], v[116:119]
    v_add_f32_e64 v130, v130, v134
    v_permlane16_swap_b32 v124, v128
    v_mfma_f32_16x16x32_bf16 v[120:123], v[76:79], a[20:23], v[120:123]
    s_waitcnt lgkmcnt(4)
    ds_read_b128 v[76:79], v46 offset:19456
    Lw4: s_cbranch_execz Lw8
    s_cmp_lg_u64 s[34:35], 0
    s_cbranch_scc1 Lre43
Lok41:
    v_mfma_f32_16x16x32_bf16 v[112:115], a[24:27], v[80:83], v[112:115]
    s_cmp_eq_u32 s44, 0
    s_cselect_b32 s76, 0, -1
    s_and_b32 s94, s76, 262144
    s_sub_u32 s94, s47, s94
    s_add_u32 s78, s87, s47
    v_mfma_f32_16x16x32_bf16 v[116:119], a[28:31], v[80:83], v[116:119]
    s_cmp_eq_u32 s53, 0
    s_cselect_b32 s77, s76, 0
    s_and_b32 s77, s77, 76800
    v_add_u32_e64 v71, s77, v46
    v_mfma_f32_16x16x32_bf16 v[120:123], v[80:83], a[32:35], v[120:123]
    s_waitcnt lgkmcnt(4)
    ds_read_b128 v[80:83], v46 offset:20480
    v_mov_b32_dpp v71, v46 quad_perm:[0,1,2,3] row_mask:0xf bank_mask:0xc
    s_add_u32 m0, s87, 36864
    s_add_u32 s78, s78, 66560
    v_mfma_f32_16x16x32_bf16 v[112:115], a[36:39], v[84:87], v[112:115]
    buffer_store_dword v68, v57, s[16:19], s47 offen offset:1280
    buffer_load_dwordx4 v46, s[16:19], s78 offen offset:0 sc1 lds
    v_mfma_f32_16x16x32_bf16 v[116:119], a[40:43], v[84:87], v[116:119]
    buffer_load_dwordx4 v46, s[16:19], s78 offen offset:1024 sc1 lds
    v_permlane16_swap_b32 v125, v129
    v_mfma_f32_16x16x32_bf16 v[120:123], v[84:87], a[44:47], v[120:123]
    s_waitcnt lgkmcnt(4)
    ds_read_b128 v[84:87], v46 offset:21504
    v_permlane16_swap_b32 v126, v130
    v_add_f32 v124, v124, v128
    v_mfma_f32_16x16x32_bf16 v[112:115], a[48:51], v[88:91], v[112:115]
    v_add_f32 v125, v125, v129
    v_add_f32 v126, v126, v130
    v_add_f32_dpp v124, v124, v124 row_ror:8 row_mask:0xf bank_mask:0xf
    v_add_f32_dpp v125, v125, v125 row_ror:8 row_mask:0xf bank_mask:0xf
    v_mfma_f32_16x16x32_bf16 v[116:119], a[52:55], v[88:91], v[116:119]
    buffer_load_dwordx4 v46, s[16:19], s78 offen offset:2048 sc1 lds
    v_add_f32_dpp v126, v126, v126 row_ror:8 row_mask:0xf bank_mask:0xf
    v_mul_f32 v124, 0xbae38e39, v124
    v_mul_f32 v126, 0x3ae38e39, v126
    v_mfma_f32_16x16x32_bf16 v[120:123], v[88:91], a[56:59], v[120:123]
    s_waitcnt lgkmcnt(4)
    ds_read_b128 v[88:91], v46 offset:22528
    s_add_u32 s78, s87, s47
    s_add_u32 m0, s87, 49152
    s_add_u32 s78, s78, 78848
    v_mfma_f32_16x16x32_bf16 v[112:115], a[60:63], v[92:95], v[112:115]
    v_fma_f32 v126, -v124, v124, v126
    v_max_f32_e64 v126, 0, v126
    v_add_f32 v132, 0x3727c5ac, v126
    v_mfma_f32_16x16x32_bf16 v[116:119], a[64:67], v[92:95], v[116:119]
    buffer_load_dwordx4 v46, s[16:19], s78 offen offset:0 sc1 lds
    v_rsq_f32_e64 v132, v132
    v_fmac_f32 v125, s50, v124
    v_mfma_f32_16x16x32_bf16 v[120:123], v[92:95], a[68:71], v[120:123]
    s_waitcnt lgkmcnt(4)
    ds_read_b128 v[92:95], v46 offset:23552
    v_mov_b32 v127, 162816
    v_mul_f32 v125, v125, v132
    v_mul_f32 v133, v124, v132
    v_mfma_f32_16x16x32_bf16 v[112:115], a[72:75], v[72:75], v[112:115]
    v_ashrrev_i32 v134, 31, v125
    v_or_b32 v134, 0x80000000, v134
    v_xor_b32 v125, v125, v134
    v_and_b32 v125, 0xfffff800, v125
    v_mfma_f32_16x16x32_bf16 v[116:119], a[76:79], v[72:75], v[116:119]
    buffer_load_dwordx4 v46, s[16:19], s78 offen offset:1024 sc1 lds
    v_or_b32 v125, v125, v67
    v_cndmask_b32 v125, 0, v125, s[88:89]
    v_mfma_f32_16x16x32_bf16 v[120:123], v[72:75], a[80:83], v[120:123]
    s_waitcnt lgkmcnt(4)
    ds_read_b128 v[72:75], v46 offset:30720
    buffer_load_dword v33, v59, s[16:19], s47 offen offset:1280 sc1
    buffer_load_dword v34, v59, s[16:19], s94 offen offset:1120 sc1
    v_mfma_f32_16x16x32_bf16 v[112:115], a[84:87], v[76:79], v[112:115]
    ds_write_b32 v66, v132 offset:768
    v_mfma_f32_16x16x32_bf16 v[116:119], a[88:91], v[76:79], v[116:119]
    ds_write_b32 v66, v133 offset:1152
    v_max_u32_dpp v125, v125, v125 row_ror:1 row_mask:0xf bank_mask:0xf
    v_add_f32 v134, 1.0, v132
    v_mfma_f32_16x16x32_bf16 v[120:123], v[76:79], a[92:95], v[120:123]
    s_waitcnt lgkmcnt(6)
    ds_read_b128 v[76:79], v46 offset:31744
    v_mul_f32 v126, v126, v134
    v_mfma_f32_16x16x32_bf16 v[112:115], a[96:99], v[80:83], v[112:115]
    buffer_load_dwordx4 v46, s[16:19], s78 offen offset:2048 sc1 lds
    s_add_u32 s78, s87, s47
    s_add_u32 m0, s87, 61440
    s_add_u32 s78, s78, 91136
    v_mfma_f32_16x16x32_bf16 v[116:119], a[100:103], v[80:83], v[116:119]
    v_max_u32_dpp v125, v125, v125 row_ror:2 row_mask:0xf bank_mask:0xf
    v_fmaak_f32 v126, v126, v134, 0x3727c5ac
    v_rsq_f32 v126, v126
    v_mfma_f32_16x16x32_bf16 v[120:123], v[80:83], a[104:107], v[120:123]
    s_waitcnt lgkmcnt(6)
    ds_read_b128 v[80:83], v46 offset:32768
    v_max_u32_dpp v125, v125, v125 row_ror:4 row_mask:0xf bank_mask:0xf
    v_mfma_f32_16x16x32_bf16 v[112:115], a[108:111], v[84:87], v[112:115]
    buffer_load_dwordx4 v46, s[16:19], s78 offen offset:0 sc1 lds
    v_mfma_f32_16x16x32_bf16 v[116:119], a[112:115], v[84:87], v[116:119]
    s_mov_b32 exec_lo, 0x10001
    s_mov_b32 exec_hi, 1
    ds_max_u32 v127, v125
    s_mov_b64 exec, -1
    v_mfma_f32_16x16x32_bf16 v[120:123], v[84:87], a[116:119], v[120:123]
    s_waitcnt lgkmcnt(7)
    ds_read_b128 v[84:87], v46 offset:33792
    v_mul_f32 v134, v134, v126
    v_mfma_f32_16x16x32_bf16 v[112:115], a[120:123], v[88:91], v[112:115]
    buffer_load_dwordx4 v46, s[16:19], s78 offen offset:1024 sc1 lds
    ds_write2_b32 v66, v134, v124 offset1:96
    v_mfma_f32_16x16x32_bf16 v[116:119], a[124:127], v[88:91], v[116:119]
    s_lshl_b32 s81, s53, 6
    s_add_u32 s81, s81, 768
    v_add_u32 v99, s81, v49
    v_mov_b32 v135, v124
    v_mov_b32 v136, s79
    v_mfma_f32_16x16x32_bf16 v[120:123], v[88:91], a[128:131], v[120:123]
    s_waitcnt lgkmcnt(8)
    ds_read_b128 v[88:91], v46 offset:34816
    s_add_u32 s81, s47, 479232
    s_cmp_eq_u32 s57, 1073741824
    s_cselect_b32 s82, 0, s52
    v_mfma_f32_16x16x32_bf16 v[112:115], a[132:135], v[92:95], v[112:115]
    s_waitcnt vmcnt(4)
    v_cmp_ne_u32 s[34:35], s46, v33
    s_mul_i32 s82, s82, 255
    buffer_load_dwordx4 v46, s[16:19], s78 offen offset:2048 sc1 lds
    v_mfma_f32_16x16x32_bf16 v[116:119], a[136:139], v[92:95], v[116:119]
    s_mov_b32 exec_lo, s82
    s_mov_b32 exec_hi, 0
    buffer_store_dwordx3 v[134:136], v46, s[16:19], s81 offen
    s_mov_b64 exec, -1
    s_waitcnt lgkmcnt(1)
    s_barrier
    v_mfma_f32_16x16x32_bf16 v[120:123], v[92:95], a[140:143], v[120:123]
    ds_read_b128 v[92:95], v46 offset:35840
    ds_read_b32 v98, v127
    v_mfma_f32_16x16x32_bf16 v[112:115], a[144:147], v[72:75], v[112:115]
    s_waitcnt vmcnt(5)
    s_cmp_lg_u64 s[34:35], 0
    s_cbranch_scc1 Lre50
Lok48:
    ds_read2_b32 v[124:125], v99 offset0:64 offset1:160
    v_cmp_ne_u32 s[34:35], s46, v34
    v_mfma_f32_16x16x32_bf16 v[116:119], a[148:151], v[72:75], v[116:119]
    ds_read2_b32 v[126:127], v99 offset0:32 offset1:128
    ds_read2_b32 v[128:129], v99 offset0:0 offset1:96
    s_mul_i32 s82, s42, 512
    v_mfma_f32_16x16x32_bf16 v[120:123], v[72:75], a[152:155], v[120:123]
    s_add_u32 s82, s82, 786432
    s_or_b32 s81, s41, s40
    s_cselect_b32 s82, 1073741824, s82
    v_mov_b32_e64 v99, s46
    v_mfma_f32_16x16x32_bf16 v[112:115], a[156:159], v[76:79], v[112:115]
    s_cmp_lg_u64 s[34:35], 0
    s_cbranch_scc1 Lre54
Lok52:
    v_mfma_f32_16x16x32_bf16 v[116:119], a[160:163], v[76:79], v[116:119]
    s_waitcnt lgkmcnt(3)
    s_mov_b64 exec, 1
    buffer_store_dwordx2 v[98:99], v46, s[16:19], s82 offen sc1
    s_mov_b64 exec, -1
    v_readfirstlane_b32 s54, v98
    v_mfma_f32_16x16x32_bf16 v[120:123], v[76:79], a[164:167], v[120:123]
    s_mul_i32 s80, s42, 2304
    s_add_u32 s80, s80, 40960
    s_and_b32 s55, s54, 0x7ff
    s_sub_u32 s55, s86, s55
    s_lshr_b32 s55, s55, 1
    v_mfma_f32_16x16x32_bf16 v[112:115], a[168:171], v[80:83], v[112:115]
    s_waitcnt lgkmcnt(0)
    s_bfe_u32 s82, s55, 0x10004
    v_mov_b32_e64 v130, v128
    s_cmp_eq_u32 s82, s53
    s_cbranch_scc0 Lnc65
    s_and_b32 s81, s55, 15
    s_lshl_b32 s74, 0x10001, s81
    s_mov_b32 s75, s74
    s_and_b32 s81, s81, 14
    s_lshl_b32 s92, 0x30003, s81
    s_mov_b32 s93, s92
    s_lshr_b32 s81, s55, 5
    s_cmp_eq_u32 s81, 1
    s_cbranch_scc1 Lsa66
    s_cmp_eq_u32 s81, 0
    s_cbranch_scc1 Lsb67
    v_fma_f32 v130, v0, v124, v125
    v_fma_f32 v131, v1, v124, v125
    v_fma_f32 v132, v2, v124, v125
    v_fma_f32 v133, v3, v124, v125
    v_fma_f32 v134, v4, v124, v125
    v_fma_f32 v135, v5, v124, v125
    v_fma_f32 v136, v6, v124, v125
    v_fma_f32 v137, v7, v124, v125
    s_branch Lsj68
Lsa66:
    v_fma_f32 v130, v8, v126, v127
    v_fma_f32 v131, v9, v126, v127
    v_fma_f32 v132, v10, v126, v127
    v_fma_f32 v133, v11, v126, v127
    v_fma_f32 v134, v12, v126, v127
    v_fma_f32 v135, v13, v126, v127
    v_fma_f32 v136, v14, v126, v127
    v_fma_f32 v137, v15, v126, v127
    s_branch Lsj68
Lsb67:
    v_fma_f32 v130, v16, v128, v129
    v_fma_f32 v131, v17, v128, v129
    v_fma_f32 v132, v18, v128, v129
    v_fma_f32 v133, v19, v128, v129
    v_fma_f32 v134, v20, v128, v129
    v_fma_f32 v135, v21, v128, v129
    v_fma_f32 v136, v22, v128, v129
    v_fma_f32 v137, v23, v128, v129
Lsj68:
    v_cvt_pk_bf16_f32 v130, v130, v131
    v_cvt_pk_bf16_f32 v131, v132, v133
    v_cvt_pk_bf16_f32 v132, v134, v135
    v_cvt_pk_bf16_f32 v133, v136, v137
    s_mov_b64 vcc, s[74:75]
    s_lshl1_add_u32 s82, s41, s52
    s_lshl_b32 s82, s82, 7
    s_add_u32 s82, s82, s80
    v_or_b32 v134, 16, v65
    v_cndmask_b32 v134, v134, v65, vcc
    v_cndmask_b32_dpp v130, v132, v130, vcc quad_perm:[1,0,3,2] row_mask:0xf bank_mask:0xf
    v_cndmask_b32_dpp v131, v133, v131, vcc quad_perm:[1,0,3,2] row_mask:0xf bank_mask:0xf
    v_mov_b32_e64 v132, s54
    v_mov_b32 v133, s46
    s_mov_b64 exec, s[92:93]
    buffer_store_dwordx4 v[130:133], v134, s[16:19], s82 offen sc1
    s_mov_b64 exec, -1
Lnc65:
    v_mfma_f32_16x16x32_bf16 v[116:119], a[172:175], v[80:83], v[116:119]
    v_add_f32 v124, 1.0, v124
    v_fma_f32 v0, v0, v124, v125
    v_mfma_f32_16x16x32_bf16 v[120:123], v[80:83], a[176:179], v[120:123]
    v_fma_f32 v1, v1, v124, v125
    v_fma_f32 v2, v2, v124, v125
    v_mfma_f32_16x16x32_bf16 v[112:115], a[180:183], v[84:87], v[112:115]
    s_barrier
    ds_read_b128 v[72:75], v96 offset:6144
    v_mfma_f32_16x16x32_bf16 v[116:119], a[184:187], v[84:87], v[116:119]
    s_nop 0
    ds_read_b128 v[76:79], v96 offset:7168
    v_fma_f32 v3, v3, v124, v125
    v_mfma_f32_16x16x32_bf16 v[120:123], v[84:87], a[188:191], v[120:123]
    ds_read_b128 v[80:83], v96 offset:8192
    v_fma_f32 v4, v4, v124, v125
    v_mfma_f32_16x16x32_bf16 v[112:115], a[192:195], v[88:91], v[112:115]
    ds_read_b128 v[84:87], v96 offset:9216
    v_fma_f32 v5, v5, v124, v125
    v_mfma_f32_16x16x32_bf16 v[116:119], a[196:199], v[88:91], v[116:119]
    v_fma_f32 v6, v6, v124, v125
    v_fma_f32 v7, v7, v124, v125
    v_mfma_f32_16x16x32_bf16 v[120:123], v[88:91], a[200:203], v[120:123]
    ds_read_b128 v[88:91], v96 offset:10240
    v_mfma_f32_16x16x32_bf16 v[112:115], a[204:207], v[92:95], v[112:115]
    ds_read2_b32 v[124:125], v49 offset0:64 offset1:160
    v_mfma_f32_16x16x32_bf16 v[116:119], a[208:211], v[92:95], v[116:119]
    ds_read_b128 v[126:129], v50 offset:256
    v_mfma_f32_16x16x32_bf16 v[120:123], v[92:95], a[212:215], v[120:123]
    s_waitcnt lgkmcnt(6)
    ds_read_b128 v[92:95], v96 offset:11264
    v_mfma_f32_16x16x32_bf16 v[140:143], a[0:3], v[72:75], 0
    s_waitcnt lgkmcnt(2)
    ds_read_b128 v[130:133], v50 offset:640
    v_fmac_f32_e64 v100, v125, v24
    v_mfma_f32_16x16x32_bf16 v[144:147], a[4:7], v[72:75], 0
    v_fmac_f32 v101, v125, v25
    v_fmac_f32 v102, v125, v26
    v_mfma_f32_16x16x32_bf16 v[148:151], v[72:75], a[8:11], 0
    v_fmac_f32 v103, v125, v27
    v_mul_f32 v100, v124, v100
    v_mfma_f32_16x16x32_bf16 v[140:143], a[12:15], v[76:79], v[140:143]
    v_mul_f32 v101, v124, v101
    v_mul_f32 v102, v124, v102
    v_mfma_f32_16x16x32_bf16 v[144:147], a[16:19], v[76:79], v[144:147]
    v_mul_f32_e64 v103, v124, v103
    v_cvt_pk_bf16_f32 v134, v100, v101
    v_mfma_f32_16x16x32_bf16 v[148:151], v[76:79], a[20:23], v[148:151]
    v_cvt_pk_bf16_f32 v135, v102, v103
    v_mfma_f32_16x16x32_bf16 v[140:143], a[24:27], v[80:83], v[140:143]
    ds_write_b64 v47, v[134:135] offset:10752
    v_mfma_f32_16x16x32_bf16 v[144:147], a[28:31], v[80:83], v[144:147]
    v_fmac_f32 v104, v125, v28
    v_fmac_f32 v105, v125, v29
    v_mfma_f32_16x16x32_bf16 v[148:151], v[80:83], a[32:35], v[148:151]
    v_fmac_f32 v106, v125, v30
    v_fmac_f32 v107, v125, v31
    v_mfma_f32_16x16x32_bf16 v[140:143], a[36:39], v[84:87], v[140:143]
    s_waitcnt vmcnt(5)
    s_barrier
    ds_read_b128 v[72:75], v96 offset:18432
    v_mfma_f32_16x16x32_bf16 v[144:147], a[40:43], v[84:87], v[144:147]
    ds_read_b128 v[76:79], v96 offset:19456
    v_mul_f32 v104, v124, v104
    v_mfma_f32_16x16x32_bf16 v[148:151], v[84:87], a[44:47], v[148:151]
    ds_read_b128 v[80:83], v96 offset:20480
    v_mul_f32 v105, v124, v105
    v_mfma_f32_16x16x32_bf16 v[140:143], a[48:51], v[88:91], v[140:143]
    ds_read_b128 v[84:87], v96 offset:21504
    v_mul_f32_e64 v106, v124, v106
    v_mfma_f32_16x16x32_bf16 v[144:147], a[52:55], v[88:91], v[144:147]
    v_mul_f32 v107, v124, v107
    v_cvt_pk_bf16_f32 v136, v104, v105
    v_mfma_f32_16x16x32_bf16 v[148:151], v[88:91], a[56:59], v[148:151]
    s_waitcnt lgkmcnt(6)
    ds_read_b128 v[88:91], v96 offset:22528
    v_cvt_pk_bf16_f32 v137, v106, v107
    v_mfma_f32_16x16x32_bf16 v[140:143], a[60:63], v[92:95], v[140:143]
    ds_write_b64 v47, v[136:137] offset:26880
    v_mfma_f32_16x16x32_bf16 v[144:147], a[64:67], v[92:95], v[144:147]
    s_waitcnt lgkmcnt(7)
    v_fmac_f32 v108, v130, v35
    v_fmac_f32 v109, v131, v35
    v_mfma_f32_16x16x32_bf16 v[148:151], v[92:95], a[68:71], v[148:151]
    s_waitcnt lgkmcnt(5)
    ds_read_b128 v[92:95], v96 offset:23552
    v_fmac_f32_e64 v110, v132, v35
    v_mfma_f32_16x16x32_bf16 v[140:143], a[72:75], v[72:75], v[140:143]
    v_fmac_f32 v111, v133, v35
    v_mul_f32 v108, v126, v108
    v_mfma_f32_16x16x32_bf16 v[144:147], a[76:79], v[72:75], v[144:147]
    v_mul_f32 v109, v127, v109
    v_mul_f32 v110, v128, v110
    v_mfma_f32_16x16x32_bf16 v[148:151], v[72:75], a[80:83], v[148:151]
    s_waitcnt lgkmcnt(5)
    v_mul_f32 v111, v129, v111
    v_cvt_pk_bf16_f32 v138, v108, v109
    v_mfma_f32_16x16x32_bf16 v[140:143], a[84:87], v[76:79], v[140:143]
    v_cvt_pk_bf16_f32 v139, v110, v111
    v_mfma_f32_16x16x32_bf16 v[144:147], a[88:91], v[76:79], v[144:147]
    ds_write_b64 v48, v[138:139] offset:32
    v_mfma_f32_16x16x32_bf16 v[148:151], v[76:79], a[92:95], v[148:151]
    s_waitcnt lgkmcnt(5)
    ds_read2_b32 v[124:125], v49 offset0:80 offset1:176
    v_mfma_f32_16x16x32_bf16 v[140:143], a[96:99], v[80:83], v[140:143]
    ds_read_b128 v[126:129], v50 offset:320
    v_mfma_f32_16x16x32_bf16 v[144:147], a[100:103], v[80:83], v[144:147]
    s_waitcnt lgkmcnt(1)
    ds_read_b128 v[130:133], v50 offset:704
    v_fmac_f32 v112, v125, v24
    v_mfma_f32_16x16x32_bf16 v[148:151], v[80:83], a[104:107], v[148:151]
    v_fmac_f32 v113, v125, v25
    v_fmac_f32 v114, v125, v26
    v_mfma_f32_16x16x32_bf16 v[140:143], a[108:111], v[84:87], v[140:143]
    s_waitcnt vmcnt(2)
    s_barrier
    v_fmac_f32 v115, v125, v27
    v_mfma_f32_16x16x32_bf16 v[144:147], a[112:115], v[84:87], v[144:147]
    buffer_store_dword v68, v57, s[16:19], s47 offen offset:1440
    ds_read_b128 v[72:75], v96 offset:30720
    v_mul_f32 v112, v124, v112
    v_mfma_f32_16x16x32_bf16 v[148:151], v[84:87], a[116:119], v[148:151]
    ds_read_b128 v[76:79], v96 offset:31744
    v_mul_f32 v113, v124, v113
    v_mfma_f32_16x16x32_bf16 v[140:143], a[120:123], v[88:91], v[140:143]
    ds_read_b128 v[80:83], v96 offset:32768
    v_mul_f32 v114, v124, v114
    v_mfma_f32_16x16x32_bf16 v[144:147], a[124:127], v[88:91], v[144:147]
    ds_read_b128 v[84:87], v96 offset:33792
    v_mul_f32 v115, v124, v115
    v_mfma_f32_16x16x32_bf16 v[148:151], v[88:91], a[128:131], v[148:151]
    ds_read_b128 v[88:91], v96 offset:34816
    v_cvt_pk_bf16_f32 v112, v112, v113
    v_mfma_f32_16x16x32_bf16 v[140:143], a[132:135], v[92:95], v[140:143]
    v_cvt_pk_bf16_f32 v113, v114, v115
    v_mfma_f32_16x16x32_bf16 v[144:147], a[136:139], v[92:95], v[144:147]
    ds_write_b64 v47, v[112:113] offset:13440
    v_mfma_f32_16x16x32_bf16 v[148:151], v[92:95], a[140:143], v[148:151]
    s_waitcnt lgkmcnt(5)
    ds_read_b128 v[92:95], v96 offset:35840
    v_fmac_f32 v116, v125, v28
    v_mfma_f32_16x16x32_bf16 v[140:143], a[144:147], v[72:75], v[140:143]
    v_fmac_f32 v117, v125, v29
    v_fmac_f32 v118, v125, v30
    v_mfma_f32_16x16x32_bf16 v[144:147], a[148:151], v[72:75], v[144:147]
    v_fmac_f32 v119, v125, v31
    v_mul_f32 v116, v124, v116
    v_mfma_f32_16x16x32_bf16 v[148:151], v[72:75], a[152:155], v[148:151]
    s_waitcnt lgkmcnt(5)
    ds_read_b128 v[72:75], v96 offset:0
    v_mul_f32 v117, v124, v117
    v_mfma_f32_16x16x32_bf16 v[140:143], a[156:159], v[76:79], v[140:143]
    v_mul_f32 v118, v124, v118
    v_mul_f32 v119, v124, v119
    v_mfma_f32_16x16x32_bf16 v[144:147], a[160:163], v[76:79], v[144:147]
    v_cvt_pk_bf16_f32 v114, v116, v117
    v_cvt_pk_bf16_f32 v115, v118, v119
    v_mfma_f32_16x16x32_bf16 v[148:151], v[76:79], a[164:167], v[148:151]
    s_waitcnt lgkmcnt(5)
    ds_read_b128 v[76:79], v96 offset:1024
    v_mfma_f32_16x16x32_bf16 v[140:143], a[168:171], v[80:83], v[140:143]
    ds_write_b64 v47, v[114:115] offset:29568
    v_mfma_f32_16x16x32_bf16 v[144:147], a[172:175], v[80:83], v[144:147]
    v_fmac_f32 v120, v130, v35
    v_fmac_f32 v121, v131, v35
    v_mfma_f32_16x16x32_bf16 v[148:151], v[80:83], a[176:179], v[148:151]
    s_waitcnt lgkmcnt(6)
    ds_read_b128 v[80:83], v96 offset:2048
    v_fmac_f32 v122, v132, v35
    v_mfma_f32_16x16x32_bf16 v[140:143], a[180:183], v[84:87], v[140:143]
    buffer_load_dword v33, v59, s[16:19], s47 offen offset:1440 sc1
    v_fmac_f32 v123, v133, v35
    v_mfma_f32_16x16x32_bf16 v[144:147], a[184:187], v[84:87], v[144:147]
    v_mul_f32 v120, v126, v120
    v_mul_f32 v121, v127, v121
    v_mfma_f32_16x16x32_bf16 v[148:151], v[84:87], a[188:191], v[148:151]
    s_waitcnt lgkmcnt(6)
    ds_read_b128 v[84:87], v96 offset:3072
    v_mul_f32 v122, v128, v122
    v_mfma_f32_16x16x32_bf16 v[140:143], a[192:195], v[88:91], v[140:143]
    v_mul_f32_e64 v123, v129, v123
    v_cvt_pk_bf16_f32 v116, v120, v121
    v_mfma_f32_16x16x32_bf16 v[144:147], a[196:199], v[88:91], v[144:147]
    v_cvt_pk_bf16_f32 v117, v122, v123
    v_mfma_f32_16x16x32_bf16 v[148:151], v[88:91], a[200:203], v[148:151]
    s_waitcnt lgkmcnt(5)
    ds_read_b128 v[88:91], v96 offset:4096
    s_add_u32 s78, s87, s47
    v_mfma_f32_16x16x32_bf16 v[140:143], a[204:207], v[92:95], v[140:143]
    s_add_u32 m0, s87, 73728
    s_add_u32 s78, s78, 103424
    v_mfma_f32_16x16x32_bf16 v[144:147], a[208:211], v[92:95], v[144:147]
    buffer_load_dwordx4 v71, s[16:19], s78 offen offset:0 sc1 lds
    buffer_load_dwordx4 v71, s[16:19], s78 offen offset:1024 sc1 lds
    v_mfma_f32_16x16x32_bf16 v[148:151], v[92:95], a[212:215], v[148:151]
    s_waitcnt lgkmcnt(5)
    ds_read_b128 v[92:95], v96 offset:5120
    v_mfma_f32_16x16x32_bf16 v[100:103], a[0:3], v[72:75], 0
    ds_write_b64 v48, v[116:117] offset:40
    v_mfma_f32_16x16x32_bf16 v[104:107], a[4:7], v[72:75], 0
    v_mfma_f32_16x16x32_bf16 v[108:111], v[72:75], a[8:11], 0
    s_waitcnt lgkmcnt(6)
    ds_read_b128 v[72:75], v96 offset:12288
    v_mfma_f32_16x16x32_bf16 v[100:103], a[12:15], v[76:79], v[100:103]
    buffer_load_dwordx4 v71, s[16:19], s78 offen offset:2048 sc1 lds
    s_add_u32 s78, s87, s47
    v_mfma_f32_16x16x32_bf16 v[104:107], a[16:19], v[76:79], v[104:107]
    s_add_u32 m0, s87, 86016
    s_add_u32 s78, s78, 115712
    v_mfma_f32_16x16x32_bf16 v[108:111], v[76:79], a[20:23], v[108:111]
    s_waitcnt lgkmcnt(5)
    ds_read_b128 v[76:79], v96 offset:13312
    v_mfma_f32_16x16x32_bf16 v[100:103], a[24:27], v[80:83], v[100:103]
    buffer_load_dwordx4 v71, s[16:19], s78 offen offset:0 sc1 lds
    v_mfma_f32_16x16x32_bf16 v[104:107], a[28:31], v[80:83], v[104:107]
    v_mfma_f32_16x16x32_bf16 v[108:111], v[80:83], a[32:35], v[108:111]
    s_waitcnt vmcnt(4) lgkmcnt(5)
    ds_read_b128 v[80:83], v96 offset:14336
    v_cmp_ne_u32 s[34:35], s46, v33
    v_mfma_f32_16x16x32_bf16 v[100:103], a[36:39], v[84:87], v[100:103]
    v_mfma_f32_16x16x32_bf16 v[104:107], a[40:43], v[84:87], v[104:107]
    buffer_load_dwordx4 v71, s[16:19], s78 offen offset:1024 sc1 lds
    v_mfma_f32_16x16x32_bf16 v[108:111], v[84:87], a[44:47], v[108:111]
    s_waitcnt lgkmcnt(5)
    ds_read_b128 v[84:87], v96 offset:15360
    v_mfma_f32_16x16x32_bf16 v[100:103], a[48:51], v[88:91], v[100:103]
    s_cmp_lg_u64 s[34:35], 0
    s_cbranch_scc1 Lre81
Lok79:
    v_mfma_f32_16x16x32_bf16 v[104:107], a[52:55], v[88:91], v[104:107]
    v_permlane32_swap_b32 v112, v114
    v_mfma_f32_16x16x32_bf16 v[108:111], v[88:91], a[56:59], v[108:111]
    s_waitcnt lgkmcnt(5)
    ds_read_b128 v[88:91], v96 offset:16384
    v_mfma_f32_16x16x32_bf16 v[100:103], a[60:63], v[92:95], v[100:103]
    buffer_load_dwordx4 v71, s[16:19], s78 offen offset:2048 sc1 lds
    s_add_u32 s78, s87, s47
    v_mfma_f32_16x16x32_bf16 v[104:107], a[64:67], v[92:95], v[104:107]
    s_add_u32 m0, s87, 98304
    s_add_u32 s78, s78, 128000
    v_mfma_f32_16x16x32_bf16 v[108:111], v[92:95], a[68:71], v[108:111]
    s_waitcnt lgkmcnt(4)
    ds_read_b128 v[92:95], v96 offset:17408
    v_mfma_f32_16x16x32_bf16 v[100:103], a[72:75], v[72:75], v[100:103]
    buffer_load_dwordx4 v71, s[16:19], s78 offen offset:0 sc1 lds
    v_mfma_f32_16x16x32_bf16 v[104:107], a[76:79], v[72:75], v[104:107]
    v_permlane32_swap_b32 v113, v115
    v_mfma_f32_16x16x32_bf16 v[108:111], v[72:75], a[80:83], v[108:111]
    s_waitcnt lgkmcnt(4)
    ds_read_b128 v[72:75], v96 offset:24576
    v_mov_b32_dpp v117, v117 row_ror:8 row_mask:0xf bank_mask:0xf
    v_mfma_f32_16x16x32_bf16 v[100:103], a[84:87], v[76:79], v[100:103]
    v_cndmask_b32 v112, v112, v114, s[28:29]
    v_cndmask_b32 v113, v113, v115, s[28:29]
    v_mfma_f32_16x16x32_bf16 v[104:107], a[88:91], v[76:79], v[104:107]
    buffer_load_dwordx4 v71, s[16:19], s78 offen offset:1024 sc1 lds
    v_cndmask_b32 v114, v116, v117, s[30:31]
    v_mfma_f32_16x16x32_bf16 v[108:111], v[76:79], a[92:95], v[108:111]
    s_waitcnt lgkmcnt(4)
    ds_read_b128 v[76:79], v96 offset:25600
    v_mov_b32 v115, s33
    v_mfma_f32_16x16x32_bf16 v[100:103], a[96:99], v[80:83], v[100:103]
    v_mfma_f32_16x16x32_bf16 v[104:107], a[100:103], v[80:83], v[104:107]
    v_mfma_f32_16x16x32_bf16 v[108:111], v[80:83], a[104:107], v[108:111]
    s_waitcnt lgkmcnt(4)
    ds_read_b128 v[80:83], v96 offset:26624
    v_mfma_f32_16x16x32_bf16 v[100:103], a[108:111], v[84:87], v[100:103]
    buffer_load_dwordx4 v71, s[16:19], s78 offen offset:2048 sc1 lds
    v_mfma_f32_16x16x32_bf16 v[104:107], a[112:115], v[84:87], v[104:107]
    v_and_b32 v71, 112, v46
    v_mfma_f32_16x16x32_bf16 v[108:111], v[84:87], a[116:119], v[108:111]
    s_waitcnt lgkmcnt(4)
    ds_read_b128 v[84:87], v96 offset:27648
    v_mfma_f32_16x16x32_bf16 v[100:103], a[120:123], v[88:91], v[100:103]
    s_bitcmp1_b32 s58, 0
    s_cbranch_scc0 Lnx69
    buffer_store_dwordx4 v[112:115], v46, s[16:19], s32 offen offset:1024
Lnx69:
    v_mfma_f32_16x16x32_bf16 v[104:107], a[124:127], v[88:91], v[104:107]
    v_permlane32_swap_b32 v134, v136
    v_mfma_f32_16x16x32_bf16 v[108:111], v[88:91], a[128:131], v[108:111]
    s_waitcnt lgkmcnt(4)
    ds_read_b128 v[88:91], v96 offset:28672
    v_mfma_f32_16x16x32_bf16 v[100:103], a[132:135], v[92:95], v[100:103]
    v_permlane32_swap_b32 v135, v137
    v_mfma_f32_16x16x32_bf16 v[104:107], a[136:139], v[92:95], v[104:107]
    v_mov_b32_dpp v139, v139 row_ror:8 row_mask:0xf bank_mask:0xf
    v_cndmask_b32 v134, v134, v136, s[28:29]
    v_mfma_f32_16x16x32_bf16 v[108:111], v[92:95], a[140:143], v[108:111]
    s_waitcnt lgkmcnt(4)
    ds_read_b128 v[92:95], v96 offset:29696
    v_cndmask_b32 v135, v135, v137, s[28:29]
    v_mfma_f32_16x16x32_bf16 v[100:103], a[144:147], v[72:75], v[100:103]
    v_cndmask_b32 v136, v138, v139, s[30:31]
    v_mov_b32 v137, s33
    v_mfma_f32_16x16x32_bf16 v[104:107], a[148:151], v[72:75], v[104:107]
    s_bitcmp1_b32 s58, 0
    s_cbranch_scc0 Lnx70
    buffer_store_dwordx4 v[134:137], v46, s[16:19], s32 offen offset:0
Lnx70:
    v_mfma_f32_16x16x32_bf16 v[108:111], v[72:75], a[152:155], v[108:111]
    s_waitcnt lgkmcnt(4)
    ds_read2_b32 v[124:125], v49 offset0:48 offset1:144
    v_mfma_f32_16x16x32_bf16 v[100:103], a[156:159], v[76:79], v[100:103]
    ds_read_b128 v[126:129], v50 offset:192
    v_mfma_f32_16x16x32_bf16 v[104:107], a[160:163], v[76:79], v[104:107]
    s_waitcnt lgkmcnt(1)
    ds_read_b128 v[130:133], v50 offset:576
    v_fmac_f32 v140, v125, v24
    v_mfma_f32_16x16x32_bf16 v[108:111], v[76:79], a[164:167], v[108:111]
    v_fmac_f32 v141, v125, v25
    v_fmac_f32 v142, v125, v26
    v_mfma_f32_16x16x32_bf16 v[100:103], a[168:171], v[80:83], v[100:103]
    v_fmac_f32 v143, v125, v27
    v_mul_f32 v140, v124, v140
    v_mfma_f32_16x16x32_bf16 v[104:107], a[172:175], v[80:83], v[104:107]
    s_add_u32 s77, s47, 217088
    buffer_load_dwordx3 v[32:34], v71, s[16:19], s77 offen sc1
    v_mfma_f32_16x16x32_bf16 v[108:111], v[80:83], a[176:179], v[108:111]
    v_mul_f32 v141, v124, v141
    v_mul_f32 v142, v124, v142
    v_mfma_f32_16x16x32_bf16 v[100:103], a[180:183], v[84:87], v[100:103]
    s_waitcnt vmcnt(7)
    s_barrier
    ds_read_b128 v[72:75], v97 offset:6144
    v_mfma_f32_16x16x32_bf16 v[104:107], a[184:187], v[84:87], v[104:107]
    ds_read_b128 v[76:79], v97 offset:7168
    v_mul_f32_e64 v143, v124, v143
    v_mfma_f32_16x16x32_bf16 v[108:111], v[84:87], a[188:191], v[108:111]
    ds_read_b128 v[80:83], v97 offset:8192
    v_cvt_pk_bf16_f32 v140, v140, v141
    v_mfma_f32_16x16x32_bf16 v[100:103], a[192:195], v[88:91], v[100:103]
    ds_read_b128 v[84:87], v97 offset:9216
    v_cvt_pk_bf16_f32 v141, v142, v143
    v_mfma_f32_16x16x32_bf16 v[104:107], a[196:199], v[88:91], v[104:107]
    ds_write_b64 v47, v[140:141] offset:8064
    v_mfma_f32_16x16x32_bf16 v[108:111], v[88:91], a[200:203], v[108:111]
    ds_read_b128 v[88:91], v97 offset:10240
    v_fmac_f32_e64 v144, v125, v28
    v_mfma_f32_16x16x32_bf16 v[100:103], a[204:207], v[92:95], v[100:103]
    v_fmac_f32 v145, v125, v29
    v_fmac_f32 v146, v125, v30
    v_mfma_f32_16x16x32_bf16 v[104:107], a[208:211], v[92:95], v[104:107]
    v_fmac_f32 v147, v125, v31
    v_mul_f32 v144, v124, v144
    v_mfma_f32_16x16x32_bf16 v[108:111], v[92:95], a[212:215], v[108:111]
    s_waitcnt lgkmcnt(5)
    ds_read_b128 v[92:95], v97 offset:11264
    v_mul_f32 v145, v124, v145
    v_mfma_f32_16x16x32_bf16 v[112:115], a[0:3], v[72:75], 0
    v_mul_f32 v146, v124, v146
    v_mul_f32 v147, v124, v147
    v_mfma_f32_16x16x32_bf16 v[116:119], a[4:7], v[72:75], 0
    v_cvt_pk_bf16_f32 v142, v144, v145
    v_cvt_pk_bf16_f32 v143, v146, v147
    v_mfma_f32_16x16x32_bf16 v[120:123], v[72:75], a[8:11], 0
    s_waitcnt lgkmcnt(5)
    ds_write_b64 v47, v[142:143] offset:24192
    v_mfma_f32_16x16x32_bf16 v[112:115], a[12:15], v[76:79], v[112:115]
    v_fmac_f32 v148, v130, v35
    v_fmac_f32_e64 v149, v131, v35
    v_mfma_f32_16x16x32_bf16 v[116:119], a[16:19], v[76:79], v[116:119]
    v_fmac_f32 v150, v132, v35
    v_fmac_f32 v151, v133, v35
    v_mfma_f32_16x16x32_bf16 v[120:123], v[76:79], a[20:23], v[120:123]
    s_waitcnt lgkmcnt(5)
    v_mul_f32 v148, v126, v148
    v_mul_f32 v149, v127, v149
    v_mfma_f32_16x16x32_bf16 v[112:115], a[24:27], v[80:83], v[112:115]
    s_waitcnt vmcnt(0)
    v_cmp_ne_u32 s[34:35], s79, v34
    v_mul_f32 v150, v128, v150
    v_mfma_f32_16x16x32_bf16 v[116:119], a[28:31], v[80:83], v[116:119]
    s_and_b32 s77, s34, s76
    s_cbranch_scc1 Lre86
Lok84:
    s_andn2_b32 s77, 1536, s76
    v_mfma_f32_16x16x32_bf16 v[120:123], v[80:83], a[32:35], v[120:123]
    s_waitcnt lgkmcnt(4)
    s_add_u32 s77, s77, 159744
    v_lshrrev_b32 v71, 2, v71
    v_mfma_f32_16x16x32_bf16 v[112:115], a[36:39], v[84:87], v[112:115]
    s_barrier
    ds_read_b128 v[72:75], v97 offset:18432
    v_mfma_f32_16x16x32_bf16 v[116:119], a[40:43], v[84:87], v[116:119]
    ds_read_b128 v[76:79], v97 offset:19456
    v_add_u32 v71, s77, v71
    v_mfma_f32_16x16x32_bf16 v[120:123], v[84:87], a[44:47], v[120:123]
    s_waitcnt lgkmcnt(4)
    ds_read_b128 v[80:83], v97 offset:20480
    v_mul_f32 v151, v129, v151
    v_mfma_f32_16x16x32_bf16 v[112:115], a[48:51], v[88:91], v[112:115]
    ds_read_b128 v[84:87], v97 offset:21504
    v_cvt_pk_bf16_f32 v144, v148, v149
    v_mfma_f32_16x16x32_bf16 v[116:119], a[52:55], v[88:91], v[116:119]
    Lw5: s_cbranch_execz Lw9
    ds_write2_b32 v71, v32, v33 offset1:96
    v_mfma_f32_16x16x32_bf16 v[120:123], v[88:91], a[56:59], v[120:123]
    s_waitcnt lgkmcnt(6)
    ds_read_b128 v[88:91], v97 offset:22528
    v_cvt_pk_bf16_f32 v145, v150, v151
    v_mfma_f32_16x16x32_bf16 v[112:115], a[60:63], v[92:95], v[112:115]
    ds_write_b64 v48, v[144:145] offset:24
    v_mfma_f32_16x16x32_bf16 v[116:119], a[64:67], v[92:95], v[116:119]
    v_permlane32_swap_b32 v140, v142
    v_mfma_f32_16x16x32_bf16 v[120:123], v[92:95], a[68:71], v[120:123]
    s_waitcnt lgkmcnt(6)
    ds_read_b128 v[92:95], v97 offset:23552
    v_mfma_f32_16x16x32_bf16 v[112:115], a[72:75], v[72:75], v[112:115]
    v_permlane32_swap_b32 v141, v143
    v_mfma_f32_16x16x32_bf16 v[116:119], a[76:79], v[72:75], v[116:119]
    v_mov_b32_dpp v145, v145 row_ror:8 row_mask:0xf bank_mask:0xf
    v_cndmask_b32 v140, v140, v142, s[28:29]
    v_mfma_f32_16x16x32_bf16 v[120:123], v[72:75], a[80:83], v[120:123]
    s_waitcnt lgkmcnt(6)
    ds_read_b128 v[72:75], v97 offset:30720
    v_cndmask_b32 v141, v141, v143, s[28:29]
    v_mfma_f32_16x16x32_bf16 v[112:115], a[84:87], v[76:79], v[112:115]
    v_cndmask_b32 v142, v144, v145, s[30:31]
    v_mov_b32 v143, s33
    v_mfma_f32_16x16x32_bf16 v[116:119], a[88:91], v[76:79], v[116:119]
    s_bitcmp1_b32 s58, 0
    s_cbranch_scc0 Lnx71
    buffer_store_dwordx4 v[140:143], v46, s[16:19], s59 offen offset:3072
Lnx71:
    v_mfma_f32_16x16x32_bf16 v[120:123], v[76:79], a[92:95], v[120:123]
    s_waitcnt lgkmcnt(6)
    ds_read_b128 v[76:79], v97 offset:31744
    v_mfma_f32_16x16x32_bf16 v[112:115], a[96:99], v[80:83], v[112:115]
    ds_read2_b32 v[124:125], v49 offset0:32 offset1:128
    v_mfma_f32_16x16x32_bf16 v[116:119], a[100:103], v[80:83], v[116:119]
    ds_read_b128 v[126:129], v50 offset:128
    v_mfma_f32_16x16x32_bf16 v[120:123], v[80:83], a[104:107], v[120:123]
    s_waitcnt lgkmcnt(8)
    ds_read_b128 v[80:83], v97 offset:32768
    v_mfma_f32_16x16x32_bf16 v[112:115], a[108:111], v[84:87], v[112:115]
    s_waitcnt lgkmcnt(2)
    ds_read_b128 v[130:133], v50 offset:512
    v_fmac_f32 v100, v125, v24
    v_mfma_f32_16x16x32_bf16 v[116:119], a[112:115], v[84:87], v[116:119]
    v_fmac_f32 v101, v125, v25
    v_fmac_f32 v102, v125, v26
    v_mfma_f32_16x16x32_bf16 v[120:123], v[84:87], a[116:119], v[120:123]
    ds_read_b128 v[84:87], v97 offset:33792
    v_fmac_f32_e64 v103, v125, v27
    v_mfma_f32_16x16x32_bf16 v[112:115], a[120:123], v[88:91], v[112:115]
    v_mul_f32 v100, v124, v100
    v_mul_f32 v101, v124, v101
    v_mfma_f32_16x16x32_bf16 v[116:119], a[124:127], v[88:91], v[116:119]
    v_mul_f32 v102, v124, v102
    v_mul_f32 v103, v124, v103
    v_mfma_f32_16x16x32_bf16 v[120:123], v[88:91], a[128:131], v[120:123]
    ds_read_b128 v[88:91], v97 offset:34816
    v_cvt_pk_bf16_f32 v134, v100, v101
    v_mfma_f32_16x16x32_bf16 v[112:115], a[132:135], v[92:95], v[112:115]
    v_cvt_pk_bf16_f32 v135, v102, v103
    v_mfma_f32_16x16x32_bf16 v[116:119], a[136:139], v[92:95], v[116:119]
    ds_write_b64 v47, v[134:135] offset:5376
    v_mfma_f32_16x16x32_bf16 v[120:123], v[92:95], a[140:143], v[120:123]
    ds_read_b128 v[92:95], v97 offset:35840
    v_fmac_f32_e64 v104, v125, v28
    v_mfma_f32_16x16x32_bf16 v[112:115], a[144:147], v[72:75], v[112:115]
    v_fmac_f32 v105, v125, v29
    v_fmac_f32 v106, v125, v30
    v_mfma_f32_16x16x32_bf16 v[116:119], a[148:151], v[72:75], v[116:119]
    v_fmac_f32 v107, v125, v31
    v_mul_f32 v104, v124, v104
    v_mfma_f32_16x16x32_bf16 v[120:123], v[72:75], a[152:155], v[120:123]
    ds_read_b128 v[72:75], v97 offset:0
    v_mul_f32_e64 v105, v124, v105
    v_mfma_f32_16x16x32_bf16 v[112:115], a[156:159], v[76:79], v[112:115]
    v_mul_f32 v106, v124, v106
    v_mul_f32 v107, v124, v107
    v_mfma_f32_16x16x32_bf16 v[116:119], a[160:163], v[76:79], v[116:119]
    v_cvt_pk_bf16_f32 v136, v104, v105
    v_cvt_pk_bf16_f32 v137, v106, v107
    v_mfma_f32_16x16x32_bf16 v[120:123], v[76:79], a[164:167], v[120:123]
    s_waitcnt lgkmcnt(6)
    ds_read_b128 v[76:79], v97 offset:1024
    v_mfma_f32_16x16x32_bf16 v[112:115], a[168:171], v[80:83], v[112:115]
    ds_write_b64 v47, v[136:137] offset:21504
    v_mfma_f32_16x16x32_bf16 v[116:119], a[172:175], v[80:83], v[116:119]
    s_waitcnt lgkmcnt(7)
    v_fmac_f32 v108, v130, v35
    v_fmac_f32 v109, v131, v35
    v_mfma_f32_16x16x32_bf16 v[120:123], v[80:83], a[176:179], v[120:123]
    s_waitcnt lgkmcnt(6)
    ds_read_b128 v[80:83], v97 offset:2048
    v_fmac_f32 v110, v132, v35
    v_mfma_f32_16x16x32_bf16 v[112:115], a[180:183], v[84:87], v[112:115]
    v_fmac_f32 v111, v133, v35
    v_mul_f32 v108, v126, v108
    v_mfma_f32_16x16x32_bf16 v[116:119], a[184:187], v[84:87], v[116:119]
    v_mul_f32 v109, v127, v109
    v_mul_f32 v110, v128, v110
    v_mfma_f32_16x16x32_bf16 v[120:123], v[84:87], a[188:191], v[120:123]
    s_waitcnt lgkmcnt(6)
    ds_read_b128 v[84:87], v97 offset:3072
    v_mul_f32 v111, v129, v111
    v_mfma_f32_16x16x32_bf16 v[112:115], a[192:195], v[88:91], v[112:115]
    s_bitcmp1_b32 s58, 1
    s_cbranch_scc0 Lni87
    buffer_load_dwordx4 v[140:143], v46, s[16:19], s32 offen offset:0 sc1
    buffer_load_dwordx4 v[144:147], v46, s[16:19], s32 offen offset:1024 sc1
    buffer_load_dwordx4 v[148:151], v46, s[16:19], s59 offen offset:3072 sc1
Lni87:
    v_mfma_f32_16x16x32_bf16 v[116:119], a[196:199], v[88:91], v[116:119]
    v_mul_u32_u24 v32, 32, v46
    v_min_u32 v32, 11776, v32
    v_mfma_f32_16x16x32_bf16 v[120:123], v[88:91], a[200:203], v[120:123]
    s_waitcnt lgkmcnt(5)
    ds_read_b128 v[88:91], v97 offset:4096
    v_cvt_pk_bf16_f32 v138, v108, v109
    v_mfma_f32_16x16x32_bf16 v[112:115], a[204:207], v[92:95], v[112:115]
    s_mov_b32 s76, 786432
    buffer_load_dwordx2 v[98:99], v32, s[16:19], s76 offen sc1
    v_mfma_f32_16x16x32_bf16 v[116:119], a[208:211], v[92:95], v[116:119]
    v_cvt_pk_bf16_f32 v139, v110, v111
    v_mfma_f32_16x16x32_bf16 v[120:123], v[92:95], a[212:215], v[120:123]
    s_waitcnt lgkmcnt(5)
    ds_read_b128 v[92:95], v97 offset:5120
    ds_write_b64 v48, v[138:139] offset:16
    v_mfma_f32_16x16x32_bf16 v[100:103], a[0:3], v[72:75], 0
    v_permlane32_swap_b32 v134, v136
    v_mfma_f32_16x16x32_bf16 v[104:107], a[4:7], v[72:75], 0
    v_permlane32_swap_b32 v135, v137
    v_mfma_f32_16x16x32_bf16 v[108:111], v[72:75], a[8:11], 0
    s_waitcnt lgkmcnt(6)
    ds_read_b128 v[72:75], v97 offset:12288
    v_mov_b32_dpp v139, v139 row_ror:8 row_mask:0xf bank_mask:0xf
    v_mfma_f32_16x16x32_bf16 v[100:103], a[12:15], v[76:79], v[100:103]
    v_cndmask_b32 v134, v134, v136, s[28:29]
    v_cndmask_b32 v135, v135, v137, s[28:29]
    v_mfma_f32_16x16x32_bf16 v[104:107], a[16:19], v[76:79], v[104:107]
    v_cndmask_b32 v136, v138, v139, s[30:31]
    v_mov_b32 v137, s33
    v_mfma_f32_16x16x32_bf16 v[108:111], v[76:79], a[20:23], v[108:111]
    s_waitcnt lgkmcnt(5)
    ds_read_b128 v[76:79], v97 offset:13312
    v_mfma_f32_16x16x32_bf16 v[100:103], a[24:27], v[80:83], v[100:103]
    s_bitcmp1_b32 s58, 0
    s_cbranch_scc0 Lnx76
    buffer_store_dwordx4 v[134:137], v46, s[16:19], s59 offen offset:2048
Lnx76:
    v_mfma_f32_16x16x32_bf16 v[104:107], a[28:31], v[80:83], v[104:107]
    v_mfma_f32_16x16x32_bf16 v[108:111], v[80:83], a[32:35], v[108:111]
    s_waitcnt lgkmcnt(5)
    ds_read_b128 v[80:83], v97 offset:14336
    v_mfma_f32_16x16x32_bf16 v[100:103], a[36:39], v[84:87], v[100:103]
    s_bitcmp1_b32 s58, 1
    s_cbranch_scc0 Lnp72
    s_waitcnt vmcnt(3)
    v_xor_b32 v143, s33, v143
    s_waitcnt vmcnt(2)
    v_xor_b32 v147, s33, v147
    s_waitcnt vmcnt(1)
    v_xor_b32_e64 v151, s33, v151
    v_or3_b32 v143, v143, v147, v151
    v_cmp_lt_u32_e64 vcc, 1, v143
    ds_write_b64 v63, v[140:141] offset:10752
    ds_write_b32 v64, v142 offset:32
    ds_write_b64 v63, v[144:145] offset:13440
    ds_write_b32 v64, v146 offset:40
    ds_write_b64 v63, v[148:149] offset:8064
    ds_write_b32 v64, v150 offset:24
    s_cmp_lg_u64 vcc, 0
    s_cbranch_scc1 Lre75
Lok73:
Lnp72:
    v_mfma_f32_16x16x32_bf16 v[104:107], a[40:43], v[84:87], v[104:107]
    ds_read2_b32 v[124:125], v49 offset0:16 offset1:112
    v_mfma_f32_16x16x32_bf16 v[108:111], v[84:87], a[44:47], v[108:111]
    s_waitcnt lgkmcnt(6)
    ds_read_b128 v[84:87], v97 offset:15360
    v_mfma_f32_16x16x32_bf16 v[100:103], a[48:51], v[88:91], v[100:103]
    ds_read_b128 v[126:129], v50 offset:64
    v_mfma_f32_16x16x32_bf16 v[104:107], a[52:55], v[88:91], v[104:107]
    s_waitcnt lgkmcnt(2)
    ds_read_b128 v[130:133], v50 offset:448
    v_fmac_f32 v112, v125, v24
    v_mfma_f32_16x16x32_bf16 v[108:111], v[88:91], a[56:59], v[108:111]
    ds_read_b128 v[88:91], v97 offset:16384
    v_fmac_f32 v113, v125, v25
    v_mfma_f32_16x16x32_bf16 v[100:103], a[60:63], v[92:95], v[100:103]
    v_fmac_f32 v114, v125, v26
    v_fmac_f32 v115, v125, v27
    v_mfma_f32_16x16x32_bf16 v[104:107], a[64:67], v[92:95], v[104:107]
    v_mul_f32 v112, v124, v112
    v_mul_f32 v113, v124, v113
    v_mfma_f32_16x16x32_bf16 v[108:111], v[92:95], a[68:71], v[108:111]
    ds_read_b128 v[92:95], v97 offset:17408
    v_mul_f32 v114, v124, v114
    v_mfma_f32_16x16x32_bf16 v[100:103], a[72:75], v[72:75], v[100:103]
    v_mul_f32 v115, v124, v115
    v_cvt_pk_bf16_f32 v112, v112, v113
    v_mfma_f32_16x16x32_bf16 v[104:107], a[76:79], v[72:75], v[104:107]
    v_cvt_pk_bf16_f32 v113, v114, v115
    v_mfma_f32_16x16x32_bf16 v[108:111], v[72:75], a[80:83], v[108:111]
    ds_read_b128 v[72:75], v97 offset:24576
    v_mfma_f32_16x16x32_bf16 v[100:103], a[84:87], v[76:79], v[100:103]
    ds_write_b64 v47, v[112:113] offset:2688
    v_mfma_f32_16x16x32_bf16 v[104:107], a[88:91], v[76:79], v[104:107]
    v_fmac_f32 v116, v125, v28
    v_fmac_f32 v117, v125, v29
    v_mfma_f32_16x16x32_bf16 v[108:111], v[76:79], a[92:95], v[108:111]
    ds_read_b128 v[76:79], v97 offset:25600
    v_fmac_f32_e64 v118, v125, v30
    v_mfma_f32_16x16x32_bf16 v[100:103], a[96:99], v[80:83], v[100:103]
    v_fmac_f32 v119, v125, v31
    v_mul_f32 v116, v124, v116
    v_mfma_f32_16x16x32_bf16 v[104:107], a[100:103], v[80:83], v[104:107]
    v_mul_f32 v117, v124, v117
    v_mul_f32 v118, v124, v118
    v_mfma_f32_16x16x32_bf16 v[108:111], v[80:83], a[104:107], v[108:111]
    s_waitcnt lgkmcnt(7)
    ds_read_b128 v[80:83], v97 offset:26624
    v_mul_f32 v119, v124, v119
    v_mfma_f32_16x16x32_bf16 v[100:103], a[108:111], v[84:87], v[100:103]
    v_cvt_pk_bf16_f32 v114, v116, v117
    v_cvt_pk_bf16_f32 v115, v118, v119
    v_mfma_f32_16x16x32_bf16 v[104:107], a[112:115], v[84:87], v[104:107]
    ds_write_b64 v47, v[114:115] offset:18816
    v_mfma_f32_16x16x32_bf16 v[108:111], v[84:87], a[116:119], v[108:111]
    s_waitcnt lgkmcnt(6)
    ds_read_b128 v[84:87], v97 offset:27648
    v_fmac_f32 v120, v130, v35
    v_mfma_f32_16x16x32_bf16 v[100:103], a[120:123], v[88:91], v[100:103]
    v_fmac_f32 v121, v131, v35
    v_fmac_f32 v122, v132, v35
    v_mfma_f32_16x16x32_bf16 v[104:107], a[124:127], v[88:91], v[104:107]
    v_fmac_f32 v123, v133, v35
    v_mul_f32 v120, v126, v120
    v_mfma_f32_16x16x32_bf16 v[108:111], v[88:91], a[128:131], v[108:111]
    s_waitcnt lgkmcnt(6)
    ds_read_b128 v[88:91], v97 offset:28672
    v_mul_f32 v121, v127, v121
    v_mfma_f32_16x16x32_bf16 v[100:103], a[132:135], v[92:95], v[100:103]
    v_mul_f32 v122, v128, v122
    v_mul_f32 v123, v129, v123
    v_mfma_f32_16x16x32_bf16 v[104:107], a[136:139], v[92:95], v[104:107]
    v_cvt_pk_bf16_f32 v116, v120, v121
    v_cvt_pk_bf16_f32 v117, v122, v123
    v_mfma_f32_16x16x32_bf16 v[108:111], v[92:95], a[140:143], v[108:111]
    s_waitcnt lgkmcnt(6)
    ds_read_b128 v[92:95], v97 offset:29696
    v_mfma_f32_16x16x32_bf16 v[100:103], a[144:147], v[72:75], v[100:103]
    ds_write_b64 v48, v[116:117] offset:8
    v_mfma_f32_16x16x32_bf16 v[104:107], a[148:151], v[72:75], v[104:107]
    v_permlane32_swap_b32 v112, v114
    v_mfma_f32_16x16x32_bf16 v[108:111], v[72:75], a[152:155], v[108:111]
    s_waitcnt lgkmcnt(6)
    v_permlane32_swap_b32 v113, v115
    v_mfma_f32_16x16x32_bf16 v[100:103], a[156:159], v[76:79], v[100:103]
    v_mov_b32_dpp v117, v117 row_ror:8 row_mask:0xf bank_mask:0xf
    v_cndmask_b32 v112, v112, v114, s[28:29]
    v_mfma_f32_16x16x32_bf16 v[104:107], a[160:163], v[76:79], v[104:107]
    v_cndmask_b32 v113, v113, v115, s[28:29]
    v_cndmask_b32 v114, v116, v117, s[30:31]
    v_mfma_f32_16x16x32_bf16 v[108:111], v[76:79], a[164:167], v[108:111]
    s_waitcnt lgkmcnt(5)
    v_mov_b32 v115, s33
    v_mfma_f32_16x16x32_bf16 v[100:103], a[168:171], v[80:83], v[100:103]
    s_bitcmp1_b32 s58, 0
    s_cbranch_scc0 Lnx77
    buffer_store_dwordx4 v[112:115], v46, s[16:19], s59 offen offset:1024
Lnx77:
    v_mfma_f32_16x16x32_bf16 v[104:107], a[172:175], v[80:83], v[104:107]
    s_cmp_lg_u32 s43, 0
    s_subb_u32 s77, s42, 0
    v_mfma_f32_16x16x32_bf16 v[108:111], v[80:83], a[176:179], v[108:111]
    s_waitcnt lgkmcnt(3)
    s_cmp_eq_u32 s44, 0
    s_cselect_b32 s78, 18, 2
    v_mfma_f32_16x16x32_bf16 v[100:103], a[180:183], v[84:87], v[100:103]
    s_sub_u32 s78, s86, s78
    ds_read2_b32 v[124:125], v49 offset0:0 offset1:96
    v_mfma_f32_16x16x32_bf16 v[104:107], a[184:187], v[84:87], v[104:107]
    ds_read_b128 v[126:129], v50 offset:0
    v_mfma_f32_16x16x32_bf16 v[108:111], v[84:87], a[188:191], v[108:111]
    s_waitcnt lgkmcnt(4)
    ds_read_b128 v[130:133], v50 offset:384
    v_mfma_f32_16x16x32_bf16 v[100:103], a[192:195], v[88:91], v[100:103]
    v_mfma_f32_16x16x32_bf16 v[104:107], a[196:199], v[88:91], v[104:107]
    v_mfma_f32_16x16x32_bf16 v[108:111], v[88:91], a[200:203], v[108:111]
    s_waitcnt lgkmcnt(4)
    v_mfma_f32_16x16x32_bf16 v[100:103], a[204:207], v[92:95], v[100:103]
    v_mfma_f32_16x16x32_bf16 v[104:107], a[208:211], v[92:95], v[104:107]
    v_mfma_f32_16x16x32_bf16 v[108:111], v[92:95], a[212:215], v[108:111]
    s_waitcnt vmcnt(0)
    v_cmp_eq_u32 s[74:75], s46, v99
    v_readlane_b32 s81, v98, s77
    s_nop 0
    s_and_b32 s82, s81, 0x7ff
    s_cmp_le_u32 s82, s78
    s_cselect_b32 s81, s81, 0
    s_max_u32 s80, s54, s81
    v_cmp_lt_u32_e64 vcc, s80, v98
    s_bitcmp1_b32 s74, s77
    s_cselect_b32 s81, s74, 0
    s_and_b32 s82, s81, vcc_lo
    s_cselect_b32 s83, 0, s74
    s_cmp_eq_u32 s83, -1
    s_cbranch_scc1 LF_early
LF_last:
    s_waitcnt lgkmcnt(2)
    v_pk_fma_f32 v[100:101], v[124:125], v[24:25], v[100:101] op_sel:[1,0,0] op_sel_hi:[1,1,1]
    v_pk_fma_f32 v[102:103], v[124:125], v[26:27], v[102:103] op_sel:[1,0,0] op_sel_hi:[1,1,1]
    v_pk_mul_f32 v[100:101], v[124:125], v[100:101] op_sel_hi:[0,1]
    v_pk_mul_f32 v[102:103], v[124:125], v[102:103] op_sel_hi:[0,1]
    v_cvt_pk_bf16_f32 v100, v100, v101
    v_cvt_pk_bf16_f32 v101, v102, v103
    ds_write_b64 v47, v[100:101] offset:0
    v_pk_fma_f32 v[104:105], v[124:125], v[28:29], v[104:105] op_sel:[1,0,0] op_sel_hi:[1,1,1]
    v_pk_fma_f32 v[106:107], v[124:125], v[30:31], v[106:107] op_sel:[1,0,0] op_sel_hi:[1,1,1]
    v_pk_mul_f32 v[104:105], v[124:125], v[104:105] op_sel_hi:[0,1]
    v_pk_mul_f32 v[106:107], v[124:125], v[106:107] op_sel_hi:[0,1]
    v_cvt_pk_bf16_f32 v102, v104, v105
    v_cvt_pk_bf16_f32 v103, v106, v107
    ds_write_b64 v47, v[102:103] offset:16128
    s_waitcnt lgkmcnt(2)
    s_nop 0
    v_pk_fma_f32 v[108:109], v[130:131], v[34:35], v[108:109] op_sel:[0,1,0]
    v_pk_fma_f32 v[110:111], v[132:133], v[34:35], v[110:111] op_sel:[0,1,0]
    v_pk_mul_f32 v[108:109], v[126:127], v[108:109]
    v_pk_mul_f32 v[110:111], v[128:129], v[110:111]
    v_cvt_pk_bf16_f32 v104, v108, v109
    v_cvt_pk_bf16_f32 v105, v110, v111
    ds_write_b64 v48, v[104:105] offset:0
    v_permlane32_swap_b32 v100, v102
    v_permlane32_swap_b32 v101, v103
    v_mov_b32_dpp v105, v105 row_ror:8 row_mask:0xf bank_mask:0xf
    v_cndmask_b32 v100, v100, v102, s[28:29]
    v_cndmask_b32 v101, v101, v103, s[28:29]
    v_cndmask_b32 v102, v104, v105, s[30:31]
    v_mov_b32_e64 v103, s33
    s_bitcmp1_b32 s58, 0
    s_cbranch_scc0 Lnx88
    buffer_store_dwordx4 v[100:103], v46, s[16:19], s59 offen offset:0
Lnx88:
    s_cmp_eq_u32 s82, 0
    s_cbranch_scc1 LF_decide
LF_free:
    s_bitcmp1_b32 s58, 1
    s_cbranch_scc0 Lni89
    buffer_load_dwordx4 v[120:123], v46, s[16:19], s59 offen offset:2048 sc1
    buffer_load_dwordx4 v[124:127], v46, s[16:19], s59 offen offset:1024 sc1
Lni89:
    s_waitcnt lgkmcnt(0)
    s_barrier
    ds_read_b64 v[92:93], v51 offset:29568
    ds_read_b32 v94, v52 offset:29568
    ds_read_b64 v[100:101], v51 offset:13440
    ds_read_b32 v102, v52 offset:13440
    ds_read_b64 v[88:89], v51 offset:26880
    ds_read_b32 v90, v52 offset:26880
    ds_read_b64 v[96:97], v51 offset:10752
    ds_read_b32 v98, v52 offset:10752
    ds_read_b64 v[84:85], v51 offset:24192
    ds_read_b32 v86, v52 offset:24192
    v_mov_b32 v87, 0
    v_mov_b32 v91, 0
    v_mov_b32 v95, 0
    v_mov_b32 v99, 0
    v_mov_b32_e64 v103, 0
    s_waitcnt lgkmcnt(6)
    s_nop 0
    v_mfma_f32_16x16x32_bf16 v[108:111], v[92:95], v[100:103], v[40:43]
    s_waitcnt lgkmcnt(4)
    ds_read_b64 v[78:79], v54 offset:24
    v_mfma_f32_16x16x32_bf16 v[116:119], v[88:91], v[100:103], v[40:43]
    s_waitcnt lgkmcnt(3)
    ds_read_b128 v[80:83], v54 offset:32
    v_mfma_f32_16x16x32_bf16 v[104:107], v[88:91], v[96:99], v[40:43]
    s_waitcnt lgkmcnt(2)
    ds_read_b64 v[72:73], v53 offset:24
    v_mfma_f32_16x16x32_bf16 v[112:115], v[84:87], v[96:99], v[40:43]
    ds_read_b128 v[74:77], v53 offset:32
    v_cndmask_b32 v108, v116, v108, s[66:67]
    v_cndmask_b32 v109, v117, v109, s[68:69]
    v_cndmask_b32 v110, v118, v110, s[70:71]
    v_cndmask_b32 v111, v119, v111, s[72:73]
    s_nop 2
    v_cndmask_b32 v104, v112, v104, s[66:67]
    v_cndmask_b32 v105, v113, v105, s[68:69]
    v_cndmask_b32 v106, v114, v106, s[70:71]
    v_cndmask_b32 v107, v115, v107, s[72:73]
    v_max3_f32 v145, v108, v109, v110
    v_max3_f32 v144, v104, v105, v106
    v_max_f32 v145, v145, v111
    v_max_f32 v144, v144, v107
    s_nop 1
    v_permlane32_swap_b32 v144, v145
    v_max_f32 v144, v144, v145
    v_mov_b32 v145, v144
    s_nop 1
    v_permlane16_swap_b32 v144, v145
    v_max_f32 v144, v144, v145
    v_mul_f32 v145, s85, v144
    v_mul_f32 v144, s85, v144
    s_nop 1
    v_permlane32_swap_b32_e64 v144, v145
    v_pk_fma_f32 v[104:105], v[104:105], s[84:85], v[144:145] op_sel:[0,1,0] op_sel_hi:[1,1,0] neg_lo:[0,0,1] neg_hi:[0,0,1]
    v_pk_fma_f32 v[106:107], v[106:107], s[84:85], v[144:145] op_sel:[0,1,0] op_sel_hi:[1,1,0] neg_lo:[0,0,1] neg_hi:[0,0,1]
    v_pk_fma_f32 v[108:109], v[108:109], s[84:85], v[144:145] op_sel:[0,1,1] op_sel_hi:[1,1,1] neg_lo:[0,0,1] neg_hi:[0,0,1]
    v_pk_fma_f32 v[110:111], v[110:111], s[84:85], v[144:145] op_sel:[0,1,1] op_sel_hi:[1,1,1] neg_lo:[0,0,1] neg_hi:[0,0,1]
    s_bitcmp1_b32 s58, 1
    s_cbranch_scc0 Lnp90
    s_waitcnt vmcnt(1)
    v_xor_b32 v123, s33, v123
    s_waitcnt vmcnt(0)
    v_xor_b32 v127, s33, v127
    v_or_b32 v123, v123, v127
    v_cmp_lt_u32 vcc, 1, v123
    ds_write_b64 v63, v[120:121] offset:5376
    ds_write_b32 v64, v122 offset:16
    ds_write_b64 v63, v[124:125] offset:2688
    ds_write_b32 v64, v126 offset:8
    s_cmp_lg_u64 vcc, 0
    s_cbranch_scc1 Lre93
Lok91:
Lnp90:
    s_bitcmp1_b32 s58, 1
    s_cbranch_scc0 Lni94
    buffer_load_dwordx4 v[148:151], v46, s[16:19], s59 offen offset:0 sc1
Lni94:
    ds_read_b64 v[100:101], v51 offset:8064
    ds_read_b32 v102, v52 offset:8064
    ds_read_b64 v[92:93], v51 offset:21504
    ds_read_b32 v94, v52 offset:21504
    ds_read_b64 v[96:97], v51 offset:5376
    ds_read_b32 v98, v52 offset:5376
    ds_read_b64 v[88:89], v51 offset:18816
    ds_read_b32 v90, v52 offset:18816
    v_exp_f32 v104, v104
    v_exp_f32 v105, v105
    v_exp_f32 v106, v106
    v_exp_f32 v107, v107
    v_exp_f32 v108, v108
    v_exp_f32 v109, v109
    v_exp_f32 v110, v110
    v_exp_f32 v111, v111
    s_waitcnt lgkmcnt(6)
    v_mfma_f32_16x16x32_bf16 v[124:127], v[84:87], v[100:103], v[40:43]
    s_waitcnt lgkmcnt(4)
    v_cvt_pk_bf16_f32 v138, v104, v105
    v_cvt_pk_bf16_f32 v139, v106, v107
    v_mfma_f32_16x16x32_bf16 v[132:135], v[92:95], v[100:103], v[40:43]
    s_waitcnt lgkmcnt(2)
    v_bfi_b32 v136, v44, 0, v138
    v_bfi_b32 v137, v45, 0, v139
    v_mfma_f32_16x16x32_bf16 v[120:123], v[92:95], v[96:99], v[40:43]
    s_waitcnt lgkmcnt(0)
    v_and_b32 v138, v44, v138
    v_and_b32 v139, v45, v139
    v_mfma_f32_16x16x32_bf16 v[128:131], v[88:91], v[96:99], v[40:43]
    s_add_u32 s76, s47, 140288
    v_cvt_pk_bf16_f32 v142, v108, v109
    v_cvt_pk_bf16_f32 v143, v110, v111
    v_mfma_f32_16x16x32_bf16 v[112:115], v[78:81], v[136:139], 0
    s_add_u32 s77, s47, 146432
    v_bfi_b32 v140, v44, 0, v142
    v_bfi_b32 v141, v45, 0, v143
    v_mfma_f32_16x16x32_bf16 v[104:107], v[72:75], v[136:139], 0
    v_and_b32_e64 v142, v44, v142
    v_and_b32 v143, v45, v143
    s_nop 1
    v_mfma_f32_16x16x32_bf16 v[116:119], v[80:83], v[140:143], 0
    v_cndmask_b32 v124, v132, v124, s[66:67]
    v_cndmask_b32 v125, v133, v125, s[68:69]
    v_mfma_f32_16x16x32_bf16 v[108:111], v[74:77], v[140:143], 0
    v_cndmask_b32 v126, v134, v126, s[70:71]
    v_cndmask_b32 v127, v135, v127, s[72:73]
    v_cndmask_b32 v120, v128, v120, s[66:67]
    v_cndmask_b32 v121, v129, v121, s[68:69]
    v_cndmask_b32 v122, v130, v122, s[70:71]
    v_cndmask_b32 v123, v131, v123, s[72:73]
    v_rcp_f32 v114, v114
    v_rcp_f32 v118, v118
    v_pk_mul_f32 v[104:105], v[104:105], v[114:115] op_sel_hi:[1,0]
    v_pk_mul_f32 v[106:107], v[106:107], v[114:115] op_sel_hi:[1,0]
    v_pk_mul_f32 v[112:113], v[112:113], v[114:115] op_sel_hi:[1,0]
    v_cvt_pk_bf16_f32 v104, v104, v105
    v_cvt_pk_bf16_f32 v105, v106, v107
    v_cvt_pk_bf16_f32 v112, v112, v113
    v_pk_mul_f32 v[108:109], v[108:109], v[118:119] op_sel_hi:[1,0]
    v_pk_mul_f32 v[110:111], v[110:111], v[118:119] op_sel_hi:[1,0]
    v_pk_mul_f32 v[116:117], v[116:117], v[118:119] op_sel_hi:[1,0]
    v_cvt_pk_bf16_f32 v108, v108, v109
    v_cvt_pk_bf16_f32 v109, v110, v111
    v_cvt_pk_bf16_f32 v116, v116, v117
    buffer_store_dwordx2 v[104:105], v55, s[16:19], s76 offen
    buffer_store_dwordx2 v[108:109], v55, s[16:19], s77 offen
    v_mov_b32_dpp v112, v116 quad_perm:[0,1,2,3] row_mask:0x2 bank_mask:0xf
    buffer_store_dword v112, v56, s[16:19], s76 offen
    v_max3_f32 v145, v124, v125, v126
    v_max3_f32 v144, v120, v121, v122
    v_max_f32 v145, v145, v127
    v_max_f32 v144, v144, v123
    ds_read_b64 v[78:79], v54 offset:8
    ds_read_b128 v[80:83], v54 offset:16
    v_permlane32_swap_b32 v144, v145
    v_max_f32 v144, v144, v145
    v_mov_b32_e64 v145, v144
    ds_read_b64 v[72:73], v53 offset:8
    ds_read_b128 v[74:77], v53 offset:16
    v_permlane16_swap_b32 v144, v145
    v_max_f32 v144, v144, v145
    v_mul_f32 v145, s85, v144
    v_mul_f32 v144, s85, v144
    s_cmp_eq_u32 s43, 0
    s_cselect_b32 s81, s84, 0
    v_permlane32_swap_b32 v144, v145
    v_min_f32 v116, s81, v40
    v_min_f32 v117, s81, v41
    v_min_f32 v118, s81, v42
    v_min_f32 v119, s81, v43
    v_mov_b32 v112, s84
    v_mov_b32 v113, s84
    v_mov_b32 v114, s84
    v_mov_b32_e64 v115, s84
    v_pk_fma_f32 v[120:121], v[120:121], s[84:85], v[144:145] op_sel:[0,1,0] op_sel_hi:[1,1,0] neg_lo:[0,0,1] neg_hi:[0,0,1]
    v_pk_fma_f32 v[122:123], v[122:123], s[84:85], v[144:145] op_sel:[0,1,0] op_sel_hi:[1,1,0] neg_lo:[0,0,1] neg_hi:[0,0,1]
    v_pk_fma_f32 v[124:125], v[124:125], s[84:85], v[144:145] op_sel:[0,1,1] op_sel_hi:[1,1,1] neg_lo:[0,0,1] neg_hi:[0,0,1]
    v_pk_fma_f32 v[126:127], v[126:127], s[84:85], v[144:145] op_sel:[0,1,1] op_sel_hi:[1,1,1] neg_lo:[0,0,1] neg_hi:[0,0,1]
    s_bitcmp1_b32 s58, 1
    s_cbranch_scc0 Lnp95
    s_waitcnt vmcnt(3)
    v_xor_b32 v151, s33, v151
    v_cmp_lt_u32_e64 vcc, 1, v151
    ds_write_b64 v63, v[148:149] offset:0
    ds_write_b32 v64, v150 offset:0
    s_cmp_lg_u64 vcc, 0
    s_cbranch_scc1 Lre98
Lok96:
Lnp95:
    ds_read_b64 v[100:101], v51 offset:2688
    ds_read_b32 v102, v52 offset:2688
    ds_read_b64 v[84:85], v51 offset:16128
    ds_read_b32 v86, v52 offset:16128
    ds_read_b64 v[96:97], v51 offset:0
    ds_read_b32 v98, v52 offset:0
    v_exp_f32 v120, v120
    v_exp_f32 v121, v121
    v_exp_f32 v122, v122
    v_exp_f32 v123, v123
    v_exp_f32 v124, v124
    v_exp_f32 v125, v125
    v_exp_f32_e64 v126, v126
    v_exp_f32 v127, v127
    s_waitcnt vmcnt(0)
    buffer_store_dword v68, v57, s[16:19], s47 offen offset:480
    s_waitcnt lgkmcnt(4)
    v_mfma_f32_16x16x32_bf16 v[108:111], v[88:91], v[100:103], v[40:43]
    s_waitcnt lgkmcnt(2)
    v_cvt_pk_bf16_f32 v138, v120, v121
    v_cvt_pk_bf16_f32 v139, v122, v123
    v_mfma_f32_16x16x32_bf16 v[116:119], v[84:87], v[100:103], v[116:119]
    s_waitcnt lgkmcnt(0)
    v_bfi_b32 v136, v44, 0, v138
    v_bfi_b32 v137, v45, 0, v139
    v_mfma_f32_16x16x32_bf16 v[104:107], v[84:87], v[96:99], v[40:43]
    s_add_u32 s76, s47, 66560
    s_add_u32 s77, s47, 72704
    v_and_b32 v138, v44, v138
    v_and_b32 v139, v45, v139
    s_nop 1
    v_mfma_f32_16x16x32_bf16 v[128:131], v[78:81], v[136:139], 0
    v_cvt_pk_bf16_f32 v142, v124, v125
    v_cvt_pk_bf16_f32 v143, v126, v127
    v_mfma_f32_16x16x32_bf16 v[120:123], v[72:75], v[136:139], 0
    v_bfi_b32 v140, v44, 0, v142
    v_bfi_b32 v141, v45, 0, v143
    v_and_b32_e64 v142, v44, v142
    v_and_b32 v143, v45, v143
    s_nop 1
    v_mfma_f32_16x16x32_bf16 v[132:135], v[80:83], v[140:143], 0
    v_cndmask_b32 v108, v116, v108, s[66:67]
    v_cndmask_b32 v109, v117, v109, s[68:69]
    v_mfma_f32_16x16x32_bf16 v[124:127], v[74:77], v[140:143], 0
    v_cndmask_b32 v110, v118, v110, s[70:71]
    v_cndmask_b32 v111, v119, v111, s[72:73]
    v_cndmask_b32 v104, v112, v104, s[66:67]
    v_cndmask_b32 v105, v113, v105, s[68:69]
    v_cndmask_b32 v106, v114, v106, s[70:71]
    v_cndmask_b32 v107, v115, v107, s[72:73]
    v_rcp_f32 v130, v130
    v_rcp_f32 v134, v134
    v_pk_mul_f32 v[120:121], v[120:121], v[130:131] op_sel_hi:[1,0]
    v_pk_mul_f32 v[122:123], v[122:123], v[130:131] op_sel_hi:[1,0]
    v_pk_mul_f32 v[128:129], v[128:129], v[130:131] op_sel_hi:[1,0]
    v_cvt_pk_bf16_f32 v120, v120, v121
    v_cvt_pk_bf16_f32 v121, v122, v123
    v_cvt_pk_bf16_f32 v128, v128, v129
    v_pk_mul_f32 v[124:125], v[124:125], v[134:135] op_sel_hi:[1,0]
    v_pk_mul_f32 v[126:127], v[126:127], v[134:135] op_sel_hi:[1,0]
    v_pk_mul_f32 v[132:133], v[132:133], v[134:135] op_sel_hi:[1,0]
    v_cvt_pk_bf16_f32 v124, v124, v125
    v_cvt_pk_bf16_f32 v125, v126, v127
    v_cvt_pk_bf16_f32 v132, v132, v133
    buffer_store_dwordx2 v[120:121], v55, s[16:19], s76 offen
    buffer_store_dwordx2 v[124:125], v55, s[16:19], s77 offen
    v_mov_b32_dpp v128, v132 quad_perm:[0,1,2,3] row_mask:0x2 bank_mask:0xf
    buffer_store_dword v128, v56, s[16:19], s76 offen
    buffer_load_dword v146, v58, s[16:19], s47 offen offset:480 sc1
    v_max3_f32 v145, v108, v109, v110
    v_max3_f32 v144, v104, v105, v106
    v_max_f32 v145, v145, v111
    v_max_f32 v144, v144, v107
    ds_read_b128 v[80:83], v54 offset:0
    ds_read_b128 v[74:77], v53 offset:0
    v_permlane32_swap_b32 v144, v145
    v_max_f32 v144, v144, v145
    v_mov_b32 v145, v144
    v_mov_b32 v78, 0
    v_mov_b32 v79, 0
    v_permlane16_swap_b32 v144, v145
    v_max_f32 v144, v144, v145
    v_mul_f32 v145, s85, v144
    v_mul_f32 v144, s85, v144
    v_mov_b32 v72, 0
    v_mov_b32 v73, 0
    v_permlane32_swap_b32 v144, v145
    v_pk_fma_f32 v[104:105], v[104:105], s[84:85], v[144:145] op_sel:[0,1,0] op_sel_hi:[1,1,0] neg_lo:[0,0,1] neg_hi:[0,0,1]
    v_pk_fma_f32 v[106:107], v[106:107], s[84:85], v[144:145] op_sel:[0,1,0] op_sel_hi:[1,1,0] neg_lo:[0,0,1] neg_hi:[0,0,1]
    v_pk_fma_f32 v[108:109], v[108:109], s[84:85], v[144:145] op_sel:[0,1,1] op_sel_hi:[1,1,1] neg_lo:[0,0,1] neg_hi:[0,0,1]
    v_pk_fma_f32 v[110:111], v[110:111], s[84:85], v[144:145] op_sel:[0,1,1] op_sel_hi:[1,1,1] neg_lo:[0,0,1] neg_hi:[0,0,1]
    v_exp_f32 v104, v104
    v_exp_f32 v105, v105
    v_exp_f32 v106, v106
    v_exp_f32 v107, v107
    v_exp_f32 v108, v108
    v_exp_f32 v109, v109
    v_exp_f32_e64 v110, v110
    v_exp_f32 v111, v111
    s_waitcnt vmcnt(0)
    v_cmp_ne_u32 s[34:35], s46, v146
    buffer_store_dword v68, v57, s[16:19], s47 offen offset:640
    s_add_u32 s78, s87, s47
    s_add_u32 m0, s87, 0
    s_add_u32 s78, s78, 140288
    s_cmp_lg_u64 s[34:35], 0
    s_cbranch_scc1 Lre101
Lok99:
    buffer_load_dwordx4 v46, s[16:19], s78 offen offset:0 sc1 lds
    buffer_load_dwordx4 v46, s[16:19], s78 offen offset:1024 sc1 lds
    Lw6: s_cbranch_execz Lwx
    v_cvt_pk_bf16_f32 v138, v104, v105
    v_cvt_pk_bf16_f32 v139, v106, v107
    v_bfi_b32 v136, v44, 0, v138
    v_bfi_b32 v137, v45, 0, v139
    v_and_b32 v138, v44, v138
    v_and_b32 v139, v45, v139
    s_waitcnt lgkmcnt(1)
    s_nop 0
    v_mfma_f32_16x16x32_bf16 v[112:115], v[78:81], v[136:139], 0
    s_waitcnt lgkmcnt(0)
    v_cvt_pk_bf16_f32 v142, v108, v109
    v_cvt_pk_bf16_f32 v143, v110, v111
    v_mfma_f32_16x16x32_bf16 v[104:107], v[72:75], v[136:139], 0
    s_add_u32 s76, s47, 103424
    s_add_u32 s77, s47, 109568
    v_bfi_b32 v140, v44, 0, v142
    v_bfi_b32 v141, v45, 0, v143
    v_and_b32_e64 v142, v44, v142
    v_and_b32 v143, v45, v143
    s_nop 1
    v_mfma_f32_16x16x32_bf16 v[116:119], v[80:83], v[140:143], 0
    v_rcp_f32 v114, v114
    v_mfma_f32_16x16x32_bf16 v[108:111], v[74:77], v[140:143], 0
    buffer_load_dwordx4 v46, s[16:19], s78 offen offset:2048 sc1 lds
    s_add_u32 s78, s87, s47
    s_add_u32 m0, s87, 12288
    s_add_u32 s78, s78, 152576
    buffer_load_dwordx4 v46, s[16:19], s78 offen offset:0 sc1 lds
    v_rcp_f32_e64 v118, v118
    v_pk_mul_f32 v[104:105], v[104:105], v[114:115] op_sel_hi:[1,0]
    v_pk_mul_f32 v[106:107], v[106:107], v[114:115] op_sel_hi:[1,0]
    v_pk_mul_f32 v[112:113], v[112:113], v[114:115] op_sel_hi:[1,0]
    v_cvt_pk_bf16_f32 v104, v104, v105
    v_cvt_pk_bf16_f32 v105, v106, v107
    v_cvt_pk_bf16_f32 v112, v112, v113
    v_pk_mul_f32 v[108:109], v[108:109], v[118:119] op_sel_hi:[1,0]
    v_pk_mul_f32 v[110:111], v[110:111], v[118:119] op_sel_hi:[1,0]
    v_pk_mul_f32 v[116:117], v[116:117], v[118:119] op_sel_hi:[1,0]
    v_cvt_pk_bf16_f32 v108, v108, v109
    v_cvt_pk_bf16_f32 v109, v110, v111
    v_cvt_pk_bf16_f32 v116, v116, v117
    buffer_store_dwordx2 v[104:105], v55, s[16:19], s76 offen
    buffer_store_dwordx2 v[108:109], v55, s[16:19], s77 offen
    v_mov_b32_dpp v112, v116 quad_perm:[0,1,2,3] row_mask:0x2 bank_mask:0xf
    buffer_store_dword v112, v56, s[16:19], s76 offen
    buffer_load_dword v146, v58, s[16:19], s47 offen offset:640 sc1
    s_mul_i32 s81, s53, 6144
    v_add_u32 v96, s81, v46
    v_add_u32 v97, 36864, v96
    s_lshl_b32 s81, s53, 6
    s_add_u32 s81, s81, 768
    v_add_u32 v99, s81, v49
    buffer_load_dwordx4 v46, s[16:19], s78 offen offset:1024 sc1 lds
    buffer_load_dwordx4 v46, s[16:19], s78 offen offset:2048 sc1 lds
    s_add_u32 s78, s87, s47
    s_add_u32 m0, s87, 24576
    s_add_u32 s78, s78, 164864
    buffer_load_dwordx4 v46, s[16:19], s78 offen offset:0 sc1 lds
    s_waitcnt vmcnt(8) lgkmcnt(0)
    s_barrier
    ds_read_b128 v[72:75], v96 offset:0
    ds_read_b128 v[76:79], v96 offset:1024
    ds_read_b128 v[80:83], v96 offset:2048
    ds_read_b128 v[84:87], v96 offset:3072
    ds_read_b128 v[88:91], v96 offset:4096
    ds_read_b128 v[92:95], v96 offset:5120
    s_waitcnt lgkmcnt(5)
    v_mfma_f32_16x16x32_bf16 v[0:3], a[216:219], v[72:75], v[0:3]
    s_waitcnt vmcnt(3)
    ds_read2_b32 v[130:131], v99 offset0:32 offset1:128
    v_cmp_ne_u32 s[34:35], s46, v146
    v_mfma_f32_16x16x32_bf16 v[4:7], a[220:223], v[72:75], v[4:7]
    s_waitcnt lgkmcnt(0)
    ds_read2_b32 v[132:133], v99 offset0:0 offset1:96
    v_add_f32 v130, 1.0, v130
    v_mfma_f32_16x16x32_bf16 v[0:3], a[224:227], v[76:79], v[0:3]
    v_fma_f32 v8, v8, v130, v131
    v_fma_f32 v9, v9, v130, v131
    buffer_load_dwordx4 v46, s[16:19], s78 offen offset:1024 sc1 lds
    buffer_load_dwordx4 v46, s[16:19], s78 offen offset:2048 sc1 lds
    v_mfma_f32_16x16x32_bf16 v[4:7], a[228:231], v[76:79], v[4:7]
    s_cmp_lg_u64 s[34:35], 0
    s_cbranch_scc1 Lre104
Lok102:
    v_fma_f32 v10, v10, v130, v131
    v_mfma_f32_16x16x32_bf16 v[0:3], a[232:235], v[80:83], v[0:3]
    buffer_store_dword v68, v57, s[16:19], s47 offen offset:800
    s_add_u32 s78, s87, s47
    v_mfma_f32_16x16x32_bf16 v[4:7], a[236:239], v[80:83], v[4:7]
    s_add_u32 m0, s87, 36864
    s_add_u32 s78, s78, 66560
    v_fma_f32 v11, v11, v130, v131
    v_mfma_f32_16x16x32_bf16 v[0:3], a[240:243], v[84:87], v[0:3]
    s_waitcnt vmcnt(4)
    s_barrier
    v_fma_f32 v12, v12, v130, v131
    v_mfma_f32_16x16x32_bf16 v[4:7], a[244:247], v[84:87], v[4:7]
    s_nop 0
    ds_read_b128 v[72:75], v96 offset:12288
    v_fma_f32 v13, v13, v130, v131
    v_mfma_f32_16x16x32_bf16 v[0:3], a[248:251], v[88:91], v[0:3]
    ds_read_b128 v[76:79], v96 offset:13312
    v_fma_f32 v14, v14, v130, v131
    v_mfma_f32_16x16x32_bf16 v[4:7], a[252:255], v[88:91], v[4:7]
    ds_read_b128 v[80:83], v96 offset:14336
    v_fma_f32 v15, v15, v130, v131
    v_mfma_f32_16x16x32_bf16 v[0:3], v[152:155], v[92:95], v[0:3]
    s_waitcnt lgkmcnt(3)
    ds_read_b128 v[84:87], v96 offset:15360
    v_add_f32 v132, 1.0, v132
    v_mfma_f32_16x16x32_bf16 v[4:7], v[156:159], v[92:95], v[4:7]
    s_waitcnt lgkmcnt(3)
    ds_read_b128 v[88:91], v96 offset:16384
    v_fma_f32 v16, v16, v132, v133
    v_mfma_f32_16x16x32_bf16 v[0:3], v[160:163], v[72:75], v[0:3]
    ds_read_b128 v[92:95], v96 offset:17408
    v_fma_f32 v17, v17, v132, v133
    v_mfma_f32_16x16x32_bf16 v[4:7], v[164:167], v[72:75], v[4:7]
    s_waitcnt lgkmcnt(4)
    buffer_load_dwordx4 v46, s[16:19], s78 offen offset:0 sc1 lds
    v_mfma_f32_16x16x32_bf16 v[0:3], v[168:171], v[76:79], v[0:3]
    v_fma_f32 v18, v18, v132, v133
    v_fma_f32 v19, v19, v132, v133
    buffer_load_dwordx4 v46, s[16:19], s78 offen offset:1024 sc1 lds
    buffer_load_dwordx4 v46, s[16:19], s78 offen offset:2048 sc1 lds
    v_mfma_f32_16x16x32_bf16 v[4:7], v[172:175], v[76:79], v[4:7]
    s_waitcnt lgkmcnt(3)
    s_add_u32 s78, s87, s47
    v_fma_f32 v20, v20, v132, v133
    v_mfma_f32_16x16x32_bf16 v[0:3], v[176:179], v[80:83], v[0:3]
    s_add_u32 m0, s87, 49152
    s_add_u32 s78, s78, 78848
    v_fma_f32 v21, v21, v132, v133
    v_mfma_f32_16x16x32_bf16 v[4:7], v[180:183], v[80:83], v[4:7]
    s_waitcnt lgkmcnt(2)
    v_fma_f32 v22, v22, v132, v133
    v_fma_f32 v23, v23, v132, v133
    v_mfma_f32_16x16x32_bf16 v[0:3], v[184:187], v[84:87], v[0:3]
    s_waitcnt vmcnt(4)
    s_barrier
    v_mfma_f32_16x16x32_bf16 v[4:7], v[188:191], v[84:87], v[4:7]
    s_waitcnt lgkmcnt(1)
    ds_read_b128 v[72:75], v96 offset:24576
    v_mfma_f32_16x16x32_bf16 v[0:3], v[192:195], v[88:91], v[0:3]
    buffer_load_dword v98, v58, s[16:19], s47 offen offset:800 sc1
    ds_read_b128 v[76:79], v96 offset:25600
    v_mfma_f32_16x16x32_bf16 v[4:7], v[196:199], v[88:91], v[4:7]
    s_waitcnt lgkmcnt(2)
    ds_read_b128 v[80:83], v96 offset:26624
    v_mfma_f32_16x16x32_bf16 v[0:3], v[200:203], v[92:95], v[0:3]
    buffer_load_dwordx4 v46, s[16:19], s78 offen offset:0 sc1 lds
    ds_read_b128 v[84:87], v96 offset:27648
    v_mfma_f32_16x16x32_bf16 v[4:7], v[204:207], v[92:95], v[4:7]
    s_waitcnt lgkmcnt(3)
    ds_read_b128 v[88:91], v96 offset:28672
    v_mfma_f32_16x16x32_bf16 v[0:3], v[208:211], v[72:75], v[0:3]
    buffer_load_dwordx4 v46, s[16:19], s78 offen offset:1024 sc1 lds
    ds_read_b128 v[92:95], v96 offset:29696
    v_mfma_f32_16x16x32_bf16 v[4:7], v[212:215], v[72:75], v[4:7]
    s_waitcnt lgkmcnt(4)
    v_mfma_f32_16x16x32_bf16 v[0:3], v[216:219], v[76:79], v[0:3]
    buffer_load_dwordx4 v46, s[16:19], s78 offen offset:2048 sc1 lds
    v_mfma_f32_16x16x32_bf16 v[4:7], v[220:223], v[76:79], v[4:7]
    s_waitcnt lgkmcnt(3)
    s_add_u32 s78, s87, s47
    v_mfma_f32_16x16x32_bf16 v[0:3], v[224:227], v[80:83], v[0:3]
    s_add_u32 m0, s87, 61440
    s_add_u32 s78, s78, 91136
    v_mfma_f32_16x16x32_bf16 v[4:7], v[228:231], v[80:83], v[4:7]
    s_waitcnt lgkmcnt(2)
    v_mfma_f32_16x16x32_bf16 v[0:3], v[232:235], v[84:87], v[0:3]
    s_waitcnt vmcnt(4)
    s_barrier
    v_mfma_f32_16x16x32_bf16 v[4:7], v[236:239], v[84:87], v[4:7]
    s_waitcnt lgkmcnt(1)
    ds_read_b128 v[72:75], v97 offset:0
    v_mfma_f32_16x16x32_bf16 v[0:3], v[240:243], v[88:91], v[0:3]
    buffer_load_dwordx4 v46, s[16:19], s78 offen offset:0 sc1 lds
    ds_read_b128 v[76:79], v97 offset:1024
    v_mfma_f32_16x16x32_bf16 v[4:7], v[244:247], v[88:91], v[4:7]
    s_waitcnt lgkmcnt(2)
    ds_read_b128 v[80:83], v97 offset:2048
    v_mfma_f32_16x16x32_bf16 v[0:3], v[248:251], v[92:95], v[0:3]
    s_waitcnt vmcnt(4)
    ds_read_b128 v[84:87], v97 offset:3072
    v_cmp_ne_u32 s[34:35], s46, v98
    v_mfma_f32_16x16x32_bf16 v[4:7], v[252:255], v[92:95], v[4:7]
    s_waitcnt lgkmcnt(3)
    ds_read_b128 v[88:91], v97 offset:4096
    v_mfma_f32_16x16x32_bf16 v[8:11], a[216:219], v[72:75], v[8:11]
    buffer_load_dwordx4 v46, s[16:19], s78 offen offset:1024 sc1 lds
    ds_read_b128 v[92:95], v97 offset:5120
    v_mfma_f32_16x16x32_bf16 v[12:15], a[220:223], v[72:75], v[12:15]
    s_waitcnt lgkmcnt(4)
    s_cmp_lg_u64 s[34:35], 0
    s_cbranch_scc1 Lre108
Lok106:
    v_mfma_f32_16x16x32_bf16 v[8:11], a[224:227], v[76:79], v[8:11]
    s_nop 0
    v_cvt_pk_bf16_f32 v140, v0, v1
    v_cvt_pk_bf16_f32 v141, v2, v3
    buffer_load_dwordx4 v46, s[16:19], s78 offen offset:2048 sc1 lds
    v_mfma_f32_16x16x32_bf16 v[12:15], a[228:231], v[76:79], v[12:15]
    s_waitcnt lgkmcnt(3)
    s_add_u32 s78, s87, s47
    v_cvt_pk_bf16_f32 v142, v4, v5
    v_mfma_f32_16x16x32_bf16 v[8:11], a[232:235], v[80:83], v[8:11]
    s_add_u32 m0, s87, 73728
    s_add_u32 s78, s78, 103424
    v_cvt_pk_bf16_f32 v143, v6, v7
    v_mfma_f32_16x16x32_bf16 v[12:15], a[236:239], v[80:83], v[12:15]
    s_waitcnt lgkmcnt(2)
    s_or_b32 s79, s46, 5
    v_mfma_f32_16x16x32_bf16 v[100:103], v[140:143], v[140:143], 0
    v_mfma_f32_16x16x32_bf16 v[146:149], v[36:39], v[140:143], 0
    s_nop 3
    v_cndmask_b32 v100, v100, v101, s[60:61]
    v_cndmask_b32 v102, v102, v103, s[60:61]
    s_nop 1
    v_mov_b32 v149, s79
    v_cndmask_b32 v148, v100, v102, s[62:63]
    v_mfma_f32_16x16x32_bf16 v[8:11], a[240:243], v[84:87], v[8:11]
    s_waitcnt vmcnt(3)
    s_barrier
    v_mfma_f32_16x16x32_bf16 v[12:15], a[244:247], v[84:87], v[12:15]
    s_waitcnt lgkmcnt(1)
    ds_read_b128 v[72:75], v97 offset:12288
    v_mfma_f32_16x16x32_bf16 v[8:11], a[248:251], v[88:91], v[8:11]
    buffer_store_dwordx4 v[146:149], v60, s[16:19], s47 offen offset:3072
    ds_read_b128 v[76:79], v97 offset:13312
    ds_read_b128 v[80:83], v97 offset:14336
    ds_read_b128 v[84:87], v97 offset:15360
    v_mfma_f32_16x16x32_bf16 v[12:15], a[252:255], v[88:91], v[12:15]
    s_waitcnt lgkmcnt(4)
    ds_read_b128 v[88:91], v97 offset:16384
    v_mfma_f32_16x16x32_bf16 v[8:11], v[152:155], v[92:95], v[8:11]
    buffer_load_dwordx4 v46, s[16:19], s78 offen offset:0 sc1 lds
    v_mfma_f32_16x16x32_bf16 v[12:15], v[156:159], v[92:95], v[12:15]
    s_waitcnt lgkmcnt(4)
    ds_read_b128 v[92:95], v97 offset:17408
    v_mfma_f32_16x16x32_bf16 v[8:11], v[160:163], v[72:75], v[8:11]
    v_mfma_f32_16x16x32_bf16 v[12:15], v[164:167], v[72:75], v[12:15]
    s_waitcnt lgkmcnt(4)
    buffer_load_dwordx4 v46, s[16:19], s78 offen offset:1024 sc1 lds
    v_mfma_f32_16x16x32_bf16 v[8:11], v[168:171], v[76:79], v[8:11]
    buffer_load_dwordx4 v46, s[16:19], s78 offen offset:2048 sc1 lds
    v_mfma_f32_16x16x32_bf16 v[12:15], v[172:175], v[76:79], v[12:15]
    s_waitcnt lgkmcnt(3)
    s_add_u32 s78, s87, s47
    v_mfma_f32_16x16x32_bf16 v[8:11], v[176:179], v[80:83], v[8:11]
    s_add_u32 m0, s87, 86016
    s_add_u32 s78, s78, 115712
    v_mfma_f32_16x16x32_bf16 v[12:15], v[180:183], v[80:83], v[12:15]
    s_waitcnt lgkmcnt(2)
    v_mfma_f32_16x16x32_bf16 v[8:11], v[184:187], v[84:87], v[8:11]
    s_waitcnt vmcnt(4)
    s_barrier
    v_mfma_f32_16x16x32_bf16 v[12:15], v[188:191], v[84:87], v[12:15]
    s_waitcnt lgkmcnt(1)
    ds_read_b128 v[72:75], v97 offset:24576
    v_mfma_f32_16x16x32_bf16 v[8:11], v[192:195], v[88:91], v[8:11]
    ds_read_b128 v[76:79], v97 offset:25600
    v_mfma_f32_16x16x32_bf16 v[12:15], v[196:199], v[88:91], v[12:15]
    s_waitcnt lgkmcnt(2)
    ds_read_b128 v[80:83], v97 offset:26624
    v_mfma_f32_16x16x32_bf16 v[8:11], v[200:203], v[92:95], v[8:11]
    buffer_load_dwordx4 v46, s[16:19], s78 offen offset:0 sc1 lds
    ds_read_b128 v[84:87], v97 offset:27648
    v_mfma_f32_16x16x32_bf16 v[12:15], v[204:207], v[92:95], v[12:15]
    s_waitcnt lgkmcnt(3)
    ds_read_b128 v[88:91], v97 offset:28672
    v_mfma_f32_16x16x32_bf16 v[8:11], v[208:211], v[72:75], v[8:11]
    ds_read_b128 v[92:95], v97 offset:29696
    v_mfma_f32_16x16x32_bf16 v[12:15], v[212:215], v[72:75], v[12:15]
    s_waitcnt lgkmcnt(4)
    buffer_load_dwordx4 v46, s[16:19], s78 offen offset:1024 sc1 lds
    v_mfma_f32_16x16x32_bf16 v[8:11], v[216:219], v[76:79], v[8:11]
    buffer_load_dwordx4 v46, s[16:19], s78 offen offset:2048 sc1 lds
    v_mfma_f32_16x16x32_bf16 v[12:15], v[220:223], v[76:79], v[12:15]
    s_waitcnt lgkmcnt(3)
    s_add_u32 s78, s87, s47
    v_mfma_f32_16x16x32_bf16 v[8:11], v[224:227], v[80:83], v[8:11]
    s_add_u32 m0, s87, 98304
    s_add_u32 s78, s78, 128000
    v_mfma_f32_16x16x32_bf16 v[12:15], v[228:231], v[80:83], v[12:15]
    s_waitcnt lgkmcnt(2)
    v_mfma_f32_16x16x32_bf16 v[8:11], v[232:235], v[84:87], v[8:11]
    s_waitcnt vmcnt(3)
    s_barrier
    v_mfma_f32_16x16x32_bf16 v[12:15], v[236:239], v[84:87], v[12:15]
    s_waitcnt lgkmcnt(1)
    v_add_u32 v96, 73728, v96
    v_mfma_f32_16x16x32_bf16 v[8:11], v[240:243], v[88:91], v[8:11]
    buffer_load_dwordx4 v46, s[16:19], s78 offen offset:0 sc1 lds
    ds_read_b128 v[72:75], v96 offset:0
    v_mfma_f32_16x16x32_bf16 v[12:15], v[244:247], v[88:91], v[12:15]
    s_waitcnt lgkmcnt(1)
    ds_read_b128 v[76:79], v96 offset:1024
    v_mfma_f32_16x16x32_bf16 v[8:11], v[248:251], v[92:95], v[8:11]
    buffer_load_dwordx4 v46, s[16:19], s78 offen offset:1024 sc1 lds
    ds_read_b128 v[80:83], v96 offset:2048
    v_mfma_f32_16x16x32_bf16 v[12:15], v[252:255], v[92:95], v[12:15]
    s_waitcnt lgkmcnt(2)
    ds_read_b128 v[84:87], v96 offset:3072
    v_mfma_f32_16x16x32_bf16 v[16:19], a[216:219], v[72:75], v[16:19]
    ds_read_b128 v[88:91], v96 offset:4096
    v_mfma_f32_16x16x32_bf16 v[20:23], a[220:223], v[72:75], v[20:23]
    s_waitcnt lgkmcnt(3)
    ds_read_b128 v[92:95], v96 offset:5120
    v_cvt_pk_bf16_f32 v116, v8, v9
    v_mfma_f32_16x16x32_bf16 v[16:19], a[224:227], v[76:79], v[16:19]
    buffer_load_dwordx4 v46, s[16:19], s78 offen offset:2048 sc1 lds
    v_cvt_pk_bf16_f32 v117, v10, v11
    v_mfma_f32_16x16x32_bf16 v[20:23], a[228:231], v[76:79], v[20:23]
    s_waitcnt lgkmcnt(3)
    v_cvt_pk_bf16_f32 v118, v12, v13
    v_cvt_pk_bf16_f32 v119, v14, v15
    v_mfma_f32_16x16x32_bf16 v[16:19], a[232:235], v[80:83], v[16:19]
    s_or_b32 s79, s46, 5
    v_mfma_f32_16x16x32_bf16 v[100:103], v[116:119], v[116:119], 0
    v_mfma_f32_16x16x32_bf16 v[104:107], v[36:39], v[116:119], 0
    s_nop 3
    v_cndmask_b32 v100, v100, v101, s[60:61]
    v_cndmask_b32 v102, v102, v103, s[60:61]
    s_nop 1
    v_mov_b32 v107, s79
    v_cndmask_b32 v106, v100, v102, s[62:63]
    v_mfma_f32_16x16x32_bf16 v[20:23], a[236:239], v[80:83], v[20:23]
    s_waitcnt lgkmcnt(2)
    v_mfma_f32_16x16x32_bf16 v[16:19], a[240:243], v[84:87], v[16:19]
    buffer_store_dwordx4 v[104:107], v60, s[16:19], s47 offen offset:2560
    s_waitcnt vmcnt(4)
    s_barrier
    v_mfma_f32_16x16x32_bf16 v[20:23], a[244:247], v[84:87], v[20:23]
    s_waitcnt lgkmcnt(1)
    ds_read_b128 v[72:75], v96 offset:12288
    v_mfma_f32_16x16x32_bf16 v[16:19], a[248:251], v[88:91], v[16:19]
    buffer_load_dwordx4 v[112:115], v61, s[16:19], s47 offen offset:3072 sc1
    ds_read_b128 v[76:79], v96 offset:13312
    v_mfma_f32_16x16x32_bf16 v[20:23], a[252:255], v[88:91], v[20:23]
    s_waitcnt lgkmcnt(2)
    ds_read_b128 v[80:83], v96 offset:14336
    v_mfma_f32_16x16x32_bf16 v[16:19], v[152:155], v[92:95], v[16:19]
    ds_read_b128 v[84:87], v96 offset:15360
    v_mfma_f32_16x16x32_bf16 v[20:23], v[156:159], v[92:95], v[20:23]
    s_waitcnt lgkmcnt(3)
    ds_read_b128 v[88:91], v96 offset:16384
    v_mfma_f32_16x16x32_bf16 v[16:19], v[160:163], v[72:75], v[16:19]
    ds_read_b128 v[92:95], v96 offset:17408
    v_mfma_f32_16x16x32_bf16 v[20:23], v[164:167], v[72:75], v[20:23]
    s_waitcnt lgkmcnt(4)
    v_mfma_f32_16x16x32_bf16 v[16:19], v[168:171], v[76:79], v[16:19]
    s_add_u32 s81, s47, 12288
    buffer_load_dwordx4 v[116:119], v61, s[16:19], s81 offen offset:3072 sc1
    v_mfma_f32_16x16x32_bf16 v[20:23], v[172:175], v[76:79], v[20:23]
    s_waitcnt lgkmcnt(3)
    v_mfma_f32_16x16x32_bf16 v[16:19], v[176:179], v[80:83], v[16:19]
    s_add_u32 s81, s47, 24576
    buffer_load_dwordx4 v[120:123], v69, s[16:19], s81 offen offset:3072 sc1
    v_mfma_f32_16x16x32_bf16 v[20:23], v[180:183], v[80:83], v[20:23]
    s_waitcnt lgkmcnt(2)
    v_mfma_f32_16x16x32_bf16 v[16:19], v[184:187], v[84:87], v[16:19]
    s_waitcnt vmcnt(4)
    s_barrier
    v_mfma_f32_16x16x32_bf16 v[20:23], v[188:191], v[84:87], v[20:23]
    s_waitcnt lgkmcnt(1)
    ds_read_b128 v[72:75], v96 offset:24576
    v_mfma_f32_16x16x32_bf16 v[16:19], v[192:195], v[88:91], v[16:19]
    buffer_load_dwordx4 v[128:131], v61, s[16:19], s47 offen offset:2560 sc1
    ds_read_b128 v[76:79], v96 offset:25600
    v_mfma_f32_16x16x32_bf16 v[20:23], v[196:199], v[88:91], v[20:23]
    s_waitcnt lgkmcnt(2)
    ds_read_b128 v[80:83], v96 offset:26624
    v_mfma_f32_16x16x32_bf16 v[16:19], v[200:203], v[92:95], v[16:19]
    ds_read_b128 v[84:87], v96 offset:27648
    v_mfma_f32_16x16x32_bf16 v[20:23], v[204:207], v[92:95], v[20:23]
    s_waitcnt lgkmcnt(3)
    ds_read_b128 v[88:91], v96 offset:28672
    v_mfma_f32_16x16x32_bf16 v[16:19], v[208:211], v[72:75], v[16:19]
    ds_read_b128 v[92:95], v96 offset:29696
    v_mfma_f32_16x16x32_bf16 v[20:23], v[212:215], v[72:75], v[20:23]
    s_waitcnt lgkmcnt(4)
    v_mfma_f32_16x16x32_bf16 v[16:19], v[216:219], v[76:79], v[16:19]
    s_add_u32 s81, s47, 12288
    buffer_load_dwordx4 v[132:135], v61, s[16:19], s81 offen offset:2560 sc1
    v_mfma_f32_16x16x32_bf16 v[20:23], v[220:223], v[76:79], v[20:23]
    s_waitcnt lgkmcnt(3)
    v_mfma_f32_16x16x32_bf16 v[16:19], v[224:227], v[80:83], v[16:19]
    s_add_u32 s81, s47, 24576
    buffer_load_dwordx4 v[136:139], v69, s[16:19], s81 offen offset:2560 sc1
    v_mfma_f32_16x16x32_bf16 v[20:23], v[228:231], v[80:83], v[20:23]
    s_waitcnt vmcnt(4) lgkmcnt(2)
    v_cmp_ne_u32 s[74:75], s79, v115
    v_cmp_ne_u32 s[92:93], s79, v119
    v_mfma_f32_16x16x32_bf16 v[16:19], v[232:235], v[84:87], v[16:19]
    s_waitcnt vmcnt(3)
    v_cmp_ne_u32 vcc, s79, v123
    s_or_b64 s[74:75], s[74:75], s[92:93]
    v_mfma_f32_16x16x32_bf16 v[20:23], v[236:239], v[84:87], v[20:23]
    s_waitcnt lgkmcnt(1)
    s_and_b32 s92, vcc_lo, 0xffff
    s_or_b32 s74, s74, s75
    v_mfma_f32_16x16x32_bf16 v[16:19], v[240:243], v[88:91], v[16:19]
    s_or_b32 s74, s74, s92
    s_cbranch_scc1 Lre112
Lok110:
    v_add_f32 v112, v112, v116
    v_mfma_f32_16x16x32_bf16 v[20:23], v[244:247], v[88:91], v[20:23]
    s_waitcnt lgkmcnt(0)
    v_add_f32 v113, v113, v117
    v_add_f32 v114, v114, v118
    v_mfma_f32_16x16x32_bf16 v[16:19], v[248:251], v[92:95], v[16:19]
    v_add_f32 v124, v112, v120
    v_add_f32 v125, v113, v121
    v_mfma_f32_16x16x32_bf16 v[20:23], v[252:255], v[92:95], v[20:23]
    v_add_f32_e64 v126, v114, v122
    s_nop 2
    v_cvt_pk_bf16_f32 v112, v16, v17
    v_cvt_pk_bf16_f32 v113, v18, v19
    s_nop 1
    v_cvt_pk_bf16_f32 v114, v20, v21
    v_cvt_pk_bf16_f32 v115, v22, v23
    s_or_b32 s79, s46, 5
    s_nop 0
    v_mfma_f32_16x16x32_bf16 v[100:103], v[112:115], v[112:115], 0
    v_mfma_f32_16x16x32_bf16 v[120:123], v[36:39], v[112:115], 0
    s_nop 3
    v_cndmask_b32 v100, v100, v101, s[60:61]
    v_cndmask_b32 v102, v102, v103, s[60:61]
    s_nop 1
    v_mov_b32_e64 v123, s79
    v_cndmask_b32 v122, v100, v102, s[62:63]
    buffer_store_dwordx4 v[120:123], v60, s[16:19], s47 offen offset:2048
    s_waitcnt vmcnt(3)
    v_cmp_ne_u32 s[74:75], s79, v131
    s_waitcnt vmcnt(2)
    v_cmp_ne_u32 s[92:93], s79, v135
    s_waitcnt vmcnt(1)
    v_cmp_ne_u32 vcc, s79, v139
    s_or_b64 s[74:75], s[74:75], s[92:93]
    s_and_b32 s92, vcc_lo, 0xffff
    s_or_b32 s74, s74, s75
    s_or_b32 s74, s74, s92
    s_cbranch_scc1 Lre115
Lok113:
    v_add_f32 v128, v128, v132
    v_add_f32 v129, v129, v133
    v_add_f32 v130, v130, v134
    v_add_f32 v128, v128, v136
    v_add_f32 v129, v129, v137
    v_add_f32 v130, v130, v138
    v_permlane32_swap_b32 v124, v128
    v_permlane32_swap_b32 v125, v129
    v_permlane32_swap_b32 v126, v130
    v_add_f32 v124, v124, v128
    v_add_f32 v125, v125, v129
    v_add_f32 v126, v126, v130
    buffer_load_dwordx4 v[112:115], v61, s[16:19], s47 offen offset:2048 sc1
    s_add_u32 s81, s47, 12288
    buffer_load_dwordx4 v[116:119], v61, s[16:19], s81 offen offset:2048 sc1
    s_add_u32 s81, s47, 24576
    buffer_load_dwordx4 v[120:123], v69, s[16:19], s81 offen offset:2048 sc1
    s_waitcnt vmcnt(2)
    v_cmp_ne_u32 s[74:75], s79, v115
    s_waitcnt vmcnt(1)
    v_cmp_ne_u32 s[92:93], s79, v119
    s_waitcnt vmcnt(0)
    v_cmp_ne_u32 vcc, s79, v123
    s_or_b64 s[74:75], s[74:75], s[92:93]
    s_and_b32 s92, vcc_lo, 0xffff
    s_or_b32 s74, s74, s75
    s_or_b32 s74, s74, s92
    s_cbranch_scc1 Lre118
Lok116:
    v_add_f32 v112, v112, v116
    v_add_f32 v113, v113, v117
    v_add_f32 v114, v114, v118
    v_add_f32 v112, v112, v120
    v_add_f32 v113, v113, v121
    v_add_f32 v114, v114, v122
    v_mov_b32 v116, v112
    v_mov_b32 v117, v113
    v_mov_b32 v118, v114
    v_permlane32_swap_b32 v112, v116
    v_permlane32_swap_b32 v113, v117
    v_permlane32_swap_b32 v114, v118
    v_add_f32 v112, v112, v116
    v_add_f32 v113, v113, v117
    v_add_f32 v114, v114, v118
    v_permlane16_swap_b32 v124, v112
    v_permlane16_swap_b32 v125, v113
    v_permlane16_swap_b32 v126, v114
    v_add_f32 v124, v124, v112
    v_add_f32 v125, v125, v113
    v_add_f32_e64 v126, v126, v114
    v_add_f32_dpp v124, v124, v124 row_ror:8 row_mask:0xf bank_mask:0xf
    v_add_f32_dpp v125, v125, v125 row_ror:8 row_mask:0xf bank_mask:0xf
    v_add_f32_dpp v126, v126, v126 row_ror:8 row_mask:0xf bank_mask:0xf
    v_mul_f32 v124, 0xbae38e39, v124
    v_mul_f32 v126, 0x3ae38e39, v126
    v_fma_f32 v126, -v124, v124, v126
    v_max_f32_e64 v126, 0, v126
    v_add_f32 v112, 0x3727c5ac, v126
    v_rsq_f32 v112, v112
    v_fmac_f32 v125, s50, v124
    v_mov_b32 v127, 162820
    v_mul_f32 v125, v125, v112
    v_mul_f32 v113, v124, v112
    v_ashrrev_i32_e64 v114, 31, v125
    v_or_b32 v114, 0x80000000, v114
    v_xor_b32_e64 v125, v125, v114
    v_and_b32 v125, 0xfffff800, v125
    v_or_b32_e64 v125, v125, v67
    v_cndmask_b32 v125, 0, v125, s[88:89]
    ds_write_b32 v66, v112 offset:768
    ds_write_b32 v66, v113 offset:1152
    v_max_u32_dpp v125, v125, v125 row_ror:1 row_mask:0xf bank_mask:0xf
    s_nop 1
    v_max_u32_dpp v125, v125, v125 row_ror:2 row_mask:0xf bank_mask:0xf
    s_nop 1
    v_max_u32_dpp v125, v125, v125 row_ror:4 row_mask:0xf bank_mask:0xf
    s_mov_b32 exec_lo, 0x10001
    s_mov_b32 exec_hi, 1
    ds_max_u32 v127, v125
    s_mov_b64 exec, -1
    s_lshl_b32 s81, s53, 6
    s_add_u32 s81, s81, 768
    v_add_u32 v99, s81, v49
    s_waitcnt lgkmcnt(0)
    s_barrier
    ds_read_b32 v98, v127
    ds_read2_b32 v[124:125], v99 offset0:64 offset1:160
    ds_read2_b32 v[126:127], v99 offset0:32 offset1:128
    ds_read2_b32 v[128:129], v99 offset0:0 offset1:96
    s_mul_i32 s82, s42, 512
    s_add_u32 s82, s82, 917504
    s_or_b32 s81, s41, s40
    s_cselect_b32 s82, 1073741824, s82
    v_mov_b32_e64 v99, s46
    s_mov_b64 exec, 1
    s_waitcnt lgkmcnt(3)
    buffer_store_dwordx2 v[98:99], v46, s[16:19], s82 offen sc1
    s_mov_b64 exec, -1
    v_readfirstlane_b32 s54, v98
    s_mul_i32 s80, s42, 2304
    s_add_u32 s80, s80, 98304
    s_and_b32 s55, s54, 0x7ff
    s_sub_u32 s55, s86, s55
    s_lshr_b32 s55, s55, 1
    s_bfe_u32 s82, s55, 0x10004
    s_waitcnt lgkmcnt(0)
    v_mov_b32_e64 v130, v128
    s_cmp_eq_u32 s82, s53
    s_cbranch_scc0 Lnc119
    s_and_b32 s81, s55, 15
    s_lshl_b32 s74, 0x10001, s81
    s_mov_b32 s75, s74
    s_and_b32 s81, s81, 14
    s_lshl_b32 s92, 0x30003, s81
    s_mov_b32 s93, s92
    s_lshr_b32 s81, s55, 5
    s_cmp_eq_u32 s81, 1
    s_cbranch_scc1 Lsa120
    s_cmp_eq_u32 s81, 0
    s_cbranch_scc1 Lsb121
    v_fma_f32 v130, v0, v124, v125
    v_fma_f32 v131, v1, v124, v125
    v_fma_f32 v132, v2, v124, v125
    v_fma_f32 v133, v3, v124, v125
    v_fma_f32 v134, v4, v124, v125
    v_fma_f32 v135, v5, v124, v125
    v_fma_f32 v136, v6, v124, v125
    v_fma_f32 v137, v7, v124, v125
    s_branch Lsj122
Lsa120:
    v_fma_f32 v130, v8, v126, v127
    v_fma_f32 v131, v9, v126, v127
    v_fma_f32 v132, v10, v126, v127
    v_fma_f32 v133, v11, v126, v127
    v_fma_f32 v134, v12, v126, v127
    v_fma_f32 v135, v13, v126, v127
    v_fma_f32 v136, v14, v126, v127
    v_fma_f32 v137, v15, v126, v127
    s_branch Lsj122
Lsb121:
    v_fma_f32 v130, v16, v128, v129
    v_fma_f32 v131, v17, v128, v129
    v_fma_f32 v132, v18, v128, v129
    v_fma_f32 v133, v19, v128, v129
    v_fma_f32 v134, v20, v128, v129
    v_fma_f32 v135, v21, v128, v129
    v_fma_f32 v136, v22, v128, v129
    v_fma_f32 v137, v23, v128, v129
Lsj122:
    v_cvt_pk_bf16_f32 v130, v130, v131
    v_cvt_pk_bf16_f32 v131, v132, v133
    v_cvt_pk_bf16_f32 v132, v134, v135
    v_cvt_pk_bf16_f32 v133, v136, v137
    s_mov_b64 vcc, s[74:75]
    s_lshl1_add_u32 s82, s41, s52
    s_lshl_b32 s82, s82, 7
    s_add_u32 s82, s82, s80
    v_or_b32 v134, 16, v65
    v_cndmask_b32 v134, v134, v65, vcc
    v_cndmask_b32_dpp v130, v132, v130, vcc quad_perm:[1,0,3,2] row_mask:0xf bank_mask:0xf
    v_cndmask_b32_dpp v131, v133, v131, vcc quad_perm:[1,0,3,2] row_mask:0xf bank_mask:0xf
    v_mov_b32_e64 v132, s54
    v_mov_b32 v133, s46
    s_mov_b64 exec, s[92:93]
    buffer_store_dwordx4 v[130:133], v134, s[16:19], s82 offen sc1
    s_mov_b64 exec, -1
Lnc119:
    v_mul_u32_u24 v32, 32, v46
    v_min_u32 v32, 11776, v32
    v_add_f32_e64 v124, 1.0, v124
    v_pk_fma_f32 v[0:1], v[0:1], v[124:125], v[124:125] op_sel:[0,0,1] op_sel_hi:[1,0,1]
    v_pk_fma_f32 v[2:3], v[2:3], v[124:125], v[124:125] op_sel:[0,0,1] op_sel_hi:[1,0,1]
    v_pk_fma_f32 v[4:5], v[4:5], v[124:125], v[124:125] op_sel:[0,0,1] op_sel_hi:[1,0,1]
    v_pk_fma_f32 v[6:7], v[6:7], v[124:125], v[124:125] op_sel:[0,0,1] op_sel_hi:[1,0,1]
    v_cvt_pk_bf16_f32 v72, v0, v1
    v_cvt_pk_bf16_f32 v73, v2, v3
    v_cvt_pk_bf16_f32 v74, v4, v5
    v_cvt_pk_bf16_f32 v75, v6, v7
    v_add_u32 v33, 147456, v62
    buffer_store_dwordx4 v[72:75], v33, s[20:23], 0 offen sc0 sc1
    v_add_f32_e64 v126, 1.0, v126
    v_pk_fma_f32 v[8:9], v[8:9], v[126:127], v[126:127] op_sel:[0,0,1] op_sel_hi:[1,0,1]
    v_pk_fma_f32 v[10:11], v[10:11], v[126:127], v[126:127] op_sel:[0,0,1] op_sel_hi:[1,0,1]
    Lw7: s_cbranch_execz Lwx
    s_nop 0
    v_pk_fma_f32 v[12:13], v[12:13], v[126:127], v[126:127] op_sel:[0,0,1] op_sel_hi:[1,0,1]
    v_pk_fma_f32 v[14:15], v[14:15], v[126:127], v[126:127] op_sel:[0,0,1] op_sel_hi:[1,0,1]
    v_cvt_pk_bf16_f32 v76, v8, v9
    v_cvt_pk_bf16_f32 v77, v10, v11
    v_cvt_pk_bf16_f32 v78, v12, v13
    v_cvt_pk_bf16_f32 v79, v14, v15
    v_add_u32 v34, 73728, v62
    buffer_store_dwordx4 v[76:79], v34, s[20:23], 0 offen sc0 sc1
    v_add_f32_e64 v128, 1.0, v128
    v_pk_fma_f32 v[16:17], v[16:17], v[128:129], v[128:129] op_sel:[0,0,1] op_sel_hi:[1,0,1]
    v_pk_fma_f32 v[18:19], v[18:19], v[128:129], v[128:129] op_sel:[0,0,1] op_sel_hi:[1,0,1]
    v_pk_fma_f32 v[20:21], v[20:21], v[128:129], v[128:129] op_sel:[0,0,1] op_sel_hi:[1,0,1]
    v_pk_fma_f32 v[22:23], v[22:23], v[128:129], v[128:129] op_sel:[0,0,1] op_sel_hi:[1,0,1]
    v_cvt_pk_bf16_f32 v80, v16, v17
    v_cvt_pk_bf16_f32 v81, v18, v19
    v_cvt_pk_bf16_f32 v82, v20, v21
    v_cvt_pk_bf16_f32 v83, v22, v23
    s_cmp_eq_u32 s44, 0
    s_cselect_b32 s81, 0, 0xff00ff00
    s_cmp_eq_u32 s53, 0
    s_cselect_b32 exec_lo, s81, -1
    s_mov_b32 exec_hi, exec_lo
    buffer_store_dwordx4 v[80:83], v62, s[20:23], 0 offen sc0 sc1
    s_mov_b64 exec, -1
    s_bfe_u32 s82, s55, 0x10004
    s_cmp_eq_u32 s82, s53
    s_cbranch_scc0 L_done
    s_mov_b32 s83, 0
Lspin125:
    s_mov_b32 s81, 917504
    buffer_load_dwordx2 v[108:109], v32, s[16:19], s81 offen sc1
    s_add_u32 s83, s83, 1
    s_cmp_gt_u32 s83, 100000
    s_cbranch_scc1 L_end
    s_waitcnt vmcnt(0)
    v_cmp_eq_u32 s[90:91], s46, v109
    v_cmp_lt_u32_e64 vcc, s54, v108
    s_nop 0
    s_and_b64 vcc, vcc, s[90:91]
    s_cbranch_scc1 L_done
    s_and_b32 s81, s90, 0xffffff
    s_bcnt1_i32_b32 s81, s81
    s_cmp_ge_u32 s81, 22
    s_cbranch_scc0 Lspin125
    s_and_b32 s81, s55, 15
    s_lshl_b32 s74, 0x10001, s81
    s_mov_b32 s75, s74
    s_and_b32 s81, s81, 14
    s_lshl_b32 s92, 0x30003, s81
    s_mov_b32 s93, s92
    s_lshr_b32 s81, s55, 5
    s_mov_b64 vcc, s[74:75]
    v_mov_b32 v112, 0
    v_mov_b32 v113, 0
    v_mov_b32 v114, 0
    v_mov_b32_e64 v115, 0
    s_cmp_eq_u32 s81, 1
    s_cbranch_scc1 Lsa126
    s_cmp_eq_u32 s81, 0
    s_cbranch_scc1 Lsb127
    v_cndmask_b32_dpp v120, v0, v0, vcc quad_perm:[1,0,3,2] row_mask:0xf bank_mask:0xf
    v_cndmask_b32_dpp v121, v1, v1, vcc quad_perm:[1,0,3,2] row_mask:0xf bank_mask:0xf
    v_cndmask_b32_dpp v122, v2, v2, vcc quad_perm:[1,0,3,2] row_mask:0xf bank_mask:0xf
    v_cndmask_b32_dpp v123, v3, v3, vcc quad_perm:[1,0,3,2] row_mask:0xf bank_mask:0xf
    v_cndmask_b32_dpp v124, v4, v4, vcc quad_perm:[1,0,3,2] row_mask:0xf bank_mask:0xf
    v_cndmask_b32_dpp v125, v5, v5, vcc quad_perm:[1,0,3,2] row_mask:0xf bank_mask:0xf
    v_cndmask_b32_dpp v126, v6, v6, vcc quad_perm:[1,0,3,2] row_mask:0xf bank_mask:0xf
    v_cndmask_b32_dpp v127, v7, v7, vcc quad_perm:[1,0,3,2] row_mask:0xf bank_mask:0xf
    s_branch Lsj128
Lsa126:
    v_cndmask_b32_dpp v120, v8, v8, vcc quad_perm:[1,0,3,2] row_mask:0xf bank_mask:0xf
    v_cndmask_b32_dpp v121, v9, v9, vcc quad_perm:[1,0,3,2] row_mask:0xf bank_mask:0xf
    v_cndmask_b32_dpp v122, v10, v10, vcc quad_perm:[1,0,3,2] row_mask:0xf bank_mask:0xf
    v_cndmask_b32_dpp v123, v11, v11, vcc quad_perm:[1,0,3,2] row_mask:0xf bank_mask:0xf
    v_cndmask_b32_dpp v124, v12, v12, vcc quad_perm:[1,0,3,2] row_mask:0xf bank_mask:0xf
    v_cndmask_b32_dpp v125, v13, v13, vcc quad_perm:[1,0,3,2] row_mask:0xf bank_mask:0xf
    v_cndmask_b32_dpp v126, v14, v14, vcc quad_perm:[1,0,3,2] row_mask:0xf bank_mask:0xf
    v_cndmask_b32_dpp v127, v15, v15, vcc quad_perm:[1,0,3,2] row_mask:0xf bank_mask:0xf
    s_branch Lsj128
Lsb127:
    v_cndmask_b32_dpp v120, v16, v16, vcc quad_perm:[1,0,3,2] row_mask:0xf bank_mask:0xf
    v_cndmask_b32_dpp v121, v17, v17, vcc quad_perm:[1,0,3,2] row_mask:0xf bank_mask:0xf
    v_cndmask_b32_dpp v122, v18, v18, vcc quad_perm:[1,0,3,2] row_mask:0xf bank_mask:0xf
    v_cndmask_b32_dpp v123, v19, v19, vcc quad_perm:[1,0,3,2] row_mask:0xf bank_mask:0xf
    v_cndmask_b32_dpp v124, v20, v20, vcc quad_perm:[1,0,3,2] row_mask:0xf bank_mask:0xf
    v_cndmask_b32_dpp v125, v21, v21, vcc quad_perm:[1,0,3,2] row_mask:0xf bank_mask:0xf
    v_cndmask_b32_dpp v126, v22, v22, vcc quad_perm:[1,0,3,2] row_mask:0xf bank_mask:0xf
    v_cndmask_b32_dpp v127, v23, v23, vcc quad_perm:[1,0,3,2] row_mask:0xf bank_mask:0xf
Lsj128:
    s_mov_b64 exec, s[92:93]
    v_cndmask_b32 v112, v120, v124, s[60:61]
    v_cndmask_b32 v113, v121, v125, s[60:61]
    v_cndmask_b32 v114, v122, v126, s[60:61]
    v_cndmask_b32 v115, v123, v127, s[60:61]
    s_mov_b64 exec, -1
    s_mul_i32 s78, s81, 73728
    v_cndmask_b32_dpp v33, v62, v62, vcc quad_perm:[1,0,3,2] row_mask:0xf bank_mask:0xf
    v_bfe_u32 v34, v46, 1, 4
    v_add3_u32 v33, v33, v34, s78
    v_cvt_pk_bf16_f32 v118, v112, v113
    v_cvt_pk_bf16_f32 v119, v114, v115
    v_bfe_u32 v85, v46, 5, 3
    v_mul_u32_u24 v85, 2304, v85
    v_and_b32 v84, 16, v46
    v_and_b32 v86, 0, v65
    v_add3_u32 v85, v85, v84, v86
    v_add_u32_e64 v85, v85, v65
    s_lshl1_add_u32 s76, s41, s52
    s_lshl_b32 s76, s76, 7
    s_add_u32 s76, s76, 335872
    s_not_b32 s77, s46
    v_mov_b32 v168, 0
    v_mov_b32 v169, 0
    v_mov_b32 v170, s54
    v_mov_b32 v171, s46
    v_mov_b32 v190, 0
    v_mov_b32 v191, 0
    v_mov_b32 v192, s54
    v_mov_b32 v193, s46
    v_mov_b32 v177, s77
    v_mov_b32 v195, s77
    v_mov_b32 v212, 0
    v_mov_b32 v213, 0
    v_mov_b32 v214, s54
    v_mov_b32 v215, s46
    v_mov_b32 v199, s77
    v_mov_b32_e64 v217, s77
    s_mov_b64 exec, 0
    s_branch Lpk132
Ldry129:
    s_mov_b64 exec, -1
    s_mov_b32 s83, 0
Lspin130:
    s_mov_b32 s81, 917504
    buffer_load_dwordx2 v[172:173], v32, s[16:19], s81 offen sc1
    buffer_load_dwordx4 v[152:155], v85, s[16:19], s76 offen sc1
    s_add_u32 s77, s76, 18432
    buffer_load_dwordx4 v[156:159], v85, s[16:19], s77 offen sc1
    s_add_u32 s77, s76, 36864
    buffer_load_dwordx4 v[160:163], v85, s[16:19], s77 offen sc1
    s_add_u32 s77, s76, 55296
    buffer_load_dwordx4 v[164:167], v85, s[16:19], s77 offen sc1
    s_add_u32 s77, s76, 73728
    s_mov_b32 exec_lo, 0x00ff00ff
    s_mov_b32 exec_hi, exec_lo
    buffer_load_dwordx4 v[168:171], v85, s[16:19], s77 offen sc1
    s_mov_b64 exec, -1
    s_waitcnt vmcnt(12)
    v_cmp_eq_u32 s[90:91], s46, v195
    v_cmp_lt_u32 vcc, s54, v194
    s_nop 0
    s_and_b64 vcc, vcc, s[90:91]
    s_cbranch_scc1 L_done
    v_xor_b32 v84, s54, v176
    v_xor_b32 v86, s46, v177
    v_or_b32 v84, v84, v86
    v_xor_b32 v86, s54, v180
    v_xor_b32 v87, s46, v181
    v_or3_b32 v84, v84, v86, v87
    v_xor_b32 v86, s54, v184
    v_xor_b32 v87, s46, v185
    v_or3_b32 v84, v84, v86, v87
    v_xor_b32 v86, s54, v188
    v_xor_b32 v87, s46, v189
    v_or3_b32 v84, v84, v86, v87
    v_xor_b32 v86, s54, v192
    v_xor_b32 v87, s46, v193
    v_or3_b32 v84, v84, v86, v87
    v_cmp_ne_u32 vcc, 0, v84
    s_cbranch_vccz Lpk133
    s_mov_b32 s81, 917504
    buffer_load_dwordx2 v[194:195], v32, s[16:19], s81 offen sc1
    buffer_load_dwordx4 v[174:177], v85, s[16:19], s76 offen sc1
    s_add_u32 s77, s76, 18432
    buffer_load_dwordx4 v[178:181], v85, s[16:19], s77 offen sc1
    s_add_u32 s77, s76, 36864
    buffer_load_dwordx4 v[182:185], v85, s[16:19], s77 offen sc1
    s_add_u32 s77, s76, 55296
    buffer_load_dwordx4 v[186:189], v85, s[16:19], s77 offen sc1
    s_add_u32 s77, s76, 73728
    s_mov_b32 exec_lo, 0x00ff00ff
    s_mov_b32 exec_hi, exec_lo
    buffer_load_dwordx4 v[190:193], v85, s[16:19], s77 offen sc1
    s_mov_b64 exec, -1
    s_waitcnt vmcnt(12)
    v_cmp_eq_u32 s[90:91], s46, v217
    v_cmp_lt_u32 vcc, s54, v216
    s_nop 0
    s_and_b64 vcc, vcc, s[90:91]
    s_cbranch_scc1 L_done
    v_xor_b32 v84, s54, v198
    v_xor_b32 v86, s46, v199
    v_or_b32 v84, v84, v86
    v_xor_b32 v86, s54, v202
    v_xor_b32 v87, s46, v203
    v_or3_b32 v84, v84, v86, v87
    v_xor_b32 v86, s54, v206
    v_xor_b32 v87, s46, v207
    v_or3_b32 v84, v84, v86, v87
    v_xor_b32 v86, s54, v210
    v_xor_b32 v87, s46, v211
    v_or3_b32 v84, v84, v86, v87
    v_xor_b32 v86, s54, v214
    v_xor_b32 v87, s46, v215
    v_or3_b32 v84, v84, v86, v87
    v_cmp_ne_u32 vcc, 0, v84
    s_cbranch_vccz Lpk134
    s_mov_b32 s81, 917504
    buffer_load_dwordx2 v[216:217], v32, s[16:19], s81 offen sc1
    buffer_load_dwordx4 v[196:199], v85, s[16:19], s76 offen sc1
    s_add_u32 s77, s76, 18432
    buffer_load_dwordx4 v[200:203], v85, s[16:19], s77 offen sc1
    s_add_u32 s77, s76, 36864
    buffer_load_dwordx4 v[204:207], v85, s[16:19], s77 offen sc1
    s_add_u32 s77, s76, 55296
    buffer_load_dwordx4 v[208:211], v85, s[16:19], s77 offen sc1
    s_add_u32 s77, s76, 73728
    s_mov_b32 exec_lo, 0x00ff00ff
    s_mov_b32 exec_hi, exec_lo
    buffer_load_dwordx4 v[212:215], v85, s[16:19], s77 offen sc1
    s_mov_b64 exec, -1
    s_waitcnt vmcnt(12)
    v_cmp_eq_u32 s[90:91], s46, v173
    v_cmp_lt_u32 vcc, s54, v172
    s_nop 0
    s_and_b64 vcc, vcc, s[90:91]
    s_cbranch_scc1 L_done
    v_xor_b32 v84, s54, v154
    v_xor_b32 v86, s46, v155
    v_or_b32 v84, v84, v86
    v_xor_b32 v86, s54, v158
    v_xor_b32 v87, s46, v159
    v_or3_b32 v84, v84, v86, v87
    v_xor_b32 v86, s54, v162
    v_xor_b32 v87, s46, v163
    v_or3_b32 v84, v84, v86, v87
    v_xor_b32 v86, s54, v166
    v_xor_b32 v87, s46, v167
    v_or3_b32 v84, v84, v86, v87
    v_xor_b32 v86, s54, v170
    v_xor_b32 v87, s46, v171
    v_or3_b32 v84, v84, v86, v87
    v_cmp_ne_u32_e64 vcc, 0, v84
    s_cbranch_vccz Lpk132
    s_add_u32 s83, s83, 1
    s_cmp_gt_u32 s83, 100000
    s_cbranch_scc0 Lspin130
    s_branch L_end
Lpk132:
    v_and_b32 v155, 0xffff0000, v153
    v_lshlrev_b32_e64 v154, 16, v153
    v_and_b32 v153, 0xffff0000, v152
    v_lshlrev_b32_e64 v152, 16, v152
    v_pk_add_f32 v[114:115], v[114:115], v[154:155]
    v_pk_add_f32 v[112:113], v[112:113], v[152:153]
    v_and_b32 v159, 0xffff0000, v157
    v_lshlrev_b32_e64 v158, 16, v157
    v_and_b32 v157, 0xffff0000, v156
    v_lshlrev_b32_e64 v156, 16, v156
    v_pk_add_f32 v[114:115], v[114:115], v[158:159]
    v_pk_add_f32 v[112:113], v[112:113], v[156:157]
    v_and_b32 v163, 0xffff0000, v161
    v_lshlrev_b32_e64 v162, 16, v161
    v_and_b32 v161, 0xffff0000, v160
    v_lshlrev_b32_e64 v160, 16, v160
    v_pk_add_f32 v[114:115], v[114:115], v[162:163]
    v_pk_add_f32 v[112:113], v[112:113], v[160:161]
    v_and_b32 v167, 0xffff0000, v165
    v_lshlrev_b32_e64 v166, 16, v165
    v_and_b32 v165, 0xffff0000, v164
    v_lshlrev_b32_e64 v164, 16, v164
    v_pk_add_f32 v[114:115], v[114:115], v[166:167]
    v_pk_add_f32 v[112:113], v[112:113], v[164:165]
    v_and_b32 v171, 0xffff0000, v169
    v_lshlrev_b32_e64 v170, 16, v169
    v_and_b32 v169, 0xffff0000, v168
    v_lshlrev_b32_e64 v168, 16, v168
    v_pk_add_f32 v[114:115], v[114:115], v[170:171]
    v_pk_add_f32 v[112:113], v[112:113], v[168:169]
    s_cbranch_execnz Lpj131
Lpk133:
    v_and_b32 v177, 0xffff0000, v175
    v_lshlrev_b32 v176, 16, v175
    v_and_b32 v175, 0xffff0000, v174
    v_lshlrev_b32_e64 v174, 16, v174
    v_pk_add_f32 v[114:115], v[114:115], v[176:177]
    v_pk_add_f32 v[112:113], v[112:113], v[174:175]
    v_and_b32 v181, 0xffff0000, v179
    v_lshlrev_b32_e64 v180, 16, v179
    v_and_b32 v179, 0xffff0000, v178
    v_lshlrev_b32_e64 v178, 16, v178
    v_pk_add_f32 v[114:115], v[114:115], v[180:181]
    v_pk_add_f32 v[112:113], v[112:113], v[178:179]
    v_and_b32 v185, 0xffff0000, v183
    v_lshlrev_b32_e64 v184, 16, v183
    v_and_b32 v183, 0xffff0000, v182
    v_lshlrev_b32_e64 v182, 16, v182
    v_pk_add_f32 v[114:115], v[114:115], v[184:185]
    v_pk_add_f32 v[112:113], v[112:113], v[182:183]
    v_and_b32 v189, 0xffff0000, v187
    v_lshlrev_b32_e64 v188, 16, v187
    v_and_b32 v187, 0xffff0000, v186
    v_lshlrev_b32_e64 v186, 16, v186
    v_pk_add_f32 v[114:115], v[114:115], v[188:189]
    v_pk_add_f32 v[112:113], v[112:113], v[186:187]
    v_and_b32 v193, 0xffff0000, v191
    v_lshlrev_b32_e64 v192, 16, v191
    v_and_b32 v191, 0xffff0000, v190
    v_lshlrev_b32_e64 v190, 16, v190
    v_pk_add_f32 v[114:115], v[114:115], v[192:193]
    v_pk_add_f32 v[112:113], v[112:113], v[190:191]
    s_cbranch_execnz Lpj131
Lpk134:
    v_and_b32 v199, 0xffff0000, v197
    v_lshlrev_b32 v198, 16, v197
    v_and_b32 v197, 0xffff0000, v196
    v_lshlrev_b32_e64 v196, 16, v196
    v_pk_add_f32 v[114:115], v[114:115], v[198:199]
    v_pk_add_f32 v[112:113], v[112:113], v[196:197]
    v_and_b32 v203, 0xffff0000, v201
    v_lshlrev_b32_e64 v202, 16, v201
    v_and_b32 v201, 0xffff0000, v200
    v_lshlrev_b32_e64 v200, 16, v200
    v_pk_add_f32 v[114:115], v[114:115], v[202:203]
    v_pk_add_f32 v[112:113], v[112:113], v[200:201]
    v_and_b32 v207, 0xffff0000, v205
    v_lshlrev_b32_e64 v206, 16, v205
    v_and_b32 v205, 0xffff0000, v204
    v_lshlrev_b32_e64 v204, 16, v204
    v_pk_add_f32 v[114:115], v[114:115], v[206:207]
    v_pk_add_f32 v[112:113], v[112:113], v[204:205]
    v_and_b32 v211, 0xffff0000, v209
    v_lshlrev_b32_e64 v210, 16, v209
    v_and_b32 v209, 0xffff0000, v208
    v_lshlrev_b32_e64 v208, 16, v208
    v_pk_add_f32 v[114:115], v[114:115], v[210:211]
    v_pk_add_f32 v[112:113], v[112:113], v[208:209]
    v_and_b32 v215, 0xffff0000, v213
    v_lshlrev_b32_e64 v214, 16, v213
    v_and_b32 v213, 0xffff0000, v212
    v_lshlrev_b32 v212, 16, v212
    v_pk_add_f32 v[114:115], v[114:115], v[214:215]
    v_pk_add_f32 v[112:113], v[112:113], v[212:213]
Lpj131:
    s_nop 1
    v_add_f32_dpp v112, v112, v112 row_ror:2 row_mask:0xf bank_mask:0xf
    v_add_f32_dpp v113, v113, v113 row_ror:2 row_mask:0xf bank_mask:0xf
    v_add_f32_dpp v114, v114, v114 row_ror:2 row_mask:0xf bank_mask:0xf
    v_add_f32_dpp v115, v115, v115 row_ror:2 row_mask:0xf bank_mask:0xf
    v_add_f32_dpp v112, v112, v112 row_ror:4 row_mask:0xf bank_mask:0xf
    v_add_f32_dpp v113, v113, v113 row_ror:4 row_mask:0xf bank_mask:0xf
    v_add_f32_dpp v114, v114, v114 row_ror:4 row_mask:0xf bank_mask:0xf
    v_add_f32_dpp v115, v115, v115 row_ror:4 row_mask:0xf bank_mask:0xf
    v_add_f32_dpp v112, v112, v112 row_ror:8 row_mask:0xf bank_mask:0xf
    v_add_f32_dpp v113, v113, v113 row_ror:8 row_mask:0xf bank_mask:0xf
    v_add_f32_dpp v114, v114, v114 row_ror:8 row_mask:0xf bank_mask:0xf
    v_add_f32_dpp v115, v115, v115 row_ror:8 row_mask:0xf bank_mask:0xf
    v_cvt_pk_bf16_f32 v116, v112, v113
    v_cvt_pk_bf16_f32 v117, v114, v115
    s_and_b64 exec, exec, s[92:93]
    buffer_store_dwordx2 v[116:117], v33, s[20:23], 0 offen sc0 sc1
    s_cbranch_execz Ldry129
    s_mov_b64 exec, -1
    s_cmp_eq_u32 s90, -1
    s_cbranch_scc1 L_done
    s_not_b32 s77, s46
    v_mov_b32 v243, s77
    v_mov_b32 v245, s77
    v_mov_b32 v247, s77
    s_mov_b32 s83, 0
Lspin136:
    s_mov_b32 s81, 917504
    buffer_load_dwordx2 v[240:241], v32, s[16:19], s81 offen sc1
    s_waitcnt vmcnt(3)
    v_cmp_eq_u32 s[90:91], s46, v243
    v_cmp_lt_u32 vcc, s54, v242
    s_nop 0
    s_and_b64 vcc, vcc, s[90:91]
    s_cbranch_scc1 Lback135
    s_cmp_eq_u32 s90, -1
    s_cbranch_scc1 L_done
    s_mov_b32 s81, 917504
    buffer_load_dwordx2 v[242:243], v32, s[16:19], s81 offen sc1
    s_waitcnt vmcnt(3)
    v_cmp_eq_u32 s[90:91], s46, v245
    v_cmp_lt_u32 vcc, s54, v244
    s_nop 0
    s_and_b64 vcc, vcc, s[90:91]
    s_cbranch_scc1 Lback135
    s_cmp_eq_u32 s90, -1
    s_cbranch_scc1 L_done
    s_mov_b32 s81, 917504
    buffer_load_dwordx2 v[244:245], v32, s[16:19], s81 offen sc1
    s_waitcnt vmcnt(3)
    v_cmp_eq_u32 s[90:91], s46, v247
    v_cmp_lt_u32 vcc, s54, v246
    s_nop 0
    s_and_b64 vcc, vcc, s[90:91]
    s_cbranch_scc1 Lback135
    s_cmp_eq_u32 s90, -1
    s_cbranch_scc1 L_done
    s_mov_b32 s81, 917504
    buffer_load_dwordx2 v[246:247], v32, s[16:19], s81 offen sc1
    s_waitcnt vmcnt(3)
    v_cmp_eq_u32 s[90:91], s46, v241
    v_cmp_lt_u32 vcc, s54, v240
    s_nop 0
    s_and_b64 vcc, vcc, s[90:91]
    s_cbranch_scc1 Lback135
    s_cmp_eq_u32 s90, -1
    s_cbranch_scc1 L_done
    s_add_u32 s83, s83, 1
    s_cmp_gt_u32 s83, 100000
    s_cbranch_scc0 Lspin136
    s_branch L_end
Lpj137:
Lback135:
    s_mov_b64 exec, s[92:93]
    buffer_store_dwordx2 v[118:119], v33, s[20:23], 0 offen sc0 sc1
    s_branch L_done
Lre3:
    s_mov_b32 s83, 0
Lrt2:
    buffer_load_dword v75, v151, s[16:19], s55 offen sc1
    s_add_u32 s83, s83, 1
    s_cmp_gt_u32 s83, 100000
    s_cbranch_scc1 L_end
    s_waitcnt vmcnt(0)
    v_xor_b32 v73, s54, v75
    v_cmp_lt_u32 vcc, 15, v73
    s_nop 0
    s_cmp_lg_u64 vcc, 0
    s_cbranch_scc1 Lrt2
    s_branch Lok1
Lre14:
    s_mov_b32 s83, 0
Lrt13:
    buffer_load_dwordx4 v[224:227], v46, s[16:19], s59 offen offset:3072 sc1
    buffer_load_dwordx4 v[228:231], v46, s[16:19], s32 offen offset:0 sc1
    buffer_load_dwordx4 v[232:235], v46, s[16:19], s32 offen offset:1024 sc1
    s_add_u32 s83, s83, 1
    s_cmp_gt_u32 s83, 100000
    s_cbranch_scc1 L_end
    s_waitcnt vmcnt(0)
    v_xor_b32 v227, s46, v227
    v_xor_b32 v231, s46, v231
    v_xor_b32 v235, s46, v235
    v_or3_b32 v227, v227, v231, v235
    v_cmp_lt_u32_e64 vcc, 0, v227
    ds_write_b64 v63, v[224:225] offset:8064
    ds_write_b32 v64, v226 offset:24
    ds_write_b64 v63, v[228:229] offset:10752
    ds_write_b32 v64, v230 offset:32
    ds_write_b64 v63, v[232:233] offset:13440
    ds_write_b32 v64, v234 offset:40
    s_cmp_lg_u64 vcc, 0
    s_cbranch_scc1 Lrt13
    s_branch Lok12
Lre19:
    s_mov_b32 s83, 0
Lrt18:
    buffer_load_dwordx4 v[184:187], v46, s[16:19], s59 offen offset:2048 sc1
    buffer_load_dwordx4 v[188:191], v46, s[16:19], s59 offen offset:1024 sc1
    buffer_load_dwordx4 v[192:195], v46, s[16:19], s59 offen offset:0 sc1
    s_add_u32 s83, s83, 1
    s_cmp_gt_u32 s83, 100000
    s_cbranch_scc1 L_end
    s_waitcnt vmcnt(0)
    v_xor_b32 v187, s46, v187
    v_xor_b32 v191, s46, v191
    v_xor_b32 v195, s46, v195
    v_or3_b32 v187, v187, v191, v195
    v_cmp_lt_u32_e64 vcc, 0, v187
    ds_write_b64 v63, v[184:185] offset:5376
    ds_write_b32 v64, v186 offset:16
    ds_write_b64 v63, v[188:189] offset:2688
    ds_write_b32 v64, v190 offset:8
    ds_write_b64 v63, v[192:193] offset:0
    ds_write_b32 v64, v194 offset:0
    s_cmp_lg_u64 vcc, 0
    s_cbranch_scc1 Lrt18
    s_branch Lok17
Lre22:
    s_mov_b32 s83, 0
Lrt21:
    buffer_load_dword v146, v58, s[16:19], s47 offen offset:0 sc1
    s_add_u32 s83, s83, 1
    s_nop 0
    s_cmp_gt_u32 s83, 100000
    s_cbranch_scc1 L_end
    s_waitcnt vmcnt(0)
    v_cmp_ne_u32 s[34:35], s46, v146
    s_nop 0
    s_cmp_lg_u64 s[34:35], 0
    s_cbranch_scc1 Lrt21
    s_branch Lok20
Lre25:
    s_mov_b32 s83, 0
Lrt24:
    buffer_load_dword v146, v58, s[16:19], s47 offen offset:160 sc1
    s_add_u32 s83, s83, 1
    s_cmp_gt_u32 s83, 100000
    s_cbranch_scc1 L_end
    s_waitcnt vmcnt(0)
    v_cmp_ne_u32 s[34:35], s46, v146
    s_nop 0
    s_cmp_lg_u64 s[34:35], 0
    s_cbranch_scc1 Lrt24
    s_branch Lok23
Lre29:
    s_mov_b32 s83, 0
Lrt28:
    buffer_load_dword v98, v58, s[16:19], s47 offen offset:320 sc1
    s_add_u32 s83, s83, 1
    s_cmp_gt_u32 s83, 100000
    s_cbranch_scc1 L_end
    s_waitcnt vmcnt(0)
    v_cmp_ne_u32 s[34:35], s46, v98
    s_nop 0
    s_cmp_lg_u64 s[34:35], 0
    s_cbranch_scc1 Lrt28
    s_branch Lok27
Lre36:
    s_mov_b32 s83, 0
Lrt35:
    buffer_load_dword v98, v59, s[16:19], s47 offen offset:960 sc1
    s_add_u32 s83, s83, 1
    s_cmp_gt_u32 s83, 100000
    s_cbranch_scc1 L_end
    s_waitcnt vmcnt(0)
    v_cmp_ne_u32 s[34:35], s46, v98
    s_nop 0
    s_cmp_lg_u64 s[34:35], 0
    s_cbranch_scc1 Lrt35
    s_branch Lok34
Lre43:
    s_mov_b32 s83, 0
Lrt42:
    buffer_load_dword v33, v59, s[16:19], s47 offen offset:1120 sc1
    s_add_u32 s83, s83, 1
    s_cmp_gt_u32 s83, 100000
    s_cbranch_scc1 L_end
    s_waitcnt vmcnt(0)
    v_cmp_ne_u32 s[34:35], s46, v33
    s_nop 0
    s_cmp_lg_u64 s[34:35], 0
    s_cbranch_scc1 Lrt42
    s_branch Lok41
Lre50:
    s_mov_b32 s83, 0
Lrt49:
    buffer_load_dword v33, v59, s[16:19], s47 offen offset:1280 sc1
    s_add_u32 s83, s83, 1
    s_cmp_gt_u32 s83, 100000
    s_cbranch_scc1 L_end
    s_waitcnt vmcnt(0)
    v_cmp_ne_u32 s[34:35], s46, v33
    s_nop 0
    s_cmp_lg_u64 s[34:35], 0
    s_cbranch_scc1 Lrt49
    s_branch Lok48
Lre54:
    s_mov_b32 s83, 0
Lrt53:
    buffer_load_dword v34, v59, s[16:19], s94 offen offset:1120 sc1
    s_add_u32 s83, s83, 1
    s_cmp_gt_u32 s83, 100000
    s_cbranch_scc1 L_end
    s_waitcnt vmcnt(0)
    v_cmp_ne_u32 s[34:35], s46, v34
    s_nop 0
    s_cmp_lg_u64 s[34:35], 0
    s_cbranch_scc1 Lrt53
    s_branch Lok52
Lre58:
    s_mov_b32 s83, 0
Lrt57:
    buffer_load_dwordx4 v[128:131], v61, s[16:19], s47 offen offset:3072 sc1
    s_add_u32 s81, s47, 12288
    buffer_load_dwordx4 v[132:135], v61, s[16:19], s81 offen offset:3072 sc1
    s_add_u32 s81, s47, 24576
    buffer_load_dwordx4 v[136:139], v69, s[16:19], s81 offen offset:3072 sc1
    s_add_u32 s83, s83, 1
    s_cmp_gt_u32 s83, 100000
    s_cbranch_scc1 L_end
    s_waitcnt vmcnt(0)
    v_cmp_ne_u32 s[74:75], s79, v131
    v_cmp_ne_u32 s[92:93], s79, v135
    v_cmp_ne_u32_e64 vcc, s79, v139
    s_or_b64 s[74:75], s[74:75], s[92:93]
    s_and_b32 s92, vcc_lo, 0xffff
    s_or_b32 s74, s74, s75
    s_or_b32 s74, s74, s92
    s_cbranch_scc1 Lrt57
    s_branch Lok56
Lre61:
    s_mov_b32 s83, 0
Lrt60:
    buffer_load_dwordx4 v[140:143], v61, s[16:19], s47 offen offset:2560 sc1
    s_add_u32 s81, s47, 12288
    buffer_load_dwordx4 v[144:147], v61, s[16:19], s81 offen offset:2560 sc1
    s_add_u32 s81, s47, 24576
    buffer_load_dwordx4 v[148:151], v69, s[16:19], s81 offen offset:2560 sc1
    s_add_u32 s83, s83, 1
    s_cmp_gt_u32 s83, 100000
    s_cbranch_scc1 L_end
    s_waitcnt vmcnt(0)
    v_cmp_ne_u32 s[74:75], s79, v143
    v_cmp_ne_u32 s[92:93], s79, v147
    v_cmp_ne_u32 vcc, s79, v151
    s_or_b64 s[74:75], s[74:75], s[92:93]
    s_and_b32 s92, vcc_lo, 0xffff
    s_or_b32 s74, s74, s75
    s_or_b32 s74, s74, s92
    s_cbranch_scc1 Lrt60
    s_branch Lok59
Lre64:
    s_mov_b32 s83, 0
Lrt63:
    buffer_load_dwordx4 v[128:131], v61, s[16:19], s47 offen offset:2048 sc1
    s_add_u32 s81, s47, 12288
    buffer_load_dwordx4 v[132:135], v61, s[16:19], s81 offen offset:2048 sc1
    s_add_u32 s81, s47, 24576
    buffer_load_dwordx4 v[136:139], v69, s[16:19], s81 offen offset:2048 sc1
    s_add_u32 s83, s83, 1
    s_cmp_gt_u32 s83, 100000
    s_cbranch_scc1 L_end
    s_waitcnt vmcnt(0)
    v_cmp_ne_u32 s[74:75], s79, v131
    v_cmp_ne_u32 s[92:93], s79, v135
    v_cmp_ne_u32 vcc, s79, v139
    s_or_b64 s[74:75], s[74:75], s[92:93]
    s_and_b32 s92, vcc_lo, 0xffff
    s_or_b32 s74, s74, s75
    s_or_b32 s74, s74, s92
    s_cbranch_scc1 Lrt63
    s_branch Lok62
Lre75:
    s_mov_b32 s83, 0
Lrt74:
    buffer_load_dwordx4 v[140:143], v46, s[16:19], s32 offen offset:0 sc1
    buffer_load_dwordx4 v[144:147], v46, s[16:19], s32 offen offset:1024 sc1
    buffer_load_dwordx4 v[148:151], v46, s[16:19], s59 offen offset:3072 sc1
    s_add_u32 s83, s83, 1
    s_cmp_gt_u32 s83, 100000
    s_cbranch_scc1 L_end
    s_waitcnt vmcnt(0)
    v_xor_b32 v143, s33, v143
    v_xor_b32 v147, s33, v147
    v_xor_b32 v151, s33, v151
    v_or3_b32 v143, v143, v147, v151
    v_cmp_lt_u32_e64 vcc, 1, v143
    ds_write_b64 v63, v[140:141] offset:10752
    ds_write_b32 v64, v142 offset:32
    ds_write_b64 v63, v[144:145] offset:13440
    ds_write_b32 v64, v146 offset:40
    ds_write_b64 v63, v[148:149] offset:8064
    ds_write_b32 v64, v150 offset:24
    s_cmp_lg_u64 vcc, 0
    s_cbranch_scc1 Lrt74
    s_branch Lok73
Lre81:
    s_mov_b32 s83, 0
Lrt80:
    buffer_load_dword v33, v59, s[16:19], s47 offen offset:1440 sc1
    s_add_u32 s83, s83, 1
    s_cmp_gt_u32 s83, 100000
    s_cbranch_scc1 L_end
    s_waitcnt vmcnt(0)
    v_cmp_ne_u32 s[34:35], s46, v33
    s_nop 0
    s_cmp_lg_u64 s[34:35], 0
    s_cbranch_scc1 Lrt80
    s_branch Lok79
Lre86:
    s_mov_b32 s83, 0
Lrt85:
    s_add_u32 s77, s47, 217088
    buffer_load_dwordx3 v[32:34], v71, s[16:19], s77 offen sc1
    s_add_u32 s83, s83, 1
    s_cmp_gt_u32 s83, 100000
    s_cbranch_scc1 L_end
    s_waitcnt vmcnt(0)
    v_cmp_ne_u32 s[34:35], s79, v34
    s_nop 0
    s_and_b32 s77, s34, s76
    s_cbranch_scc1 Lrt85
    s_branch Lok84
LF_early:
    s_and_b32 s55, s80, 0x7ff
    s_sub_u32 s55, s86, s55
    s_lshr_b32 s55, s55, 1
    s_bfe_u32 s79, s55, 0x10004
    s_xor_b32 s79, s79, s53
    s_cmp_eq_u32 s44, 0
    s_cselect_b32 s95, 125952, s94
    s_xor_b32 s81, s80, s54
    s_cselect_b32 s95, s95, s47
    s_add_u32 s95, s95, 29696
    s_mov_b32 s54, s80
    s_or_b32 s81, s81, s79
    s_cbranch_scc1 LF_last
    v_bfe_u32 v73, v46, 5, 3
    v_mul_u32_u24 v73, 2304, v73
    v_and_b32 v72, 16, v46
    v_and_b32 v74, 0, v65
    v_add3_u32 v73, v73, v72, v74
    v_add_u32_e64 v73, v73, v65
    s_lshl1_add_u32 s76, s41, s52
    s_lshl_b32 s76, s76, 7
    s_add_u32 s76, s76, 163840
    v_mov_b32 v92, 0
    v_mov_b32 v93, 0
    v_mov_b32 v94, s54
    v_mov_b32 v95, s46
    buffer_load_dwordx4 v[76:79], v73, s[16:19], s76 offen sc1
    s_add_u32 s77, s76, 18432
    buffer_load_dwordx4 v[80:83], v73, s[16:19], s77 offen sc1
    s_add_u32 s77, s76, 36864
    buffer_load_dwordx4 v[84:87], v73, s[16:19], s77 offen sc1
    s_add_u32 s77, s76, 55296
    buffer_load_dwordx4 v[88:91], v73, s[16:19], s77 offen sc1
    s_add_u32 s77, s76, 73728
    s_mov_b32 exec_lo, 0x00ff00ff
    s_mov_b32 exec_hi, exec_lo
    buffer_load_dwordx4 v[92:95], v73, s[16:19], s77 offen sc1
    s_mov_b64 exec, -1
    Lw8: s_cbranch_execz Lwx
    s_branch LF_last
LF_decide:
    s_cmp_eq_u32 s83, -1
    s_cbranch_scc1 Lgo140
    s_waitcnt vmcnt(0) lgkmcnt(0)
    s_mov_b32 s83, 0
Lspin141:
    s_mov_b32 s81, 786432
    buffer_load_dwordx2 v[98:99], v32, s[16:19], s81 offen sc1
    s_add_u32 s83, s83, 1
    s_cmp_gt_u32 s83, 100000
    s_cbranch_scc1 L_end
    s_waitcnt vmcnt(0)
    v_cmp_eq_u32 s[74:75], s46, v99
    v_readlane_b32 s81, v98, s77
    s_nop 0
    s_and_b32 s82, s81, 0x7ff
    s_cmp_le_u32 s82, s78
    s_cselect_b32 s81, s81, 0
    s_max_u32 s80, s54, s81
    v_cmp_lt_u32 vcc, s80, v98
    s_bitcmp1_b32 s74, s77
    s_cselect_b32 s81, s74, 0
    s_and_b32 s82, s81, vcc_lo
    s_cbranch_scc1 LF_free
    s_cmp_eq_u32 s74, -1
    s_cbranch_scc0 Lspin141
    s_and_b32 s55, s80, 0x7ff
    s_sub_u32 s55, s86, s55
    s_lshr_b32 s55, s55, 1
    s_bfe_u32 s79, s55, 0x10004
    s_xor_b32 s79, s79, s53
    s_cmp_eq_u32 s44, 0
    s_cselect_b32 s95, 125952, s94
    s_xor_b32 s81, s80, s54
    s_cselect_b32 s95, s95, s47
    s_add_u32 s95, s95, 29696
    s_mov_b32 s54, s80
    s_or_b32 s81, s81, s79
    s_cbranch_scc1 Lgo140
    v_bfe_u32 v73, v46, 5, 3
    v_mul_u32_u24 v73, 2304, v73
    v_and_b32 v72, 16, v46
    v_and_b32_e64 v74, 0, v65
    v_add3_u32 v73, v73, v72, v74
    v_add_u32_e64 v73, v73, v65
    s_lshl1_add_u32 s76, s41, s52
    s_lshl_b32 s76, s76, 7
    s_add_u32 s76, s76, 163840
    v_mov_b32 v92, 0
    v_mov_b32 v93, 0
    v_mov_b32 v94, s54
    v_mov_b32 v95, s46
    buffer_load_dwordx4 v[76:79], v73, s[16:19], s76 offen sc1
    s_add_u32 s77, s76, 18432
    buffer_load_dwordx4 v[80:83], v73, s[16:19], s77 offen sc1
    s_add_u32 s77, s76, 36864
    buffer_load_dwordx4 v[84:87], v73, s[16:19], s77 offen sc1
    s_add_u32 s77, s76, 55296
    buffer_load_dwordx4 v[88:91], v73, s[16:19], s77 offen sc1
    s_add_u32 s77, s76, 73728
    s_mov_b32 exec_lo, 0x00ff00ff
    s_mov_b32 exec_hi, exec_lo
    buffer_load_dwordx4 v[92:95], v73, s[16:19], s77 offen sc1
    s_mov_b64 exec, -1
Lgo140:
    s_cmp_lg_u32 s81, 0
    s_cbranch_scc1 Lnotown138
    v_mov_b32 v116, 0
    v_mov_b32 v117, 0
    v_mov_b32 v118, s54
    v_mov_b32 v119, s46
    buffer_load_dwordx4 v[100:103], v73, s[16:19], s76 offen sc1
    s_add_u32 s77, s76, 18432
    buffer_load_dwordx4 v[104:107], v73, s[16:19], s77 offen sc1
    s_add_u32 s77, s76, 36864
    buffer_load_dwordx4 v[108:111], v73, s[16:19], s77 offen sc1
    s_add_u32 s77, s76, 55296
    buffer_load_dwordx4 v[112:115], v73, s[16:19], s77 offen sc1
    s_add_u32 s77, s76, 73728
    s_mov_b32 exec_lo, 0x00ff00ff
    s_mov_b32 exec_hi, exec_lo
    buffer_load_dwordx4 v[116:119], v73, s[16:19], s77 offen sc1
    s_mov_b64 exec, -1
Lnotown138:
    s_lshl_b32 s82, s53, 6
    s_add_u32 s82, s82, 768
    v_add_u32 v99, s82, v49
    ds_read2_b32 v[126:127], v99 offset0:32 offset1:128
    ds_read2_b32 v[128:129], v99 offset0:0 offset1:96
    s_waitcnt lgkmcnt(1)
    v_add_f32 v126, 1.0, v126
    v_pk_fma_f32 v[8:9], v[8:9], v[126:127], v[126:127] op_sel:[0,0,1] op_sel_hi:[1,0,1]
    v_pk_fma_f32 v[10:11], v[10:11], v[126:127], v[126:127] op_sel:[0,0,1] op_sel_hi:[1,0,1]
    v_pk_fma_f32 v[12:13], v[12:13], v[126:127], v[126:127] op_sel:[0,0,1] op_sel_hi:[1,0,1]
    v_pk_fma_f32 v[14:15], v[14:15], v[126:127], v[126:127] op_sel:[0,0,1] op_sel_hi:[1,0,1]
    s_waitcnt lgkmcnt(0)
    v_add_f32 v128, 1.0, v128
    v_pk_fma_f32 v[16:17], v[16:17], v[128:129], v[128:129] op_sel:[0,0,1] op_sel_hi:[1,0,1]
    v_pk_fma_f32 v[18:19], v[18:19], v[128:129], v[128:129] op_sel:[0,0,1] op_sel_hi:[1,0,1]
    v_pk_fma_f32 v[20:21], v[20:21], v[128:129], v[128:129] op_sel:[0,0,1] op_sel_hi:[1,0,1]
    v_pk_fma_f32 v[22:23], v[22:23], v[128:129], v[128:129] op_sel:[0,0,1] op_sel_hi:[1,0,1]
    v_mov_b32 v72, 0
    s_barrier
    ds_write2_b32 v99, v72, v72 offset0:0 offset1:96
    ds_write2_b32 v99, v72, v72 offset0:32 offset1:128
    s_lshr_b32 s82, s55, 5
    s_sub_u32 s82, 2, s82
    s_mul_i32 s78, s82, 36864
    s_bfe_u32 s82, s55, 0x10004
    s_mul_i32 s82, s82, 6144
    s_add_u32 s78, s78, s82
    v_lshrrev_b32 v140, 4, v46
    v_bfe_u32 v141, v140, 1, 2
    v_lshlrev_b32 v141, 8, v141
    v_and_b32 v142, 1, v140
    v_lshl_add_u32 v141, v142, 3, v141
    s_and_b32 s82, s55, 15
    s_lshl4_add_u32 s82, s82, s78
    v_add_u32_e64 v141, s82, v141
    v_bfe_u32 v144, v140, 3, 1
    v_lshrrev_b32 v140, 4, v140
    v_subrev_u32 v140, s45, v140
    v_add_u32 v96, s78, v46
    v_add_u32 v142, 0, v140
    v_add_u32 v143, 9, v140
    v_min_u32 v142, v142, v143
    v_lshlrev_b32_e64 v142, 2, v142
    v_lshrrev_b64 v[142:143], v142, s[90:91]
    v_and_b32_e64 v142, 15, v142
    v_lshl_add_u32 v142, v142, 1, v144
    v_mul_u32_u24 v143, 43, v142
    v_lshrrev_b32 v143, 8, v143
    v_mul_u32_u24 v143, 6144, v143
    v_lshl_add_u32 v142, v142, 10, v143
    v_add_u32 v148, v142, v141
    v_add_u32 v142, 3, v140
    v_add_u32 v143, 12, v140
    v_min_u32 v142, v142, v143
    v_lshlrev_b32_e64 v142, 2, v142
    v_lshrrev_b64 v[142:143], v142, s[90:91]
    v_and_b32_e64 v142, 15, v142
    v_lshl_add_u32 v142, v142, 1, v144
    v_mul_u32_u24 v143, 43, v142
    v_lshrrev_b32 v143, 8, v143
    v_mul_u32_u24 v143, 6144, v143
    v_lshl_add_u32 v142, v142, 10, v143
    v_add_u32 v149, v142, v141
    v_add_u32 v142, 6, v140
    v_add_u32 v143, 15, v140
    v_min_u32 v142, v142, v143
    v_lshlrev_b32_e64 v142, 2, v142
    v_lshrrev_b64 v[142:143], v142, s[90:91]
    v_and_b32_e64 v142, 15, v142
    v_lshl_add_u32 v142, v142, 1, v144
    v_mul_u32_u24 v143, 43, v142
    v_lshrrev_b32 v143, 8, v143
    v_mul_u32_u24 v143, 6144, v143
    v_lshl_add_u32 v142, v142, 10, v143
    v_add_u32_e64 v150, v142, v141
    s_cmp_eq_u32 s44, 2
    s_cselect_b32 s80, s55, 0
    s_cmp_ge_u32 s80, 80
    s_cselect_b32 s80, 155648, 2.0
    s_mov_b32 s79, s81
    s_and_b32 s81, s55, 15
    s_lshl_b32 s74, 0x10001, s81
    s_mov_b32 s75, s74
    s_and_b32 s81, s81, 14
    s_lshl_b32 s92, 0x30003, s81
    s_mov_b32 s93, s92
    s_lshr_b32 s81, s55, 5
    s_mov_b64 vcc, s[74:75]
    v_mov_b32 v140, 0
    v_mov_b32 v141, 0
    v_mov_b32 v142, 0
    v_mov_b32_e64 v143, 0
    s_cmp_eq_u32 s81, 1
    s_cbranch_scc1 Lsa142
    s_cmp_eq_u32 s81, 0
    s_cbranch_scc1 Lsb143
    v_cndmask_b32_dpp v120, v0, v0, vcc quad_perm:[1,0,3,2] row_mask:0xf bank_mask:0xf
    v_cndmask_b32_dpp v121, v1, v1, vcc quad_perm:[1,0,3,2] row_mask:0xf bank_mask:0xf
    v_cndmask_b32_dpp v122, v2, v2, vcc quad_perm:[1,0,3,2] row_mask:0xf bank_mask:0xf
    v_cndmask_b32_dpp v123, v3, v3, vcc quad_perm:[1,0,3,2] row_mask:0xf bank_mask:0xf
    v_cndmask_b32_dpp v124, v4, v4, vcc quad_perm:[1,0,3,2] row_mask:0xf bank_mask:0xf
    v_cndmask_b32_dpp v125, v5, v5, vcc quad_perm:[1,0,3,2] row_mask:0xf bank_mask:0xf
    v_cndmask_b32_dpp v126, v6, v6, vcc quad_perm:[1,0,3,2] row_mask:0xf bank_mask:0xf
    v_cndmask_b32_dpp v127, v7, v7, vcc quad_perm:[1,0,3,2] row_mask:0xf bank_mask:0xf
    s_branch Lsj144
Lsa142:
    v_cndmask_b32_dpp v120, v8, v8, vcc quad_perm:[1,0,3,2] row_mask:0xf bank_mask:0xf
    v_cndmask_b32_dpp v121, v9, v9, vcc quad_perm:[1,0,3,2] row_mask:0xf bank_mask:0xf
    v_cndmask_b32_dpp v122, v10, v10, vcc quad_perm:[1,0,3,2] row_mask:0xf bank_mask:0xf
    v_cndmask_b32_dpp v123, v11, v11, vcc quad_perm:[1,0,3,2] row_mask:0xf bank_mask:0xf
    v_cndmask_b32_dpp v124, v12, v12, vcc quad_perm:[1,0,3,2] row_mask:0xf bank_mask:0xf
    v_cndmask_b32_dpp v125, v13, v13, vcc quad_perm:[1,0,3,2] row_mask:0xf bank_mask:0xf
    v_cndmask_b32_dpp v126, v14, v14, vcc quad_perm:[1,0,3,2] row_mask:0xf bank_mask:0xf
    v_cndmask_b32_dpp v127, v15, v15, vcc quad_perm:[1,0,3,2] row_mask:0xf bank_mask:0xf
    s_branch Lsj144
Lsb143:
    v_cndmask_b32_dpp v120, v16, v16, vcc quad_perm:[1,0,3,2] row_mask:0xf bank_mask:0xf
    v_cndmask_b32_dpp v121, v17, v17, vcc quad_perm:[1,0,3,2] row_mask:0xf bank_mask:0xf
    v_cndmask_b32_dpp v122, v18, v18, vcc quad_perm:[1,0,3,2] row_mask:0xf bank_mask:0xf
    v_cndmask_b32_dpp v123, v19, v19, vcc quad_perm:[1,0,3,2] row_mask:0xf bank_mask:0xf
    v_cndmask_b32_dpp v124, v20, v20, vcc quad_perm:[1,0,3,2] row_mask:0xf bank_mask:0xf
    v_cndmask_b32_dpp v125, v21, v21, vcc quad_perm:[1,0,3,2] row_mask:0xf bank_mask:0xf
    v_cndmask_b32_dpp v126, v22, v22, vcc quad_perm:[1,0,3,2] row_mask:0xf bank_mask:0xf
    v_cndmask_b32_dpp v127, v23, v23, vcc quad_perm:[1,0,3,2] row_mask:0xf bank_mask:0xf
Lsj144:
    s_mov_b64 exec, s[92:93]
    v_cndmask_b32 v140, v120, v124, s[60:61]
    v_cndmask_b32 v141, v121, v125, s[60:61]
    v_cndmask_b32 v142, v122, v126, s[60:61]
    v_cndmask_b32 v143, v123, v127, s[60:61]
    s_mov_b64 exec, -1
    s_lshl1_add_u32 s82, s41, s52
    s_lshl_b32 s82, s82, 7
    s_add_u32 s78, s82, s95
    s_add_u32 s82, s82, s80
    v_and_or_b32 v151, v46, 16, v65
    v_mov_b32 v146, s54
    v_mov_b32 v147, s46
    v_mov_b32 v136, 0
    v_mov_b32 v137, 0
    v_mov_b32 v138, s54
    v_mov_b32 v139, s46
    s_cmp_lg_u32 s79, 0
    s_cselect_b64 exec, 0, -1
    s_cbranch_scc1 Lpk147
    s_mov_b32 s83, 0
Lspin145:
    buffer_load_dwordx4 v[120:123], v73, s[16:19], s76 offen sc1
    s_add_u32 s77, s76, 18432
    buffer_load_dwordx4 v[124:127], v73, s[16:19], s77 offen sc1
    s_add_u32 s77, s76, 36864
    buffer_load_dwordx4 v[128:131], v73, s[16:19], s77 offen sc1
    s_add_u32 s77, s76, 55296
    buffer_load_dwordx4 v[132:135], v73, s[16:19], s77 offen sc1
    s_add_u32 s77, s76, 73728
    s_mov_b32 exec_lo, 0x00ff00ff
    s_mov_b32 exec_hi, exec_lo
    buffer_load_dwordx4 v[136:139], v73, s[16:19], s77 offen sc1
    s_mov_b64 exec, -1
    s_waitcnt vmcnt(10)
    v_xor_b32 v72, s54, v78
    v_xor_b32 v74, s46, v79
    v_or_b32 v72, v72, v74
    v_xor_b32 v74, s54, v82
    v_xor_b32 v75, s46, v83
    v_or3_b32 v72, v72, v74, v75
    v_xor_b32 v74, s54, v86
    v_xor_b32 v75, s46, v87
    v_or3_b32 v72, v72, v74, v75
    v_xor_b32 v74, s54, v90
    v_xor_b32 v75, s46, v91
    v_or3_b32 v72, v72, v74, v75
    v_xor_b32 v74, s54, v94
    v_xor_b32 v75, s46, v95
    v_or3_b32 v72, v72, v74, v75
    v_cmp_ne_u32 vcc, 0, v72
    s_cbranch_vccz Lpk147
    buffer_load_dwordx4 v[76:79], v73, s[16:19], s76 offen sc1
    s_add_u32 s77, s76, 18432
    buffer_load_dwordx4 v[80:83], v73, s[16:19], s77 offen sc1
    s_add_u32 s77, s76, 36864
    buffer_load_dwordx4 v[84:87], v73, s[16:19], s77 offen sc1
    s_add_u32 s77, s76, 55296
    buffer_load_dwordx4 v[88:91], v73, s[16:19], s77 offen sc1
    s_add_u32 s77, s76, 73728
    s_mov_b32 exec_lo, 0x00ff00ff
    s_mov_b32 exec_hi, exec_lo
    buffer_load_dwordx4 v[92:95], v73, s[16:19], s77 offen sc1
    s_mov_b64 exec, -1
    s_waitcnt vmcnt(10)
    v_xor_b32 v72, s54, v102
    v_xor_b32 v74, s46, v103
    v_or_b32 v72, v72, v74
    v_xor_b32 v74, s54, v106
    v_xor_b32 v75, s46, v107
    v_or3_b32 v72, v72, v74, v75
    v_xor_b32 v74, s54, v110
    v_xor_b32 v75, s46, v111
    v_or3_b32 v72, v72, v74, v75
    v_xor_b32 v74, s54, v114
    v_xor_b32 v75, s46, v115
    v_or3_b32 v72, v72, v74, v75
    v_xor_b32 v74, s54, v118
    v_xor_b32 v75, s46, v119
    v_or3_b32 v72, v72, v74, v75
    v_cmp_ne_u32 vcc, 0, v72
    s_cbranch_vccz Lpk148
    buffer_load_dwordx4 v[100:103], v73, s[16:19], s76 offen sc1
    s_add_u32 s77, s76, 18432
    buffer_load_dwordx4 v[104:107], v73, s[16:19], s77 offen sc1
    s_add_u32 s77, s76, 36864
    buffer_load_dwordx4 v[108:111], v73, s[16:19], s77 offen sc1
    s_add_u32 s77, s76, 55296
    buffer_load_dwordx4 v[112:115], v73, s[16:19], s77 offen sc1
    s_add_u32 s77, s76, 73728
    s_mov_b32 exec_lo, 0x00ff00ff
    s_mov_b32 exec_hi, exec_lo
    buffer_load_dwordx4 v[116:119], v73, s[16:19], s77 offen sc1
    s_mov_b64 exec, -1
    s_waitcnt vmcnt(10)
    v_xor_b32 v72, s54, v122
    v_xor_b32 v74, s46, v123
    v_or_b32 v72, v72, v74
    v_xor_b32 v74, s54, v126
    v_xor_b32 v75, s46, v127
    v_or3_b32 v72, v72, v74, v75
    v_xor_b32 v74, s54, v130
    v_xor_b32 v75, s46, v131
    v_or3_b32 v72, v72, v74, v75
    v_xor_b32 v74, s54, v134
    v_xor_b32 v75, s46, v135
    v_or3_b32 v72, v72, v74, v75
    v_xor_b32 v74, s54, v138
    v_xor_b32 v75, s46, v139
    v_or3_b32 v72, v72, v74, v75
    v_cmp_ne_u32_e64 vcc, 0, v72
    s_cbranch_vccz Lpk149
    s_add_u32 s83, s83, 1
    s_cmp_gt_u32 s83, 100000
    s_cbranch_scc0 Lspin145
    s_branch L_end
Lpk147:
    v_and_b32 v79, 0xffff0000, v77
    v_lshlrev_b32_e64 v78, 16, v77
    v_and_b32 v77, 0xffff0000, v76
    v_lshlrev_b32_e64 v76, 16, v76
    v_pk_add_f32 v[142:143], v[142:143], v[78:79]
    v_pk_add_f32 v[140:141], v[140:141], v[76:77]
    v_and_b32 v83, 0xffff0000, v81
    v_lshlrev_b32_e64 v82, 16, v81
    v_and_b32 v81, 0xffff0000, v80
    v_lshlrev_b32_e64 v80, 16, v80
    v_pk_add_f32 v[142:143], v[142:143], v[82:83]
    v_pk_add_f32 v[140:141], v[140:141], v[80:81]
    v_and_b32 v87, 0xffff0000, v85
    v_lshlrev_b32_e64 v86, 16, v85
    v_and_b32 v85, 0xffff0000, v84
    v_lshlrev_b32_e64 v84, 16, v84
    v_pk_add_f32 v[142:143], v[142:143], v[86:87]
    v_pk_add_f32 v[140:141], v[140:141], v[84:85]
    v_and_b32 v91, 0xffff0000, v89
    v_lshlrev_b32_e64 v90, 16, v89
    v_and_b32 v89, 0xffff0000, v88
    v_lshlrev_b32_e64 v88, 16, v88
    v_pk_add_f32 v[142:143], v[142:143], v[90:91]
    v_pk_add_f32 v[140:141], v[140:141], v[88:89]
    v_and_b32 v95, 0xffff0000, v93
    v_lshlrev_b32_e64 v94, 16, v93
    v_and_b32 v93, 0xffff0000, v92
    v_lshlrev_b32_e64 v92, 16, v92
    v_pk_add_f32 v[142:143], v[142:143], v[94:95]
    v_pk_add_f32 v[140:141], v[140:141], v[92:93]
    s_cbranch_execnz Lpj146
Lpk148:
    v_and_b32 v103, 0xffff0000, v101
    v_lshlrev_b32 v102, 16, v101
    v_and_b32 v101, 0xffff0000, v100
    v_lshlrev_b32_e64 v100, 16, v100
    v_pk_add_f32 v[142:143], v[142:143], v[102:103]
    v_pk_add_f32 v[140:141], v[140:141], v[100:101]
    v_and_b32 v107, 0xffff0000, v105
    v_lshlrev_b32_e64 v106, 16, v105
    v_and_b32 v105, 0xffff0000, v104
    v_lshlrev_b32_e64 v104, 16, v104
    v_pk_add_f32 v[142:143], v[142:143], v[106:107]
    v_pk_add_f32 v[140:141], v[140:141], v[104:105]
    v_and_b32 v111, 0xffff0000, v109
    v_lshlrev_b32_e64 v110, 16, v109
    v_and_b32 v109, 0xffff0000, v108
    v_lshlrev_b32_e64 v108, 16, v108
    v_pk_add_f32 v[142:143], v[142:143], v[110:111]
    v_pk_add_f32 v[140:141], v[140:141], v[108:109]
    v_and_b32 v115, 0xffff0000, v113
    v_lshlrev_b32_e64 v114, 16, v113
    v_and_b32 v113, 0xffff0000, v112
    v_lshlrev_b32_e64 v112, 16, v112
    v_pk_add_f32 v[142:143], v[142:143], v[114:115]
    v_pk_add_f32 v[140:141], v[140:141], v[112:113]
    v_and_b32 v119, 0xffff0000, v117
    v_lshlrev_b32_e64 v118, 16, v117
    v_and_b32 v117, 0xffff0000, v116
    v_lshlrev_b32_e64 v116, 16, v116
    v_pk_add_f32 v[142:143], v[142:143], v[118:119]
    v_pk_add_f32 v[140:141], v[140:141], v[116:117]
    s_cbranch_execnz Lpj146
Lpk149:
    v_and_b32 v123, 0xffff0000, v121
    v_lshlrev_b32 v122, 16, v121
    v_and_b32 v121, 0xffff0000, v120
    v_lshlrev_b32_e64 v120, 16, v120
    v_pk_add_f32 v[142:143], v[142:143], v[122:123]
    v_pk_add_f32 v[140:141], v[140:141], v[120:121]
    v_and_b32 v127, 0xffff0000, v125
    v_lshlrev_b32_e64 v126, 16, v125
    v_and_b32 v125, 0xffff0000, v124
    v_lshlrev_b32_e64 v124, 16, v124
    v_pk_add_f32 v[142:143], v[142:143], v[126:127]
    v_pk_add_f32 v[140:141], v[140:141], v[124:125]
    v_and_b32 v131, 0xffff0000, v129
    v_lshlrev_b32_e64 v130, 16, v129
    v_and_b32 v129, 0xffff0000, v128
    v_lshlrev_b32_e64 v128, 16, v128
    v_pk_add_f32 v[142:143], v[142:143], v[130:131]
    v_pk_add_f32 v[140:141], v[140:141], v[128:129]
    v_and_b32 v135, 0xffff0000, v133
    v_lshlrev_b32_e64 v134, 16, v133
    v_and_b32 v133, 0xffff0000, v132
    v_lshlrev_b32_e64 v132, 16, v132
    v_pk_add_f32 v[142:143], v[142:143], v[134:135]
    v_pk_add_f32 v[140:141], v[140:141], v[132:133]
    v_and_b32 v139, 0xffff0000, v137
    v_lshlrev_b32_e64 v138, 16, v137
    v_and_b32 v137, 0xffff0000, v136
    v_lshlrev_b32 v136, 16, v136
    v_pk_add_f32 v[142:143], v[142:143], v[138:139]
    v_pk_add_f32 v[140:141], v[140:141], v[136:137]
Lpj146:
    s_nop 1
    v_add_f32_dpp v140, v140, v140 row_ror:2 row_mask:0xf bank_mask:0xf
    v_add_f32_dpp v141, v141, v141 row_ror:2 row_mask:0xf bank_mask:0xf
    v_add_f32_dpp v142, v142, v142 row_ror:2 row_mask:0xf bank_mask:0xf
    v_add_f32_dpp v143, v143, v143 row_ror:2 row_mask:0xf bank_mask:0xf
    v_add_f32_dpp v140, v140, v140 row_ror:4 row_mask:0xf bank_mask:0xf
    v_add_f32_dpp v141, v141, v141 row_ror:4 row_mask:0xf bank_mask:0xf
    v_add_f32_dpp v142, v142, v142 row_ror:4 row_mask:0xf bank_mask:0xf
    v_add_f32_dpp v143, v143, v143 row_ror:4 row_mask:0xf bank_mask:0xf
    v_add_f32_dpp v140, v140, v140 row_ror:8 row_mask:0xf bank_mask:0xf
    v_add_f32_dpp v141, v141, v141 row_ror:8 row_mask:0xf bank_mask:0xf
    v_add_f32_dpp v142, v142, v142 row_ror:8 row_mask:0xf bank_mask:0xf
    v_add_f32_dpp v143, v143, v143 row_ror:8 row_mask:0xf bank_mask:0xf
    v_cvt_pk_bf16_f32 v144, v140, v141
    v_cvt_pk_bf16_f32 v145, v142, v143
    s_and_saveexec_b64 s[34:35], s[92:93]
    s_nop 0
    buffer_store_dwordx4 v[144:147], v151, s[16:19], s78 offen
    buffer_store_dwordx4 v[144:147], v151, s[16:19], s82 offen sc1
    s_mov_b64 exec, s[34:35]
    s_not_b64 vcc, s[74:75]
    s_cmp_eq_u32 s81, 1
    s_cbranch_scc1 Lsa150
    s_cmp_eq_u32 s81, 0
    s_cbranch_scc1 Lsb151
    v_cndmask_b32_dpp v0, v140, v0, vcc quad_perm:[0,0,2,2] row_mask:0xf bank_mask:0xf
    v_cndmask_b32_dpp v1, v141, v1, vcc quad_perm:[0,0,2,2] row_mask:0xf bank_mask:0xf
    v_cndmask_b32_dpp v2, v142, v2, vcc quad_perm:[0,0,2,2] row_mask:0xf bank_mask:0xf
    v_cndmask_b32_dpp v3, v143, v3, vcc quad_perm:[0,0,2,2] row_mask:0xf bank_mask:0xf
    v_cndmask_b32_dpp v4, v140, v4, vcc quad_perm:[1,1,3,3] row_mask:0xf bank_mask:0xf
    v_cndmask_b32_dpp v5, v141, v5, vcc quad_perm:[1,1,3,3] row_mask:0xf bank_mask:0xf
    v_cndmask_b32_dpp v6, v142, v6, vcc quad_perm:[1,1,3,3] row_mask:0xf bank_mask:0xf
    v_cndmask_b32_dpp v7, v143, v7, vcc quad_perm:[1,1,3,3] row_mask:0xf bank_mask:0xf
    s_branch Lsj152
Lsa150:
    v_cndmask_b32_dpp v8, v140, v8, vcc quad_perm:[0,0,2,2] row_mask:0xf bank_mask:0xf
    v_cndmask_b32_dpp v9, v141, v9, vcc quad_perm:[0,0,2,2] row_mask:0xf bank_mask:0xf
    v_cndmask_b32_dpp v10, v142, v10, vcc quad_perm:[0,0,2,2] row_mask:0xf bank_mask:0xf
    v_cndmask_b32_dpp v11, v143, v11, vcc quad_perm:[0,0,2,2] row_mask:0xf bank_mask:0xf
    v_cndmask_b32_dpp v12, v140, v12, vcc quad_perm:[1,1,3,3] row_mask:0xf bank_mask:0xf
    v_cndmask_b32_dpp v13, v141, v13, vcc quad_perm:[1,1,3,3] row_mask:0xf bank_mask:0xf
    v_cndmask_b32_dpp v14, v142, v14, vcc quad_perm:[1,1,3,3] row_mask:0xf bank_mask:0xf
    v_cndmask_b32_dpp v15, v143, v15, vcc quad_perm:[1,1,3,3] row_mask:0xf bank_mask:0xf
    s_branch Lsj152
Lsb151:
    v_cndmask_b32_dpp v16, v140, v16, vcc quad_perm:[0,0,2,2] row_mask:0xf bank_mask:0xf
    v_cndmask_b32_dpp v17, v141, v17, vcc quad_perm:[0,0,2,2] row_mask:0xf bank_mask:0xf
    v_cndmask_b32_dpp v18, v142, v18, vcc quad_perm:[0,0,2,2] row_mask:0xf bank_mask:0xf
    v_cndmask_b32_dpp v19, v143, v19, vcc quad_perm:[0,0,2,2] row_mask:0xf bank_mask:0xf
    v_cndmask_b32_dpp v20, v140, v20, vcc quad_perm:[1,1,3,3] row_mask:0xf bank_mask:0xf
    v_cndmask_b32_dpp v21, v141, v21, vcc quad_perm:[1,1,3,3] row_mask:0xf bank_mask:0xf
    v_cndmask_b32_dpp v22, v142, v22, vcc quad_perm:[1,1,3,3] row_mask:0xf bank_mask:0xf
    v_cndmask_b32_dpp v23, v143, v23, vcc quad_perm:[1,1,3,3] row_mask:0xf bank_mask:0xf
Lsj152:
    s_mov_b64 exec, -1
    s_waitcnt vmcnt(2)
    s_mov_b32 s76, s95
    v_mov_b32 v140, 0
    v_mov_b32 v142, 0
    v_mov_b32 v141, 0x3f803f80
    s_mov_b32 exec_hi, 0xffff
    s_mov_b32 s83, 0
Lspin153:
    buffer_load_dwordx4 v[112:115], v46, s[16:19], s76 offen offset:0 sc1
    buffer_load_dwordx4 v[116:119], v46, s[16:19], s76 offen offset:768 sc1
    buffer_load_dwordx4 v[120:123], v46, s[16:19], s76 offen offset:1536 sc1
    s_add_u32 s83, s83, 1
    s_cmp_gt_u32 s83, 100000
    s_cbranch_scc1 L_end
    s_waitcnt vmcnt(2)
    v_xor_b32 v72, s46, v115
    s_waitcnt vmcnt(1)
    v_xor_b32 v73, s46, v119
    s_waitcnt vmcnt(0)
    v_xor_b32 v74, s46, v123
    v_or3_b32 v72, v72, v73, v74
    v_cmp_ne_u32_e64 vcc, 0, v72
    s_cbranch_vccnz Lspin153
    ds_write_b64 v148, v[112:113]
    ds_write_b64 v149, v[116:117]
    ds_write_b64 v150, v[120:121]
    v_dot2c_f32_bf16 v140, v112, v141
    v_dot2c_f32_bf16 v142, v112, v112
    v_dot2c_f32_bf16 v140, v113, v141
    v_dot2c_f32_bf16 v142, v113, v113
    v_dot2c_f32_bf16 v140, v116, v141
    v_dot2c_f32_bf16 v142, v116, v116
    v_dot2c_f32_bf16 v140, v117, v141
    v_dot2c_f32_bf16 v142, v117, v117
    v_dot2c_f32_bf16 v140, v120, v141
    v_dot2c_f32_bf16 v142, v120, v120
    v_dot2c_f32_bf16 v140, v121, v141
    v_dot2c_f32_bf16 v142, v121, v121
    s_mov_b64 exec, -1
    ds_read_b128 v[72:75], v96 offset:0
    ds_read_b128 v[76:79], v96 offset:1024
    ds_read_b128 v[80:83], v96 offset:2048
    ds_read_b128 v[84:87], v96 offset:3072
    ds_read_b128 v[88:91], v96 offset:4096
    ds_read_b128 v[92:95], v96 offset:5120
    v_add_f32_dpp v140, v140, v140 row_ror:1 row_mask:0xf bank_mask:0xf
    v_add_f32_dpp v142, v142, v142 row_ror:1 row_mask:0xf bank_mask:0xf
    s_nop 0
    v_add_f32_dpp v140, v140, v140 row_ror:2 row_mask:0xf bank_mask:0xf
    v_add_f32_dpp v142, v142, v142 row_ror:2 row_mask:0xf bank_mask:0xf
    s_nop 0
    v_add_f32_dpp v140, v140, v140 row_ror:4 row_mask:0xf bank_mask:0xf
    v_add_f32_dpp v142, v142, v142 row_ror:4 row_mask:0xf bank_mask:0xf
    s_nop 0
    v_add_f32_dpp v140, v140, v140 row_ror:8 row_mask:0xf bank_mask:0xf
    v_add_f32_dpp v142, v142, v142 row_ror:8 row_mask:0xf bank_mask:0xf
    s_waitcnt lgkmcnt(5)
    v_mfma_f32_16x16x32_bf16 v[100:103], a[0:3], v[72:75], 0
    v_mov_b32 v141, v140
    v_mov_b32 v143, v142
    v_mfma_f32_16x16x32_bf16 v[104:107], a[4:7], v[72:75], 0
    v_permlane16_swap_b32 v140, v141
    v_mfma_f32_16x16x32_bf16 v[108:111], v[72:75], a[8:11], 0
    s_waitcnt lgkmcnt(4)
    ds_read_b128 v[72:75], v96 offset:12288
    v_mfma_f32_16x16x32_bf16 v[100:103], a[12:15], v[76:79], v[100:103]
    v_permlane16_swap_b32 v142, v143
    v_mfma_f32_16x16x32_bf16 v[104:107], a[16:19], v[76:79], v[104:107]
    v_add_f32 v140, v140, v141
    v_add_f32 v142, v142, v143
    v_mfma_f32_16x16x32_bf16 v[108:111], v[76:79], a[20:23], v[108:111]
    s_waitcnt lgkmcnt(4)
    ds_read_b128 v[76:79], v96 offset:13312
    v_mov_b32 v141, v140
    v_mfma_f32_16x16x32_bf16 v[100:103], a[24:27], v[80:83], v[100:103]
    v_mov_b32 v143, v142
    v_mfma_f32_16x16x32_bf16 v[104:107], a[28:31], v[80:83], v[104:107]
    v_permlane32_swap_b32 v140, v141
    v_mfma_f32_16x16x32_bf16 v[108:111], v[80:83], a[32:35], v[108:111]
    s_waitcnt lgkmcnt(4)
    ds_read_b128 v[80:83], v96 offset:14336
    v_mfma_f32_16x16x32_bf16 v[100:103], a[36:39], v[84:87], v[100:103]
    v_permlane32_swap_b32 v142, v143
    v_mfma_f32_16x16x32_bf16 v[104:107], a[40:43], v[84:87], v[104:107]
    v_add_f32 v140, v140, v141
    v_add_f32 v142, v142, v143
    v_mfma_f32_16x16x32_bf16 v[108:111], v[84:87], a[44:47], v[108:111]
    s_waitcnt lgkmcnt(4)
    ds_read_b128 v[84:87], v96 offset:15360
    v_mul_f32 v140, 0xbae38e39, v140
    v_mfma_f32_16x16x32_bf16 v[100:103], a[48:51], v[88:91], v[100:103]
    v_mul_f32 v142, 0x3ae38e39, v142
    v_fma_f32 v142, -v140, v140, v142
    v_mfma_f32_16x16x32_bf16 v[104:107], a[52:55], v[88:91], v[104:107]
    v_max_f32 v142, 0, v142
    v_add_f32 v141, 0x3727c5ac, v142
    v_mfma_f32_16x16x32_bf16 v[108:111], v[88:91], a[56:59], v[108:111]
    s_waitcnt lgkmcnt(4)
    ds_read_b128 v[88:91], v96 offset:16384
    v_mfma_f32_16x16x32_bf16 v[100:103], a[60:63], v[92:95], v[100:103]
    v_rsq_f32 v141, v141
    v_mfma_f32_16x16x32_bf16 v[104:107], a[64:67], v[92:95], v[104:107]
    s_lshl_b32 s76, s55, 2
    s_add_u32 s76, s76, 159744
    v_mov_b32_e64 v142, s76
    v_mfma_f32_16x16x32_bf16 v[108:111], v[92:95], a[68:71], v[108:111]
    s_waitcnt lgkmcnt(4)
    ds_read_b128 v[92:95], v96 offset:17408
    s_lshr_b32 s81, s55, 4
    v_mfma_f32_16x16x32_bf16 v[100:103], a[72:75], v[72:75], v[100:103]
    v_lshl_add_u32 v114, s81, 6, v49
    v_lshl_add_u32 v115, s81, 6, v50
    v_mfma_f32_16x16x32_bf16 v[104:107], a[76:79], v[72:75], v[104:107]
    ds_write2_b32 v142, v141, v140 offset1:96
    v_mfma_f32_16x16x32_bf16 v[108:111], v[72:75], a[80:83], v[108:111]
    s_waitcnt lgkmcnt(5)
    ds_read_b128 v[72:75], v96 offset:24576
    v_mfma_f32_16x16x32_bf16 v[100:103], a[84:87], v[76:79], v[100:103]
    ds_read2_b32 v[124:125], v114 offset0:0 offset1:96
    v_mfma_f32_16x16x32_bf16 v[104:107], a[88:91], v[76:79], v[104:107]
    ds_read_b128 v[126:129], v115 offset:0
    v_mfma_f32_16x16x32_bf16 v[108:111], v[76:79], a[92:95], v[108:111]
    s_waitcnt lgkmcnt(7)
    ds_read_b128 v[76:79], v96 offset:25600
    v_mfma_f32_16x16x32_bf16 v[100:103], a[96:99], v[80:83], v[100:103]
    ds_read_b128 v[130:133], v115 offset:384
    s_mul_i32 s82, s81, 2688
    v_mfma_f32_16x16x32_bf16 v[104:107], a[100:103], v[80:83], v[104:107]
    v_add_u32_e64 v112, s82, v47
    v_add_u32 v116, s82, v63
    v_mfma_f32_16x16x32_bf16 v[108:111], v[80:83], a[104:107], v[108:111]
    s_waitcnt lgkmcnt(8)
    ds_read_b128 v[80:83], v96 offset:26624
    v_lshl_add_u32 v113, s81, 3, v48
    v_mfma_f32_16x16x32_bf16 v[100:103], a[108:111], v[84:87], v[100:103]
    v_lshl_add_u32 v117, s81, 3, v64
    s_lshl_b32 s76, s81, 10
    v_mfma_f32_16x16x32_bf16 v[104:107], a[112:115], v[84:87], v[104:107]
    s_add_u32 s76, s76, s59
    v_mfma_f32_16x16x32_bf16 v[108:111], v[84:87], a[116:119], v[108:111]
    s_waitcnt lgkmcnt(8)
    ds_read_b128 v[84:87], v96 offset:27648
    v_mfma_f32_16x16x32_bf16 v[100:103], a[120:123], v[88:91], v[100:103]
    v_mfma_f32_16x16x32_bf16 v[104:107], a[124:127], v[88:91], v[104:107]
    v_mfma_f32_16x16x32_bf16 v[108:111], v[88:91], a[128:131], v[108:111]
    s_waitcnt lgkmcnt(8)
    ds_read_b128 v[88:91], v96 offset:28672
    v_mfma_f32_16x16x32_bf16 v[100:103], a[132:135], v[92:95], v[100:103]
    v_mfma_f32_16x16x32_bf16 v[104:107], a[136:139], v[92:95], v[104:107]
    v_mfma_f32_16x16x32_bf16 v[108:111], v[92:95], a[140:143], v[108:111]
    s_waitcnt lgkmcnt(7)
    ds_read_b128 v[92:95], v96 offset:29696
    v_mfma_f32_16x16x32_bf16 v[100:103], a[144:147], v[72:75], v[100:103]
    v_mfma_f32_16x16x32_bf16 v[104:107], a[148:151], v[72:75], v[104:107]
    v_mfma_f32_16x16x32_bf16 v[108:111], v[72:75], a[152:155], v[108:111]
    s_waitcnt lgkmcnt(5)
    v_mfma_f32_16x16x32_bf16 v[100:103], a[156:159], v[76:79], v[100:103]
    v_mfma_f32_16x16x32_bf16 v[104:107], a[160:163], v[76:79], v[104:107]
    v_mfma_f32_16x16x32_bf16 v[108:111], v[76:79], a[164:167], v[108:111]
    s_waitcnt lgkmcnt(3)
    v_mfma_f32_16x16x32_bf16 v[100:103], a[168:171], v[80:83], v[100:103]
    v_mfma_f32_16x16x32_bf16 v[104:107], a[172:175], v[80:83], v[104:107]
    v_mfma_f32_16x16x32_bf16 v[108:111], v[80:83], a[176:179], v[108:111]
    s_waitcnt lgkmcnt(2)
    v_mfma_f32_16x16x32_bf16 v[100:103], a[180:183], v[84:87], v[100:103]
    v_mfma_f32_16x16x32_bf16 v[104:107], a[184:187], v[84:87], v[104:107]
    v_mfma_f32_16x16x32_bf16 v[108:111], v[84:87], a[188:191], v[108:111]
    s_waitcnt lgkmcnt(1)
    v_mfma_f32_16x16x32_bf16 v[100:103], a[192:195], v[88:91], v[100:103]
    v_mfma_f32_16x16x32_bf16 v[104:107], a[196:199], v[88:91], v[104:107]
    Lw9: s_cbranch_execz Lwx
    v_mfma_f32_16x16x32_bf16 v[108:111], v[88:91], a[200:203], v[108:111]
    s_waitcnt lgkmcnt(0)
    v_mfma_f32_16x16x32_bf16 v[100:103], a[204:207], v[92:95], v[100:103]
    v_mfma_f32_16x16x32_bf16 v[104:107], a[208:211], v[92:95], v[104:107]
    v_mfma_f32_16x16x32_bf16 v[108:111], v[92:95], a[212:215], v[108:111]
    s_nop 0
    v_pk_fma_f32 v[100:101], v[124:125], v[24:25], v[100:101] op_sel:[1,0,0] op_sel_hi:[1,1,1]
    v_pk_fma_f32 v[102:103], v[124:125], v[26:27], v[102:103] op_sel:[1,0,0] op_sel_hi:[1,1,1]
    v_pk_mul_f32 v[100:101], v[124:125], v[100:101] op_sel_hi:[0,1]
    v_pk_mul_f32 v[102:103], v[124:125], v[102:103] op_sel_hi:[0,1]
    v_cvt_pk_bf16_f32 v134, v100, v101
    v_cvt_pk_bf16_f32 v135, v102, v103
    ds_write_b64 v112, v[134:135] offset:0
    v_pk_fma_f32 v[104:105], v[124:125], v[28:29], v[104:105] op_sel:[1,0,0] op_sel_hi:[1,1,1]
    v_pk_fma_f32 v[106:107], v[124:125], v[30:31], v[106:107] op_sel:[1,0,0] op_sel_hi:[1,1,1]
    v_pk_mul_f32 v[104:105], v[124:125], v[104:105] op_sel_hi:[0,1]
    v_pk_mul_f32 v[106:107], v[124:125], v[106:107] op_sel_hi:[0,1]
    v_cvt_pk_bf16_f32 v136, v104, v105
    v_cvt_pk_bf16_f32 v137, v106, v107
    ds_write_b64 v112, v[136:137] offset:16128
    v_pk_fma_f32 v[108:109], v[130:131], v[34:35], v[108:109] op_sel:[0,1,0]
    v_pk_fma_f32 v[110:111], v[132:133], v[34:35], v[110:111] op_sel:[0,1,0]
    v_pk_mul_f32 v[108:109], v[126:127], v[108:109]
    v_pk_mul_f32 v[110:111], v[128:129], v[110:111]
    v_cvt_pk_bf16_f32 v138, v108, v109
    v_cvt_pk_bf16_f32 v139, v110, v111
    ds_write_b64 v113, v[138:139] offset:0
    s_or_b32 s94, s46, 3
    v_permlane32_swap_b32 v134, v136
    v_permlane32_swap_b32_e64 v135, v137
    v_mov_b32_dpp v139, v139 row_ror:8 row_mask:0xf bank_mask:0xf
    v_cndmask_b32 v134, v134, v136, s[28:29]
    v_cndmask_b32 v135, v135, v137, s[28:29]
    v_cndmask_b32 v136, v138, v139, s[30:31]
    v_mov_b32_e64 v137, s94
    s_bitcmp1_b32 s58, 0
    s_cbranch_scc0 Lnx154
    buffer_store_dwordx4 v[134:137], v46, s[16:19], s76 offen offset:0
Lnx154:
    v_mov_b32 v143, s46
    s_bitcmp1_b32 s58, 1
    s_cbranch_scc0 Lnp155
    v_xor_b32 v143, s94, v143
    v_cmp_lt_u32_e64 vcc, 0, v143
    ds_write_b64 v116, v[140:141] offset:0
    ds_write_b32 v117, v142 offset:0
    s_cmp_lg_u64 vcc, 0
    s_cbranch_scc1 Lre158
Lok156:
Lnp155:
    s_waitcnt vmcnt(0) lgkmcnt(0)
    s_branch LF_free
Lre93:
    s_mov_b32 s83, 0
Lrt92:
    buffer_load_dwordx4 v[120:123], v46, s[16:19], s59 offen offset:2048 sc1
    buffer_load_dwordx4 v[124:127], v46, s[16:19], s59 offen offset:1024 sc1
    s_add_u32 s83, s83, 1
    s_cmp_gt_u32 s83, 100000
    s_cbranch_scc1 L_end
    s_waitcnt vmcnt(0)
    v_xor_b32 v123, s33, v123
    v_xor_b32 v127, s33, v127
    v_or_b32 v123, v123, v127
    v_cmp_lt_u32 vcc, 1, v123
    ds_write_b64 v63, v[120:121] offset:5376
    ds_write_b32 v64, v122 offset:16
    ds_write_b64 v63, v[124:125] offset:2688
    ds_write_b32 v64, v126 offset:8
    s_cmp_lg_u64 vcc, 0
    s_cbranch_scc1 Lrt92
    s_branch Lok91
Lre98:
    s_mov_b32 s83, 0
Lrt97:
    buffer_load_dwordx4 v[148:151], v46, s[16:19], s59 offen offset:0 sc1
    s_add_u32 s83, s83, 1
    s_cmp_gt_u32 s83, 100000
    s_cbranch_scc1 L_end
    s_waitcnt vmcnt(0)
    v_xor_b32 v151, s33, v151
    v_cmp_lt_u32_e64 vcc, 1, v151
    ds_write_b64 v63, v[148:149] offset:0
    ds_write_b32 v64, v150 offset:0
    s_cmp_lg_u64 vcc, 0
    s_cbranch_scc1 Lrt97
    s_branch Lok96
Lre101:
    s_mov_b32 s83, 0
Lrt100:
    buffer_load_dword v146, v58, s[16:19], s47 offen offset:480 sc1
    s_add_u32 s83, s83, 1
    s_cmp_gt_u32 s83, 100000
    s_cbranch_scc1 L_end
    s_waitcnt vmcnt(0)
    v_cmp_ne_u32 s[34:35], s46, v146
    s_nop 0
    s_cmp_lg_u64 s[34:35], 0
    s_cbranch_scc1 Lrt100
    s_branch Lok99
Lre104:
    s_mov_b32 s83, 0
Lrt103:
    buffer_load_dword v146, v58, s[16:19], s47 offen offset:640 sc1
    s_add_u32 s83, s83, 1
    s_cmp_gt_u32 s83, 100000
    s_cbranch_scc1 L_end
    s_waitcnt vmcnt(0)
    v_cmp_ne_u32 s[34:35], s46, v146
    s_nop 0
    s_cmp_lg_u64 s[34:35], 0
    s_cbranch_scc1 Lrt103
    s_branch Lok102
Lre108:
    s_mov_b32 s83, 0
Lrt107:
    buffer_load_dword v98, v58, s[16:19], s47 offen offset:800 sc1
    s_add_u32 s83, s83, 1
    s_cmp_gt_u32 s83, 100000
    s_cbranch_scc1 L_end
    s_waitcnt vmcnt(0)
    v_cmp_ne_u32 s[34:35], s46, v98
    s_nop 0
    s_cmp_lg_u64 s[34:35], 0
    s_cbranch_scc1 Lrt107
    s_branch Lok106
Lre112:
    s_mov_b32 s83, 0
Lrt111:
    buffer_load_dwordx4 v[112:115], v61, s[16:19], s47 offen offset:3072 sc1
    s_add_u32 s81, s47, 12288
    buffer_load_dwordx4 v[116:119], v61, s[16:19], s81 offen offset:3072 sc1
    s_add_u32 s81, s47, 24576
    buffer_load_dwordx4 v[120:123], v69, s[16:19], s81 offen offset:3072 sc1
    s_add_u32 s83, s83, 1
    s_cmp_gt_u32 s83, 100000
    s_cbranch_scc1 L_end
    s_waitcnt vmcnt(0)
    v_cmp_ne_u32 s[74:75], s79, v115
    v_cmp_ne_u32 s[92:93], s79, v119
    v_cmp_ne_u32 vcc, s79, v123
    s_or_b64 s[74:75], s[74:75], s[92:93]
    s_and_b32 s92, vcc_lo, 0xffff
    s_or_b32 s74, s74, s75
    s_or_b32 s74, s74, s92
    s_cbranch_scc1 Lrt111
    s_branch Lok110
Lre115:
    s_mov_b32 s83, 0
Lrt114:
    buffer_load_dwordx4 v[128:131], v61, s[16:19], s47 offen offset:2560 sc1
    s_add_u32 s81, s47, 12288
    buffer_load_dwordx4 v[132:135], v61, s[16:19], s81 offen offset:2560 sc1
    s_add_u32 s81, s47, 24576
    buffer_load_dwordx4 v[136:139], v69, s[16:19], s81 offen offset:2560 sc1
    s_add_u32 s83, s83, 1
    s_cmp_gt_u32 s83, 100000
    s_cbranch_scc1 L_end
    s_waitcnt vmcnt(0)
    v_cmp_ne_u32 s[74:75], s79, v131
    v_cmp_ne_u32 s[92:93], s79, v135
    v_cmp_ne_u32 vcc, s79, v139
    s_or_b64 s[74:75], s[74:75], s[92:93]
    s_and_b32 s92, vcc_lo, 0xffff
    s_or_b32 s74, s74, s75
    s_or_b32 s74, s74, s92
    s_cbranch_scc1 Lrt114
    s_branch Lok113
Lre118:
    s_mov_b32 s83, 0
Lrt117:
    buffer_load_dwordx4 v[112:115], v61, s[16:19], s47 offen offset:2048 sc1
    s_add_u32 s81, s47, 12288
    buffer_load_dwordx4 v[116:119], v61, s[16:19], s81 offen offset:2048 sc1
    s_add_u32 s81, s47, 24576
    buffer_load_dwordx4 v[120:123], v69, s[16:19], s81 offen offset:2048 sc1
    s_add_u32 s83, s83, 1
    s_cmp_gt_u32 s83, 100000
    s_cbranch_scc1 L_end
    s_waitcnt vmcnt(0)
    v_cmp_ne_u32 s[74:75], s79, v115
    v_cmp_ne_u32 s[92:93], s79, v119
    v_cmp_ne_u32 vcc, s79, v123
    s_or_b64 s[74:75], s[74:75], s[92:93]
    s_and_b32 s92, vcc_lo, 0xffff
    s_or_b32 s74, s74, s75
    s_or_b32 s74, s74, s92
    s_cbranch_scc1 Lrt117
    s_branch Lok116
Lre158:
    s_mov_b32 s83, 0
Lrt157:
    buffer_load_dwordx4 v[140:143], v46, s[16:19], s76 offen offset:0 sc1
    s_add_u32 s83, s83, 1
    s_cmp_gt_u32 s83, 100000
    s_cbranch_scc1 L_end
    s_waitcnt vmcnt(0)
    v_xor_b32 v143, s94, v143
    v_cmp_lt_u32_e64 vcc, 0, v143
    ds_write_b64 v116, v[140:141] offset:0
    ds_write_b32 v117, v142 offset:0
    s_cmp_lg_u64 vcc, 0
    s_cbranch_scc1 Lrt157
    s_branch Lok156
L_done:
L_end:
    s_endpgm
Lcold:
L_ffn:
    s_mov_b32 s6, 2359296
    s_mov_b32 s7, 0x20000
    s_mov_b32 s26, 1152
    s_mov_b32 s27, 0x20000
    s_mov_b32 s18, 268435456
    s_mov_b32 s19, 0x20000
    s_mov_b32 s30, 5308416
    s_mov_b32 s31, 0x20000
    s_mov_b32 s34, 5308416
    s_mov_b32 s35, 0x20000
    s_mov_b32 s38, 5308416
    s_mov_b32 s39, 0x20000
    s_mov_b32 s14, 663552
    s_mov_b32 s15, 0x20000
    s_lshl_b32 s78, s41, 8
    v_add_u32 v7, s78, v0
    v_mul_u32_u24 v9, 9846, v7
    v_lshrrev_b32_e64 v9, 22, v9
    v_mul_u32_u24 v10, 1622, v9
    v_add_lshl_u32 v23, v7, v10, 7
    v_mul_u32_u24 v9, 426, v9
    v_sub_u32_e64 v7, v7, v9
    v_cmp_gt_u32 vcc, 106, v7
    s_mul_i32 s79, s45, 786432
    s_add_u32 s79, s79, 1048576
    v_subrev_u32 v9, 106, v7
    v_min_u32 v9, 72, v9
    v_mul_u32_u24 v27, 43, v9
    v_lshrrev_b32 v27, 10, v27
    v_mad_u32_u24 v9, v27, 24, v9
    v_lshlrev_b32 v9, 1, v9
    v_sub_u32 v9, v9, v7
    v_add_u32 v9, 130, v9
    v_cndmask_b32 v9, v9, 0, vcc
    v_lshl_add_u32 v27, v9, 7, v23
    s_lshl_b32 s42, s41, 3
    s_add_u32 s42, s42, s45
    v_lshrrev_b32_e64 v9, 4, v0
    v_mul_u32_u24 v12, 9216, v9
    v_xor_b32 v10, v4, v9
    v_and_b32 v10, 1, v10
    v_lshl_add_u32 v12, v10, 7, v12
    v_and_b32 v10, 2, v9
    v_lshrrev_b32 v9, 1, v9
    v_and_or_b32 v10, v9, 4, v10
    v_xor_b32_e64 v10, v5, v10
    v_lshl_add_u32 v12, v10, 4, v12
    v_mul_u32_u24 v14, 1152, v4
    v_add_u32 v14, v14, v6
    s_lshl_b32 s76, s42, 8
    s_mul_i32 s77, s42, 147456
    s_and_b32 s81, s45, 3
    s_lshl_b32 s81, s81, 9
    s_lshr_b32 s82, s45, 2
    s_add_u32 s81, s81, s82
    v_lshl_add_u32 v24, v0, 1, s81
    v_mul_u32_u24 v24, 1152, v24
    v_lshrrev_b32_e64 v25, 4, v0
    v_lshl_add_u32 v25, v25, 1, s81
    v_mul_u32_u24 v25, 1152, v25
    v_subrev_u32 v25, 36864, v25
    v_max_i32_e64 v25, 0, v25
    v_lshlrev_b32 v26, 7, v0
    s_add_u32 s81, s45, s41
    s_add_u32 s94, s81, 5
    s_sub_u32 s82, s81, 9
    s_min_u32 s81, s81, s82
    s_lshl_b32 s81, s81, 7
    s_sub_u32 s82, s94, 9
    s_min_u32 s94, s94, s82
    s_lshl_b32 s94, s94, 7
    s_cmp_eq_u32 s41, 4
    s_cselect_b32 s94, 1073741824, s94
    s_waitcnt lgkmcnt(0)
    buffer_load_dword v47, v26, s[24:27], 0 offen
    buffer_load_dword v47, v25, s[4:7], s81 offen nt
    buffer_load_dword v47, v24, s[4:7], s81 offen nt
    buffer_load_dword v47, v25, s[4:7], s94 offen nt
    buffer_load_dword v47, v24, s[4:7], s94 offen nt
    s_cmp_ge_u32 s42, 36
    s_cbranch_scc1 L_idle
    s_load_dword s46, s[16:17], 0
    s_add_u32 m0, s51, 0
    s_waitcnt vmcnt(3)
    buffer_load_dwordx4 v12, s[28:31], s76 offen nt lds
    s_add_u32 m0, s51, 16384
    s_waitcnt vmcnt(3)
    s_nop 0
    buffer_load_dwordx4 v12, s[32:35], s76 offen nt lds
    s_add_u32 s76, s76, 147456
    s_add_u32 m0, s51, 4096
    s_waitcnt vmcnt(3)
    buffer_load_dwordx4 v12, s[28:31], s76 offen nt lds
    s_add_u32 m0, s51, 20480
    s_waitcnt vmcnt(3)
    buffer_load_dwordx4 v12, s[32:35], s76 offen nt lds
    s_add_u32 s76, s76, 147456
    s_add_u32 m0, s51, 8192
    s_waitcnt vmcnt(3)
    buffer_load_dwordx4 v12, s[28:31], s76 offen nt lds
    s_add_u32 m0, s51, 24576
    s_waitcnt vmcnt(3)
    buffer_load_dwordx4 v12, s[32:35], s76 offen nt lds
    s_add_u32 s76, s76, 147456
    s_add_u32 m0, s51, 12288
    s_waitcnt vmcnt(3)
    buffer_load_dwordx4 v12, s[28:31], s76 offen nt lds
    s_add_u32 m0, s51, 28672
    s_waitcnt vmcnt(3)
    buffer_load_dwordx4 v12, s[32:35], s76 offen nt lds
    s_add_u32 s76, s76, 147456
    s_add_u32 m0, s51, 36864
    s_waitcnt vmcnt(3)
    buffer_load_dwordx4 v12, s[28:31], s76 offen nt lds
    s_add_u32 m0, s51, 53248
    s_waitcnt vmcnt(3)
    buffer_load_dwordx4 v12, s[32:35], s76 offen nt lds
    s_add_u32 s76, s76, 147456
    s_add_u32 m0, s51, 40960
    s_waitcnt vmcnt(3)
    buffer_load_dwordx4 v12, s[28:31], s76 offen nt lds
    s_add_u32 m0, s51, 57344
    s_waitcnt vmcnt(3)
    buffer_load_dwordx4 v12, s[32:35], s76 offen nt lds
    s_add_u32 s76, s76, 147456
    s_add_u32 m0, s51, 45056
    s_waitcnt vmcnt(3)
    buffer_load_dwordx4 v12, s[28:31], s76 offen nt lds
    s_add_u32 m0, s51, 61440
    s_waitcnt vmcnt(3)
    buffer_load_dwordx4 v12, s[32:35], s76 offen nt lds
    s_add_u32 s76, s76, 147456
    s_add_u32 m0, s51, 49152
    s_waitcnt vmcnt(3)
    buffer_load_dwordx4 v12, s[28:31], s76 offen nt lds
    s_add_u32 m0, s51, 65536
    s_waitcnt vmcnt(3)
    buffer_load_dwordx4 v12, s[32:35], s76 offen nt lds
    s_add_u32 s76, s76, 147456
    s_add_u32 m0, s51, 73728
    s_nop 0
    buffer_load_dwordx4 v12, s[28:31], s76 offen nt lds
    s_add_u32 m0, s51, 90112
    s_nop 0
    buffer_load_dwordx4 v12, s[32:35], s76 offen nt lds
    s_add_u32 s76, s76, 147456
    s_add_u32 m0, s51, 77824
    s_nop 0
    buffer_load_dwordx4 v12, s[28:31], s76 offen nt lds
    s_add_u32 m0, s51, 94208
    s_nop 0
    buffer_load_dwordx4 v12, s[32:35], s76 offen nt lds
    s_add_u32 s76, s76, 147456
    s_add_u32 m0, s51, 81920
    s_nop 0
    buffer_load_dwordx4 v12, s[28:31], s76 offen nt lds
    s_add_u32 m0, s51, 98304
    s_nop 0
    buffer_load_dwordx4 v12, s[32:35], s76 offen nt lds
    s_add_u32 s76, s76, 147456
    s_add_u32 m0, s51, 86016
    s_nop 0
    buffer_load_dwordx4 v12, s[28:31], s76 offen nt lds
    s_add_u32 m0, s51, 102400
    s_nop 0
    buffer_load_dwordx4 v12, s[32:35], s76 offen nt lds
    s_add_u32 s76, s76, 147456
    v_bfe_u32 v7, v0, 2, 2
    v_lshl_add_u32 v8, v3, 3, v7
    v_lshlrev_b32 v8, 7, v8
    v_and_b32 v9, 2, v7
    v_and_b32_e64 v10, 1, v3
    v_lshl_or_b32 v9, v10, 2, v9
    v_bfe_u32 v10, v0, 1, 1
    v_lshl_or_b32 v10, s40, 1, v10
    v_xor_b32_e64 v9, v9, v10
    v_lshl_add_u32 v8, v9, 4, v8
    v_and_b32_e64 v9, 1, v0
    v_lshl_add_u32 v8, v9, 3, v8
    v_mov_b32_e64 v15, v8
    v_add_u32 v16, 73728, v8
    v_and_b32 v7, 0xff80, v8
    v_and_b32 v9, 0x80, v8
    v_add3_u32 v28, v8, v7, v9
    v_xor_b32 v29, 0x80, v28
    v_add_u32 v30, 73728, v28
    v_add_u32 v31, 73728, v29
    v_and_b32_e64 v7, 1, v0
    v_lshl_add_u32 v9, v3, 1, v7
    v_lshlrev_b32_e64 v9, 4, v9
    v_add_u32 v17, 147456, v9
    v_mul_u32_u24 v18, 0xaaaa, v7
    v_add_u32 v18, 0x4444, v18
    v_and_b32_e64 v9, 1, v3
    v_cmp_eq_u32 s[60:61], 1, v9
    v_lshl_add_u32 v9, v9, 2, s40
    v_and_b32_e64 v10, 2, v2
    v_lshl_add_u32 v9, v9, 2, v10
    v_lshrrev_b32_e64 v10, 2, v2
    v_lshl_add_u32 v9, v9, 1, v10
    v_lshl_add_u32 v9, v9, 1, v7
    s_mov_b32 s78, 148608
    v_lshl_add_u32 v19, v9, 1, s78
    v_mul_u32_u24 v9, 12, v3
    v_add_u32 v9, s40, v9
    v_lshl_add_u32 v9, v9, 2, v10
    v_lshlrev_b32 v9, 4, v9
    v_and_b32 v7, 3, v0
    v_cmp_eq_u32 vcc, 0, v7
    v_mov_b32 v10, 1073741824
    s_and_b32 vcc_hi, vcc_hi, 0xffff
    v_cndmask_b32_e64 v20, v10, v9, vcc
    v_mul_u32_u24 v21, 512, v1
    v_lshrrev_b32_e64 v9, 2, v1
    v_lshl_add_u32 v9, v9, 3, v7
    s_mov_b32 s78, 147456
    v_lshl_add_u32 v11, v9, 2, s78
    v_mov_b32 v4, v46
    v_cmp_eq_u32 s[62:63], 1, v3
    v_cmp_eq_u32 s[64:65], 2, v3
    s_waitcnt lgkmcnt(0)
    s_mul_i32 s46, s46, 1664525
    s_add_u32 s46, s46, 1013904223
    s_mov_b32 s48, s46
    s_andn2_b32 s46, s46, 15
    s_waitcnt lgkmcnt(0)
    s_barrier
    ds_read_b64_tr_b16 a[0:1], v28 offset:0
    ds_read_b64_tr_b16 a[2:3], v28 offset:1024
    ds_read_b64_tr_b16 a[8:9], v29 offset:0
    ds_read_b64_tr_b16 a[10:11], v29 offset:1024
    ds_read_b64_tr_b16 a[16:17], v28 offset:16384
    ds_read_b64_tr_b16 a[18:19], v28 offset:17408
    ds_read_b64_tr_b16 a[24:25], v29 offset:16384
    ds_read_b64_tr_b16 a[26:27], v29 offset:17408
    ds_read_b64_tr_b16 a[4:5], v28 offset:8192
    ds_read_b64_tr_b16 a[6:7], v28 offset:9216
    ds_read_b64_tr_b16 a[12:13], v29 offset:8192
    ds_read_b64_tr_b16 a[14:15], v29 offset:9216
    ds_read_b64_tr_b16 a[20:21], v28 offset:24576
    ds_read_b64_tr_b16 a[22:23], v28 offset:25600
    ds_read_b64_tr_b16 a[28:29], v29 offset:24576
    ds_read_b64_tr_b16 a[30:31], v29 offset:25600
    s_add_u32 m0, s51, 110592
    s_nop 0
    buffer_load_dwordx4 v12, s[28:31], s76 offen nt lds
    s_add_u32 m0, s51, 126976
    s_nop 0
    buffer_load_dwordx4 v12, s[32:35], s76 offen nt lds
    s_add_u32 s76, s76, 147456
    s_add_u32 m0, s51, 114688
    s_nop 0
    buffer_load_dwordx4 v12, s[28:31], s76 offen nt lds
    s_add_u32 m0, s51, 131072
    s_nop 0
    buffer_load_dwordx4 v12, s[32:35], s76 offen nt lds
    s_add_u32 s76, s76, 147456
    s_add_u32 m0, s51, 118784
    s_nop 0
    buffer_load_dwordx4 v12, s[28:31], s76 offen nt lds
    s_add_u32 m0, s51, 135168
    s_nop 0
    buffer_load_dwordx4 v12, s[32:35], s76 offen nt lds
    s_add_u32 s76, s76, 147456
    s_add_u32 m0, s51, 122880
    s_nop 0
    buffer_load_dwordx4 v12, s[28:31], s76 offen nt lds
    s_add_u32 m0, s51, 139264
    s_nop 0
    buffer_load_dwordx4 v12, s[32:35], s76 offen nt lds
    s_add_u32 s76, s76, 147456
    s_waitcnt vmcnt(16) lgkmcnt(0)
    s_barrier
    ds_read_b64_tr_b16 a[32:33], v28 offset:36864
    ds_read_b64_tr_b16 a[34:35], v28 offset:37888
    ds_read_b64_tr_b16 a[40:41], v29 offset:36864
    ds_read_b64_tr_b16 a[42:43], v29 offset:37888
    ds_read_b64_tr_b16 a[48:49], v28 offset:53248
    ds_read_b64_tr_b16 a[50:51], v28 offset:54272
    ds_read_b64_tr_b16 a[56:57], v29 offset:53248
    ds_read_b64_tr_b16 a[58:59], v29 offset:54272
    ds_read_b64_tr_b16 a[36:37], v28 offset:45056
    ds_read_b64_tr_b16 a[38:39], v28 offset:46080
    ds_read_b64_tr_b16 a[44:45], v29 offset:45056
    ds_read_b64_tr_b16 a[46:47], v29 offset:46080
    ds_read_b64_tr_b16 a[52:53], v28 offset:61440
    ds_read_b64_tr_b16 a[54:55], v28 offset:62464
    ds_read_b64_tr_b16 a[60:61], v29 offset:61440
    ds_read_b64_tr_b16 a[62:63], v29 offset:62464
    s_add_u32 m0, s51, 0
    s_nop 0
    buffer_load_dwordx4 v12, s[28:31], s76 offen nt lds
    s_add_u32 m0, s51, 16384
    s_nop 0
    s_nop 0
    buffer_load_dwordx4 v12, s[32:35], s76 offen nt lds
    s_add_u32 s76, s76, 147456
    s_add_u32 m0, s51, 4096
    s_nop 0
    buffer_load_dwordx4 v12, s[28:31], s76 offen nt lds
    s_add_u32 m0, s51, 20480
    s_nop 0
    buffer_load_dwordx4 v12, s[32:35], s76 offen nt lds
    s_add_u32 s76, s76, 147456
    s_add_u32 m0, s51, 8192
    s_nop 0
    buffer_load_dwordx4 v12, s[28:31], s76 offen nt lds
    s_add_u32 m0, s51, 24576
    s_nop 0
    buffer_load_dwordx4 v12, s[32:35], s76 offen nt lds
    s_add_u32 s76, s76, 147456
    s_add_u32 m0, s51, 12288
    s_nop 0
    buffer_load_dwordx4 v12, s[28:31], s76 offen nt lds
    s_add_u32 m0, s51, 28672
    s_nop 0
    buffer_load_dwordx4 v12, s[32:35], s76 offen nt lds
    s_add_u32 s76, s76, 147456
    s_waitcnt vmcnt(16) lgkmcnt(0)
    s_barrier
    ds_read_b64_tr_b16 a[64:65], v30 offset:0
    ds_read_b64_tr_b16 a[66:67], v30 offset:1024
    ds_read_b64_tr_b16 a[72:73], v31 offset:0
    ds_read_b64_tr_b16 a[74:75], v31 offset:1024
    ds_read_b64_tr_b16 a[80:81], v30 offset:16384
    ds_read_b64_tr_b16 a[82:83], v30 offset:17408
    ds_read_b64_tr_b16 a[88:89], v31 offset:16384
    ds_read_b64_tr_b16 a[90:91], v31 offset:17408
    ds_read_b64_tr_b16 a[68:69], v30 offset:8192
    ds_read_b64_tr_b16 a[70:71], v30 offset:9216
    ds_read_b64_tr_b16 a[76:77], v31 offset:8192
    ds_read_b64_tr_b16 a[78:79], v31 offset:9216
    ds_read_b64_tr_b16 a[84:85], v30 offset:24576
    ds_read_b64_tr_b16 a[86:87], v30 offset:25600
    ds_read_b64_tr_b16 a[92:93], v31 offset:24576
    ds_read_b64_tr_b16 a[94:95], v31 offset:25600
    s_add_u32 m0, s51, 36864
    s_nop 0
    buffer_load_dwordx4 v12, s[28:31], s76 offen nt lds
    s_add_u32 m0, s51, 53248
    s_nop 0
    buffer_load_dwordx4 v12, s[32:35], s76 offen nt lds
    s_add_u32 s76, s76, 147456
    s_add_u32 m0, s51, 40960
    s_nop 0
    buffer_load_dwordx4 v12, s[28:31], s76 offen nt lds
    s_add_u32 m0, s51, 57344
    s_nop 0
    buffer_load_dwordx4 v12, s[32:35], s76 offen nt lds
    s_add_u32 s76, s76, 147456
    s_add_u32 m0, s51, 45056
    s_nop 0
    buffer_load_dwordx4 v12, s[28:31], s76 offen nt lds
    s_add_u32 m0, s51, 61440
    s_nop 0
    buffer_load_dwordx4 v12, s[32:35], s76 offen nt lds
    s_add_u32 s76, s76, 147456
    s_add_u32 m0, s51, 49152
    s_nop 0
    buffer_load_dwordx4 v12, s[28:31], s76 offen nt lds
    s_add_u32 m0, s51, 65536
    s_nop 0
    buffer_load_dwordx4 v12, s[32:35], s76 offen nt lds
    s_add_u32 s76, s76, 147456
    s_waitcnt vmcnt(16) lgkmcnt(0)
    s_barrier
    ds_read_b64_tr_b16 a[96:97], v30 offset:36864
    ds_read_b64_tr_b16 a[98:99], v30 offset:37888
    ds_read_b64_tr_b16 a[104:105], v31 offset:36864
    ds_read_b64_tr_b16 a[106:107], v31 offset:37888
    ds_read_b64_tr_b16 a[112:113], v30 offset:53248
    ds_read_b64_tr_b16 a[114:115], v30 offset:54272
    ds_read_b64_tr_b16 a[120:121], v31 offset:53248
    ds_read_b64_tr_b16 a[122:123], v31 offset:54272
    ds_read_b64_tr_b16 a[100:101], v30 offset:45056
    ds_read_b64_tr_b16 a[102:103], v30 offset:46080
    ds_read_b64_tr_b16 a[108:109], v31 offset:45056
    ds_read_b64_tr_b16 a[110:111], v31 offset:46080
    ds_read_b64_tr_b16 a[116:117], v30 offset:61440
    ds_read_b64_tr_b16 a[118:119], v30 offset:62464
    ds_read_b64_tr_b16 a[124:125], v31 offset:61440
    ds_read_b64_tr_b16 a[126:127], v31 offset:62464
    s_add_u32 m0, s51, 73728
    s_nop 0
    buffer_load_dwordx4 v12, s[28:31], s76 offen nt lds
    s_add_u32 m0, s51, 90112
    s_nop 0
    buffer_load_dwordx4 v12, s[32:35], s76 offen nt lds
    s_add_u32 s76, s76, 147456
    s_add_u32 m0, s51, 77824
    s_nop 0
    buffer_load_dwordx4 v12, s[28:31], s76 offen nt lds
    s_add_u32 m0, s51, 94208
    s_nop 0
    buffer_load_dwordx4 v12, s[32:35], s76 offen nt lds
    s_add_u32 s76, s76, 147456
    s_add_u32 m0, s51, 81920
    s_nop 0
    buffer_load_dwordx4 v12, s[28:31], s76 offen nt lds
    s_add_u32 m0, s51, 98304
    s_nop 0
    buffer_load_dwordx4 v12, s[32:35], s76 offen nt lds
    s_add_u32 s76, s76, 147456
    s_add_u32 m0, s51, 86016
    s_nop 0
    buffer_load_dwordx4 v12, s[28:31], s76 offen nt lds
    s_add_u32 m0, s51, 102400
    s_nop 0
    buffer_load_dwordx4 v12, s[32:35], s76 offen nt lds
    s_add_u32 s76, s76, 147456
    s_waitcnt vmcnt(16) lgkmcnt(0)
    s_barrier
    ds_read_b64_tr_b16 a[128:129], v28 offset:0
    ds_read_b64_tr_b16 a[130:131], v28 offset:1024
    ds_read_b64_tr_b16 a[136:137], v29 offset:0
    ds_read_b64_tr_b16 a[138:139], v29 offset:1024
    ds_read_b64_tr_b16 a[144:145], v28 offset:16384
    ds_read_b64_tr_b16 a[146:147], v28 offset:17408
    ds_read_b64_tr_b16 a[152:153], v29 offset:16384
    ds_read_b64_tr_b16 a[154:155], v29 offset:17408
    ds_read_b64_tr_b16 a[132:133], v28 offset:8192
    ds_read_b64_tr_b16 a[134:135], v28 offset:9216
    ds_read_b64_tr_b16 a[140:141], v29 offset:8192
    ds_read_b64_tr_b16 a[142:143], v29 offset:9216
    ds_read_b64_tr_b16 a[148:149], v28 offset:24576
    ds_read_b64_tr_b16 a[150:151], v28 offset:25600
    ds_read_b64_tr_b16 a[156:157], v29 offset:24576
    ds_read_b64_tr_b16 a[158:159], v29 offset:25600
    s_add_u32 m0, s51, 110592
    s_nop 0
    buffer_load_dwordx4 v12, s[28:31], s76 offen nt lds
    s_add_u32 m0, s51, 126976
    s_nop 0
    buffer_load_dwordx4 v12, s[32:35], s76 offen nt lds
    s_add_u32 s76, s76, 147456
    s_add_u32 m0, s51, 114688
    s_nop 0
    buffer_load_dwordx4 v12, s[28:31], s76 offen nt lds
    s_add_u32 m0, s51, 131072
    s_nop 0
    buffer_load_dwordx4 v12, s[32:35], s76 offen nt lds
    s_add_u32 s76, s76, 147456
    s_add_u32 m0, s51, 118784
    s_nop 0
    buffer_load_dwordx4 v12, s[28:31], s76 offen nt lds
    s_add_u32 m0, s51, 135168
    s_nop 0
    buffer_load_dwordx4 v12, s[32:35], s76 offen nt lds
    s_add_u32 s76, s76, 147456
    s_add_u32 m0, s51, 122880
    s_nop 0
    buffer_load_dwordx4 v12, s[28:31], s76 offen nt lds
    s_add_u32 m0, s51, 139264
    s_nop 0
    buffer_load_dwordx4 v12, s[32:35], s76 offen nt lds
    s_add_u32 s76, s76, 147456
    s_waitcnt vmcnt(16) lgkmcnt(0)
    s_barrier
    ds_read_b64_tr_b16 a[160:161], v28 offset:36864
    ds_read_b64_tr_b16 a[162:163], v28 offset:37888
    ds_read_b64_tr_b16 a[168:169], v29 offset:36864
    ds_read_b64_tr_b16 a[170:171], v29 offset:37888
    ds_read_b64_tr_b16 a[176:177], v28 offset:53248
    ds_read_b64_tr_b16 a[178:179], v28 offset:54272
    ds_read_b64_tr_b16 a[184:185], v29 offset:53248
    ds_read_b64_tr_b16 a[186:187], v29 offset:54272
    ds_read_b64_tr_b16 a[164:165], v28 offset:45056
    ds_read_b64_tr_b16 a[166:167], v28 offset:46080
    ds_read_b64_tr_b16 a[172:173], v29 offset:45056
    ds_read_b64_tr_b16 a[174:175], v29 offset:46080
    ds_read_b64_tr_b16 a[180:181], v28 offset:61440
    ds_read_b64_tr_b16 a[182:183], v28 offset:62464
    ds_read_b64_tr_b16 a[188:189], v29 offset:61440
    ds_read_b64_tr_b16 a[190:191], v29 offset:62464
    s_add_u32 m0, s51, 0
    s_nop 0
    buffer_load_dwordx4 v12, s[28:31], s76 offen nt lds
    s_add_u32 m0, s51, 16384
    s_nop 0
    s_nop 0
    buffer_load_dwordx4 v12, s[32:35], s76 offen nt lds
    s_add_u32 s76, s76, 147456
    s_add_u32 m0, s51, 4096
    s_nop 0
    buffer_load_dwordx4 v12, s[28:31], s76 offen nt lds
    s_add_u32 m0, s51, 20480
    s_nop 0
    buffer_load_dwordx4 v12, s[32:35], s76 offen nt lds
    s_add_u32 s76, s76, 147456
    s_add_u32 m0, s51, 8192
    s_nop 0
    buffer_load_dwordx4 v12, s[28:31], s76 offen nt lds
    s_add_u32 m0, s51, 24576
    s_nop 0
    buffer_load_dwordx4 v12, s[32:35], s76 offen nt lds
    s_add_u32 s76, s76, 147456
    s_add_u32 m0, s51, 12288
    s_nop 0
    buffer_load_dwordx4 v12, s[28:31], s76 offen nt lds
    s_add_u32 m0, s51, 28672
    s_nop 0
    buffer_load_dwordx4 v12, s[32:35], s76 offen nt lds
    s_add_u32 s76, s76, 147456
    s_waitcnt vmcnt(16) lgkmcnt(0)
    s_barrier
    ds_read_b64_tr_b16 a[192:193], v30 offset:0
    ds_read_b64_tr_b16 a[194:195], v30 offset:1024
    ds_read_b64_tr_b16 a[200:201], v31 offset:0
    ds_read_b64_tr_b16 a[202:203], v31 offset:1024
    ds_read_b64_tr_b16 a[208:209], v30 offset:16384
    ds_read_b64_tr_b16 a[210:211], v30 offset:17408
    ds_read_b64_tr_b16 a[216:217], v31 offset:16384
    ds_read_b64_tr_b16 a[218:219], v31 offset:17408
    ds_read_b64_tr_b16 a[196:197], v30 offset:8192
    ds_read_b64_tr_b16 a[198:199], v30 offset:9216
    ds_read_b64_tr_b16 a[204:205], v31 offset:8192
    ds_read_b64_tr_b16 a[206:207], v31 offset:9216
    ds_read_b64_tr_b16 a[212:213], v30 offset:24576
    ds_read_b64_tr_b16 a[214:215], v30 offset:25600
    ds_read_b64_tr_b16 a[220:221], v31 offset:24576
    ds_read_b64_tr_b16 a[222:223], v31 offset:25600
    s_add_u32 m0, s51, 36864
    s_nop 0
    buffer_load_dwordx4 v14, s[36:39], s77 offen offset:0 nt lds
    s_add_u32 m0, s51, 40832
    s_nop 0
    buffer_load_dwordx4 v14, s[36:39], s77 offen offset:128 nt lds
    s_add_u32 m0, s51, 44800
    s_nop 0
    buffer_load_dwordx4 v14, s[36:39], s77 offen offset:256 nt lds
    s_add_u32 m0, s51, 48768
    s_nop 0
    buffer_load_dwordx4 v14, s[36:39], s77 offen offset:384 nt lds
    s_add_u32 m0, s51, 52736
    s_nop 0
    buffer_load_dwordx4 v14, s[36:39], s77 offen offset:512 nt lds
    s_add_u32 m0, s51, 56704
    s_nop 0
    buffer_load_dwordx4 v14, s[36:39], s77 offen offset:640 nt lds
    s_add_u32 m0, s51, 60672
    s_nop 0
    buffer_load_dwordx4 v14, s[36:39], s77 offen offset:768 nt lds
    s_add_u32 m0, s51, 64640
    s_nop 0
    buffer_load_dwordx4 v14, s[36:39], s77 offen offset:896 nt lds
    s_add_u32 m0, s51, 68608
    s_nop 0
    s_nop 0
    buffer_load_dwordx4 v14, s[36:39], s77 offen offset:1024 nt lds
    s_add_u32 s77, s77, 36864
    s_waitcnt vmcnt(17) lgkmcnt(0)
    s_barrier
    ds_read_b64_tr_b16 a[224:225], v30 offset:36864
    ds_read_b64_tr_b16 a[226:227], v30 offset:37888
    ds_read_b64_tr_b16 a[232:233], v31 offset:36864
    ds_read_b64_tr_b16 a[234:235], v31 offset:37888
    ds_read_b64_tr_b16 a[240:241], v30 offset:53248
    ds_read_b64_tr_b16 a[242:243], v30 offset:54272
    ds_read_b64_tr_b16 a[248:249], v31 offset:53248
    ds_read_b64_tr_b16 a[250:251], v31 offset:54272
    ds_read_b64_tr_b16 a[228:229], v30 offset:45056
    ds_read_b64_tr_b16 a[230:231], v30 offset:46080
    ds_read_b64_tr_b16 a[236:237], v31 offset:45056
    ds_read_b64_tr_b16 a[238:239], v31 offset:46080
    ds_read_b64_tr_b16 a[244:245], v30 offset:61440
    ds_read_b64_tr_b16 a[246:247], v30 offset:62464
    ds_read_b64_tr_b16 a[252:253], v31 offset:61440
    ds_read_b64_tr_b16 a[254:255], v31 offset:62464
    s_add_u32 m0, s51, 73728
    s_nop 0
    buffer_load_dwordx4 v14, s[36:39], s77 offen offset:0 nt lds
    s_add_u32 m0, s51, 77696
    s_nop 0
    buffer_load_dwordx4 v14, s[36:39], s77 offen offset:128 nt lds
    s_add_u32 m0, s51, 81664
    s_nop 0
    buffer_load_dwordx4 v14, s[36:39], s77 offen offset:256 nt lds
    s_add_u32 m0, s51, 85632
    s_nop 0
    buffer_load_dwordx4 v14, s[36:39], s77 offen offset:384 nt lds
    s_add_u32 m0, s51, 89600
    s_nop 0
    buffer_load_dwordx4 v14, s[36:39], s77 offen offset:512 nt lds
    s_add_u32 m0, s51, 93568
    s_nop 0
    buffer_load_dwordx4 v14, s[36:39], s77 offen offset:640 nt lds
    s_add_u32 m0, s51, 97536
    s_nop 0
    buffer_load_dwordx4 v14, s[36:39], s77 offen offset:768 nt lds
    s_add_u32 m0, s51, 101504
    s_nop 0
    buffer_load_dwordx4 v14, s[36:39], s77 offen offset:896 nt lds
    s_add_u32 m0, s51, 105472
    s_nop 0
    buffer_load_dwordx4 v14, s[36:39], s77 offen offset:1024 nt lds
    s_add_u32 s77, s77, 36864
    s_mov_b64 exec, 0
    s_branch Lf_in
Lf_back:
    s_mov_b64 exec, -1
    s_waitcnt vmcnt(18) lgkmcnt(0)
    s_barrier
    ds_read_b64_tr_b16 v[80:81], v28 offset:0
    ds_read_b64_tr_b16 v[82:83], v28 offset:1024
    ds_read_b64_tr_b16 v[88:89], v29 offset:0
    ds_read_b64_tr_b16 v[90:91], v29 offset:1024
    ds_read_b64_tr_b16 v[96:97], v28 offset:16384
    ds_read_b64_tr_b16 v[98:99], v28 offset:17408
    ds_read_b64_tr_b16 v[104:105], v29 offset:16384
    ds_read_b64_tr_b16 v[106:107], v29 offset:17408
    ds_read_b64_tr_b16 v[84:85], v28 offset:8192
    ds_read_b64_tr_b16 v[86:87], v28 offset:9216
    ds_read_b64_tr_b16 v[92:93], v29 offset:8192
    ds_read_b64_tr_b16 v[94:95], v29 offset:9216
    ds_read_b64_tr_b16 v[100:101], v28 offset:24576
    ds_read_b64_tr_b16 v[102:103], v28 offset:25600
    ds_read_b64_tr_b16 v[108:109], v29 offset:24576
    ds_read_b64_tr_b16 v[110:111], v29 offset:25600
    s_add_u32 m0, s51, 110592
    s_nop 0
    buffer_load_dwordx4 v14, s[36:39], s77 offen offset:0 nt lds
    s_add_u32 m0, s51, 114560
    s_nop 0
    buffer_load_dwordx4 v14, s[36:39], s77 offen offset:128 nt lds
    s_add_u32 m0, s51, 118528
    s_nop 0
    buffer_load_dwordx4 v14, s[36:39], s77 offen offset:256 nt lds
    s_add_u32 m0, s51, 122496
    s_nop 0
    buffer_load_dwordx4 v14, s[36:39], s77 offen offset:384 nt lds
    s_add_u32 m0, s51, 126464
    s_nop 0
    buffer_load_dwordx4 v14, s[36:39], s77 offen offset:512 nt lds
    s_add_u32 m0, s51, 130432
    s_nop 0
    buffer_load_dwordx4 v14, s[36:39], s77 offen offset:640 nt lds
    s_add_u32 m0, s51, 134400
    s_nop 0
    buffer_load_dwordx4 v14, s[36:39], s77 offen offset:768 nt lds
    s_add_u32 m0, s51, 138368
    s_nop 0
    buffer_load_dwordx4 v14, s[36:39], s77 offen offset:896 nt lds
    s_add_u32 m0, s51, 142336
    s_nop 0
    s_nop 0
    buffer_load_dwordx4 v14, s[36:39], s77 offen offset:1024 nt lds
    s_add_u32 s77, s77, 36864
    s_waitcnt vmcnt(18) lgkmcnt(0)
    s_barrier
    v_add_u32 v7, 32768, v15
    ds_read_b64_tr_b16 v[112:113], v15 offset:36864
    ds_read_b64_tr_b16 v[114:115], v15 offset:37376
    ds_read_b64_tr_b16 v[128:129], v15 offset:40960
    ds_read_b64_tr_b16 v[130:131], v15 offset:41472
    ds_read_b64_tr_b16 v[144:145], v15 offset:45056
    ds_read_b64_tr_b16 v[146:147], v15 offset:45568
    ds_read_b64_tr_b16 v[160:161], v15 offset:49152
    ds_read_b64_tr_b16 v[162:163], v15 offset:49664
    ds_read_b64_tr_b16 v[176:177], v15 offset:53248
    ds_read_b64_tr_b16 v[178:179], v15 offset:53760
    ds_read_b64_tr_b16 v[192:193], v15 offset:57344
    ds_read_b64_tr_b16 v[194:195], v15 offset:57856
    ds_read_b64_tr_b16 v[208:209], v15 offset:61440
    ds_read_b64_tr_b16 v[210:211], v15 offset:61952
    ds_read_b64_tr_b16 v[224:225], v7 offset:32768
    ds_read_b64_tr_b16 v[226:227], v7 offset:33280
    ds_read_b64_tr_b16 v[240:241], v7 offset:36864
    ds_read_b64_tr_b16 v[242:243], v7 offset:37376
    s_mov_b32 s59, 0
    s_nop 0
    s_mov_b32 s56, 0xffffff
    s_mov_b32 s49, 0
    s_mov_b32 s57, 0
    s_mul_i32 s79, s59, 57344
    s_add_u32 s79, s79, 40960
    s_mul_i32 s80, s59, 172032
    s_lshl_b32 s47, s59, 17
    s_add_u32 s47, s47, 786432
    s_mul_i32 s78, s42, 2304
    s_add_u32 s80, s80, s78
    s_add_u32 s80, s80, 163840
    s_mov_b32 s55, s79
    s_mov_b64 exec, 0xffffff
    buffer_load_dwordx2 v[76:77], v21, s[16:19], s47 offen sc1
    s_mov_b64 exec, -1
    s_add_u32 m0, s51, 0
    s_nop 0
    buffer_load_dwordx4 v14, s[36:39], s77 offen offset:0 nt lds
    s_add_u32 m0, s51, 3968
    s_nop 0
    buffer_load_dwordx4 v14, s[36:39], s77 offen offset:128 nt lds
    s_add_u32 m0, s51, 7936
    s_nop 0
    buffer_load_dwordx4 v14, s[36:39], s77 offen offset:256 nt lds
    s_add_u32 m0, s51, 11904
    s_nop 0
    buffer_load_dwordx4 v14, s[36:39], s77 offen offset:384 nt lds
    s_add_u32 m0, s51, 15872
    s_nop 0
    buffer_load_dwordx4 v14, s[36:39], s77 offen offset:512 nt lds
    s_add_u32 m0, s51, 19840
    s_nop 0
    buffer_load_dwordx4 v14, s[36:39], s77 offen offset:640 nt lds
    s_add_u32 m0, s51, 23808
    s_nop 0
    buffer_load_dwordx4 v14, s[36:39], s77 offen offset:768 nt lds
    s_add_u32 m0, s51, 27776
    s_nop 0
    buffer_load_dwordx4 v14, s[36:39], s77 offen offset:896 nt lds
    s_add_u32 m0, s51, 31744
    s_nop 0
    buffer_load_dwordx4 v14, s[36:39], s77 offen offset:1024 nt lds
    s_add_u32 s77, s77, 36864
    s_waitcnt vmcnt(19) lgkmcnt(0)
    s_barrier
    ds_read_b64_tr_b16 v[116:117], v16 offset:0
    ds_read_b64_tr_b16 v[118:119], v16 offset:512
    ds_read_b64_tr_b16 v[132:133], v16 offset:4096
    ds_read_b64_tr_b16 v[134:135], v16 offset:4608
    ds_read_b64_tr_b16 v[148:149], v16 offset:8192
    ds_read_b64_tr_b16 v[150:151], v16 offset:8704
    ds_read_b64_tr_b16 v[164:165], v16 offset:12288
    ds_read_b64_tr_b16 v[166:167], v16 offset:12800
    ds_read_b64_tr_b16 v[180:181], v16 offset:16384
    ds_read_b64_tr_b16 v[182:183], v16 offset:16896
    ds_read_b64_tr_b16 v[196:197], v16 offset:20480
    ds_read_b64_tr_b16 v[198:199], v16 offset:20992
    ds_read_b64_tr_b16 v[212:213], v16 offset:24576
    ds_read_b64_tr_b16 v[214:215], v16 offset:25088
    ds_read_b64_tr_b16 v[228:229], v16 offset:28672
    ds_read_b64_tr_b16 v[230:231], v16 offset:29184
    ds_read_b64_tr_b16 v[244:245], v16 offset:32768
    ds_read_b64_tr_b16 v[246:247], v16 offset:33280
    s_waitcnt vmcnt(10) lgkmcnt(0)
    s_barrier
    s_waitcnt vmcnt(9)
    v_cmp_eq_u32 vcc, s46, v77
    s_nop 0
    s_and_b32 vcc_lo, vcc_lo, 0xffffff
    s_mov_b32 s81, vcc_lo
    v_cndmask_b32 v76, 0, v76, vcc
    s_nop 1
    v_max_u32_dpp v78, v76, v76 row_ror:1 row_mask:0xf bank_mask:0xf
    s_nop 1
    v_max_u32_dpp v78, v78, v78 row_ror:2 row_mask:0xf bank_mask:0xf
    s_nop 1
    v_max_u32_dpp v78, v78, v78 row_ror:4 row_mask:0xf bank_mask:0xf
    s_nop 1
    v_max_u32_dpp v78, v78, v78 row_ror:8 row_mask:0xf bank_mask:0xf
    s_nop 0
    v_readlane_b32 s54, v78, 0
    v_readlane_b32 s78, v78, 16
    s_nop 0
    s_max_u32 s54, s54, s78
    v_cmp_eq_u32 vcc, s54, v76
    s_nop 0
    s_ff1_i32_b32 s78, vcc_lo
    s_mul_i32 s78, s78, 2304
    s_add_u32 s55, s78, s79
    s_mov_b64 exec, 0xffffff
    buffer_load_dwordx2 v[76:77], v21, s[16:19], s47 offen sc1
    s_mov_b32 exec_lo, -1
    s_mov_b32 exec_hi, 0xffff
    buffer_load_dwordx4 v[24:27], v4, s[16:19], s55 offen offset:0 sc1
    buffer_load_dwordx4 v[28:31], v4, s[16:19], s55 offen offset:768 sc1
    buffer_load_dwordx4 v[32:35], v4, s[16:19], s55 offen offset:1536 sc1
    s_mov_b64 exec, -1
    v_add_u32 v7, 32768, v16
    ds_read_b64_tr_b16 v[120:121], v16 offset:36864
    ds_read_b64_tr_b16 v[122:123], v16 offset:37376
    ds_read_b64_tr_b16 v[136:137], v16 offset:40960
    ds_read_b64_tr_b16 v[138:139], v16 offset:41472
    ds_read_b64_tr_b16 v[152:153], v16 offset:45056
    ds_read_b64_tr_b16 v[154:155], v16 offset:45568
    ds_read_b64_tr_b16 v[168:169], v16 offset:49152
    ds_read_b64_tr_b16 v[170:171], v16 offset:49664
    ds_read_b64_tr_b16 v[184:185], v16 offset:53248
    ds_read_b64_tr_b16 v[186:187], v16 offset:53760
    ds_read_b64_tr_b16 v[200:201], v16 offset:57344
    ds_read_b64_tr_b16 v[202:203], v16 offset:57856
    ds_read_b64_tr_b16 v[216:217], v16 offset:61440
    ds_read_b64_tr_b16 v[218:219], v16 offset:61952
    ds_read_b64_tr_b16 v[232:233], v7 offset:32768
    ds_read_b64_tr_b16 v[234:235], v7 offset:33280
    ds_read_b64_tr_b16 v[248:249], v7 offset:36864
    ds_read_b64_tr_b16 v[250:251], v7 offset:37376
    s_waitcnt vmcnt(4) lgkmcnt(0)
    s_barrier
    ds_read_b64_tr_b16 v[124:125], v15 offset:0
    ds_read_b64_tr_b16 v[126:127], v15 offset:512
    ds_read_b64_tr_b16 v[140:141], v15 offset:4096
    ds_read_b64_tr_b16 v[142:143], v15 offset:4608
    ds_read_b64_tr_b16 v[156:157], v15 offset:8192
    ds_read_b64_tr_b16 v[158:159], v15 offset:8704
    ds_read_b64_tr_b16 v[172:173], v15 offset:12288
    ds_read_b64_tr_b16 v[174:175], v15 offset:12800
    ds_read_b64_tr_b16 v[188:189], v15 offset:16384
    ds_read_b64_tr_b16 v[190:191], v15 offset:16896
    ds_read_b64_tr_b16 v[204:205], v15 offset:20480
    ds_read_b64_tr_b16 v[206:207], v15 offset:20992
    ds_read_b64_tr_b16 v[220:221], v15 offset:24576
    ds_read_b64_tr_b16 v[222:223], v15 offset:25088
    ds_read_b64_tr_b16 v[236:237], v15 offset:28672
    ds_read_b64_tr_b16 v[238:239], v15 offset:29184
    ds_read_b64_tr_b16 v[252:253], v15 offset:32768
    ds_read_b64_tr_b16 v[254:255], v15 offset:33280
    s_waitcnt lgkmcnt(0)
    v_mov_b32 v60, 0
    v_mov_b32 v61, 0
    v_mov_b32 v64, 0
    v_mov_b32 v65, 0
    v_mov_b32 v68, 0
    v_mov_b32 v69, 0
    v_mov_b32 v72, 0
    v_mov_b32 v73, 0
    s_cmp_eq_u32 s40, 0
    s_waitcnt vmcnt(0)
    s_cbranch_scc0 Lf_wait
    v_mov_b32 v12, v76
    v_mov_b32 v13, v77
    s_branch Lf_in
.p2align 12
Lf_round:
    s_mov_b32 s57, 0
    s_mul_i32 s79, s59, 57344
    s_add_u32 s79, s79, 40960
    s_mul_i32 s80, s59, 172032
    s_lshl_b32 s47, s59, 17
    s_add_u32 s47, s47, 786432
    s_mul_i32 s78, s42, 2304
    s_add_u32 s80, s80, s78
    s_add_u32 s80, s80, 163840
    s_mov_b32 s55, s79
Lf_next:
    s_add_u32 s49, s49, 1
    s_cmp_gt_u32 s49, 64
    s_cbranch_scc1 L_end
    v_mov_b32 v60, 0
    v_mov_b32 v61, 0
    v_mov_b32 v64, 0
    v_mov_b32 v65, 0
    v_mov_b32 v68, 0
    v_mov_b32 v69, 0
    v_mov_b32 v72, 0
    v_mov_b32 v73, 0
    s_cmp_eq_u32 s40, 0
    s_cbranch_scc0 Lf_wait
    s_waitcnt vmcnt(0)
    s_mov_b32 s54, s57
    v_not_b32 v13, s46
Lf_in:
    s_cbranch_execz Lf_wait
    v_mov_b32 v10, 1073741824
    s_mov_b32 s76, 1
    s_mov_b32 s83, 0
    s_branch Lf_g0
Lf_p0:
    s_andn2_b32 exec_lo, 0x1ffffff, s77
    s_mov_b32 exec_hi, 0
    buffer_load_dwordx2 v[12:13], v21, s[16:19], s47 offen sc1
Lf_g0:
    s_mov_b32 exec_lo, -1
    s_mov_b32 exec_hi, 0xffff
    s_add_u32 s76, s76, 1
    s_waitcnt vmcnt(0)
    v_cmp_eq_u32 vcc, s46, v13
    s_nop 0
    s_and_b32 vcc_lo, vcc_lo, 0xffffff
    s_mov_b32 s81, vcc_lo
    v_cndmask_b32_e64 v12, 0, v12, vcc
    s_nop 1
    v_max_u32_dpp v78, v12, v12 row_ror:1 row_mask:0xf bank_mask:0xf
    s_nop 1
    v_max_u32_dpp v78, v78, v78 row_ror:2 row_mask:0xf bank_mask:0xf
    s_nop 1
    v_max_u32_dpp v78, v78, v78 row_ror:4 row_mask:0xf bank_mask:0xf
    s_nop 1
    v_max_u32_dpp v78, v78, v78 row_ror:8 row_mask:0xf bank_mask:0xf
    s_nop 0
    v_readlane_b32 s82, v78, 0
    v_readlane_b32 s78, v78, 16
    s_nop 0
    s_max_u32 s82, s82, s78
    s_mov_b32 s77, s81
    s_cmp_gt_u32 s82, s54
    s_cbranch_scc1 Lf_c0
    s_cmp_eq_u32 s54, s57
    s_cbranch_scc1 Lf_s0
    s_cmp_lt_u32 s76, 1
    s_cbranch_scc1 Lf_p1
    v_xor_b32 v76, s46, v27
    v_xor_b32 v77, s46, v31
    v_xor_b32 v78, s46, v35
    v_xor_b32_e64 v79, s54, v26
    v_or3_b32 v76, v76, v77, v78
    v_or_b32 v76, v76, v79
    v_cmp_ne_u32 vcc, 0, v76
    s_andn2_b32 s81, s56, s81
    s_cbranch_vccnz Lf_r0
    ds_write2_b32 v11, v24, v25 offset0:0 offset1:4
    ds_write2_b32 v11, v28, v29 offset0:96 offset1:100
    ds_write2_b32 v11, v32, v33 offset0:192 offset1:196
    s_cbranch_scc0 Lf_acc
Lf_t:
    s_andn2_b32 exec_lo, 0xffffff, s77
    s_mov_b32 exec_hi, 0
    buffer_load_dwordx2 v[12:13], v21, s[16:19], s47 offen sc1
    s_add_u32 s83, s83, 1
    s_cmp_gt_u32 s83, 100000
    s_cbranch_scc1 L_end
    s_waitcnt vmcnt(0)
    v_cmp_eq_u32 s[74:75], s46, v13
    v_cmp_lt_u32 vcc, s54, v12
    s_or_b32 s77, s77, s74
    s_and_b32 s78, vcc_lo, s74
    s_cbranch_scc1 Lf_g0
    s_andn2_b32 s81, s56, s77
    s_cbranch_scc1 Lf_t
    s_branch Lf_acc
Lf_s0:
    s_cmp_eq_u32 s81, 0xffffff
    s_cbranch_scc0 Lf_p1
    s_mov_b32 s54, 0
    s_branch Lf_ctl
Lf_c0:
    v_cmp_eq_u32_e64 vcc, s82, v12
    s_mov_b32 s54, s82
    s_ff1_i32_b32 s78, vcc_lo
    s_mul_i32 s78, s78, 2304
    s_add_u32 s55, s78, s79
Lf_r0:
    buffer_load_dwordx4 v[24:27], v4, s[16:19], s55 offen offset:0 sc1
    buffer_load_dwordx4 v[28:31], v4, s[16:19], s55 offen offset:768 sc1
    buffer_load_dwordx4 v[32:35], v4, s[16:19], s55 offen offset:1536 sc1
    s_andn2_b32 exec_lo, 0x1ffffff, s77
    s_mov_b32 exec_hi, 0
    buffer_load_dwordx2 v[12:13], v21, s[16:19], s47 offen sc1
    s_add_u32 s83, s83, 1
    s_cmp_gt_u32 s83, 100000
    s_cbranch_scc1 L_end
    s_mov_b32 s76, 0
    s_branch Lf_g0
Lf_p1:
    s_add_u32 s83, s83, 1
    s_cmp_gt_u32 s83, 100000
    s_cbranch_scc0 Lf_p0
    s_branch L_end
Lf_acc:
    s_mov_b32 s57, s54
Lf_ctl:
    s_mov_b64 exec, -1
    v_mov_b32 v77, s54
    ds_write_b32 v17, v77 offset:1408
    s_waitcnt lgkmcnt(0)
Lf_wait:
    s_cbranch_execz Lf_back
    s_barrier
    ds_read_b32 v77, v17 offset:1408
    ds_read_b128 v[24:27], v17 offset:0
    ds_read_b128 v[28:31], v17 offset:128
    ds_read_b128 v[32:35], v17 offset:256
    ds_read_b128 v[36:39], v17 offset:384
    ds_read_b128 v[40:43], v17 offset:512
    ds_read_b128 v[44:47], v17 offset:640
    ds_read_b128 v[48:51], v17 offset:768
    ds_read_b128 v[52:55], v17 offset:896
    ds_read_b128 v[56:59], v17 offset:1024
    s_waitcnt lgkmcnt(9)
    v_readfirstlane_b32 s54, v77
    s_nop 0
    s_cmp_eq_u32 s54, 0
    s_cbranch_scc1 Lf_done
    s_waitcnt lgkmcnt(8)
    v_smfmac_f32_16x16x64_bf16 v[60:63], v[24:27], a[0:7], v18
    s_mov_b32 s58, s54
    s_not_b32 s78, s54
    s_ashr_i32 s78, s78, 31
    v_smfmac_f32_16x16x64_bf16 v[64:67], v[24:27], a[8:15], v18
    s_or_b32 s78, s78, 0x80000000
    s_xor_b32 s78, s78, s54
    v_mov_b32 v76, 0xbfb8aa3b
    v_smfmac_f32_16x16x64_bf16 v[68:71], v[24:27], a[16:23], v18
    v_mul_f32_e64 v77, s78, v76
    v_smfmac_f32_16x16x64_bf16 v[72:75], v[24:27], a[24:31], v18
    s_waitcnt lgkmcnt(7)
    v_exp_f32 v77, v77
    v_smfmac_f32_16x16x64_bf16 v[60:63], v[28:31], a[32:39], v18
    v_add_f32 v77, 1.0, v77
    v_smfmac_f32_16x16x64_bf16 v[64:67], v[28:31], a[40:47], v18
    v_mov_b32 v24, 0
    v_mov_b32 v25, 0
    v_smfmac_f32_16x16x64_bf16 v[68:71], v[28:31], a[48:55], v18
    v_smfmac_f32_16x16x64_bf16 v[72:75], v[28:31], a[56:63], v18
    s_waitcnt lgkmcnt(6)
    v_smfmac_f32_16x16x64_bf16 v[60:63], v[32:35], a[64:71], v18
    v_smfmac_f32_16x16x64_bf16 v[64:67], v[32:35], a[72:79], v18
    v_mov_b32 v28, 0
    v_mov_b32 v29, 0
    v_smfmac_f32_16x16x64_bf16 v[68:71], v[32:35], a[80:87], v18
    v_smfmac_f32_16x16x64_bf16 v[72:75], v[32:35], a[88:95], v18
    s_waitcnt lgkmcnt(5)
    v_smfmac_f32_16x16x64_bf16 v[60:63], v[36:39], a[96:103], v18
    v_smfmac_f32_16x16x64_bf16 v[64:67], v[36:39], a[104:111], v18
    v_mov_b32 v32, 0
    v_mov_b32 v33, 0
    v_smfmac_f32_16x16x64_bf16 v[68:71], v[36:39], a[112:119], v18
    v_smfmac_f32_16x16x64_bf16 v[72:75], v[36:39], a[120:127], v18
    s_waitcnt lgkmcnt(4)
    v_smfmac_f32_16x16x64_bf16 v[60:63], v[40:43], a[128:135], v18
    v_smfmac_f32_16x16x64_bf16 v[64:67], v[40:43], a[136:143], v18
    v_mov_b32 v36, 0
    v_mov_b32 v37, 0
    v_smfmac_f32_16x16x64_bf16 v[68:71], v[40:43], a[144:151], v18
    v_smfmac_f32_16x16x64_bf16 v[72:75], v[40:43], a[152:159], v18
    s_waitcnt lgkmcnt(3)
    v_smfmac_f32_16x16x64_bf16 v[60:63], v[44:47], a[160:167], v18
    v_smfmac_f32_16x16x64_bf16 v[64:67], v[44:47], a[168:175], v18
    v_mov_b32 v40, 0
    v_mov_b32 v41, 0
    v_smfmac_f32_16x16x64_bf16 v[68:71], v[44:47], a[176:183], v18
    v_smfmac_f32_16x16x64_bf16 v[72:75], v[44:47], a[184:191], v18
    s_waitcnt lgkmcnt(2)
    v_smfmac_f32_16x16x64_bf16 v[60:63], v[48:51], a[192:199], v18
    v_smfmac_f32_16x16x64_bf16 v[64:67], v[48:51], a[200:207], v18
    v_mov_b32 v44, 0
    v_mov_b32 v45, 0
    v_smfmac_f32_16x16x64_bf16 v[68:71], v[48:51], a[208:215], v18
    v_smfmac_f32_16x16x64_bf16 v[72:75], v[48:51], a[216:223], v18
    s_waitcnt lgkmcnt(1)
    v_smfmac_f32_16x16x64_bf16 v[60:63], v[52:55], a[224:231], v18
    v_smfmac_f32_16x16x64_bf16 v[64:67], v[52:55], a[232:239], v18
    v_mov_b32 v48, 0
    v_mov_b32 v49, 0
    v_smfmac_f32_16x16x64_bf16 v[68:71], v[52:55], a[240:247], v18
    v_smfmac_f32_16x16x64_bf16 v[72:75], v[52:55], a[248:255], v18
    s_waitcnt lgkmcnt(0)
    v_smfmac_f32_16x16x64_bf16 v[60:63], v[56:59], v[80:87], v18
    v_smfmac_f32_16x16x64_bf16 v[64:67], v[56:59], v[88:95], v18
    v_mov_b32 v52, 0
    v_mov_b32 v53, 0
    v_smfmac_f32_16x16x64_bf16 v[68:71], v[56:59], v[96:103], v18
    v_smfmac_f32_16x16x64_bf16 v[72:75], v[56:59], v[104:111], v18
    v_add_f32 v60, v60, v61
    v_add_f32 v64, v64, v65
    s_nop 1
    v_add_f32 v68, v68, v69
    s_nop 2
    v_add_f32 v72, v72, v73
    v_cndmask_b32 v60, v60, v64, s[60:61]
    v_mul_f32 v76, v76, v60
    v_exp_f32 v76, v76
    v_cndmask_b32 v68, v68, v72, s[60:61]
    v_fmac_f32 v77, v76, v77
    v_rcp_f32 v77, v77
    v_mul_f32 v60, v60, v68
    v_mul_f32 v60, v60, v77
    v_cvt_pk_bf16_f32 v60, v60, v60
    ds_write_b16 v19, v60
    v_mov_b32 v56, 0
    v_mov_b32 v57, 0
    v_mov_b32 v62, s54
    v_mov_b32 v63, s46
    v_mov_b32 v66, s54
    v_mov_b32 v67, s46
    v_mov_b32 v78, s54
    v_mov_b32 v79, s46
    s_waitcnt lgkmcnt(0)
    s_barrier
    ds_read_b128 v[68:71], v17 offset:1152
    ds_read_b128 v[72:75], v17 offset:1280
    s_waitcnt lgkmcnt(1)
    v_smfmac_f32_16x16x64_bf16 v[24:27], v[68:71], v[112:119], v18
    s_waitcnt lgkmcnt(0)
    v_smfmac_f32_16x16x64_bf16 v[24:27], v[72:75], v[120:127], v18
    v_smfmac_f32_16x16x64_bf16 v[36:39], v[68:71], v[160:167], v18
    v_smfmac_f32_16x16x64_bf16 v[36:39], v[72:75], v[168:175], v18
    v_add_f32 v60, v24, v25
    v_smfmac_f32_16x16x64_bf16 v[48:51], v[68:71], v[208:215], v18
    v_smfmac_f32_16x16x64_bf16 v[48:51], v[72:75], v[216:223], v18
    v_add_f32 v36, v36, v37
    v_cndmask_b32 v60, v60, v36, s[62:63]
    v_smfmac_f32_16x16x64_bf16 v[28:31], v[68:71], v[128:135], v18
    v_smfmac_f32_16x16x64_bf16 v[28:31], v[72:75], v[136:143], v18
    v_add_f32_e64 v48, v48, v49
    v_cndmask_b32 v60, v60, v48, s[64:65]
    v_smfmac_f32_16x16x64_bf16 v[40:43], v[68:71], v[176:183], v18
    s_nop 0
    v_mov_b32_dpp v61, v60 quad_perm:[1,1,3,3] row_mask:0xf bank_mask:0xf
    v_cvt_pk_bf16_f32 v60, v60, v61
    v_smfmac_f32_16x16x64_bf16 v[40:43], v[72:75], v[184:191], v18
    s_nop 0
    v_mov_b32_dpp v61, v60 quad_perm:[2,2,2,2] row_mask:0xf bank_mask:0xf
    v_smfmac_f32_16x16x64_bf16 v[52:55], v[68:71], v[224:231], v18
    buffer_store_dwordx4 v[60:63], v20, s[16:19], s80 offen offset:0 sc1
    v_add_f32 v64, v28, v29
    v_smfmac_f32_16x16x64_bf16 v[52:55], v[72:75], v[232:239], v18
    v_add_f32 v40, v40, v41
    v_cndmask_b32 v64, v64, v40, s[62:63]
    v_smfmac_f32_16x16x64_bf16 v[32:35], v[68:71], v[144:151], v18
    v_smfmac_f32_16x16x64_bf16 v[32:35], v[72:75], v[152:159], v18
    v_add_f32 v52, v52, v53
    v_cndmask_b32 v64, v64, v52, s[64:65]
    v_smfmac_f32_16x16x64_bf16 v[44:47], v[68:71], v[192:199], v18
    s_nop 0
    v_mov_b32_dpp v65, v64 quad_perm:[1,1,3,3] row_mask:0xf bank_mask:0xf
    v_cvt_pk_bf16_f32 v64, v64, v65
    v_smfmac_f32_16x16x64_bf16 v[44:47], v[72:75], v[200:207], v18
    s_nop 0
    v_mov_b32_dpp v65, v64 quad_perm:[2,2,2,2] row_mask:0xf bank_mask:0xf
    v_smfmac_f32_16x16x64_bf16 v[56:59], v[68:71], v[240:247], v18
    buffer_store_dwordx4 v[64:67], v20, s[16:19], s80 offen offset:256 sc1
    v_add_f32 v76, v32, v33
    v_smfmac_f32_16x16x64_bf16 v[56:59], v[72:75], v[248:255], v18
    v_add_f32 v44, v44, v45
    v_cndmask_b32 v76, v76, v44, s[62:63]
    s_nop 5
    v_add_f32 v56, v56, v57
    v_cndmask_b32 v76, v76, v56, s[64:65]
    s_nop 1
    v_mov_b32_dpp v77, v76 quad_perm:[1,1,3,3] row_mask:0xf bank_mask:0xf
    v_cvt_pk_bf16_f32 v76, v76, v77
    s_nop 1
    v_mov_b32_dpp v77, v76 quad_perm:[2,2,2,2] row_mask:0xf bank_mask:0xf
    buffer_store_dwordx4 v[76:79], v20, s[16:19], s80 offen offset:512 sc1
    s_branch Lf_next
Lf_done:
    s_waitcnt lgkmcnt(0)
    s_barrier
    s_cmp_eq_u32 s59, 0
    s_cbranch_scc0 Lf_exit
    s_and_b32 s78, s58, 0x7ff
    s_sub_u32 s78, 2047, s78
    s_and_b32 s81, s78, 1
    s_lshr_b32 s78, s78, 1
    s_mul_i32 s81, s81, 12
    v_subrev_u32 v76, s81, v1
    v_cmp_gt_u32 s[74:75], 12, v76
    v_mul_u32_u24 v77, 43, v76
    v_lshrrev_b32 v77, 7, v77
    v_mul_u32_u24 v76, 88, v76
    s_add_u32 s78, s78, 16
    v_lshl_add_u32 v77, v77, 3, s78
    v_sub_u32 v76, v77, v76
    v_cmp_gt_u32 vcc, 96, v76
    s_nop 0
    s_and_b64 vcc, vcc, s[74:75]
    s_andn2_b32 s56, 0xffffff, vcc_lo
    s_mov_b32 s59, 1
    s_branch Lf_round
Lf_exit:
    s_or_b32 s78, s42, s40
    s_cbranch_scc1 L_done
    v_mov_b32 v76, s48
    s_mov_b64 exec, 1
    buffer_store_dword v76, v4, s[16:19], 0 offen sc1
    s_branch L_done
L_idle:
    s_sub_u32 s78, s42, 36
    s_lshl_b32 s76, s78, 15
    v_lshlrev_b32 v7, 7, v0
    buffer_load_dword v47, v7, s[12:15], s76 offen
    s_add_u32 s76, s76, 131072
    buffer_load_dword v47, v7, s[12:15], s76 offen
    s_add_u32 s76, s76, 131072
    buffer_load_dword v47, v7, s[12:15], s76 offen
    s_add_u32 s76, s76, 131072
    buffer_load_dword v47, v7, s[12:15], s76 offen
    s_add_u32 s76, s76, 131072
    buffer_load_dword v47, v7, s[12:15], s76 offen
    s_add_u32 s76, s76, 131072
    buffer_load_dword v47, v7, s[12:15], s76 offen
    s_add_u32 s76, s76, 131072
    s_lshl_b32 s76, s78, 15
    s_nop 0
    s_add_u32 s76, s76, 32768
    buffer_load_dword v47, v7, s[16:19], s76 offen
    s_add_u32 s76, s76, 131072
    buffer_load_dword v47, v7, s[16:19], s76 offen
    s_add_u32 s76, s76, 131072
    buffer_load_dword v47, v7, s[16:19], s76 offen
    s_add_u32 s76, s76, 131072
    buffer_load_dword v47, v7, s[16:19], s76 offen
    s_add_u32 s76, s76, 131072
    s_waitcnt vmcnt(0)
    s_endpgm
L_slow:
    s_waitcnt vmcnt(0)
    v_mfma_f32_16x16x32_bf16 v[176:179], a[180:183], v[108:111], v[176:179]
    s_add_u32 m0, s51, 73728
    ds_read_b64_tr_b16 a[192:193], v141 offset:0
    s_mov_b32 s76, 373248
    v_mfma_f32_16x16x32_bf16 v[180:183], a[184:187], v[108:111], v[180:183]
    s_lshl2_add_u32 s94, s41, s40
    ds_read_b64_tr_b16 a[194:195], v141 offset:512
    s_mul_i32 s94, s94, 3456
    v_mfma_f32_16x16x32_bf16 v[184:187], v[108:111], a[188:191], v[184:187]
    s_add_u32 s94, s94, s47
    ds_read_b64_tr_b16 a[196:197], v141 offset:8192
    s_add_u32 s94, s94, 54528
    v_mfma_f32_16x16x32_bf16 v[188:191], a[180:183], v[112:115], v[188:191]
    ds_read_b64_tr_b16 a[198:199], v141 offset:8704
    v_lshlrev_b32 v32, 3, v46
    v_mfma_f32_16x16x32_bf16 v[192:195], a[184:187], v[112:115], v[192:195]
    buffer_load_dwordx4 v149, s[12:15], s76 offen lds
    ds_read_b64_tr_b16 a[200:201], v141 offset:16384
    v_mfma_f32_16x16x32_bf16 v[196:199], v[112:115], a[188:191], v[196:199]
    s_add_u32 m0, s51, 77824
    ds_read_b64_tr_b16 a[202:203], v141 offset:16896
    s_mov_b32 s76, 414720
    v_mfma_f32_16x16x32_bf16 v[200:203], a[180:183], v[116:119], v[200:203]
    ds_read_b128 v[76:79], v143 offset:0
    v_min_u32 v32, 3328, v32
    v_mfma_f32_16x16x32_bf16 v[204:207], a[184:187], v[116:119], v[204:207]
    ds_read_b128 v[80:83], v143 offset:6144
    v_mfma_f32_16x16x32_bf16 v[208:211], v[116:119], a[188:191], v[208:211]
    ds_read_b64_tr_b16 a[204:205], v141 offset:4096
    v_mfma_f32_16x16x32_bf16 v[212:215], a[180:183], v[120:123], v[212:215]
    buffer_load_dwordx4 v149, s[12:15], s76 offen lds
    ds_read_b64_tr_b16 a[206:207], v141 offset:4608
    v_mfma_f32_16x16x32_bf16 v[216:219], a[184:187], v[120:123], v[216:219]
    s_add_u32 m0, s51, 81920
    ds_read_b64_tr_b16 a[208:209], v141 offset:12288
    s_mov_b32 s76, 456192
    v_mfma_f32_16x16x32_bf16 v[220:223], v[120:123], a[188:191], v[220:223]
    s_waitcnt lgkmcnt(4)
    ds_read_b64_tr_b16 a[210:211], v141 offset:12800
    v_mfma_f32_16x16x32_bf16 v[152:155], a[192:195], v[76:79], v[152:155]
    ds_read_b64_tr_b16 a[212:213], v141 offset:20480
    v_mfma_f32_16x16x32_bf16 v[156:159], a[196:199], v[76:79], v[156:159]
    ds_read_b64_tr_b16 a[214:215], v141 offset:20992
    v_mfma_f32_16x16x32_bf16 v[160:163], v[76:79], a[200:203], v[160:163]
    s_waitcnt lgkmcnt(6)
    ds_read_b128 v[100:103], v144 offset:0
    v_mfma_f32_16x16x32_bf16 v[188:191], a[192:195], v[80:83], v[188:191]
    buffer_load_dwordx4 v149, s[12:15], s76 offen lds
    ds_read_b128 v[104:107], v144 offset:6144
    v_mfma_f32_16x16x32_bf16 v[192:195], a[196:199], v[80:83], v[192:195]
    s_add_u32 m0, s51, 86016
    ds_read_b128 v[84:87], v143 offset:8192
    s_mov_b32 s76, 497664
    v_mfma_f32_16x16x32_bf16 v[196:199], v[80:83], a[200:203], v[196:199]
    s_waitcnt lgkmcnt(2)
    ds_read_b128 v[108:111], v144 offset:8192
    v_mfma_f32_16x16x32_bf16 v[152:155], a[204:207], v[100:103], v[152:155]
    ds_read_b128 v[88:91], v143 offset:10240
    v_mfma_f32_16x16x32_bf16 v[156:159], a[208:211], v[100:103], v[156:159]
    buffer_load_dwordx4 v149, s[12:15], s76 offen lds
    ds_read_b128 v[112:115], v144 offset:10240
    v_mfma_f32_16x16x32_bf16 v[160:163], v[100:103], a[212:215], v[160:163]
    s_waitcnt lgkmcnt(4)
    ds_read2_b32 v[224:225], v49 offset0:48 offset1:144
    s_add_u32 m0, s51, 90112
    v_mfma_f32_16x16x32_bf16 v[188:191], a[204:207], v[104:107], v[188:191]
    s_mov_b32 s76, 539136
    ds_read_b128 v[226:229], v50 offset:192
    v_mov_b32_dpp v24, v152 row_newbcast:0 row_mask:0xf bank_mask:0xf
    v_mfma_f32_16x16x32_bf16 v[192:195], a[208:211], v[104:107], v[192:195]
    ds_read_b128 v[230:233], v50 offset:576
    v_mov_b32_dpp v25, v153 row_newbcast:0 row_mask:0xf bank_mask:0xf
    v_mfma_f32_16x16x32_bf16 v[196:199], v[104:107], a[212:215], v[196:199]
    s_waitcnt lgkmcnt(6)
    ds_read_b128 v[92:95], v143 offset:4096
    v_mov_b32_dpp v26, v154 row_newbcast:0 row_mask:0xf bank_mask:0xf
    v_mfma_f32_16x16x32_bf16 v[200:203], a[192:195], v[84:87], v[200:203]
    buffer_load_dwordx4 v149, s[12:15], s76 offen lds
    ds_read_b128 v[116:119], v144 offset:4096
    v_mfma_f32_16x16x32_bf16 v[204:207], a[196:199], v[84:87], v[204:207]
    s_add_u32 m0, s51, 94208
    ds_read_b128 v[96:99], v143 offset:2048
    s_mov_b32 s76, 580608
    v_mfma_f32_16x16x32_bf16 v[208:211], v[84:87], a[200:203], v[208:211]
    s_waitcnt lgkmcnt(8)
    ds_read_b128 v[120:123], v144 offset:2048
    v_mov_b32_dpp v27, v155 row_newbcast:0 row_mask:0xf bank_mask:0xf
    v_mfma_f32_16x16x32_bf16 v[200:203], a[204:207], v[108:111], v[200:203]
    buffer_load_dword v71, v32, s[16:19], s94 offen nt
    ds_read2_b32 v[234:235], v49 offset0:64 offset1:160
    v_mfma_f32_16x16x32_bf16 v[204:207], a[208:211], v[108:111], v[204:207]
    buffer_load_dword v71, v32, s[16:19], s94 offen sc1
    ds_read_b128 v[236:239], v50 offset:256
    v_mfma_f32_16x16x32_bf16 v[208:211], v[108:111], a[212:215], v[208:211]
    s_waitcnt lgkmcnt(10)
    ds_read_b128 v[240:243], v50 offset:640
    v_mov_b32_dpp v28, v156 row_newbcast:0 row_mask:0xf bank_mask:0xf
    v_mfma_f32_16x16x32_bf16 v[212:215], a[192:195], v[88:91], v[212:215]
    buffer_load_dwordx4 v149, s[12:15], s76 offen lds
    ds_read2_b32 v[124:125], v49 offset0:80 offset1:176
    v_mfma_f32_16x16x32_bf16 v[216:219], a[196:199], v[88:91], v[216:219]
    s_add_u32 m0, s51, 98304
    ds_read_b128 v[126:129], v50 offset:320
    s_mov_b32 s76, 622080
    v_mfma_f32_16x16x32_bf16 v[220:223], v[88:91], a[200:203], v[220:223]
    s_waitcnt lgkmcnt(12)
    ds_read_b128 v[130:133], v50 offset:704
    v_mov_b32_dpp v29, v157 row_newbcast:0 row_mask:0xf bank_mask:0xf
    v_mfma_f32_16x16x32_bf16 v[212:215], a[204:207], v[112:115], v[212:215]
    ds_write_b64 v253, v[254:255]
    v_mov_b32_dpp v30, v158 row_newbcast:0 row_mask:0xf bank_mask:0xf
    v_mfma_f32_16x16x32_bf16 v[216:219], a[208:211], v[112:115], v[216:219]
    buffer_load_dwordx4 v149, s[12:15], s76 offen lds
    s_add_u32 m0, s51, 102400
    v_mfma_f32_16x16x32_bf16 v[220:223], v[112:115], a[212:215], v[220:223]
    s_waitcnt lgkmcnt(10)
    s_mov_b32 s76, 0
    v_mov_b32_dpp v31, v159 row_newbcast:0 row_mask:0xf bank_mask:0xf
    v_mfma_f32_16x16x32_bf16 v[176:179], a[192:195], v[92:95], v[176:179]
    v_mov_b32 v35, v160
    v_mov_b32 v72, v160
    v_mfma_f32_16x16x32_bf16 v[180:183], a[196:199], v[92:95], v[180:183]
    v_fmac_f32 v188, v225, v24
    v_fmac_f32 v189, v225, v25
    v_mfma_f32_16x16x32_bf16 v[184:187], v[92:95], a[200:203], v[184:187]
    s_waitcnt lgkmcnt(9)
    v_permlane16_swap_b32 v35, v72
    v_mfma_f32_16x16x32_bf16 v[176:179], a[204:207], v[116:119], v[176:179]
    buffer_load_dwordx4 v150, s[12:15], s76 offen lds
    s_add_u32 m0, s51, 106496
    v_mfma_f32_16x16x32_bf16 v[180:183], a[208:211], v[116:119], v[180:183]
    s_mov_b32 s76, 331776
    v_mov_b32 v72, v35
    v_fmac_f32 v190, v225, v26
    v_mfma_f32_16x16x32_bf16 v[184:187], v[116:119], a[212:215], v[184:187]
    s_waitcnt lgkmcnt(8)
    v_fmac_f32 v191, v225, v27
    v_mfma_f32_16x16x32_bf16 v[164:167], a[192:195], v[96:99], v[164:167]
    v_permlane32_swap_b32 v35, v72
    v_mfma_f32_16x16x32_bf16 v[168:171], a[196:199], v[96:99], v[168:171]
    v_mul_f32 v188, v224, v188
    v_mul_f32 v189, v224, v189
    v_mfma_f32_16x16x32_bf16 v[172:175], v[96:99], a[200:203], v[172:175]
    s_waitcnt lgkmcnt(7)
    buffer_load_dwordx4 v150, s[12:15], s76 offen lds
    v_mfma_f32_16x16x32_bf16 v[164:167], a[204:207], v[120:123], v[164:167]
    v_mul_f32 v190, v224, v190
    v_mul_f32 v191, v224, v191
    v_mfma_f32_16x16x32_bf16 v[168:171], a[208:211], v[120:123], v[168:171]
    v_cvt_pk_bf16_f32 v80, v188, v189
    v_cvt_pk_bf16_f32 v81, v190, v191
    v_mfma_f32_16x16x32_bf16 v[172:175], v[120:123], a[212:215], v[172:175]
    ds_write_b64 v47, v[80:81] offset:8064
    v_pk_fma_f32 v[192:193], v[224:225], v[28:29], v[192:193] op_sel:[1,0,0] op_sel_hi:[1,1,1]
    v_pk_fma_f32 v[194:195], v[224:225], v[30:31], v[194:195] op_sel:[1,0,0] op_sel_hi:[1,1,1]
    v_pk_mul_f32 v[192:193], v[224:225], v[192:193] op_sel_hi:[0,1]
    v_pk_mul_f32 v[194:195], v[224:225], v[194:195] op_sel_hi:[0,1]
    v_cvt_pk_bf16_f32 v82, v192, v193
    v_cvt_pk_bf16_f32 v83, v194, v195
    ds_write_b64 v47, v[82:83] offset:24192
    v_pk_fma_f32 v[196:197], v[230:231], v[34:35], v[196:197] op_sel:[0,1,0]
    v_pk_fma_f32 v[198:199], v[232:233], v[34:35], v[198:199] op_sel:[0,1,0]
    v_pk_mul_f32 v[196:197], v[226:227], v[196:197]
    v_pk_mul_f32 v[198:199], v[228:229], v[198:199]
    v_cvt_pk_bf16_f32 v104, v196, v197
    v_cvt_pk_bf16_f32 v105, v198, v199
    ds_write_b64 v48, v[104:105] offset:24
    ds_read2_b32 v[224:225], v49 offset0:32 offset1:128
    ds_read_b128 v[226:229], v50 offset:128
    ds_read_b128 v[230:233], v50 offset:512
    v_permlane32_swap_b32 v80, v82
    v_permlane32_swap_b32 v81, v83
    v_mov_b32_dpp v105, v105 row_ror:8 row_mask:0xf bank_mask:0xf
    v_cndmask_b32 v80, v80, v82, s[28:29]
    v_cndmask_b32 v81, v81, v83, s[28:29]
    v_cndmask_b32 v82, v104, v105, s[30:31]
    v_mov_b32 v83, s46
    s_bitcmp1_b32 s58, 0
    s_cbranch_scc0 Lnx159
    buffer_store_dwordx4 v[80:83], v46, s[16:19], s59 offen offset:3072 sc1
Lnx159:
    s_waitcnt lgkmcnt(12)
    v_pk_fma_f32 v[200:201], v[234:235], v[24:25], v[200:201] op_sel:[1,0,0] op_sel_hi:[1,1,1]
    v_pk_fma_f32 v[202:203], v[234:235], v[26:27], v[202:203] op_sel:[1,0,0] op_sel_hi:[1,1,1]
    v_pk_mul_f32 v[200:201], v[234:235], v[200:201] op_sel_hi:[0,1]
    v_pk_mul_f32 v[202:203], v[234:235], v[202:203] op_sel_hi:[0,1]
    v_cvt_pk_bf16_f32 v84, v200, v201
    v_cvt_pk_bf16_f32 v85, v202, v203
    ds_write_b64 v47, v[84:85] offset:10752
    v_pk_fma_f32 v[204:205], v[234:235], v[28:29], v[204:205] op_sel:[1,0,0] op_sel_hi:[1,1,1]
    v_pk_fma_f32 v[206:207], v[234:235], v[30:31], v[206:207] op_sel:[1,0,0] op_sel_hi:[1,1,1]
    v_pk_mul_f32 v[204:205], v[234:235], v[204:205] op_sel_hi:[0,1]
    v_pk_mul_f32 v[206:207], v[234:235], v[206:207] op_sel_hi:[0,1]
    v_cvt_pk_bf16_f32 v86, v204, v205
    v_cvt_pk_bf16_f32 v87, v206, v207
    ds_write_b64 v47, v[86:87] offset:26880
    s_waitcnt lgkmcnt(12)
    s_nop 0
    v_pk_fma_f32 v[208:209], v[240:241], v[34:35], v[208:209] op_sel:[0,1,0]
    v_pk_fma_f32 v[210:211], v[242:243], v[34:35], v[210:211] op_sel:[0,1,0]
    v_pk_mul_f32 v[208:209], v[236:237], v[208:209]
    v_pk_mul_f32 v[210:211], v[238:239], v[210:211]
    v_cvt_pk_bf16_f32 v108, v208, v209
    v_cvt_pk_bf16_f32 v109, v210, v211
    ds_write_b64 v48, v[108:109] offset:32
    ds_read2_b32 v[234:235], v49 offset0:16 offset1:112
    ds_read_b128 v[236:239], v50 offset:64
    ds_read_b128 v[240:243], v50 offset:448
    v_permlane32_swap_b32 v84, v86
    v_permlane32_swap_b32 v85, v87
    v_mov_b32_dpp v109, v109 row_ror:8 row_mask:0xf bank_mask:0xf
    v_cndmask_b32 v84, v84, v86, s[28:29]
    v_cndmask_b32 v85, v85, v87, s[28:29]
    v_cndmask_b32 v86, v108, v109, s[30:31]
    v_mov_b32 v87, s46
    s_bitcmp1_b32 s58, 0
    s_cbranch_scc0 Lnx160
    buffer_store_dwordx4 v[84:87], v46, s[16:19], s32 offen offset:0 sc1
Lnx160:
    s_waitcnt lgkmcnt(15)
    v_pk_fma_f32 v[212:213], v[124:125], v[24:25], v[212:213] op_sel:[1,0,0] op_sel_hi:[1,1,1]
    v_pk_fma_f32 v[214:215], v[124:125], v[26:27], v[214:215] op_sel:[1,0,0] op_sel_hi:[1,1,1]
    v_pk_mul_f32 v[212:213], v[124:125], v[212:213] op_sel_hi:[0,1]
    v_pk_mul_f32 v[214:215], v[124:125], v[214:215] op_sel_hi:[0,1]
    v_cvt_pk_bf16_f32 v88, v212, v213
    v_cvt_pk_bf16_f32 v89, v214, v215
    ds_write_b64 v47, v[88:89] offset:13440
    v_pk_fma_f32 v[216:217], v[124:125], v[28:29], v[216:217] op_sel:[1,0,0] op_sel_hi:[1,1,1]
    v_pk_fma_f32 v[218:219], v[124:125], v[30:31], v[218:219] op_sel:[1,0,0] op_sel_hi:[1,1,1]
    v_pk_mul_f32 v[216:217], v[124:125], v[216:217] op_sel_hi:[0,1]
    v_pk_mul_f32 v[218:219], v[124:125], v[218:219] op_sel_hi:[0,1]
    v_cvt_pk_bf16_f32 v90, v216, v217
    v_cvt_pk_bf16_f32 v91, v218, v219
    ds_write_b64 v47, v[90:91] offset:29568
    s_waitcnt lgkmcnt(15)
    s_nop 0
    v_pk_fma_f32 v[220:221], v[130:131], v[34:35], v[220:221] op_sel:[0,1,0]
    v_pk_fma_f32 v[222:223], v[132:133], v[34:35], v[222:223] op_sel:[0,1,0]
    v_pk_mul_f32 v[220:221], v[126:127], v[220:221]
    v_pk_mul_f32 v[222:223], v[128:129], v[222:223]
    v_cvt_pk_bf16_f32 v112, v220, v221
    v_cvt_pk_bf16_f32 v113, v222, v223
    ds_write_b64 v48, v[112:113] offset:40
    ds_read2_b32 v[124:125], v49 offset0:0 offset1:96
    ds_read_b128 v[126:129], v50 offset:0
    ds_read_b128 v[130:133], v50 offset:384
    v_permlane32_swap_b32 v88, v90
    v_permlane32_swap_b32 v89, v91
    v_mov_b32_dpp v113, v113 row_ror:8 row_mask:0xf bank_mask:0xf
    v_cndmask_b32 v88, v88, v90, s[28:29]
    v_cndmask_b32 v89, v89, v91, s[28:29]
    v_cndmask_b32 v90, v112, v113, s[30:31]
    v_mov_b32 v91, s46
    s_bitcmp1_b32 s58, 0
    s_cbranch_scc0 Lnx161
    buffer_store_dwordx4 v[88:91], v46, s[16:19], s32 offen offset:1024 sc1
Lnx161:
    s_waitcnt lgkmcnt(14)
    v_pk_fma_f32 v[176:177], v[224:225], v[24:25], v[176:177] op_sel:[1,0,0] op_sel_hi:[1,1,1]
    v_pk_fma_f32 v[178:179], v[224:225], v[26:27], v[178:179] op_sel:[1,0,0] op_sel_hi:[1,1,1]
    v_pk_mul_f32 v[176:177], v[224:225], v[176:177] op_sel_hi:[0,1]
    v_pk_mul_f32 v[178:179], v[224:225], v[178:179] op_sel_hi:[0,1]
    v_cvt_pk_bf16_f32 v92, v176, v177
    v_cvt_pk_bf16_f32 v93, v178, v179
    ds_write_b64 v47, v[92:93] offset:5376
    v_pk_fma_f32 v[180:181], v[224:225], v[28:29], v[180:181] op_sel:[1,0,0] op_sel_hi:[1,1,1]
    v_pk_fma_f32 v[182:183], v[224:225], v[30:31], v[182:183] op_sel:[1,0,0] op_sel_hi:[1,1,1]
    v_pk_mul_f32 v[180:181], v[224:225], v[180:181] op_sel_hi:[0,1]
    v_pk_mul_f32 v[182:183], v[224:225], v[182:183] op_sel_hi:[0,1]
    v_cvt_pk_bf16_f32 v94, v180, v181
    v_cvt_pk_bf16_f32 v95, v182, v183
    ds_write_b64 v47, v[94:95] offset:21504
    s_waitcnt lgkmcnt(14)
    s_nop 0
    v_pk_fma_f32 v[184:185], v[230:231], v[34:35], v[184:185] op_sel:[0,1,0]
    v_pk_fma_f32 v[186:187], v[232:233], v[34:35], v[186:187] op_sel:[0,1,0]
    v_pk_mul_f32 v[184:185], v[226:227], v[184:185]
    v_pk_mul_f32 v[186:187], v[228:229], v[186:187]
    v_cvt_pk_bf16_f32 v116, v184, v185
    v_cvt_pk_bf16_f32 v117, v186, v187
    ds_write_b64 v48, v[116:117] offset:16
    v_permlane32_swap_b32 v92, v94
    v_permlane32_swap_b32 v93, v95
    v_mov_b32_dpp v117, v117 row_ror:8 row_mask:0xf bank_mask:0xf
    v_cndmask_b32 v92, v92, v94, s[28:29]
    v_cndmask_b32 v93, v93, v95, s[28:29]
    v_cndmask_b32 v94, v116, v117, s[30:31]
    v_mov_b32 v95, s46
    s_bitcmp1_b32 s58, 0
    s_cbranch_scc0 Lnx162
    buffer_store_dwordx4 v[92:95], v46, s[16:19], s59 offen offset:2048 sc1
Lnx162:
    s_waitcnt lgkmcnt(11)
    v_pk_fma_f32 v[164:165], v[234:235], v[24:25], v[164:165] op_sel:[1,0,0] op_sel_hi:[1,1,1]
    v_pk_fma_f32 v[166:167], v[234:235], v[26:27], v[166:167] op_sel:[1,0,0] op_sel_hi:[1,1,1]
    v_pk_mul_f32 v[164:165], v[234:235], v[164:165] op_sel_hi:[0,1]
    v_pk_mul_f32 v[166:167], v[234:235], v[166:167] op_sel_hi:[0,1]
    v_cvt_pk_bf16_f32 v96, v164, v165
    v_cvt_pk_bf16_f32 v97, v166, v167
    ds_write_b64 v47, v[96:97] offset:2688
    v_pk_fma_f32 v[168:169], v[234:235], v[28:29], v[168:169] op_sel:[1,0,0] op_sel_hi:[1,1,1]
    v_pk_fma_f32 v[170:171], v[234:235], v[30:31], v[170:171] op_sel:[1,0,0] op_sel_hi:[1,1,1]
    v_pk_mul_f32 v[168:169], v[234:235], v[168:169] op_sel_hi:[0,1]
    v_pk_mul_f32 v[170:171], v[234:235], v[170:171] op_sel_hi:[0,1]
    v_cvt_pk_bf16_f32 v98, v168, v169
    v_cvt_pk_bf16_f32 v99, v170, v171
    ds_write_b64 v47, v[98:99] offset:18816
    s_waitcnt lgkmcnt(11)
    s_nop 0
    v_pk_fma_f32 v[172:173], v[240:241], v[34:35], v[172:173] op_sel:[0,1,0]
    v_pk_fma_f32 v[174:175], v[242:243], v[34:35], v[174:175] op_sel:[0,1,0]
    v_pk_mul_f32 v[172:173], v[236:237], v[172:173]
    v_pk_mul_f32 v[174:175], v[238:239], v[174:175]
    v_cvt_pk_bf16_f32 v120, v172, v173
    v_cvt_pk_bf16_f32 v121, v174, v175
    ds_write_b64 v48, v[120:121] offset:8
    v_permlane32_swap_b32 v96, v98
    v_permlane32_swap_b32 v97, v99
    v_mov_b32_dpp v121, v121 row_ror:8 row_mask:0xf bank_mask:0xf
    v_cndmask_b32 v96, v96, v98, s[28:29]
    v_cndmask_b32 v97, v97, v99, s[28:29]
    v_cndmask_b32 v98, v120, v121, s[30:31]
    v_mov_b32 v99, s46
    s_bitcmp1_b32 s58, 0
    s_cbranch_scc0 Lnx163
    buffer_store_dwordx4 v[96:99], v46, s[16:19], s59 offen offset:1024 sc1
Lnx163:
    s_bitcmp1_b32 s58, 1
    s_cbranch_scc0 Lni164
    buffer_load_dwordx4 v[224:227], v46, s[16:19], s59 offen offset:3072 sc1
    buffer_load_dwordx4 v[228:231], v46, s[16:19], s32 offen offset:0 sc1
    buffer_load_dwordx4 v[232:235], v46, s[16:19], s32 offen offset:1024 sc1
Lni164:
    s_waitcnt lgkmcnt(8)
    v_pk_fma_f32 v[152:153], v[124:125], v[24:25], v[152:153] op_sel:[1,0,0] op_sel_hi:[1,1,1]
    v_pk_fma_f32 v[154:155], v[124:125], v[26:27], v[154:155] op_sel:[1,0,0] op_sel_hi:[1,1,1]
    v_pk_mul_f32 v[152:153], v[124:125], v[152:153] op_sel_hi:[0,1]
    v_pk_mul_f32 v[154:155], v[124:125], v[154:155] op_sel_hi:[0,1]
    v_cvt_pk_bf16_f32 v76, v152, v153
    v_cvt_pk_bf16_f32 v77, v154, v155
    ds_write_b64 v47, v[76:77] offset:0
    v_pk_fma_f32 v[156:157], v[124:125], v[28:29], v[156:157] op_sel:[1,0,0] op_sel_hi:[1,1,1]
    v_pk_fma_f32 v[158:159], v[124:125], v[30:31], v[158:159] op_sel:[1,0,0] op_sel_hi:[1,1,1]
    v_pk_mul_f32 v[156:157], v[124:125], v[156:157] op_sel_hi:[0,1]
    v_pk_mul_f32 v[158:159], v[124:125], v[158:159] op_sel_hi:[0,1]
    v_cvt_pk_bf16_f32 v78, v156, v157
    v_cvt_pk_bf16_f32 v79, v158, v159
    ds_write_b64 v47, v[78:79] offset:16128
    s_waitcnt lgkmcnt(8)
    s_nop 0
    v_pk_fma_f32 v[160:161], v[130:131], v[34:35], v[160:161] op_sel:[0,1,0]
    v_pk_fma_f32 v[162:163], v[132:133], v[34:35], v[162:163] op_sel:[0,1,0]
    v_pk_mul_f32 v[160:161], v[126:127], v[160:161]
    v_pk_mul_f32 v[162:163], v[128:129], v[162:163]
    v_cvt_pk_bf16_f32 v100, v160, v161
    v_cvt_pk_bf16_f32 v101, v162, v163
    ds_write_b64 v48, v[100:101] offset:0
    v_permlane32_swap_b32 v76, v78
    v_permlane32_swap_b32 v77, v79
    v_mov_b32_dpp v101, v101 row_ror:8 row_mask:0xf bank_mask:0xf
    v_cndmask_b32 v76, v76, v78, s[28:29]
    v_cndmask_b32 v77, v77, v79, s[28:29]
    v_cndmask_b32 v78, v100, v101, s[30:31]
    v_mov_b32_e64 v79, s46
    s_bitcmp1_b32 s58, 0
    s_cbranch_scc0 Lnx165
    buffer_store_dwordx4 v[76:79], v46, s[16:19], s59 offen offset:0 sc1
Lnx165:
    s_waitcnt lgkmcnt(0)
    s_barrier
    s_bitcmp1_b32 s58, 1
    s_cbranch_scc0 Lnp166
    s_waitcnt vmcnt(2)
    v_xor_b32 v227, s46, v227
    s_waitcnt vmcnt(1)
    v_xor_b32 v231, s46, v231
    s_waitcnt vmcnt(0)
    v_xor_b32 v235, s46, v235
    v_or3_b32 v227, v227, v231, v235
    v_cmp_lt_u32_e64 vcc, 0, v227
    ds_write_b64 v63, v[224:225] offset:8064
    ds_write_b32 v64, v226 offset:24
    ds_write_b64 v63, v[228:229] offset:10752
    ds_write_b32 v64, v230 offset:32
    ds_write_b64 v63, v[232:233] offset:13440
    ds_write_b32 v64, v234 offset:40
    s_cmp_lg_u64 vcc, 0
    s_cbranch_scc1 Lre169
Lok167:
Lnp166:
    ds_read_b64 v[92:93], v51 offset:29568
    ds_read_b32 v94, v52 offset:29568
    ds_read_b64 v[100:101], v51 offset:13440
    ds_read_b32 v102, v52 offset:13440
    ds_read_b64 v[88:89], v51 offset:26880
    ds_read_b32 v90, v52 offset:26880
    ds_read_b64 v[96:97], v51 offset:10752
    ds_read_b32 v98, v52 offset:10752
    ds_read_b64 v[84:85], v51 offset:24192
    ds_read_b32 v86, v52 offset:24192
    v_mov_b32 v87, 0
    v_mov_b32 v91, 0
    v_mov_b32 v95, 0
    v_mov_b32 v99, 0
    v_mov_b32 v103, 0
    s_waitcnt lgkmcnt(6)
    s_nop 0
    v_mfma_f32_16x16x32_bf16 v[108:111], v[92:95], v[100:103], v[40:43]
    s_waitcnt lgkmcnt(4)
    ds_read_b64 v[78:79], v54 offset:24
    v_mfma_f32_16x16x32_bf16 v[116:119], v[88:91], v[100:103], v[40:43]
    s_waitcnt lgkmcnt(3)
    ds_read_b128 v[80:83], v54 offset:32
    v_mfma_f32_16x16x32_bf16 v[104:107], v[88:91], v[96:99], v[40:43]
    s_waitcnt lgkmcnt(2)
    ds_read_b64 v[72:73], v53 offset:24
    v_mfma_f32_16x16x32_bf16 v[112:115], v[84:87], v[96:99], v[40:43]
    ds_read_b128 v[74:77], v53 offset:32
    s_bitcmp1_b32 s58, 1
    s_cbranch_scc0 Lni170
    buffer_load_dwordx4 v[184:187], v46, s[16:19], s59 offen offset:2048 sc1
    buffer_load_dwordx4 v[188:191], v46, s[16:19], s59 offen offset:1024 sc1
    buffer_load_dwordx4 v[192:195], v46, s[16:19], s59 offen offset:0 sc1
Lni170:
    v_cndmask_b32 v108, v116, v108, s[66:67]
    v_cndmask_b32 v109, v117, v109, s[68:69]
    v_cndmask_b32 v110, v118, v110, s[70:71]
    v_cndmask_b32 v111, v119, v111, s[72:73]
    s_nop 0
    s_nop 0
    v_cndmask_b32 v104, v112, v104, s[66:67]
    v_cndmask_b32 v105, v113, v105, s[68:69]
    v_cndmask_b32 v106, v114, v106, s[70:71]
    v_cndmask_b32 v107, v115, v107, s[72:73]
    v_max3_f32 v145, v108, v109, v110
    v_max3_f32 v144, v104, v105, v106
    v_max_f32 v145, v145, v111
    v_max_f32 v144, v144, v107
    s_nop 1
    v_permlane32_swap_b32 v144, v145
    v_max_f32 v144, v144, v145
    v_mov_b32 v145, v144
    s_nop 1
    v_permlane16_swap_b32 v144, v145
    v_max_f32 v144, v144, v145
    v_mul_f32 v145, s85, v144
    v_mul_f32 v144, s85, v144
    s_nop 1
    v_permlane32_swap_b32_e64 v144, v145
    v_pk_fma_f32 v[104:105], v[104:105], s[84:85], v[144:145] op_sel:[0,1,0] op_sel_hi:[1,1,0] neg_lo:[0,0,1] neg_hi:[0,0,1]
    v_pk_fma_f32 v[106:107], v[106:107], s[84:85], v[144:145] op_sel:[0,1,0] op_sel_hi:[1,1,0] neg_lo:[0,0,1] neg_hi:[0,0,1]
    v_pk_fma_f32 v[108:109], v[108:109], s[84:85], v[144:145] op_sel:[0,1,1] op_sel_hi:[1,1,1] neg_lo:[0,0,1] neg_hi:[0,0,1]
    v_pk_fma_f32 v[110:111], v[110:111], s[84:85], v[144:145] op_sel:[0,1,1] op_sel_hi:[1,1,1] neg_lo:[0,0,1] neg_hi:[0,0,1]
    s_bitcmp1_b32 s58, 1
    s_cbranch_scc0 Lnp171
    s_waitcnt vmcnt(2)
    v_xor_b32 v187, s46, v187
    s_waitcnt vmcnt(1)
    v_xor_b32 v191, s46, v191
    s_waitcnt vmcnt(0)
    v_xor_b32 v195, s46, v195
    v_or3_b32 v187, v187, v191, v195
    v_cmp_lt_u32_e64 vcc, 0, v187
    ds_write_b64 v63, v[184:185] offset:5376
    ds_write_b32 v64, v186 offset:16
    ds_write_b64 v63, v[188:189] offset:2688
    ds_write_b32 v64, v190 offset:8
    ds_write_b64 v63, v[192:193] offset:0
    ds_write_b32 v64, v194 offset:0
    s_cmp_lg_u64 vcc, 0
    s_cbranch_scc1 Lre174
Lok172:
Lnp171:
    ds_read_b64 v[100:101], v51 offset:8064
    ds_read_b32 v102, v52 offset:8064
    ds_read_b64 v[92:93], v51 offset:21504
    ds_read_b32 v94, v52 offset:21504
    ds_read_b64 v[96:97], v51 offset:5376
    ds_read_b32 v98, v52 offset:5376
    ds_read_b64 v[88:89], v51 offset:18816
    ds_read_b32 v90, v52 offset:18816
    v_exp_f32 v104, v104
    v_exp_f32 v105, v105
    v_exp_f32 v106, v106
    v_exp_f32 v107, v107
    v_exp_f32 v108, v108
    v_exp_f32 v109, v109
    v_exp_f32 v110, v110
    v_exp_f32 v111, v111
    s_waitcnt lgkmcnt(6)
    v_mfma_f32_16x16x32_bf16 v[124:127], v[84:87], v[100:103], v[40:43]
    s_waitcnt lgkmcnt(4)
    v_cvt_pk_bf16_f32 v138, v104, v105
    v_cvt_pk_bf16_f32 v139, v106, v107
    v_mfma_f32_16x16x32_bf16 v[132:135], v[92:95], v[100:103], v[40:43]
    s_waitcnt lgkmcnt(2)
    v_bfi_b32 v136, v44, 0, v138
    v_bfi_b32 v137, v45, 0, v139
    v_mfma_f32_16x16x32_bf16 v[120:123], v[92:95], v[96:99], v[40:43]
    s_waitcnt lgkmcnt(0)
    v_and_b32 v138, v44, v138
    v_and_b32 v139, v45, v139
    v_mfma_f32_16x16x32_bf16 v[128:131], v[88:91], v[96:99], v[40:43]
    s_add_u32 s76, s47, 66560
    v_cvt_pk_bf16_f32 v142, v108, v109
    v_cvt_pk_bf16_f32 v143, v110, v111
    v_mfma_f32_16x16x32_bf16 v[112:115], v[78:81], v[136:139], 0
    s_add_u32 s77, s47, 72704
    v_bfi_b32 v140, v44, 0, v142
    v_bfi_b32 v141, v45, 0, v143
    v_mfma_f32_16x16x32_bf16 v[104:107], v[72:75], v[136:139], 0
    v_and_b32_e64 v142, v44, v142
    v_and_b32 v143, v45, v143
    s_nop 1
    v_mfma_f32_16x16x32_bf16 v[116:119], v[80:83], v[140:143], 0
    v_cndmask_b32 v124, v132, v124, s[66:67]
    v_cndmask_b32 v125, v133, v125, s[68:69]
    v_mfma_f32_16x16x32_bf16 v[108:111], v[74:77], v[140:143], 0
    v_cndmask_b32 v126, v134, v126, s[70:71]
    v_cndmask_b32 v127, v135, v127, s[72:73]
    v_cndmask_b32 v120, v128, v120, s[66:67]
    v_cndmask_b32 v121, v129, v121, s[68:69]
    v_cndmask_b32 v122, v130, v122, s[70:71]
    v_cndmask_b32 v123, v131, v123, s[72:73]
    v_rcp_f32 v114, v114
    v_rcp_f32 v118, v118
    v_pk_mul_f32 v[104:105], v[104:105], v[114:115] op_sel_hi:[1,0]
    v_pk_mul_f32 v[106:107], v[106:107], v[114:115] op_sel_hi:[1,0]
    v_pk_mul_f32 v[112:113], v[112:113], v[114:115] op_sel_hi:[1,0]
    v_cvt_pk_bf16_f32 v104, v104, v105
    v_cvt_pk_bf16_f32 v105, v106, v107
    v_cvt_pk_bf16_f32 v112, v112, v113
    v_pk_mul_f32 v[108:109], v[108:109], v[118:119] op_sel_hi:[1,0]
    v_pk_mul_f32 v[110:111], v[110:111], v[118:119] op_sel_hi:[1,0]
    v_pk_mul_f32 v[116:117], v[116:117], v[118:119] op_sel_hi:[1,0]
    v_cvt_pk_bf16_f32 v108, v108, v109
    v_cvt_pk_bf16_f32 v109, v110, v111
    v_cvt_pk_bf16_f32 v116, v116, v117
    buffer_store_dwordx2 v[104:105], v55, s[16:19], s76 offen sc1
    buffer_store_dwordx2 v[108:109], v55, s[16:19], s77 offen sc1
    v_mov_b32_dpp v112, v116 quad_perm:[0,1,2,3] row_mask:0x2 bank_mask:0xf
    buffer_store_dword v112, v56, s[16:19], s76 offen sc1
    v_max3_f32 v145, v124, v125, v126
    v_max3_f32 v144, v120, v121, v122
    v_max_f32 v145, v145, v127
    v_max_f32 v144, v144, v123
    ds_read_b64 v[78:79], v54 offset:8
    ds_read_b128 v[80:83], v54 offset:16
    v_permlane32_swap_b32 v144, v145
    v_max_f32 v144, v144, v145
    v_mov_b32_e64 v145, v144
    ds_read_b64 v[72:73], v53 offset:8
    ds_read_b128 v[74:77], v53 offset:16
    v_permlane16_swap_b32 v144, v145
    v_max_f32 v144, v144, v145
    v_mul_f32 v145, s85, v144
    v_mul_f32 v144, s85, v144
    s_cmp_eq_u32 s43, 0
    s_cselect_b32 s81, s84, 0
    v_permlane32_swap_b32 v144, v145
    v_min_f32 v116, s81, v40
    v_min_f32 v117, s81, v41
    v_min_f32 v118, s81, v42
    v_min_f32 v119, s81, v43
    v_mov_b32 v112, s84
    v_mov_b32 v113, s84
    v_mov_b32 v114, s84
    v_mov_b32_e64 v115, s84
    v_pk_fma_f32 v[120:121], v[120:121], s[84:85], v[144:145] op_sel:[0,1,0] op_sel_hi:[1,1,0] neg_lo:[0,0,1] neg_hi:[0,0,1]
    v_pk_fma_f32 v[122:123], v[122:123], s[84:85], v[144:145] op_sel:[0,1,0] op_sel_hi:[1,1,0] neg_lo:[0,0,1] neg_hi:[0,0,1]
    v_pk_fma_f32 v[124:125], v[124:125], s[84:85], v[144:145] op_sel:[0,1,1] op_sel_hi:[1,1,1] neg_lo:[0,0,1] neg_hi:[0,0,1]
    v_pk_fma_f32 v[126:127], v[126:127], s[84:85], v[144:145] op_sel:[0,1,1] op_sel_hi:[1,1,1] neg_lo:[0,0,1] neg_hi:[0,0,1]
    ds_read_b64 v[100:101], v51 offset:2688
    ds_read_b32 v102, v52 offset:2688
    ds_read_b64 v[84:85], v51 offset:16128
    ds_read_b32 v86, v52 offset:16128
    ds_read_b64 v[96:97], v51 offset:0
    ds_read_b32 v98, v52 offset:0
    v_exp_f32 v120, v120
    v_exp_f32 v121, v121
    v_exp_f32 v122, v122
    v_exp_f32 v123, v123
    v_exp_f32 v124, v124
    v_exp_f32 v125, v125
    v_exp_f32_e64 v126, v126
    v_exp_f32 v127, v127
    s_waitcnt vmcnt(0)
    buffer_store_dword v68, v57, s[16:19], s47 offen offset:0 sc1
    s_waitcnt lgkmcnt(4)
    v_mfma_f32_16x16x32_bf16 v[108:111], v[88:91], v[100:103], v[40:43]
    s_waitcnt lgkmcnt(2)
    v_cvt_pk_bf16_f32 v138, v120, v121
    v_cvt_pk_bf16_f32 v139, v122, v123
    v_mfma_f32_16x16x32_bf16 v[116:119], v[84:87], v[100:103], v[116:119]
    s_waitcnt lgkmcnt(0)
    v_bfi_b32 v136, v44, 0, v138
    v_bfi_b32 v137, v45, 0, v139
    v_mfma_f32_16x16x32_bf16 v[104:107], v[84:87], v[96:99], v[40:43]
    s_add_u32 s76, s47, 103424
    s_add_u32 s77, s47, 109568
    v_and_b32 v138, v44, v138
    v_and_b32 v139, v45, v139
    s_nop 1
    v_mfma_f32_16x16x32_bf16 v[128:131], v[78:81], v[136:139], 0
    v_cvt_pk_bf16_f32 v142, v124, v125
    v_cvt_pk_bf16_f32 v143, v126, v127
    v_mfma_f32_16x16x32_bf16 v[120:123], v[72:75], v[136:139], 0
    v_bfi_b32 v140, v44, 0, v142
    v_bfi_b32 v141, v45, 0, v143
    v_and_b32_e64 v142, v44, v142
    v_and_b32 v143, v45, v143
    s_nop 1
    v_mfma_f32_16x16x32_bf16 v[132:135], v[80:83], v[140:143], 0
    v_cndmask_b32 v108, v116, v108, s[66:67]
    v_cndmask_b32 v109, v117, v109, s[68:69]
    v_mfma_f32_16x16x32_bf16 v[124:127], v[74:77], v[140:143], 0
    v_cndmask_b32 v110, v118, v110, s[70:71]
    v_cndmask_b32 v111, v119, v111, s[72:73]
    v_cndmask_b32 v104, v112, v104, s[66:67]
    v_cndmask_b32 v105, v113, v105, s[68:69]
    v_cndmask_b32 v106, v114, v106, s[70:71]
    v_cndmask_b32 v107, v115, v107, s[72:73]
    v_rcp_f32 v130, v130
    v_rcp_f32 v134, v134
    v_pk_mul_f32 v[120:121], v[120:121], v[130:131] op_sel_hi:[1,0]
    v_pk_mul_f32 v[122:123], v[122:123], v[130:131] op_sel_hi:[1,0]
    v_pk_mul_f32 v[128:129], v[128:129], v[130:131] op_sel_hi:[1,0]
    v_cvt_pk_bf16_f32 v120, v120, v121
    v_cvt_pk_bf16_f32 v121, v122, v123
    v_cvt_pk_bf16_f32 v128, v128, v129
    v_pk_mul_f32 v[124:125], v[124:125], v[134:135] op_sel_hi:[1,0]
    v_pk_mul_f32 v[126:127], v[126:127], v[134:135] op_sel_hi:[1,0]
    v_pk_mul_f32 v[132:133], v[132:133], v[134:135] op_sel_hi:[1,0]
    v_cvt_pk_bf16_f32 v124, v124, v125
    v_cvt_pk_bf16_f32 v125, v126, v127
    v_cvt_pk_bf16_f32 v132, v132, v133
    buffer_store_dwordx2 v[120:121], v55, s[16:19], s76 offen sc1
    buffer_store_dwordx2 v[124:125], v55, s[16:19], s77 offen sc1
    v_mov_b32_dpp v128, v132 quad_perm:[0,1,2,3] row_mask:0x2 bank_mask:0xf
    buffer_store_dword v128, v56, s[16:19], s76 offen sc1
    buffer_load_dword v146, v58, s[16:19], s47 offen offset:0 sc1
    v_max3_f32 v145, v108, v109, v110
    v_max3_f32 v144, v104, v105, v106
    v_max_f32 v145, v145, v111
    v_max_f32 v144, v144, v107
    ds_read_b128 v[80:83], v54 offset:0
    ds_read_b128 v[74:77], v53 offset:0
    v_permlane32_swap_b32 v144, v145
    v_max_f32 v144, v144, v145
    v_mov_b32 v145, v144
    v_mov_b32 v78, 0
    v_mov_b32 v79, 0
    v_permlane16_swap_b32 v144, v145
    v_max_f32 v144, v144, v145
    v_mul_f32 v145, s85, v144
    v_mul_f32 v144, s85, v144
    v_mov_b32 v72, 0
    v_mov_b32 v73, 0
    v_permlane32_swap_b32 v144, v145
    v_pk_fma_f32 v[104:105], v[104:105], s[84:85], v[144:145] op_sel:[0,1,0] op_sel_hi:[1,1,0] neg_lo:[0,0,1] neg_hi:[0,0,1]
    v_pk_fma_f32 v[106:107], v[106:107], s[84:85], v[144:145] op_sel:[0,1,0] op_sel_hi:[1,1,0] neg_lo:[0,0,1] neg_hi:[0,0,1]
    v_pk_fma_f32 v[108:109], v[108:109], s[84:85], v[144:145] op_sel:[0,1,1] op_sel_hi:[1,1,1] neg_lo:[0,0,1] neg_hi:[0,0,1]
    v_pk_fma_f32 v[110:111], v[110:111], s[84:85], v[144:145] op_sel:[0,1,1] op_sel_hi:[1,1,1] neg_lo:[0,0,1] neg_hi:[0,0,1]
    v_exp_f32 v104, v104
    v_exp_f32 v105, v105
    v_exp_f32 v106, v106
    v_exp_f32 v107, v107
    v_exp_f32 v108, v108
    v_exp_f32 v109, v109
    v_exp_f32 v110, v110
    v_exp_f32 v111, v111
    s_waitcnt vmcnt(0)
    v_cmp_ne_u32 s[34:35], s46, v146
    buffer_store_dword v68, v57, s[16:19], s47 offen offset:160 sc1
    s_add_u32 s78, s87, s47
    s_add_u32 m0, s87, 0
    s_add_u32 s78, s78, 66560
    s_cmp_lg_u64 s[34:35], 0
    s_cbranch_scc1 Lre177
Lok175:
    buffer_inv sc1
    s_waitcnt vmcnt(0)
    buffer_load_dwordx4 v46, s[16:19], s78 offen offset:0 sc1 lds
    buffer_load_dwordx4 v46, s[16:19], s78 offen offset:1024 sc1 lds
    v_cvt_pk_bf16_f32 v138, v104, v105
    v_cvt_pk_bf16_f32 v139, v106, v107
    v_bfi_b32 v136, v44, 0, v138
    v_bfi_b32 v137, v45, 0, v139
    v_and_b32_e64 v138, v44, v138
    v_and_b32 v139, v45, v139
    s_waitcnt lgkmcnt(1)
    s_nop 0
    v_mfma_f32_16x16x32_bf16 v[112:115], v[78:81], v[136:139], 0
    s_waitcnt lgkmcnt(0)
    v_cvt_pk_bf16_f32 v142, v108, v109
    v_cvt_pk_bf16_f32 v143, v110, v111
    v_mfma_f32_16x16x32_bf16 v[104:107], v[72:75], v[136:139], 0
    s_add_u32 s76, s47, 140288
    s_add_u32 s77, s47, 146432
    v_bfi_b32 v140, v44, 0, v142
    v_bfi_b32 v141, v45, 0, v143
    v_and_b32_e64 v142, v44, v142
    v_and_b32 v143, v45, v143
    s_nop 1
    v_mfma_f32_16x16x32_bf16 v[116:119], v[80:83], v[140:143], 0
    v_rcp_f32 v114, v114
    v_mfma_f32_16x16x32_bf16 v[108:111], v[74:77], v[140:143], 0
    buffer_load_dwordx4 v46, s[16:19], s78 offen offset:2048 sc1 lds
    s_add_u32 s78, s87, s47
    s_add_u32 m0, s87, 12288
    s_add_u32 s78, s78, 78848
    buffer_load_dwordx4 v46, s[16:19], s78 offen offset:0 sc1 lds
    v_rcp_f32_e64 v118, v118
    v_pk_mul_f32 v[104:105], v[104:105], v[114:115] op_sel_hi:[1,0]
    v_pk_mul_f32 v[106:107], v[106:107], v[114:115] op_sel_hi:[1,0]
    v_pk_mul_f32 v[112:113], v[112:113], v[114:115] op_sel_hi:[1,0]
    v_cvt_pk_bf16_f32 v104, v104, v105
    v_cvt_pk_bf16_f32 v105, v106, v107
    v_cvt_pk_bf16_f32 v112, v112, v113
    v_pk_mul_f32 v[108:109], v[108:109], v[118:119] op_sel_hi:[1,0]
    v_pk_mul_f32 v[110:111], v[110:111], v[118:119] op_sel_hi:[1,0]
    v_pk_mul_f32 v[116:117], v[116:117], v[118:119] op_sel_hi:[1,0]
    v_cvt_pk_bf16_f32 v108, v108, v109
    v_cvt_pk_bf16_f32 v109, v110, v111
    v_cvt_pk_bf16_f32 v116, v116, v117
    buffer_store_dwordx2 v[104:105], v55, s[16:19], s76 offen sc1
    buffer_store_dwordx2 v[108:109], v55, s[16:19], s77 offen sc1
    v_mov_b32_dpp v112, v116 quad_perm:[0,1,2,3] row_mask:0x2 bank_mask:0xf
    buffer_store_dword v112, v56, s[16:19], s76 offen sc1
    buffer_load_dword v146, v58, s[16:19], s47 offen offset:160 sc1
    s_mul_i32 s81, s53, 6144
    v_add_u32_e64 v96, s81, v46
    v_add_u32 v97, 36864, v96
    ds_read_b64_tr_b16 a[216:217], v33 offset:0
    ds_read_b64_tr_b16 a[218:219], v33 offset:512
    ds_read_b64_tr_b16 a[220:221], v33 offset:8
    ds_read_b64_tr_b16 a[222:223], v33 offset:520
    ds_read_b64_tr_b16 a[224:225], v33 offset:4096
    ds_read_b64_tr_b16 a[226:227], v33 offset:4608
    ds_read_b64_tr_b16 a[228:229], v33 offset:4104
    buffer_load_dwordx4 v46, s[16:19], s78 offen offset:1024 sc1 lds
    ds_read_b64_tr_b16 a[230:231], v33 offset:4616
    ds_read_b64_tr_b16 a[232:233], v33 offset:8192
    ds_read_b64_tr_b16 a[234:235], v33 offset:8704
    ds_read_b64_tr_b16 a[236:237], v33 offset:8200
    ds_read_b64_tr_b16 a[238:239], v33 offset:8712
    ds_read_b64_tr_b16 a[240:241], v33 offset:12288
    ds_read_b64_tr_b16 a[242:243], v33 offset:12800
    buffer_load_dwordx4 v46, s[16:19], s78 offen offset:2048 sc1 lds
    ds_read_b64_tr_b16 a[244:245], v33 offset:12296
    ds_read_b64_tr_b16 a[246:247], v33 offset:12808
    ds_read_b64_tr_b16 a[248:249], v33 offset:16384
    ds_read_b64_tr_b16 a[250:251], v33 offset:16896
    ds_read_b64_tr_b16 a[252:253], v33 offset:16392
    ds_read_b64_tr_b16 a[254:255], v33 offset:16904
    ds_read_b64_tr_b16 v[152:153], v33 offset:20480
    s_add_u32 s78, s87, s47
    s_nop 0
    s_add_u32 m0, s87, 24576
    s_add_u32 s78, s78, 91136
    buffer_load_dwordx4 v46, s[16:19], s78 offen offset:0 sc1 lds
    ds_read_b64_tr_b16 v[154:155], v33 offset:20992
    ds_read_b64_tr_b16 v[156:157], v33 offset:20488
    ds_read_b64_tr_b16 v[158:159], v33 offset:21000
    ds_read_b64_tr_b16 v[160:161], v33 offset:24576
    ds_read_b64_tr_b16 v[162:163], v33 offset:25088
    ds_read_b64_tr_b16 v[164:165], v33 offset:24584
    ds_read_b64_tr_b16 v[166:167], v33 offset:25096
    buffer_load_dwordx4 v46, s[16:19], s78 offen offset:1024 sc1 lds
    ds_read_b64_tr_b16 v[168:169], v33 offset:28672
    ds_read_b64_tr_b16 v[170:171], v33 offset:29184
    ds_read_b64_tr_b16 v[172:173], v33 offset:28680
    ds_read_b64_tr_b16 v[174:175], v33 offset:29192
    ds_read_b64_tr_b16 v[176:177], v33 offset:32768
    ds_read_b64_tr_b16 v[178:179], v33 offset:33280
    ds_read_b64_tr_b16 v[180:181], v33 offset:32776
    buffer_load_dwordx4 v46, s[16:19], s78 offen offset:2048 sc1 lds
    ds_read_b64_tr_b16 v[182:183], v33 offset:33288
    s_waitcnt vmcnt(10) lgkmcnt(0)
    s_barrier
    ds_read_b128 v[72:75], v96 offset:0
    ds_read_b128 v[76:79], v96 offset:1024
    ds_read_b128 v[80:83], v96 offset:2048
    ds_read_b128 v[84:87], v96 offset:3072
    ds_read_b128 v[88:91], v96 offset:4096
    ds_read_b128 v[92:95], v96 offset:5120
    s_waitcnt lgkmcnt(5)
    v_mfma_f32_16x16x32_bf16 v[0:3], a[216:219], v[72:75], v[0:3]
    s_waitcnt vmcnt(5)
    ds_read_b64_tr_b16 v[184:185], v34 offset:0
    ds_read_b64_tr_b16 v[186:187], v34 offset:512
    v_cmp_ne_u32 s[34:35], s46, v146
    v_mfma_f32_16x16x32_bf16 v[4:7], a[220:223], v[72:75], v[4:7]
    s_waitcnt lgkmcnt(6)
    ds_read_b64_tr_b16 v[188:189], v34 offset:8
    ds_read_b64_tr_b16 v[190:191], v34 offset:520
    v_mfma_f32_16x16x32_bf16 v[0:3], a[224:227], v[76:79], v[0:3]
    ds_read_b64_tr_b16 v[192:193], v34 offset:4096
    ds_read_b64_tr_b16 v[194:195], v34 offset:4608
    v_mfma_f32_16x16x32_bf16 v[4:7], a[228:231], v[76:79], v[4:7]
    s_waitcnt lgkmcnt(9)
    ds_read_b64_tr_b16 v[196:197], v34 offset:4104
    ds_read_b64_tr_b16 v[198:199], v34 offset:4616
    v_mfma_f32_16x16x32_bf16 v[0:3], a[232:235], v[80:83], v[0:3]
    s_cmp_lg_u64 s[34:35], 0
    s_cbranch_scc1 Lre180
Lok178:
    buffer_inv sc1
    s_waitcnt vmcnt(0)
    v_mfma_f32_16x16x32_bf16 v[4:7], a[236:239], v[80:83], v[4:7]
    s_waitcnt lgkmcnt(10)
    buffer_store_dword v68, v57, s[16:19], s47 offen offset:320 sc1
    s_add_u32 s78, s87, s47
    v_mfma_f32_16x16x32_bf16 v[0:3], a[240:243], v[84:87], v[0:3]
    s_barrier
    s_add_u32 m0, s87, 36864
    s_add_u32 s78, s78, 103424
    ds_read_b64_tr_b16 v[200:201], v34 offset:8192
    v_mfma_f32_16x16x32_bf16 v[4:7], a[244:247], v[84:87], v[4:7]
    s_waitcnt lgkmcnt(10)
    ds_read_b128 v[72:75], v96 offset:12288
    buffer_load_dwordx4 v46, s[16:19], s78 offen offset:0 sc1 lds
    ds_read_b128 v[76:79], v96 offset:13312
    v_mfma_f32_16x16x32_bf16 v[0:3], a[248:251], v[88:91], v[0:3]
    s_nop 0
    ds_read_b128 v[80:83], v96 offset:14336
    ds_read_b128 v[84:87], v96 offset:15360
    v_mfma_f32_16x16x32_bf16 v[4:7], a[252:255], v[88:91], v[4:7]
    s_waitcnt lgkmcnt(13)
    ds_read_b128 v[88:91], v96 offset:16384
    buffer_load_dwordx4 v46, s[16:19], s78 offen offset:1024 sc1 lds
    ds_read_b64_tr_b16 v[202:203], v34 offset:8704
    v_mfma_f32_16x16x32_bf16 v[0:3], v[152:155], v[92:95], v[0:3]
    ds_read_b64_tr_b16 v[204:205], v34 offset:8200
    ds_read_b64_tr_b16 v[206:207], v34 offset:8712
    v_mfma_f32_16x16x32_bf16 v[4:7], v[156:159], v[92:95], v[4:7]
    s_waitcnt lgkmcnt(7)
    ds_read_b128 v[92:95], v96 offset:17408
    ds_read_b64_tr_b16 v[208:209], v34 offset:12288
    v_mfma_f32_16x16x32_bf16 v[0:3], v[160:163], v[72:75], v[0:3]
    buffer_load_dwordx4 v46, s[16:19], s78 offen offset:2048 sc1 lds
    ds_read_b64_tr_b16 v[210:211], v34 offset:12800
    ds_read_b64_tr_b16 v[212:213], v34 offset:12296
    v_mfma_f32_16x16x32_bf16 v[4:7], v[164:167], v[72:75], v[4:7]
    s_waitcnt lgkmcnt(10)
    s_add_u32 s78, s87, s47
    s_add_u32 m0, s87, 49152
    s_add_u32 s78, s78, 115712
    ds_read_b64_tr_b16 v[214:215], v34 offset:12808
    v_mfma_f32_16x16x32_bf16 v[0:3], v[168:171], v[76:79], v[0:3]
    buffer_load_dwordx4 v46, s[16:19], s78 offen offset:0 sc1 lds
    ds_read_b64_tr_b16 v[216:217], v34 offset:16384
    ds_read_b64_tr_b16 v[218:219], v34 offset:16896
    v_mfma_f32_16x16x32_bf16 v[4:7], v[172:175], v[76:79], v[4:7]
    s_waitcnt lgkmcnt(12)
    ds_read_b64_tr_b16 v[220:221], v34 offset:16392
    ds_read_b64_tr_b16 v[222:223], v34 offset:16904
    v_mfma_f32_16x16x32_bf16 v[0:3], v[176:179], v[80:83], v[0:3]
    ds_read_b64_tr_b16 v[224:225], v34 offset:20480
    ds_read_b64_tr_b16 v[226:227], v34 offset:20992
    v_mfma_f32_16x16x32_bf16 v[4:7], v[180:183], v[80:83], v[4:7]
    s_waitcnt lgkmcnt(15)
    ds_read_b64_tr_b16 v[228:229], v34 offset:20488
    buffer_load_dwordx4 v46, s[16:19], s78 offen offset:1024 sc1 lds
    ds_read_b64_tr_b16 v[230:231], v34 offset:21000
    v_mfma_f32_16x16x32_bf16 v[0:3], v[184:187], v[84:87], v[0:3]
    s_barrier
    buffer_load_dword v98, v58, s[16:19], s47 offen offset:320 sc1
    ds_read_b64_tr_b16 v[232:233], v34 offset:24576
    v_mfma_f32_16x16x32_bf16 v[4:7], v[188:191], v[84:87], v[4:7]
    s_waitcnt lgkmcnt(15)
    ds_read_b128 v[72:75], v96 offset:24576
    ds_read_b128 v[76:79], v96 offset:25600
    v_mfma_f32_16x16x32_bf16 v[0:3], v[192:195], v[88:91], v[0:3]
    ds_read_b128 v[80:83], v96 offset:26624
    ds_read_b128 v[84:87], v96 offset:27648
    v_mfma_f32_16x16x32_bf16 v[4:7], v[196:199], v[88:91], v[4:7]
    s_waitcnt lgkmcnt(15)
    ds_read_b128 v[88:91], v96 offset:28672
    buffer_load_dwordx4 v46, s[16:19], s78 offen offset:2048 sc1 lds
    ds_read_b64_tr_b16 v[234:235], v34 offset:25088
    v_mfma_f32_16x16x32_bf16 v[0:3], v[200:203], v[92:95], v[0:3]
    s_add_u32 s78, s87, s47
    ds_read_b64_tr_b16 v[236:237], v34 offset:24584
    s_add_u32 m0, s87, 61440
    s_add_u32 s78, s78, 128000
    ds_read_b64_tr_b16 v[238:239], v34 offset:25096
    v_mfma_f32_16x16x32_bf16 v[4:7], v[204:207], v[92:95], v[4:7]
    s_waitcnt lgkmcnt(7)
    ds_read_b128 v[92:95], v96 offset:29696
    ds_read_b64_tr_b16 v[240:241], v34 offset:28672
    v_mfma_f32_16x16x32_bf16 v[0:3], v[208:211], v[72:75], v[0:3]
    buffer_load_dwordx4 v46, s[16:19], s78 offen offset:0 sc1 lds
    ds_read_b64_tr_b16 v[242:243], v34 offset:29184
    ds_read_b64_tr_b16 v[244:245], v34 offset:28680
    v_mfma_f32_16x16x32_bf16 v[4:7], v[212:215], v[72:75], v[4:7]
    s_waitcnt lgkmcnt(10)
    ds_read_b64_tr_b16 v[246:247], v34 offset:29192
    ds_read_b64_tr_b16 v[248:249], v34 offset:32768
    v_mfma_f32_16x16x32_bf16 v[0:3], v[216:219], v[76:79], v[0:3]
    ds_read_b64_tr_b16 v[250:251], v34 offset:33280
    ds_read_b64_tr_b16 v[252:253], v34 offset:32776
    v_mfma_f32_16x16x32_bf16 v[4:7], v[220:223], v[76:79], v[4:7]
    s_waitcnt lgkmcnt(13)
    buffer_load_dwordx4 v46, s[16:19], s78 offen offset:1024 sc1 lds
    ds_read_b64_tr_b16 v[254:255], v34 offset:33288
    v_mfma_f32_16x16x32_bf16 v[0:3], v[224:227], v[80:83], v[0:3]
    v_mfma_f32_16x16x32_bf16 v[4:7], v[228:231], v[80:83], v[4:7]
    s_waitcnt lgkmcnt(11)
    v_mfma_f32_16x16x32_bf16 v[0:3], v[232:235], v[84:87], v[0:3]
    s_waitcnt lgkmcnt(9)
    s_waitcnt vmcnt(6)
    s_waitcnt lgkmcnt(0)
    s_barrier
    v_mfma_f32_16x16x32_bf16 v[4:7], v[236:239], v[84:87], v[4:7]
    s_waitcnt vmcnt(3)
    ds_read_b128 v[72:75], v97 offset:0
    v_cmp_ne_u32 s[34:35], s46, v98
    v_mfma_f32_16x16x32_bf16 v[0:3], v[240:243], v[88:91], v[0:3]
    s_nop 0
    ds_read_b128 v[76:79], v97 offset:1024
    v_mfma_f32_16x16x32_bf16 v[4:7], v[244:247], v[88:91], v[4:7]
    ds_read_b128 v[80:83], v97 offset:2048
    v_mfma_f32_16x16x32_bf16 v[0:3], v[248:251], v[92:95], v[0:3]
    ds_read_b128 v[84:87], v97 offset:3072
    v_mfma_f32_16x16x32_bf16 v[4:7], v[252:255], v[92:95], v[4:7]
    s_waitcnt lgkmcnt(3)
    ds_read_b128 v[88:91], v97 offset:4096
    v_mfma_f32_16x16x32_bf16 v[8:11], a[216:219], v[72:75], v[8:11]
    buffer_load_dwordx4 v46, s[16:19], s78 offen offset:2048 sc1 lds
    ds_read_b128 v[92:95], v97 offset:5120
    v_mfma_f32_16x16x32_bf16 v[12:15], a[220:223], v[72:75], v[12:15]
    s_waitcnt lgkmcnt(4)
    v_cvt_pk_bf16_f32 v140, v0, v1
    v_cvt_pk_bf16_f32 v141, v2, v3
    v_mfma_f32_16x16x32_bf16 v[8:11], a[224:227], v[76:79], v[8:11]
    s_cmp_lg_u64 s[34:35], 0
    s_cbranch_scc1 Lre184
Lok182:
    buffer_inv sc1
    s_waitcnt vmcnt(0)
    v_mfma_f32_16x16x32_bf16 v[12:15], a[228:231], v[76:79], v[12:15]
    s_waitcnt lgkmcnt(3)
    v_cvt_pk_bf16_f32 v142, v4, v5
    v_cvt_pk_bf16_f32 v143, v6, v7
    v_mfma_f32_16x16x32_bf16 v[8:11], a[232:235], v[80:83], v[8:11]
    s_add_u32 s80, s56, 29696
    s_add_u32 s78, s87, s47
    v_mfma_f32_16x16x32_bf16 v[12:15], a[236:239], v[80:83], v[12:15]
    s_waitcnt lgkmcnt(2)
    s_add_u32 m0, s87, 73728
    s_add_u32 s78, s78, 140288
    v_mfma_f32_16x16x32_bf16 v[8:11], a[240:243], v[84:87], v[8:11]
    buffer_store_dwordx4 v[140:143], v46, s[16:19], s80 offen sc1
    s_barrier
    v_mfma_f32_16x16x32_bf16 v[12:15], a[244:247], v[84:87], v[12:15]
    s_waitcnt lgkmcnt(1)
    s_or_b32 s79, s46, 4
    v_mfma_f32_16x16x32_bf16 v[100:103], v[140:143], v[140:143], 0
    s_nop 0
    ds_read_b128 v[72:75], v97 offset:12288
    ds_read_b128 v[76:79], v97 offset:13312
    ds_read_b128 v[80:83], v97 offset:14336
    ds_read_b128 v[84:87], v97 offset:15360
    v_mfma_f32_16x16x32_bf16 v[146:149], v[36:39], v[140:143], 0
    v_mfma_f32_16x16x32_bf16 v[8:11], a[248:251], v[88:91], v[8:11]
    v_cndmask_b32 v100, v100, v101, s[60:61]
    v_cndmask_b32 v102, v102, v103, s[60:61]
    v_mfma_f32_16x16x32_bf16 v[12:15], a[252:255], v[88:91], v[12:15]
    s_waitcnt lgkmcnt(4)
    ds_read_b128 v[88:91], v97 offset:16384
    v_mov_b32 v149, s79
    v_mfma_f32_16x16x32_bf16 v[8:11], v[152:155], v[92:95], v[8:11]
    buffer_load_dwordx4 v46, s[16:19], s78 offen offset:0 sc1 lds
    v_cndmask_b32 v148, v100, v102, s[62:63]
    v_mfma_f32_16x16x32_bf16 v[12:15], v[156:159], v[92:95], v[12:15]
    s_waitcnt lgkmcnt(4)
    ds_read_b128 v[92:95], v97 offset:17408
    v_mfma_f32_16x16x32_bf16 v[8:11], v[160:163], v[72:75], v[8:11]
    v_mfma_f32_16x16x32_bf16 v[12:15], v[164:167], v[72:75], v[12:15]
    s_waitcnt lgkmcnt(4)
    buffer_load_dwordx4 v46, s[16:19], s78 offen offset:1024 sc1 lds
    v_mfma_f32_16x16x32_bf16 v[8:11], v[168:171], v[76:79], v[8:11]
    buffer_load_dwordx4 v46, s[16:19], s78 offen offset:2048 sc1 lds
    v_mfma_f32_16x16x32_bf16 v[12:15], v[172:175], v[76:79], v[12:15]
    s_waitcnt lgkmcnt(3)
    s_add_u32 s78, s87, s47
    v_mfma_f32_16x16x32_bf16 v[8:11], v[176:179], v[80:83], v[8:11]
    s_add_u32 m0, s87, 86016
    s_add_u32 s78, s78, 152576
    v_mfma_f32_16x16x32_bf16 v[12:15], v[180:183], v[80:83], v[12:15]
    s_waitcnt lgkmcnt(2)
    v_mfma_f32_16x16x32_bf16 v[8:11], v[184:187], v[84:87], v[8:11]
    s_barrier
    v_mfma_f32_16x16x32_bf16 v[12:15], v[188:191], v[84:87], v[12:15]
    s_waitcnt lgkmcnt(1)
    ds_read_b128 v[72:75], v97 offset:24576
    v_mfma_f32_16x16x32_bf16 v[8:11], v[192:195], v[88:91], v[8:11]
    s_nop 0
    ds_read_b128 v[76:79], v97 offset:25600
    v_mfma_f32_16x16x32_bf16 v[12:15], v[196:199], v[88:91], v[12:15]
    s_waitcnt lgkmcnt(2)
    ds_read_b128 v[80:83], v97 offset:26624
    v_mfma_f32_16x16x32_bf16 v[8:11], v[200:203], v[92:95], v[8:11]
    buffer_load_dwordx4 v46, s[16:19], s78 offen offset:0 sc1 lds
    ds_read_b128 v[84:87], v97 offset:27648
    v_mfma_f32_16x16x32_bf16 v[12:15], v[204:207], v[92:95], v[12:15]
    s_waitcnt lgkmcnt(3)
    ds_read_b128 v[88:91], v97 offset:28672
    v_mfma_f32_16x16x32_bf16 v[8:11], v[208:211], v[72:75], v[8:11]
    s_waitcnt vmcnt(4)
    buffer_store_dword v68, v57, s[16:19], s47 offen offset:960 sc1
    ds_read_b128 v[92:95], v97 offset:29696
    v_mfma_f32_16x16x32_bf16 v[12:15], v[212:215], v[72:75], v[12:15]
    s_waitcnt lgkmcnt(4)
    buffer_load_dwordx4 v46, s[16:19], s78 offen offset:1024 sc1 lds
    v_mfma_f32_16x16x32_bf16 v[8:11], v[216:219], v[76:79], v[8:11]
    buffer_load_dwordx4 v46, s[16:19], s78 offen offset:2048 sc1 lds
    v_mfma_f32_16x16x32_bf16 v[12:15], v[220:223], v[76:79], v[12:15]
    s_waitcnt lgkmcnt(3)
    s_add_u32 s78, s87, s47
    v_mfma_f32_16x16x32_bf16 v[8:11], v[224:227], v[80:83], v[8:11]
    s_add_u32 m0, s87, 98304
    s_add_u32 s78, s78, 164864
    v_mfma_f32_16x16x32_bf16 v[12:15], v[228:231], v[80:83], v[12:15]
    s_waitcnt lgkmcnt(2)
    v_mfma_f32_16x16x32_bf16 v[8:11], v[232:235], v[84:87], v[8:11]
    s_waitcnt vmcnt(4)
    s_barrier
    v_mfma_f32_16x16x32_bf16 v[12:15], v[236:239], v[84:87], v[12:15]
    s_waitcnt lgkmcnt(1)
    v_add_u32 v96, 73728, v96
    v_mfma_f32_16x16x32_bf16 v[8:11], v[240:243], v[88:91], v[8:11]
    buffer_load_dwordx4 v46, s[16:19], s78 offen offset:0 sc1 lds
    ds_read_b128 v[72:75], v96 offset:0
    v_mfma_f32_16x16x32_bf16 v[12:15], v[244:247], v[88:91], v[12:15]
    s_waitcnt lgkmcnt(1)
    ds_read_b128 v[76:79], v96 offset:1024
    v_mfma_f32_16x16x32_bf16 v[8:11], v[248:251], v[92:95], v[8:11]
    ds_read_b128 v[80:83], v96 offset:2048
    v_mfma_f32_16x16x32_bf16 v[12:15], v[252:255], v[92:95], v[12:15]
    s_waitcnt lgkmcnt(2)
    ds_read_b128 v[84:87], v96 offset:3072
    v_mfma_f32_16x16x32_bf16 v[16:19], a[216:219], v[72:75], v[16:19]
    buffer_load_dwordx4 v46, s[16:19], s78 offen offset:1024 sc1 lds
    ds_read_b128 v[88:91], v96 offset:4096
    v_mfma_f32_16x16x32_bf16 v[20:23], a[220:223], v[72:75], v[20:23]
    s_waitcnt lgkmcnt(3)
    ds_read_b128 v[92:95], v96 offset:5120
    v_mfma_f32_16x16x32_bf16 v[16:19], a[224:227], v[76:79], v[16:19]
    buffer_load_dwordx4 v46, s[16:19], s78 offen offset:2048 sc1 lds
    v_mfma_f32_16x16x32_bf16 v[20:23], a[228:231], v[76:79], v[20:23]
    s_waitcnt lgkmcnt(3)
    buffer_load_dword v98, v59, s[16:19], s47 offen offset:960 sc1
    v_mfma_f32_16x16x32_bf16 v[16:19], a[232:235], v[80:83], v[16:19]
    v_mfma_f32_16x16x32_bf16 v[20:23], a[236:239], v[80:83], v[20:23]
    s_waitcnt lgkmcnt(2)
    v_mfma_f32_16x16x32_bf16 v[16:19], a[240:243], v[84:87], v[16:19]
    s_waitcnt vmcnt(4)
    s_barrier
    v_mfma_f32_16x16x32_bf16 v[20:23], a[244:247], v[84:87], v[20:23]
    s_waitcnt lgkmcnt(1)
    ds_read_b128 v[72:75], v96 offset:12288
    v_mfma_f32_16x16x32_bf16 v[16:19], a[248:251], v[88:91], v[16:19]
    buffer_store_dwordx4 v[146:149], v60, s[16:19], s47 offen offset:3072 sc1
    ds_read_b128 v[76:79], v96 offset:13312
    ds_read_b128 v[80:83], v96 offset:14336
    ds_read_b128 v[84:87], v96 offset:15360
    v_mfma_f32_16x16x32_bf16 v[20:23], a[252:255], v[88:91], v[20:23]
    s_waitcnt lgkmcnt(4)
    ds_read_b128 v[88:91], v96 offset:16384
    v_mfma_f32_16x16x32_bf16 v[16:19], v[152:155], v[92:95], v[16:19]
    s_mov_b32 exec_lo, 0xff00ff00
    s_mov_b32 exec_hi, 0xff00ff00
    buffer_store_dwordx4 v[140:143], v46, s[16:19], s57 offen sc1
    s_mov_b64 exec, -1
    v_cvt_pk_bf16_f32 v116, v8, v9
    v_cvt_pk_bf16_f32 v117, v10, v11
    v_cvt_pk_bf16_f32 v118, v12, v13
    v_cvt_pk_bf16_f32 v119, v14, v15
    v_mfma_f32_16x16x32_bf16 v[20:23], v[156:159], v[92:95], v[20:23]
    s_waitcnt lgkmcnt(4)
    s_or_b32 s79, s46, 4
    v_mfma_f32_16x16x32_bf16 v[100:103], v[116:119], v[116:119], 0
    ds_read_b128 v[92:95], v96 offset:17408
    v_mfma_f32_16x16x32_bf16 v[104:107], v[36:39], v[116:119], 0
    s_nop 3
    v_cndmask_b32 v100, v100, v101, s[60:61]
    v_cndmask_b32 v102, v102, v103, s[60:61]
    s_nop 1
    v_mov_b32_e64 v107, s79
    v_mfma_f32_16x16x32_bf16 v[16:19], v[160:163], v[72:75], v[16:19]
    v_mfma_f32_16x16x32_bf16 v[20:23], v[164:167], v[72:75], v[20:23]
    s_waitcnt vmcnt(2) lgkmcnt(4)
    v_cmp_ne_u32 s[34:35], s46, v98
    v_cndmask_b32 v106, v100, v102, s[62:63]
    v_mfma_f32_16x16x32_bf16 v[16:19], v[168:171], v[76:79], v[16:19]
    buffer_store_dwordx4 v[104:107], v60, s[16:19], s47 offen offset:2560 sc1
    v_mfma_f32_16x16x32_bf16 v[20:23], v[172:175], v[76:79], v[20:23]
    s_waitcnt lgkmcnt(3)
    v_mfma_f32_16x16x32_bf16 v[16:19], v[176:179], v[80:83], v[16:19]
    s_cmp_lg_u64 s[34:35], 0
    s_cbranch_scc1 Lre191
Lok189:
    buffer_inv sc1
    s_waitcnt vmcnt(0)
    v_mfma_f32_16x16x32_bf16 v[20:23], v[180:183], v[80:83], v[20:23]
    s_waitcnt lgkmcnt(2)
    s_add_u32 s78, s87, s47
    v_mfma_f32_16x16x32_bf16 v[16:19], v[184:187], v[84:87], v[16:19]
    s_barrier
    v_mfma_f32_16x16x32_bf16 v[20:23], v[188:191], v[84:87], v[20:23]
    s_waitcnt lgkmcnt(1)
    ds_read_b128 v[72:75], v96 offset:24576
    v_mfma_f32_16x16x32_bf16 v[16:19], v[192:195], v[88:91], v[16:19]
    s_add_u32 m0, s87, 0
    s_add_u32 s78, s78, 29696
    ds_read_b128 v[76:79], v96 offset:25600
    v_mfma_f32_16x16x32_bf16 v[20:23], v[196:199], v[88:91], v[20:23]
    s_waitcnt lgkmcnt(2)
    ds_read_b128 v[80:83], v96 offset:26624
    v_mfma_f32_16x16x32_bf16 v[16:19], v[200:203], v[92:95], v[16:19]
    buffer_load_dwordx4 v46, s[16:19], s78 offen offset:0 sc1 lds
    ds_read_b128 v[84:87], v96 offset:27648
    v_mfma_f32_16x16x32_bf16 v[20:23], v[204:207], v[92:95], v[20:23]
    s_waitcnt lgkmcnt(3)
    ds_read_b128 v[88:91], v96 offset:28672
    v_mfma_f32_16x16x32_bf16 v[16:19], v[208:211], v[72:75], v[16:19]
    buffer_load_dwordx4 v46, s[16:19], s78 offen offset:1024 sc1 lds
    ds_read_b128 v[92:95], v96 offset:29696
    v_mfma_f32_16x16x32_bf16 v[20:23], v[212:215], v[72:75], v[20:23]
    s_waitcnt lgkmcnt(4)
    v_mfma_f32_16x16x32_bf16 v[16:19], v[216:219], v[76:79], v[16:19]
    v_mfma_f32_16x16x32_bf16 v[20:23], v[220:223], v[76:79], v[20:23]
    s_waitcnt lgkmcnt(3)
    v_mfma_f32_16x16x32_bf16 v[16:19], v[224:227], v[80:83], v[16:19]
    buffer_load_dwordx4 v46, s[16:19], s78 offen offset:2048 sc1 lds
    s_add_u32 s78, s87, s47
    v_mfma_f32_16x16x32_bf16 v[20:23], v[228:231], v[80:83], v[20:23]
    s_waitcnt lgkmcnt(2)
    s_add_u32 m0, s87, 12288
    s_add_u32 s78, s78, 41984
    v_mfma_f32_16x16x32_bf16 v[16:19], v[232:235], v[84:87], v[16:19]
    v_mfma_f32_16x16x32_bf16 v[20:23], v[236:239], v[84:87], v[20:23]
    s_waitcnt lgkmcnt(1)
    v_mfma_f32_16x16x32_bf16 v[16:19], v[240:243], v[88:91], v[16:19]
    buffer_load_dwordx4 v46, s[16:19], s78 offen offset:0 sc1 lds
    v_mfma_f32_16x16x32_bf16 v[20:23], v[244:247], v[88:91], v[20:23]
    s_waitcnt lgkmcnt(0)
    v_mfma_f32_16x16x32_bf16 v[16:19], v[248:251], v[92:95], v[16:19]
    v_mfma_f32_16x16x32_bf16 v[20:23], v[252:255], v[92:95], v[20:23]
    buffer_load_dwordx4 v46, s[16:19], s78 offen offset:1024 sc1 lds
    buffer_load_dwordx4 v46, s[16:19], s78 offen offset:2048 sc1 lds
    buffer_load_dwordx4 v[128:131], v61, s[16:19], s47 offen offset:3072 sc1
    s_add_u32 s81, s47, 12288
    buffer_load_dwordx4 v[132:135], v61, s[16:19], s81 offen offset:3072 sc1
    s_add_u32 s81, s47, 24576
    buffer_load_dwordx4 v[136:139], v69, s[16:19], s81 offen offset:3072 sc1
    s_add_u32 s78, s87, s47
    s_nop 0
    s_add_u32 m0, s87, 24576
    s_add_u32 s78, s78, 54272
    buffer_load_dwordx4 v46, s[16:19], s78 offen offset:0 sc1 lds
    v_cvt_pk_bf16_f32 v112, v16, v17
    v_cvt_pk_bf16_f32 v113, v18, v19
    v_cvt_pk_bf16_f32 v114, v20, v21
    v_cvt_pk_bf16_f32 v115, v22, v23
    s_or_b32 s79, s46, 4
    s_nop 0
    v_mfma_f32_16x16x32_bf16 v[100:103], v[112:115], v[112:115], 0
    v_mfma_f32_16x16x32_bf16 v[120:123], v[36:39], v[112:115], 0
    buffer_load_dwordx4 v46, s[16:19], s78 offen offset:1024 sc1 lds
    s_nop 2
    v_cndmask_b32 v100, v100, v101, s[60:61]
    v_cndmask_b32 v102, v102, v103, s[60:61]
    s_nop 1
    v_mov_b32_e64 v123, s79
    v_cndmask_b32 v122, v100, v102, s[62:63]
    buffer_load_dwordx4 v46, s[16:19], s78 offen offset:2048 sc1 lds
    v_add_u32 v96, 36864, v46
    v_add_u32 v97, 73728, v46
    buffer_store_dwordx4 v[120:123], v60, s[16:19], s47 offen offset:2048 sc1
    s_waitcnt vmcnt(10)
    s_barrier
    ds_read_b128 v[72:75], v46 offset:0
    ds_read_b128 v[76:79], v46 offset:1024
    ds_read_b128 v[80:83], v46 offset:2048
    ds_read_b128 v[84:87], v46 offset:3072
    ds_read_b128 v[88:91], v46 offset:4096
    ds_read_b128 v[92:95], v46 offset:5120
    s_waitcnt lgkmcnt(5)
    v_mfma_f32_16x16x32_bf16 v[100:103], a[0:3], v[72:75], 0
    s_add_u32 s80, s56, 66560
    v_mfma_f32_16x16x32_bf16 v[104:107], a[4:7], v[72:75], 0
    v_mfma_f32_16x16x32_bf16 v[108:111], v[72:75], a[8:11], 0
    s_waitcnt lgkmcnt(4)
    v_mfma_f32_16x16x32_bf16 v[100:103], a[12:15], v[76:79], v[100:103]
    buffer_store_dwordx4 v[116:119], v46, s[16:19], s80 offen sc1
    v_mfma_f32_16x16x32_bf16 v[104:107], a[16:19], v[76:79], v[104:107]
    v_mfma_f32_16x16x32_bf16 v[108:111], v[76:79], a[20:23], v[108:111]
    s_waitcnt lgkmcnt(3)
    v_mfma_f32_16x16x32_bf16 v[100:103], a[24:27], v[80:83], v[100:103]
    v_mfma_f32_16x16x32_bf16 v[104:107], a[28:31], v[80:83], v[104:107]
    v_mfma_f32_16x16x32_bf16 v[108:111], v[80:83], a[32:35], v[108:111]
    s_waitcnt lgkmcnt(2)
    v_mfma_f32_16x16x32_bf16 v[100:103], a[36:39], v[84:87], v[100:103]
    s_waitcnt vmcnt(8)
    s_barrier
    ds_read_b128 v[72:75], v46 offset:12288
    v_mfma_f32_16x16x32_bf16 v[104:107], a[40:43], v[84:87], v[104:107]
    buffer_load_dwordx4 v[140:143], v61, s[16:19], s47 offen offset:2560 sc1
    ds_read_b128 v[76:79], v46 offset:13312
    v_mfma_f32_16x16x32_bf16 v[108:111], v[84:87], a[44:47], v[108:111]
    s_waitcnt lgkmcnt(3)
    ds_read_b128 v[80:83], v46 offset:14336
    v_mfma_f32_16x16x32_bf16 v[100:103], a[48:51], v[88:91], v[100:103]
    ds_read_b128 v[84:87], v46 offset:15360
    v_mfma_f32_16x16x32_bf16 v[104:107], a[52:55], v[88:91], v[104:107]
    v_mfma_f32_16x16x32_bf16 v[108:111], v[88:91], a[56:59], v[108:111]
    s_waitcnt lgkmcnt(4)
    ds_read_b128 v[88:91], v46 offset:16384
    v_mfma_f32_16x16x32_bf16 v[100:103], a[60:63], v[92:95], v[100:103]
    s_add_u32 s81, s47, 12288
    buffer_load_dwordx4 v[144:147], v61, s[16:19], s81 offen offset:2560 sc1
    v_mfma_f32_16x16x32_bf16 v[104:107], a[64:67], v[92:95], v[104:107]
    v_mfma_f32_16x16x32_bf16 v[108:111], v[92:95], a[68:71], v[108:111]
    s_waitcnt lgkmcnt(4)
    ds_read_b128 v[92:95], v46 offset:17408
    v_mfma_f32_16x16x32_bf16 v[100:103], a[72:75], v[72:75], v[100:103]
    s_add_u32 s81, s47, 24576
    buffer_load_dwordx4 v[148:151], v69, s[16:19], s81 offen offset:2560 sc1
    v_mfma_f32_16x16x32_bf16 v[104:107], a[76:79], v[72:75], v[104:107]
    s_waitcnt vmcnt(9)
    v_cmp_ne_u32 s[74:75], s79, v131
    v_cmp_ne_u32 s[92:93], s79, v135
    v_mfma_f32_16x16x32_bf16 v[108:111], v[72:75], a[80:83], v[108:111]
    s_waitcnt vmcnt(8) lgkmcnt(4)
    v_cmp_ne_u32 vcc, s79, v139
    s_or_b64 s[74:75], s[74:75], s[92:93]
    v_mfma_f32_16x16x32_bf16 v[100:103], a[84:87], v[76:79], v[100:103]
    s_and_b32 s92, vcc_lo, 0xffff
    s_or_b32 s74, s74, s75
    v_mfma_f32_16x16x32_bf16 v[104:107], a[88:91], v[76:79], v[104:107]
    s_or_b32 s74, s74, s92
    s_cbranch_scc1 Lre213
Lok211:
    v_add_f32 v128, v128, v132
    v_mfma_f32_16x16x32_bf16 v[108:111], v[76:79], a[92:95], v[108:111]
    s_waitcnt lgkmcnt(3)
    v_add_f32 v129, v129, v133
    v_add_f32 v130, v130, v134
    v_mfma_f32_16x16x32_bf16 v[100:103], a[96:99], v[80:83], v[100:103]
    v_add_f32 v124, v128, v136
    v_add_f32 v125, v129, v137
    v_mfma_f32_16x16x32_bf16 v[104:107], a[100:103], v[80:83], v[104:107]
    v_add_f32 v126, v130, v138
    v_mfma_f32_16x16x32_bf16 v[108:111], v[80:83], a[104:107], v[108:111]
    s_waitcnt lgkmcnt(2)
    buffer_load_dwordx4 v[128:131], v61, s[16:19], s47 offen offset:2048 sc1
    v_mfma_f32_16x16x32_bf16 v[100:103], a[108:111], v[84:87], v[100:103]
    s_waitcnt vmcnt(6)
    s_barrier
    ds_read_b128 v[72:75], v46 offset:24576
    v_mfma_f32_16x16x32_bf16 v[104:107], a[112:115], v[84:87], v[104:107]
    s_waitcnt vmcnt(4)
    buffer_store_dword v68, v57, s[16:19], s47 offen offset:1120 sc1
    ds_read_b128 v[76:79], v46 offset:25600
    v_mfma_f32_16x16x32_bf16 v[108:111], v[84:87], a[116:119], v[108:111]
    s_waitcnt lgkmcnt(3)
    ds_read_b128 v[80:83], v46 offset:26624
    v_mfma_f32_16x16x32_bf16 v[100:103], a[120:123], v[88:91], v[100:103]
    ds_read_b128 v[84:87], v46 offset:27648
    v_mfma_f32_16x16x32_bf16 v[104:107], a[124:127], v[88:91], v[104:107]
    s_add_u32 s81, s47, 12288
    buffer_load_dwordx4 v[132:135], v61, s[16:19], s81 offen offset:2048 sc1
    v_mfma_f32_16x16x32_bf16 v[108:111], v[88:91], a[128:131], v[108:111]
    s_waitcnt lgkmcnt(4)
    ds_read_b128 v[88:91], v46 offset:28672
    v_mfma_f32_16x16x32_bf16 v[100:103], a[132:135], v[92:95], v[100:103]
    s_add_u32 s81, s47, 24576
    buffer_load_dwordx4 v[136:139], v69, s[16:19], s81 offen offset:2048 sc1
    v_mfma_f32_16x16x32_bf16 v[104:107], a[136:139], v[92:95], v[104:107]
    s_add_u32 s80, s56, 103424
    v_mfma_f32_16x16x32_bf16 v[108:111], v[92:95], a[140:143], v[108:111]
    s_waitcnt lgkmcnt(4)
    ds_read_b128 v[92:95], v46 offset:29696
    v_mfma_f32_16x16x32_bf16 v[100:103], a[144:147], v[72:75], v[100:103]
    buffer_store_dwordx4 v[112:115], v46, s[16:19], s80 offen sc1
    v_mfma_f32_16x16x32_bf16 v[104:107], a[148:151], v[72:75], v[104:107]
    s_waitcnt vmcnt(6)
    v_cmp_ne_u32 s[74:75], s79, v143
    v_cmp_ne_u32 s[92:93], s79, v147
    v_mfma_f32_16x16x32_bf16 v[108:111], v[72:75], a[152:155], v[108:111]
    s_waitcnt vmcnt(5) lgkmcnt(4)
    ds_read_b128 v[72:75], v46 offset:6144
    v_cmp_ne_u32 vcc, s79, v151
    v_mfma_f32_16x16x32_bf16 v[100:103], a[156:159], v[76:79], v[100:103]
    s_or_b64 s[74:75], s[74:75], s[92:93]
    s_and_b32 s92, vcc_lo, 0xffff
    s_or_b32 s74, s74, s75
    v_mfma_f32_16x16x32_bf16 v[104:107], a[160:163], v[76:79], v[104:107]
    s_or_b32 s74, s74, s92
    s_cbranch_scc1 Lre216
Lok214:
    v_add_f32 v140, v140, v144
    v_mfma_f32_16x16x32_bf16 v[108:111], v[76:79], a[164:167], v[108:111]
    s_waitcnt lgkmcnt(4)
    ds_read_b128 v[76:79], v46 offset:7168
    v_add_f32 v141, v141, v145
    v_mfma_f32_16x16x32_bf16 v[100:103], a[168:171], v[80:83], v[100:103]
    buffer_load_dword v33, v59, s[16:19], s47 offen offset:1120 sc1
    v_add_f32 v142, v142, v146
    v_mfma_f32_16x16x32_bf16 v[104:107], a[172:175], v[80:83], v[104:107]
    v_add_f32 v140, v140, v148
    v_add_f32 v141, v141, v149
    v_mfma_f32_16x16x32_bf16 v[108:111], v[80:83], a[176:179], v[108:111]
    s_waitcnt lgkmcnt(4)
    ds_read_b128 v[80:83], v46 offset:8192
    v_add_f32 v142, v142, v150
    v_mfma_f32_16x16x32_bf16 v[100:103], a[180:183], v[84:87], v[100:103]
    v_permlane32_swap_b32 v124, v140
    v_mfma_f32_16x16x32_bf16 v[104:107], a[184:187], v[84:87], v[104:107]
    v_permlane32_swap_b32 v125, v141
    v_mfma_f32_16x16x32_bf16 v[108:111], v[84:87], a[188:191], v[108:111]
    s_waitcnt lgkmcnt(4)
    ds_read_b128 v[84:87], v46 offset:9216
    v_mfma_f32_16x16x32_bf16 v[100:103], a[192:195], v[88:91], v[100:103]
    v_permlane32_swap_b32 v126, v142
    v_mfma_f32_16x16x32_bf16 v[104:107], a[196:199], v[88:91], v[104:107]
    v_add_f32 v124, v124, v140
    v_add_f32 v125, v125, v141
    v_mfma_f32_16x16x32_bf16 v[108:111], v[88:91], a[200:203], v[108:111]
    s_waitcnt lgkmcnt(4)
    ds_read_b128 v[88:91], v46 offset:10240
    v_add_f32 v126, v126, v142
    v_mfma_f32_16x16x32_bf16 v[100:103], a[204:207], v[92:95], v[100:103]
    s_waitcnt vmcnt(2)
    v_cmp_ne_u32 s[74:75], s79, v131
    v_cmp_ne_u32 s[92:93], s79, v135
    v_cmp_ne_u32 vcc, s79, v139
    v_mfma_f32_16x16x32_bf16 v[104:107], a[208:211], v[92:95], v[104:107]
    s_or_b64 s[74:75], s[74:75], s[92:93]
    s_and_b32 s92, vcc_lo, 0xffff
    s_or_b32 s74, s74, s75
    s_or_b32 s74, s74, s92
    s_cbranch_scc1 Lre219
Lok217:
    v_mfma_f32_16x16x32_bf16 v[108:111], v[92:95], a[212:215], v[108:111]
    s_waitcnt lgkmcnt(4)
    ds_read_b128 v[92:95], v46 offset:11264
    v_add_f32 v128, v128, v132
    v_add_f32 v129, v129, v133
    v_add_f32_e64 v130, v130, v134
    v_mfma_f32_16x16x32_bf16 v[112:115], a[0:3], v[72:75], 0
    v_add_f32 v128, v128, v136
    v_add_f32 v129, v129, v137
    v_add_f32 v130, v130, v138
    v_mov_b32 v132, v128
    v_mfma_f32_16x16x32_bf16 v[116:119], a[4:7], v[72:75], 0
    v_mov_b32 v133, v129
    v_mov_b32 v134, v130
    v_permlane32_swap_b32 v128, v132
    v_mfma_f32_16x16x32_bf16 v[120:123], v[72:75], a[8:11], 0
    s_waitcnt vmcnt(0) lgkmcnt(4)
    ds_read_b128 v[72:75], v46 offset:18432
    v_cmp_ne_u32 s[34:35], s46, v33
    v_permlane32_swap_b32 v129, v133
    v_mfma_f32_16x16x32_bf16 v[112:115], a[12:15], v[76:79], v[112:115]
    v_permlane32_swap_b32 v130, v134
    v_add_f32 v128, v128, v132
    v_add_f32 v129, v129, v133
    v_mfma_f32_16x16x32_bf16 v[116:119], a[16:19], v[76:79], v[116:119]
    v_add_f32 v130, v130, v134
    v_permlane16_swap_b32 v124, v128
    v_mfma_f32_16x16x32_bf16 v[120:123], v[76:79], a[20:23], v[120:123]
    s_waitcnt lgkmcnt(4)
    ds_read_b128 v[76:79], v46 offset:19456
    v_permlane16_swap_b32 v125, v129
    v_mfma_f32_16x16x32_bf16 v[112:115], a[24:27], v[80:83], v[112:115]
    s_cmp_lg_u64 s[34:35], 0
    s_cbranch_scc1 Lre198
Lok196:
    buffer_inv sc1
    s_waitcnt vmcnt(0)
    v_mfma_f32_16x16x32_bf16 v[116:119], a[28:31], v[80:83], v[116:119]
    s_cmp_eq_u32 s44, 0
    s_cselect_b32 s76, 0, -1
    s_and_b32 s94, s76, 262144
    s_sub_u32 s94, s47, s94
    s_add_u32 s78, s87, s47
    v_mfma_f32_16x16x32_bf16 v[120:123], v[80:83], a[32:35], v[120:123]
    s_waitcnt lgkmcnt(4)
    ds_read_b128 v[80:83], v46 offset:20480
    s_cmp_eq_u32 s53, 0
    s_cselect_b32 s77, s76, 0
    s_and_b32 s77, s77, 76800
    v_mfma_f32_16x16x32_bf16 v[112:115], a[36:39], v[84:87], v[112:115]
    v_add_u32_e64 v71, s77, v46
    s_add_u32 m0, s87, 36864
    s_add_u32 s78, s78, 66560
    v_mov_b32_dpp v71, v46 quad_perm:[0,1,2,3] row_mask:0xf bank_mask:0xc
    v_mfma_f32_16x16x32_bf16 v[116:119], a[40:43], v[84:87], v[116:119]
    buffer_store_dword v68, v57, s[16:19], s47 offen offset:1280 sc1
    buffer_load_dwordx4 v46, s[16:19], s78 offen offset:0 sc1 lds
    v_mfma_f32_16x16x32_bf16 v[120:123], v[84:87], a[44:47], v[120:123]
    s_waitcnt lgkmcnt(4)
    ds_read_b128 v[84:87], v46 offset:21504
    buffer_load_dwordx4 v46, s[16:19], s78 offen offset:1024 sc1 lds
    v_mfma_f32_16x16x32_bf16 v[112:115], a[48:51], v[88:91], v[112:115]
    v_permlane16_swap_b32 v126, v130
    v_add_f32 v124, v124, v128
    v_add_f32 v125, v125, v129
    v_mfma_f32_16x16x32_bf16 v[116:119], a[52:55], v[88:91], v[116:119]
    v_add_f32_e64 v126, v126, v130
    v_add_f32_dpp v124, v124, v124 row_ror:8 row_mask:0xf bank_mask:0xf
    v_add_f32_dpp v125, v125, v125 row_ror:8 row_mask:0xf bank_mask:0xf
    v_add_f32_dpp v126, v126, v126 row_ror:8 row_mask:0xf bank_mask:0xf
    v_mfma_f32_16x16x32_bf16 v[120:123], v[88:91], a[56:59], v[120:123]
    s_waitcnt lgkmcnt(4)
    ds_read_b128 v[88:91], v46 offset:22528
    buffer_load_dwordx4 v46, s[16:19], s78 offen offset:2048 sc1 lds
    v_mul_f32 v124, 0xbae38e39, v124
    v_mfma_f32_16x16x32_bf16 v[112:115], a[60:63], v[92:95], v[112:115]
    s_add_u32 s78, s87, s47
    s_add_u32 m0, s87, 49152
    s_add_u32 s78, s78, 78848
    v_mul_f32 v126, 0x3ae38e39, v126
    v_fma_f32 v126, -v124, v124, v126
    v_mfma_f32_16x16x32_bf16 v[116:119], a[64:67], v[92:95], v[116:119]
    v_max_f32 v126, 0, v126
    v_add_f32 v132, 0x3727c5ac, v126
    v_rsq_f32 v132, v132
    v_mfma_f32_16x16x32_bf16 v[120:123], v[92:95], a[68:71], v[120:123]
    s_waitcnt lgkmcnt(4)
    ds_read_b128 v[92:95], v46 offset:23552
    buffer_load_dwordx4 v46, s[16:19], s78 offen offset:0 sc1 lds
    v_fmac_f32 v125, s50, v124
    v_mfma_f32_16x16x32_bf16 v[112:115], a[72:75], v[72:75], v[112:115]
    v_mov_b32 v127, 162816
    v_mul_f32 v125, v125, v132
    v_mul_f32 v133, v124, v132
    v_ashrrev_i32 v134, 31, v125
    v_mfma_f32_16x16x32_bf16 v[116:119], a[76:79], v[72:75], v[116:119]
    v_or_b32 v134, 0x80000000, v134
    v_xor_b32 v125, v125, v134
    v_and_b32 v125, 0xfffff800, v125
    v_or_b32 v125, v125, v67
    v_mfma_f32_16x16x32_bf16 v[120:123], v[72:75], a[80:83], v[120:123]
    s_waitcnt lgkmcnt(4)
    ds_read_b128 v[72:75], v46 offset:30720
    buffer_load_dwordx4 v46, s[16:19], s78 offen offset:1024 sc1 lds
    v_cndmask_b32 v125, 0, v125, s[88:89]
    v_mfma_f32_16x16x32_bf16 v[112:115], a[84:87], v[76:79], v[112:115]
    buffer_load_dword v33, v59, s[16:19], s47 offen offset:1280 sc1
    buffer_load_dword v34, v59, s[16:19], s94 offen offset:1120 sc1
    ds_write_b32 v66, v132 offset:768
    v_mfma_f32_16x16x32_bf16 v[116:119], a[88:91], v[76:79], v[116:119]
    ds_write_b32 v66, v133 offset:1152
    v_max_u32_dpp v125, v125, v125 row_ror:1 row_mask:0xf bank_mask:0xf
    v_add_f32 v134, 1.0, v132
    v_mfma_f32_16x16x32_bf16 v[120:123], v[76:79], a[92:95], v[120:123]
    s_waitcnt lgkmcnt(6)
    ds_read_b128 v[76:79], v46 offset:31744
    v_mul_f32 v126, v126, v134
    v_mfma_f32_16x16x32_bf16 v[112:115], a[96:99], v[80:83], v[112:115]
    buffer_load_dwordx4 v46, s[16:19], s78 offen offset:2048 sc1 lds
    s_add_u32 s78, s87, s47
    s_add_u32 m0, s87, 61440
    s_add_u32 s78, s78, 91136
    v_mfma_f32_16x16x32_bf16 v[116:119], a[100:103], v[80:83], v[116:119]
    v_max_u32_dpp v125, v125, v125 row_ror:2 row_mask:0xf bank_mask:0xf
    v_fmaak_f32 v126, v126, v134, 0x3727c5ac
    v_rsq_f32 v126, v126
    v_mfma_f32_16x16x32_bf16 v[120:123], v[80:83], a[104:107], v[120:123]
    s_waitcnt lgkmcnt(6)
    ds_read_b128 v[80:83], v46 offset:32768
    v_max_u32_dpp v125, v125, v125 row_ror:4 row_mask:0xf bank_mask:0xf
    v_mfma_f32_16x16x32_bf16 v[112:115], a[108:111], v[84:87], v[112:115]
    buffer_load_dwordx4 v46, s[16:19], s78 offen offset:0 sc1 lds
    v_mfma_f32_16x16x32_bf16 v[116:119], a[112:115], v[84:87], v[116:119]
    s_mov_b32 exec_lo, 0x10001
    s_mov_b32 exec_hi, 1
    ds_max_u32 v127, v125
    s_mov_b64 exec, -1
    v_mfma_f32_16x16x32_bf16 v[120:123], v[84:87], a[116:119], v[120:123]
    s_waitcnt lgkmcnt(7)
    ds_read_b128 v[84:87], v46 offset:33792
    v_mul_f32 v134, v134, v126
    v_mfma_f32_16x16x32_bf16 v[112:115], a[120:123], v[88:91], v[112:115]
    ds_write2_b32 v66, v134, v124 offset1:96
    s_lshl_b32 s81, s53, 6
    v_mfma_f32_16x16x32_bf16 v[116:119], a[124:127], v[88:91], v[116:119]
    buffer_load_dwordx4 v46, s[16:19], s78 offen offset:1024 sc1 lds
    s_add_u32 s81, s81, 768
    v_add_u32 v99, s81, v49
    v_mov_b32 v135, v124
    v_mfma_f32_16x16x32_bf16 v[120:123], v[88:91], a[128:131], v[120:123]
    s_waitcnt lgkmcnt(8)
    ds_read_b128 v[88:91], v46 offset:34816
    v_mov_b32_e64 v136, s79
    s_add_u32 s81, s47, 479232
    v_mfma_f32_16x16x32_bf16 v[112:115], a[132:135], v[92:95], v[112:115]
    s_cmp_eq_u32 s57, 1073741824
    s_cselect_b32 s82, 0, s52
    s_mul_i32 s82, s82, 255
    v_mfma_f32_16x16x32_bf16 v[116:119], a[136:139], v[92:95], v[116:119]
    s_waitcnt vmcnt(4)
    v_cmp_ne_u32 s[34:35], s46, v33
    buffer_load_dwordx4 v46, s[16:19], s78 offen offset:2048 sc1 lds
    v_mfma_f32_16x16x32_bf16 v[120:123], v[92:95], a[140:143], v[120:123]
    s_waitcnt lgkmcnt(8)
    ds_read_b128 v[92:95], v46 offset:35840
    v_mfma_f32_16x16x32_bf16 v[112:115], a[144:147], v[72:75], v[112:115]
    s_mov_b32 exec_lo, s82
    s_mov_b32 exec_hi, 0
    buffer_store_dwordx3 v[134:136], v46, s[16:19], s81 offen sc1
    s_mov_b64 exec, -1
    s_waitcnt lgkmcnt(2)
    s_barrier
    v_mfma_f32_16x16x32_bf16 v[116:119], a[148:151], v[72:75], v[116:119]
    s_cmp_lg_u64 s[34:35], 0
    s_cbranch_scc1 Lre205
Lok203:
    buffer_inv sc1
    s_waitcnt vmcnt(0)
    v_mfma_f32_16x16x32_bf16 v[120:123], v[72:75], a[152:155], v[120:123]
    ds_read_b32 v98, v127
    ds_read2_b32 v[124:125], v99 offset0:64 offset1:160
    v_cmp_ne_u32 s[34:35], s46, v34
    v_mfma_f32_16x16x32_bf16 v[112:115], a[156:159], v[76:79], v[112:115]
    ds_read2_b32 v[126:127], v99 offset0:32 offset1:128
    ds_read2_b32 v[128:129], v99 offset0:0 offset1:96
    s_mul_i32 s82, s42, 512
    v_mfma_f32_16x16x32_bf16 v[116:119], a[160:163], v[76:79], v[116:119]
    s_add_u32 s82, s82, 786432
    s_or_b32 s81, s41, s40
    s_cselect_b32 s82, 1073741824, s82
    v_mov_b32_e64 v99, s46
    v_mfma_f32_16x16x32_bf16 v[120:123], v[76:79], a[164:167], v[120:123]
    s_waitcnt lgkmcnt(3)
    s_mov_b64 exec, 1
    buffer_store_dwordx2 v[98:99], v46, s[16:19], s82 offen sc1
    s_mov_b64 exec, -1
    v_readfirstlane_b32 s54, v98
    v_mfma_f32_16x16x32_bf16 v[112:115], a[168:171], v[80:83], v[112:115]
    s_cmp_lg_u64 s[34:35], 0
    s_cbranch_scc1 Lre209
Lok207:
    buffer_inv sc1
    s_waitcnt vmcnt(0)
    v_mfma_f32_16x16x32_bf16 v[116:119], a[172:175], v[80:83], v[116:119]
    s_mul_i32 s80, s42, 2304
    s_add_u32 s80, s80, 40960
    s_and_b32 s55, s54, 0x7ff
    s_sub_u32 s55, s86, s55
    s_lshr_b32 s55, s55, 1
    v_mfma_f32_16x16x32_bf16 v[120:123], v[80:83], a[176:179], v[120:123]
    s_waitcnt lgkmcnt(0)
    s_bfe_u32 s82, s55, 0x10004
    v_mov_b32 v130, v128
    s_cmp_eq_u32 s82, s53
    s_cbranch_scc0 Lnc220
    s_and_b32 s81, s55, 15
    s_lshl_b32 s74, 0x10001, s81
    s_mov_b32 s75, s74
    s_and_b32 s81, s81, 14
    s_lshl_b32 s92, 0x30003, s81
    s_mov_b32 s93, s92
    s_lshr_b32 s81, s55, 5
    s_cmp_eq_u32 s81, 1
    s_cbranch_scc1 Lsa221
    s_cmp_eq_u32 s81, 0
    s_cbranch_scc1 Lsb222
    v_fma_f32 v130, v0, v124, v125
    v_fma_f32 v131, v1, v124, v125
    v_fma_f32 v132, v2, v124, v125
    v_fma_f32 v133, v3, v124, v125
    v_fma_f32 v134, v4, v124, v125
    v_fma_f32 v135, v5, v124, v125
    v_fma_f32 v136, v6, v124, v125
    v_fma_f32 v137, v7, v124, v125
    s_branch Lsj223
Lsa221:
    v_fma_f32 v130, v8, v126, v127
    v_fma_f32 v131, v9, v126, v127
    v_fma_f32 v132, v10, v126, v127
    v_fma_f32 v133, v11, v126, v127
    v_fma_f32 v134, v12, v126, v127
    v_fma_f32 v135, v13, v126, v127
    v_fma_f32 v136, v14, v126, v127
    v_fma_f32 v137, v15, v126, v127
    s_branch Lsj223
Lsb222:
    v_fma_f32 v130, v16, v128, v129
    v_fma_f32 v131, v17, v128, v129
    v_fma_f32 v132, v18, v128, v129
    v_fma_f32 v133, v19, v128, v129
    v_fma_f32 v134, v20, v128, v129
    v_fma_f32 v135, v21, v128, v129
    v_fma_f32 v136, v22, v128, v129
    v_fma_f32 v137, v23, v128, v129
Lsj223:
    v_cvt_pk_bf16_f32 v130, v130, v131
    v_cvt_pk_bf16_f32 v131, v132, v133
    v_cvt_pk_bf16_f32 v132, v134, v135
    v_cvt_pk_bf16_f32 v133, v136, v137
    s_mov_b64 vcc, s[74:75]
    s_lshl1_add_u32 s82, s41, s52
    s_lshl_b32 s82, s82, 7
    s_add_u32 s82, s82, s80
    v_or_b32 v134, 16, v65
    v_cndmask_b32 v134, v134, v65, vcc
    v_cndmask_b32_dpp v130, v132, v130, vcc quad_perm:[1,0,3,2] row_mask:0xf bank_mask:0xf
    v_cndmask_b32_dpp v131, v133, v131, vcc quad_perm:[1,0,3,2] row_mask:0xf bank_mask:0xf
    v_mov_b32_e64 v132, s54
    v_mov_b32 v133, s46
    s_mov_b64 exec, s[92:93]
    buffer_store_dwordx4 v[130:133], v134, s[16:19], s82 offen sc1
    s_mov_b64 exec, -1
Lnc220:
    v_mfma_f32_16x16x32_bf16 v[112:115], a[180:183], v[84:87], v[112:115]
    s_barrier
    ds_read_b128 v[72:75], v96 offset:6144
    v_mfma_f32_16x16x32_bf16 v[116:119], a[184:187], v[84:87], v[116:119]
    ds_read_b128 v[76:79], v96 offset:7168
    v_add_f32_e64 v124, 1.0, v124
    v_mfma_f32_16x16x32_bf16 v[120:123], v[84:87], a[188:191], v[120:123]
    ds_read_b128 v[80:83], v96 offset:8192
    v_fma_f32 v0, v0, v124, v125
    v_mfma_f32_16x16x32_bf16 v[112:115], a[192:195], v[88:91], v[112:115]
    ds_read_b128 v[84:87], v96 offset:9216
    v_fma_f32 v1, v1, v124, v125
    v_mfma_f32_16x16x32_bf16 v[116:119], a[196:199], v[88:91], v[116:119]
    v_fma_f32 v2, v2, v124, v125
    v_fma_f32 v3, v3, v124, v125
    v_mfma_f32_16x16x32_bf16 v[120:123], v[88:91], a[200:203], v[120:123]
    ds_read_b128 v[88:91], v96 offset:10240
    v_fma_f32 v4, v4, v124, v125
    v_mfma_f32_16x16x32_bf16 v[112:115], a[204:207], v[92:95], v[112:115]
    v_fma_f32 v5, v5, v124, v125
    v_fma_f32 v6, v6, v124, v125
    v_mfma_f32_16x16x32_bf16 v[116:119], a[208:211], v[92:95], v[116:119]
    v_fma_f32 v7, v7, v124, v125
    v_mfma_f32_16x16x32_bf16 v[120:123], v[92:95], a[212:215], v[120:123]
    s_waitcnt lgkmcnt(4)
    ds_read_b128 v[92:95], v96 offset:11264
    v_mfma_f32_16x16x32_bf16 v[140:143], a[0:3], v[72:75], 0
    s_nop 0
    ds_read2_b32 v[124:125], v49 offset0:64 offset1:160
    v_mfma_f32_16x16x32_bf16 v[144:147], a[4:7], v[72:75], 0
    ds_read_b128 v[126:129], v50 offset:256
    v_mfma_f32_16x16x32_bf16 v[148:151], v[72:75], a[8:11], 0
    s_waitcnt lgkmcnt(1)
    ds_read_b128 v[130:133], v50 offset:640
    v_fmac_f32 v100, v125, v24
    v_mfma_f32_16x16x32_bf16 v[140:143], a[12:15], v[76:79], v[140:143]
    v_fmac_f32 v101, v125, v25
    v_fmac_f32 v102, v125, v26
    v_mfma_f32_16x16x32_bf16 v[144:147], a[16:19], v[76:79], v[144:147]
    v_fmac_f32 v103, v125, v27
    v_mul_f32 v100, v124, v100
    v_mfma_f32_16x16x32_bf16 v[148:151], v[76:79], a[20:23], v[148:151]
    v_mul_f32 v101, v124, v101
    v_mul_f32 v102, v124, v102
    v_mfma_f32_16x16x32_bf16 v[140:143], a[24:27], v[80:83], v[140:143]
    v_mul_f32_e64 v103, v124, v103
    v_cvt_pk_bf16_f32 v134, v100, v101
    v_mfma_f32_16x16x32_bf16 v[144:147], a[28:31], v[80:83], v[144:147]
    v_cvt_pk_bf16_f32 v135, v102, v103
    v_mfma_f32_16x16x32_bf16 v[148:151], v[80:83], a[32:35], v[148:151]
    ds_write_b64 v47, v[134:135] offset:10752
    v_mfma_f32_16x16x32_bf16 v[140:143], a[36:39], v[84:87], v[140:143]
    s_barrier
    ds_read_b128 v[72:75], v96 offset:18432
    v_mfma_f32_16x16x32_bf16 v[144:147], a[40:43], v[84:87], v[144:147]
    ds_read_b128 v[76:79], v96 offset:19456
    v_fmac_f32 v104, v125, v28
    v_mfma_f32_16x16x32_bf16 v[148:151], v[84:87], a[44:47], v[148:151]
    ds_read_b128 v[80:83], v96 offset:20480
    v_fmac_f32 v105, v125, v29
    v_mfma_f32_16x16x32_bf16 v[140:143], a[48:51], v[88:91], v[140:143]
    ds_read_b128 v[84:87], v96 offset:21504
    v_fmac_f32 v106, v125, v30
    v_mfma_f32_16x16x32_bf16 v[144:147], a[52:55], v[88:91], v[144:147]
    v_fmac_f32 v107, v125, v31
    v_mul_f32 v104, v124, v104
    v_mfma_f32_16x16x32_bf16 v[148:151], v[88:91], a[56:59], v[148:151]
    ds_read_b128 v[88:91], v96 offset:22528
    v_mul_f32 v105, v124, v105
    v_mfma_f32_16x16x32_bf16 v[140:143], a[60:63], v[92:95], v[140:143]
    v_mul_f32 v106, v124, v106
    v_mul_f32 v107, v124, v107
    v_mfma_f32_16x16x32_bf16 v[144:147], a[64:67], v[92:95], v[144:147]
    v_cvt_pk_bf16_f32 v136, v104, v105
    v_cvt_pk_bf16_f32 v137, v106, v107
    v_mfma_f32_16x16x32_bf16 v[148:151], v[92:95], a[68:71], v[148:151]
    s_waitcnt lgkmcnt(4)
    ds_read_b128 v[92:95], v96 offset:23552
    v_mfma_f32_16x16x32_bf16 v[140:143], a[72:75], v[72:75], v[140:143]
    ds_write_b64 v47, v[136:137] offset:26880
    v_mfma_f32_16x16x32_bf16 v[144:147], a[76:79], v[72:75], v[144:147]
    v_fmac_f32 v108, v130, v35
    v_fmac_f32 v109, v131, v35
    v_mfma_f32_16x16x32_bf16 v[148:151], v[72:75], a[80:83], v[148:151]
    s_waitcnt lgkmcnt(5)
    v_fmac_f32 v110, v132, v35
    v_fmac_f32 v111, v133, v35
    v_mfma_f32_16x16x32_bf16 v[140:143], a[84:87], v[76:79], v[140:143]
    v_mul_f32 v108, v126, v108
    v_mul_f32 v109, v127, v109
    v_mfma_f32_16x16x32_bf16 v[144:147], a[88:91], v[76:79], v[144:147]
    v_mul_f32 v110, v128, v110
    v_mul_f32 v111, v129, v111
    v_mfma_f32_16x16x32_bf16 v[148:151], v[76:79], a[92:95], v[148:151]
    s_waitcnt lgkmcnt(4)
    v_cvt_pk_bf16_f32 v138, v108, v109
    v_cvt_pk_bf16_f32 v139, v110, v111
    v_mfma_f32_16x16x32_bf16 v[140:143], a[96:99], v[80:83], v[140:143]
    ds_write_b64 v48, v[138:139] offset:32
    v_mfma_f32_16x16x32_bf16 v[144:147], a[100:103], v[80:83], v[144:147]
    ds_read2_b32 v[124:125], v49 offset0:80 offset1:176
    v_mfma_f32_16x16x32_bf16 v[148:151], v[80:83], a[104:107], v[148:151]
    s_waitcnt lgkmcnt(5)
    ds_read_b128 v[126:129], v50 offset:320
    v_mfma_f32_16x16x32_bf16 v[140:143], a[108:111], v[84:87], v[140:143]
    s_barrier
    ds_read_b128 v[130:133], v50 offset:704
    v_mfma_f32_16x16x32_bf16 v[144:147], a[112:115], v[84:87], v[144:147]
    buffer_store_dword v68, v57, s[16:19], s47 offen offset:1440 sc1
    ds_read_b128 v[72:75], v96 offset:30720
    v_mfma_f32_16x16x32_bf16 v[148:151], v[84:87], a[116:119], v[148:151]
    s_waitcnt lgkmcnt(3)
    ds_read_b128 v[76:79], v96 offset:31744
    v_fmac_f32 v112, v125, v24
    v_mfma_f32_16x16x32_bf16 v[140:143], a[120:123], v[88:91], v[140:143]
    ds_read_b128 v[80:83], v96 offset:32768
    v_fmac_f32 v113, v125, v25
    v_mfma_f32_16x16x32_bf16 v[144:147], a[124:127], v[88:91], v[144:147]
    ds_read_b128 v[84:87], v96 offset:33792
    v_fmac_f32 v114, v125, v26
    v_mfma_f32_16x16x32_bf16 v[148:151], v[88:91], a[128:131], v[148:151]
    ds_read_b128 v[88:91], v96 offset:34816
    v_fmac_f32 v115, v125, v27
    v_mfma_f32_16x16x32_bf16 v[140:143], a[132:135], v[92:95], v[140:143]
    v_mul_f32 v112, v124, v112
    v_mul_f32 v113, v124, v113
    v_mfma_f32_16x16x32_bf16 v[144:147], a[136:139], v[92:95], v[144:147]
    v_mul_f32 v114, v124, v114
    v_mul_f32 v115, v124, v115
    v_mfma_f32_16x16x32_bf16 v[148:151], v[92:95], a[140:143], v[148:151]
    s_waitcnt lgkmcnt(4)
    ds_read_b128 v[92:95], v96 offset:35840
    v_cvt_pk_bf16_f32 v112, v112, v113
    v_mfma_f32_16x16x32_bf16 v[140:143], a[144:147], v[72:75], v[140:143]
    v_cvt_pk_bf16_f32 v113, v114, v115
    v_mfma_f32_16x16x32_bf16 v[144:147], a[148:151], v[72:75], v[144:147]
    ds_write_b64 v47, v[112:113] offset:13440
    v_mfma_f32_16x16x32_bf16 v[148:151], v[72:75], a[152:155], v[148:151]
    s_waitcnt lgkmcnt(5)
    ds_read_b128 v[72:75], v96 offset:0
    v_fmac_f32 v116, v125, v28
    v_mfma_f32_16x16x32_bf16 v[140:143], a[156:159], v[76:79], v[140:143]
    v_fmac_f32 v117, v125, v29
    v_fmac_f32 v118, v125, v30
    v_mfma_f32_16x16x32_bf16 v[144:147], a[160:163], v[76:79], v[144:147]
    v_fmac_f32 v119, v125, v31
    v_mul_f32 v116, v124, v116
    v_mfma_f32_16x16x32_bf16 v[148:151], v[76:79], a[164:167], v[148:151]
    s_waitcnt lgkmcnt(5)
    ds_read_b128 v[76:79], v96 offset:1024
    v_mul_f32 v117, v124, v117
    v_mfma_f32_16x16x32_bf16 v[140:143], a[168:171], v[80:83], v[140:143]
    v_mul_f32_e64 v118, v124, v118
    v_mul_f32 v119, v124, v119
    v_mfma_f32_16x16x32_bf16 v[144:147], a[172:175], v[80:83], v[144:147]
    v_cvt_pk_bf16_f32 v114, v116, v117
    v_cvt_pk_bf16_f32 v115, v118, v119
    v_mfma_f32_16x16x32_bf16 v[148:151], v[80:83], a[176:179], v[148:151]
    s_waitcnt lgkmcnt(5)
    ds_read_b128 v[80:83], v96 offset:2048
    v_mfma_f32_16x16x32_bf16 v[140:143], a[180:183], v[84:87], v[140:143]
    buffer_load_dword v33, v59, s[16:19], s47 offen offset:1440 sc1
    v_mfma_f32_16x16x32_bf16 v[144:147], a[184:187], v[84:87], v[144:147]
    ds_write_b64 v47, v[114:115] offset:29568
    v_mfma_f32_16x16x32_bf16 v[148:151], v[84:87], a[188:191], v[148:151]
    s_waitcnt lgkmcnt(6)
    ds_read_b128 v[84:87], v96 offset:3072
    v_fmac_f32 v120, v130, v35
    v_mfma_f32_16x16x32_bf16 v[140:143], a[192:195], v[88:91], v[140:143]
    v_fmac_f32 v121, v131, v35
    v_fmac_f32 v122, v132, v35
    v_mfma_f32_16x16x32_bf16 v[144:147], a[196:199], v[88:91], v[144:147]
    v_fmac_f32 v123, v133, v35
    v_mul_f32 v120, v126, v120
    v_mfma_f32_16x16x32_bf16 v[148:151], v[88:91], a[200:203], v[148:151]
    s_waitcnt lgkmcnt(6)
    ds_read_b128 v[88:91], v96 offset:4096
    s_add_u32 s78, s87, s47
    v_mfma_f32_16x16x32_bf16 v[140:143], a[204:207], v[92:95], v[140:143]
    s_add_u32 m0, s87, 73728
    s_add_u32 s78, s78, 103424
    v_mul_f32_e64 v121, v127, v121
    v_mfma_f32_16x16x32_bf16 v[144:147], a[208:211], v[92:95], v[144:147]
    buffer_load_dwordx4 v71, s[16:19], s78 offen offset:0 sc1 lds
    buffer_load_dwordx4 v71, s[16:19], s78 offen offset:1024 sc1 lds
    v_mfma_f32_16x16x32_bf16 v[148:151], v[92:95], a[212:215], v[148:151]
    s_waitcnt lgkmcnt(5)
    ds_read_b128 v[92:95], v96 offset:5120
    v_mul_f32 v122, v128, v122
    v_mfma_f32_16x16x32_bf16 v[100:103], a[0:3], v[72:75], 0
    v_mul_f32_e64 v123, v129, v123
    v_cvt_pk_bf16_f32 v116, v120, v121
    v_mfma_f32_16x16x32_bf16 v[104:107], a[4:7], v[72:75], 0
    v_cvt_pk_bf16_f32 v117, v122, v123
    v_mfma_f32_16x16x32_bf16 v[108:111], v[72:75], a[8:11], 0
    s_waitcnt lgkmcnt(5)
    ds_read_b128 v[72:75], v96 offset:12288
    v_mfma_f32_16x16x32_bf16 v[100:103], a[12:15], v[76:79], v[100:103]
    buffer_load_dwordx4 v71, s[16:19], s78 offen offset:2048 sc1 lds
    s_add_u32 s78, s87, s47
    v_mfma_f32_16x16x32_bf16 v[104:107], a[16:19], v[76:79], v[104:107]
    s_add_u32 m0, s87, 86016
    s_add_u32 s78, s78, 115712
    v_mfma_f32_16x16x32_bf16 v[108:111], v[76:79], a[20:23], v[108:111]
    s_waitcnt lgkmcnt(5)
    ds_read_b128 v[76:79], v96 offset:13312
    v_mfma_f32_16x16x32_bf16 v[100:103], a[24:27], v[80:83], v[100:103]
    buffer_load_dwordx4 v71, s[16:19], s78 offen offset:0 sc1 lds
    v_mfma_f32_16x16x32_bf16 v[104:107], a[28:31], v[80:83], v[104:107]
    ds_write_b64 v48, v[116:117] offset:40
    v_mfma_f32_16x16x32_bf16 v[108:111], v[80:83], a[32:35], v[108:111]
    s_waitcnt vmcnt(4) lgkmcnt(5)
    ds_read_b128 v[80:83], v96 offset:14336
    v_cmp_ne_u32 s[34:35], s46, v33
    v_mfma_f32_16x16x32_bf16 v[100:103], a[36:39], v[84:87], v[100:103]
    v_mfma_f32_16x16x32_bf16 v[104:107], a[40:43], v[84:87], v[104:107]
    buffer_load_dwordx4 v71, s[16:19], s78 offen offset:1024 sc1 lds
    v_mfma_f32_16x16x32_bf16 v[108:111], v[84:87], a[44:47], v[108:111]
    s_waitcnt lgkmcnt(5)
    ds_read_b128 v[84:87], v96 offset:15360
    v_mfma_f32_16x16x32_bf16 v[100:103], a[48:51], v[88:91], v[100:103]
    s_cmp_lg_u64 s[34:35], 0
    s_cbranch_scc1 Lre236
Lok234:
    buffer_inv sc1
    s_waitcnt vmcnt(0)
    v_mfma_f32_16x16x32_bf16 v[104:107], a[52:55], v[88:91], v[104:107]
    v_permlane32_swap_b32 v112, v114
    v_mfma_f32_16x16x32_bf16 v[108:111], v[88:91], a[56:59], v[108:111]
    s_waitcnt lgkmcnt(5)
    ds_read_b128 v[88:91], v96 offset:16384
    v_mfma_f32_16x16x32_bf16 v[100:103], a[60:63], v[92:95], v[100:103]
    buffer_load_dwordx4 v71, s[16:19], s78 offen offset:2048 sc1 lds
    s_add_u32 s78, s87, s47
    v_mfma_f32_16x16x32_bf16 v[104:107], a[64:67], v[92:95], v[104:107]
    s_add_u32 m0, s87, 98304
    s_add_u32 s78, s78, 128000
    v_mfma_f32_16x16x32_bf16 v[108:111], v[92:95], a[68:71], v[108:111]
    s_waitcnt lgkmcnt(5)
    ds_read_b128 v[92:95], v96 offset:17408
    v_mfma_f32_16x16x32_bf16 v[100:103], a[72:75], v[72:75], v[100:103]
    buffer_load_dwordx4 v71, s[16:19], s78 offen offset:0 sc1 lds
    v_mfma_f32_16x16x32_bf16 v[104:107], a[76:79], v[72:75], v[104:107]
    v_permlane32_swap_b32 v113, v115
    v_mfma_f32_16x16x32_bf16 v[108:111], v[72:75], a[80:83], v[108:111]
    s_waitcnt lgkmcnt(5)
    ds_read_b128 v[72:75], v96 offset:24576
    v_mov_b32_dpp v117, v117 row_ror:8 row_mask:0xf bank_mask:0xf
    v_mfma_f32_16x16x32_bf16 v[100:103], a[84:87], v[76:79], v[100:103]
    v_cndmask_b32 v112, v112, v114, s[28:29]
    v_cndmask_b32 v113, v113, v115, s[28:29]
    v_mfma_f32_16x16x32_bf16 v[104:107], a[88:91], v[76:79], v[104:107]
    buffer_load_dwordx4 v71, s[16:19], s78 offen offset:1024 sc1 lds
    v_cndmask_b32 v114, v116, v117, s[30:31]
    v_mfma_f32_16x16x32_bf16 v[108:111], v[76:79], a[92:95], v[108:111]
    s_waitcnt lgkmcnt(4)
    ds_read_b128 v[76:79], v96 offset:25600
    v_mov_b32 v115, s33
    v_mfma_f32_16x16x32_bf16 v[100:103], a[96:99], v[80:83], v[100:103]
    v_mfma_f32_16x16x32_bf16 v[104:107], a[100:103], v[80:83], v[104:107]
    v_mfma_f32_16x16x32_bf16 v[108:111], v[80:83], a[104:107], v[108:111]
    s_waitcnt lgkmcnt(4)
    ds_read_b128 v[80:83], v96 offset:26624
    v_mfma_f32_16x16x32_bf16 v[100:103], a[108:111], v[84:87], v[100:103]
    buffer_load_dwordx4 v71, s[16:19], s78 offen offset:2048 sc1 lds
    v_mfma_f32_16x16x32_bf16 v[104:107], a[112:115], v[84:87], v[104:107]
    v_and_b32 v71, 112, v46
    v_mfma_f32_16x16x32_bf16 v[108:111], v[84:87], a[116:119], v[108:111]
    s_waitcnt lgkmcnt(4)
    ds_read_b128 v[84:87], v96 offset:27648
    v_mfma_f32_16x16x32_bf16 v[100:103], a[120:123], v[88:91], v[100:103]
    s_bitcmp1_b32 s58, 0
    s_cbranch_scc0 Lnx224
    buffer_store_dwordx4 v[112:115], v46, s[16:19], s32 offen offset:1024 sc1
Lnx224:
    v_mfma_f32_16x16x32_bf16 v[104:107], a[124:127], v[88:91], v[104:107]
    v_permlane32_swap_b32 v134, v136
    v_mfma_f32_16x16x32_bf16 v[108:111], v[88:91], a[128:131], v[108:111]
    s_waitcnt lgkmcnt(4)
    ds_read_b128 v[88:91], v96 offset:28672
    v_mfma_f32_16x16x32_bf16 v[100:103], a[132:135], v[92:95], v[100:103]
    v_permlane32_swap_b32 v135, v137
    v_mfma_f32_16x16x32_bf16 v[104:107], a[136:139], v[92:95], v[104:107]
    v_mov_b32_dpp v139, v139 row_ror:8 row_mask:0xf bank_mask:0xf
    v_cndmask_b32 v134, v134, v136, s[28:29]
    v_mfma_f32_16x16x32_bf16 v[108:111], v[92:95], a[140:143], v[108:111]
    s_waitcnt lgkmcnt(4)
    ds_read_b128 v[92:95], v96 offset:29696
    v_cndmask_b32 v135, v135, v137, s[28:29]
    v_mfma_f32_16x16x32_bf16 v[100:103], a[144:147], v[72:75], v[100:103]
    v_cndmask_b32 v136, v138, v139, s[30:31]
    v_mov_b32 v137, s33
    v_mfma_f32_16x16x32_bf16 v[104:107], a[148:151], v[72:75], v[104:107]
    s_bitcmp1_b32 s58, 0
    s_cbranch_scc0 Lnx225
    buffer_store_dwordx4 v[134:137], v46, s[16:19], s32 offen offset:0 sc1
Lnx225:
    v_mfma_f32_16x16x32_bf16 v[108:111], v[72:75], a[152:155], v[108:111]
    s_waitcnt lgkmcnt(4)
    ds_read2_b32 v[124:125], v49 offset0:48 offset1:144
    v_mfma_f32_16x16x32_bf16 v[100:103], a[156:159], v[76:79], v[100:103]
    ds_read_b128 v[126:129], v50 offset:192
    v_mfma_f32_16x16x32_bf16 v[104:107], a[160:163], v[76:79], v[104:107]
    s_waitcnt lgkmcnt(1)
    ds_read_b128 v[130:133], v50 offset:576
    v_fmac_f32 v140, v125, v24
    v_mfma_f32_16x16x32_bf16 v[108:111], v[76:79], a[164:167], v[108:111]
    v_fmac_f32 v141, v125, v25
    v_fmac_f32 v142, v125, v26
    v_mfma_f32_16x16x32_bf16 v[100:103], a[168:171], v[80:83], v[100:103]
    v_fmac_f32 v143, v125, v27
    v_mul_f32 v140, v124, v140
    v_mfma_f32_16x16x32_bf16 v[104:107], a[172:175], v[80:83], v[104:107]
    s_add_u32 s77, s47, 217088
    buffer_load_dwordx3 v[32:34], v71, s[16:19], s77 offen sc1
    v_mfma_f32_16x16x32_bf16 v[108:111], v[80:83], a[176:179], v[108:111]
    v_mul_f32 v141, v124, v141
    v_mul_f32 v142, v124, v142
    v_mfma_f32_16x16x32_bf16 v[100:103], a[180:183], v[84:87], v[100:103]
    s_barrier
    ds_read_b128 v[72:75], v97 offset:6144
    v_mfma_f32_16x16x32_bf16 v[104:107], a[184:187], v[84:87], v[104:107]
    ds_read_b128 v[76:79], v97 offset:7168
    v_mul_f32 v143, v124, v143
    v_mfma_f32_16x16x32_bf16 v[108:111], v[84:87], a[188:191], v[108:111]
    ds_read_b128 v[80:83], v97 offset:8192
    v_cvt_pk_bf16_f32 v140, v140, v141
    v_mfma_f32_16x16x32_bf16 v[100:103], a[192:195], v[88:91], v[100:103]
    ds_read_b128 v[84:87], v97 offset:9216
    v_cvt_pk_bf16_f32 v141, v142, v143
    v_mfma_f32_16x16x32_bf16 v[104:107], a[196:199], v[88:91], v[104:107]
    ds_write_b64 v47, v[140:141] offset:8064
    v_mfma_f32_16x16x32_bf16 v[108:111], v[88:91], a[200:203], v[108:111]
    ds_read_b128 v[88:91], v97 offset:10240
    v_fmac_f32_e64 v144, v125, v28
    v_mfma_f32_16x16x32_bf16 v[100:103], a[204:207], v[92:95], v[100:103]
    v_fmac_f32 v145, v125, v29
    v_fmac_f32 v146, v125, v30
    v_mfma_f32_16x16x32_bf16 v[104:107], a[208:211], v[92:95], v[104:107]
    v_fmac_f32 v147, v125, v31
    v_mul_f32 v144, v124, v144
    v_mfma_f32_16x16x32_bf16 v[108:111], v[92:95], a[212:215], v[108:111]
    s_waitcnt lgkmcnt(5)
    ds_read_b128 v[92:95], v97 offset:11264
    v_mul_f32 v145, v124, v145
    v_mfma_f32_16x16x32_bf16 v[112:115], a[0:3], v[72:75], 0
    v_mul_f32 v146, v124, v146
    v_mul_f32 v147, v124, v147
    v_mfma_f32_16x16x32_bf16 v[116:119], a[4:7], v[72:75], 0
    v_cvt_pk_bf16_f32 v142, v144, v145
    v_cvt_pk_bf16_f32 v143, v146, v147
    v_mfma_f32_16x16x32_bf16 v[120:123], v[72:75], a[8:11], 0
    s_waitcnt lgkmcnt(5)
    ds_write_b64 v47, v[142:143] offset:24192
    v_mfma_f32_16x16x32_bf16 v[112:115], a[12:15], v[76:79], v[112:115]
    v_fmac_f32 v148, v130, v35
    v_fmac_f32_e64 v149, v131, v35
    v_mfma_f32_16x16x32_bf16 v[116:119], a[16:19], v[76:79], v[116:119]
    v_fmac_f32 v150, v132, v35
    v_fmac_f32 v151, v133, v35
    v_mfma_f32_16x16x32_bf16 v[120:123], v[76:79], a[20:23], v[120:123]
    s_waitcnt lgkmcnt(5)
    v_mul_f32 v148, v126, v148
    v_mul_f32 v149, v127, v149
    v_mfma_f32_16x16x32_bf16 v[112:115], a[24:27], v[80:83], v[112:115]
    s_waitcnt vmcnt(0)
    v_cmp_ne_u32 s[34:35], s79, v34
    v_mul_f32 v150, v128, v150
    v_mfma_f32_16x16x32_bf16 v[116:119], a[28:31], v[80:83], v[116:119]
    s_and_b32 s77, s34, s76
    s_cbranch_scc1 Lre241
Lok239:
    s_andn2_b32 s77, 1536, s76
    v_mfma_f32_16x16x32_bf16 v[120:123], v[80:83], a[32:35], v[120:123]
    s_waitcnt lgkmcnt(4)
    s_add_u32 s77, s77, 159744
    v_lshrrev_b32 v71, 2, v71
    v_mfma_f32_16x16x32_bf16 v[112:115], a[36:39], v[84:87], v[112:115]
    s_barrier
    ds_read_b128 v[72:75], v97 offset:18432
    v_mfma_f32_16x16x32_bf16 v[116:119], a[40:43], v[84:87], v[116:119]
    ds_read_b128 v[76:79], v97 offset:19456
    v_add_u32 v71, s77, v71
    v_mfma_f32_16x16x32_bf16 v[120:123], v[84:87], a[44:47], v[120:123]
    s_waitcnt lgkmcnt(4)
    ds_read_b128 v[80:83], v97 offset:20480
    v_mul_f32 v151, v129, v151
    v_mfma_f32_16x16x32_bf16 v[112:115], a[48:51], v[88:91], v[112:115]
    ds_read_b128 v[84:87], v97 offset:21504
    v_cvt_pk_bf16_f32 v144, v148, v149
    v_mfma_f32_16x16x32_bf16 v[116:119], a[52:55], v[88:91], v[116:119]
    ds_write2_b32 v71, v32, v33 offset1:96
    v_mfma_f32_16x16x32_bf16 v[120:123], v[88:91], a[56:59], v[120:123]
    s_waitcnt lgkmcnt(6)
    ds_read_b128 v[88:91], v97 offset:22528
    v_cvt_pk_bf16_f32 v145, v150, v151
    v_mfma_f32_16x16x32_bf16 v[112:115], a[60:63], v[92:95], v[112:115]
    ds_write_b64 v48, v[144:145] offset:24
    v_mfma_f32_16x16x32_bf16 v[116:119], a[64:67], v[92:95], v[116:119]
    v_permlane32_swap_b32 v140, v142
    v_mfma_f32_16x16x32_bf16 v[120:123], v[92:95], a[68:71], v[120:123]
    s_waitcnt lgkmcnt(6)
    ds_read_b128 v[92:95], v97 offset:23552
    v_mfma_f32_16x16x32_bf16 v[112:115], a[72:75], v[72:75], v[112:115]
    v_permlane32_swap_b32 v141, v143
    v_mfma_f32_16x16x32_bf16 v[116:119], a[76:79], v[72:75], v[116:119]
    v_mov_b32_dpp v145, v145 row_ror:8 row_mask:0xf bank_mask:0xf
    v_cndmask_b32 v140, v140, v142, s[28:29]
    v_mfma_f32_16x16x32_bf16 v[120:123], v[72:75], a[80:83], v[120:123]
    s_waitcnt lgkmcnt(6)
    ds_read_b128 v[72:75], v97 offset:30720
    v_cndmask_b32 v141, v141, v143, s[28:29]
    v_mfma_f32_16x16x32_bf16 v[112:115], a[84:87], v[76:79], v[112:115]
    v_cndmask_b32 v142, v144, v145, s[30:31]
    v_mov_b32 v143, s33
    v_mfma_f32_16x16x32_bf16 v[116:119], a[88:91], v[76:79], v[116:119]
    s_bitcmp1_b32 s58, 0
    s_cbranch_scc0 Lnx226
    buffer_store_dwordx4 v[140:143], v46, s[16:19], s59 offen offset:3072 sc1
Lnx226:
    v_mfma_f32_16x16x32_bf16 v[120:123], v[76:79], a[92:95], v[120:123]
    s_waitcnt lgkmcnt(6)
    ds_read_b128 v[76:79], v97 offset:31744
    v_mfma_f32_16x16x32_bf16 v[112:115], a[96:99], v[80:83], v[112:115]
    ds_read2_b32 v[124:125], v49 offset0:32 offset1:128
    v_mfma_f32_16x16x32_bf16 v[116:119], a[100:103], v[80:83], v[116:119]
    ds_read_b128 v[126:129], v50 offset:128
    v_mfma_f32_16x16x32_bf16 v[120:123], v[80:83], a[104:107], v[120:123]
    s_waitcnt lgkmcnt(8)
    ds_read_b128 v[80:83], v97 offset:32768
    v_mfma_f32_16x16x32_bf16 v[112:115], a[108:111], v[84:87], v[112:115]
    s_waitcnt lgkmcnt(2)
    ds_read_b128 v[130:133], v50 offset:512
    v_fmac_f32 v100, v125, v24
    v_mfma_f32_16x16x32_bf16 v[116:119], a[112:115], v[84:87], v[116:119]
    v_fmac_f32 v101, v125, v25
    v_fmac_f32 v102, v125, v26
    v_mfma_f32_16x16x32_bf16 v[120:123], v[84:87], a[116:119], v[120:123]
    ds_read_b128 v[84:87], v97 offset:33792
    v_fmac_f32 v103, v125, v27
    v_mfma_f32_16x16x32_bf16 v[112:115], a[120:123], v[88:91], v[112:115]
    v_mul_f32 v100, v124, v100
    v_mul_f32 v101, v124, v101
    v_mfma_f32_16x16x32_bf16 v[116:119], a[124:127], v[88:91], v[116:119]
    v_mul_f32 v102, v124, v102
    v_mul_f32 v103, v124, v103
    v_mfma_f32_16x16x32_bf16 v[120:123], v[88:91], a[128:131], v[120:123]
    ds_read_b128 v[88:91], v97 offset:34816
    v_cvt_pk_bf16_f32 v134, v100, v101
    v_mfma_f32_16x16x32_bf16 v[112:115], a[132:135], v[92:95], v[112:115]
    v_cvt_pk_bf16_f32 v135, v102, v103
    v_mfma_f32_16x16x32_bf16 v[116:119], a[136:139], v[92:95], v[116:119]
    ds_write_b64 v47, v[134:135] offset:5376
    v_mfma_f32_16x16x32_bf16 v[120:123], v[92:95], a[140:143], v[120:123]
    ds_read_b128 v[92:95], v97 offset:35840
    v_fmac_f32_e64 v104, v125, v28
    v_mfma_f32_16x16x32_bf16 v[112:115], a[144:147], v[72:75], v[112:115]
    v_fmac_f32 v105, v125, v29
    v_fmac_f32 v106, v125, v30
    v_mfma_f32_16x16x32_bf16 v[116:119], a[148:151], v[72:75], v[116:119]
    v_fmac_f32 v107, v125, v31
    v_mul_f32 v104, v124, v104
    v_mfma_f32_16x16x32_bf16 v[120:123], v[72:75], a[152:155], v[120:123]
    ds_read_b128 v[72:75], v97 offset:0
    v_mul_f32_e64 v105, v124, v105
    v_mfma_f32_16x16x32_bf16 v[112:115], a[156:159], v[76:79], v[112:115]
    v_mul_f32 v106, v124, v106
    v_mul_f32 v107, v124, v107
    v_mfma_f32_16x16x32_bf16 v[116:119], a[160:163], v[76:79], v[116:119]
    v_cvt_pk_bf16_f32 v136, v104, v105
    v_cvt_pk_bf16_f32 v137, v106, v107
    v_mfma_f32_16x16x32_bf16 v[120:123], v[76:79], a[164:167], v[120:123]
    s_waitcnt lgkmcnt(6)
    ds_read_b128 v[76:79], v97 offset:1024
    v_mfma_f32_16x16x32_bf16 v[112:115], a[168:171], v[80:83], v[112:115]
    ds_write_b64 v47, v[136:137] offset:21504
    v_mfma_f32_16x16x32_bf16 v[116:119], a[172:175], v[80:83], v[116:119]
    s_waitcnt lgkmcnt(7)
    v_fmac_f32 v108, v130, v35
    v_fmac_f32 v109, v131, v35
    v_mfma_f32_16x16x32_bf16 v[120:123], v[80:83], a[176:179], v[120:123]
    s_waitcnt lgkmcnt(6)
    ds_read_b128 v[80:83], v97 offset:2048
    v_fmac_f32 v110, v132, v35
    v_mfma_f32_16x16x32_bf16 v[112:115], a[180:183], v[84:87], v[112:115]
    v_fmac_f32 v111, v133, v35
    v_mul_f32 v108, v126, v108
    v_mfma_f32_16x16x32_bf16 v[116:119], a[184:187], v[84:87], v[116:119]
    v_mul_f32 v109, v127, v109
    v_mul_f32 v110, v128, v110
    v_mfma_f32_16x16x32_bf16 v[120:123], v[84:87], a[188:191], v[120:123]
    s_waitcnt lgkmcnt(6)
    ds_read_b128 v[84:87], v97 offset:3072
    v_mul_f32 v111, v129, v111
    v_mfma_f32_16x16x32_bf16 v[112:115], a[192:195], v[88:91], v[112:115]
    s_bitcmp1_b32 s58, 1
    s_cbranch_scc0 Lni242
    buffer_load_dwordx4 v[140:143], v46, s[16:19], s32 offen offset:0 sc1
    buffer_load_dwordx4 v[144:147], v46, s[16:19], s32 offen offset:1024 sc1
    buffer_load_dwordx4 v[148:151], v46, s[16:19], s59 offen offset:3072 sc1
Lni242:
    v_mfma_f32_16x16x32_bf16 v[116:119], a[196:199], v[88:91], v[116:119]
    v_mul_u32_u24 v32, 32, v46
    v_min_u32 v32, 11776, v32
    v_mfma_f32_16x16x32_bf16 v[120:123], v[88:91], a[200:203], v[120:123]
    s_waitcnt lgkmcnt(5)
    ds_read_b128 v[88:91], v97 offset:4096
    v_cvt_pk_bf16_f32 v138, v108, v109
    v_mfma_f32_16x16x32_bf16 v[112:115], a[204:207], v[92:95], v[112:115]
    s_mov_b32 s76, 786432
    buffer_load_dwordx2 v[98:99], v32, s[16:19], s76 offen sc1
    v_mfma_f32_16x16x32_bf16 v[116:119], a[208:211], v[92:95], v[116:119]
    v_cvt_pk_bf16_f32 v139, v110, v111
    v_mfma_f32_16x16x32_bf16 v[120:123], v[92:95], a[212:215], v[120:123]
    s_waitcnt lgkmcnt(5)
    ds_read_b128 v[92:95], v97 offset:5120
    ds_write_b64 v48, v[138:139] offset:16
    v_mfma_f32_16x16x32_bf16 v[100:103], a[0:3], v[72:75], 0
    v_permlane32_swap_b32 v134, v136
    v_mfma_f32_16x16x32_bf16 v[104:107], a[4:7], v[72:75], 0
    v_permlane32_swap_b32 v135, v137
    v_mfma_f32_16x16x32_bf16 v[108:111], v[72:75], a[8:11], 0
    s_waitcnt lgkmcnt(6)
    ds_read_b128 v[72:75], v97 offset:12288
    v_mov_b32_dpp v139, v139 row_ror:8 row_mask:0xf bank_mask:0xf
    v_mfma_f32_16x16x32_bf16 v[100:103], a[12:15], v[76:79], v[100:103]
    v_cndmask_b32 v134, v134, v136, s[28:29]
    v_cndmask_b32 v135, v135, v137, s[28:29]
    v_mfma_f32_16x16x32_bf16 v[104:107], a[16:19], v[76:79], v[104:107]
    v_cndmask_b32 v136, v138, v139, s[30:31]
    v_mov_b32 v137, s33
    v_mfma_f32_16x16x32_bf16 v[108:111], v[76:79], a[20:23], v[108:111]
    s_waitcnt lgkmcnt(5)
    ds_read_b128 v[76:79], v97 offset:13312
    v_mfma_f32_16x16x32_bf16 v[100:103], a[24:27], v[80:83], v[100:103]
    s_bitcmp1_b32 s58, 0
    s_cbranch_scc0 Lnx231
    buffer_store_dwordx4 v[134:137], v46, s[16:19], s59 offen offset:2048 sc1
Lnx231:
    v_mfma_f32_16x16x32_bf16 v[104:107], a[28:31], v[80:83], v[104:107]
    v_mfma_f32_16x16x32_bf16 v[108:111], v[80:83], a[32:35], v[108:111]
    s_waitcnt lgkmcnt(5)
    ds_read_b128 v[80:83], v97 offset:14336
    v_mfma_f32_16x16x32_bf16 v[100:103], a[36:39], v[84:87], v[100:103]
    s_bitcmp1_b32 s58, 1
    s_cbranch_scc0 Lnp227
    s_waitcnt vmcnt(3)
    v_xor_b32 v143, s33, v143
    s_waitcnt vmcnt(2)
    v_xor_b32 v147, s33, v147
    s_waitcnt vmcnt(1)
    v_xor_b32_e64 v151, s33, v151
    v_or3_b32 v143, v143, v147, v151
    v_cmp_lt_u32_e64 vcc, 1, v143
    ds_write_b64 v63, v[140:141] offset:10752
    ds_write_b32 v64, v142 offset:32
    ds_write_b64 v63, v[144:145] offset:13440
    ds_write_b32 v64, v146 offset:40
    ds_write_b64 v63, v[148:149] offset:8064
    ds_write_b32 v64, v150 offset:24
    s_cmp_lg_u64 vcc, 0
    s_cbranch_scc1 Lre230
Lok228:
Lnp227:
    v_mfma_f32_16x16x32_bf16 v[104:107], a[40:43], v[84:87], v[104:107]
    ds_read2_b32 v[124:125], v49 offset0:16 offset1:112
    v_mfma_f32_16x16x32_bf16 v[108:111], v[84:87], a[44:47], v[108:111]
    s_waitcnt lgkmcnt(6)
    ds_read_b128 v[84:87], v97 offset:15360
    v_mfma_f32_16x16x32_bf16 v[100:103], a[48:51], v[88:91], v[100:103]
    ds_read_b128 v[126:129], v50 offset:64
    v_mfma_f32_16x16x32_bf16 v[104:107], a[52:55], v[88:91], v[104:107]
    s_waitcnt lgkmcnt(2)
    ds_read_b128 v[130:133], v50 offset:448
    v_fmac_f32 v112, v125, v24
    v_mfma_f32_16x16x32_bf16 v[108:111], v[88:91], a[56:59], v[108:111]
    ds_read_b128 v[88:91], v97 offset:16384
    v_fmac_f32 v113, v125, v25
    v_mfma_f32_16x16x32_bf16 v[100:103], a[60:63], v[92:95], v[100:103]
    v_fmac_f32 v114, v125, v26
    v_fmac_f32 v115, v125, v27
    v_mfma_f32_16x16x32_bf16 v[104:107], a[64:67], v[92:95], v[104:107]
    v_mul_f32 v112, v124, v112
    v_mul_f32 v113, v124, v113
    v_mfma_f32_16x16x32_bf16 v[108:111], v[92:95], a[68:71], v[108:111]
    ds_read_b128 v[92:95], v97 offset:17408
    v_mul_f32 v114, v124, v114
    v_mfma_f32_16x16x32_bf16 v[100:103], a[72:75], v[72:75], v[100:103]
    v_mul_f32 v115, v124, v115
    v_cvt_pk_bf16_f32 v112, v112, v113
    v_mfma_f32_16x16x32_bf16 v[104:107], a[76:79], v[72:75], v[104:107]
    v_cvt_pk_bf16_f32 v113, v114, v115
    v_mfma_f32_16x16x32_bf16 v[108:111], v[72:75], a[80:83], v[108:111]
    ds_read_b128 v[72:75], v97 offset:24576
    v_mfma_f32_16x16x32_bf16 v[100:103], a[84:87], v[76:79], v[100:103]
    ds_write_b64 v47, v[112:113] offset:2688
    v_mfma_f32_16x16x32_bf16 v[104:107], a[88:91], v[76:79], v[104:107]
    v_fmac_f32 v116, v125, v28
    v_fmac_f32 v117, v125, v29
    v_mfma_f32_16x16x32_bf16 v[108:111], v[76:79], a[92:95], v[108:111]
    ds_read_b128 v[76:79], v97 offset:25600
    v_fmac_f32_e64 v118, v125, v30
    v_mfma_f32_16x16x32_bf16 v[100:103], a[96:99], v[80:83], v[100:103]
    v_fmac_f32 v119, v125, v31
    v_mul_f32 v116, v124, v116
    v_mfma_f32_16x16x32_bf16 v[104:107], a[100:103], v[80:83], v[104:107]
    v_mul_f32 v117, v124, v117
    v_mul_f32 v118, v124, v118
    v_mfma_f32_16x16x32_bf16 v[108:111], v[80:83], a[104:107], v[108:111]
    s_waitcnt lgkmcnt(7)
    ds_read_b128 v[80:83], v97 offset:26624
    v_mul_f32 v119, v124, v119
    v_mfma_f32_16x16x32_bf16 v[100:103], a[108:111], v[84:87], v[100:103]
    v_cvt_pk_bf16_f32 v114, v116, v117
    v_cvt_pk_bf16_f32 v115, v118, v119
    v_mfma_f32_16x16x32_bf16 v[104:107], a[112:115], v[84:87], v[104:107]
    ds_write_b64 v47, v[114:115] offset:18816
    v_mfma_f32_16x16x32_bf16 v[108:111], v[84:87], a[116:119], v[108:111]
    s_waitcnt lgkmcnt(6)
    ds_read_b128 v[84:87], v97 offset:27648
    v_fmac_f32 v120, v130, v35
    v_mfma_f32_16x16x32_bf16 v[100:103], a[120:123], v[88:91], v[100:103]
    v_fmac_f32 v121, v131, v35
    v_fmac_f32 v122, v132, v35
    v_mfma_f32_16x16x32_bf16 v[104:107], a[124:127], v[88:91], v[104:107]
    v_fmac_f32 v123, v133, v35
    v_mul_f32 v120, v126, v120
    v_mfma_f32_16x16x32_bf16 v[108:111], v[88:91], a[128:131], v[108:111]
    s_waitcnt lgkmcnt(6)
    ds_read_b128 v[88:91], v97 offset:28672
    v_mul_f32 v121, v127, v121
    v_mfma_f32_16x16x32_bf16 v[100:103], a[132:135], v[92:95], v[100:103]
    v_mul_f32 v122, v128, v122
    v_mul_f32 v123, v129, v123
    v_mfma_f32_16x16x32_bf16 v[104:107], a[136:139], v[92:95], v[104:107]
    v_cvt_pk_bf16_f32 v116, v120, v121
    v_cvt_pk_bf16_f32 v117, v122, v123
    v_mfma_f32_16x16x32_bf16 v[108:111], v[92:95], a[140:143], v[108:111]
    s_waitcnt lgkmcnt(6)
    ds_read_b128 v[92:95], v97 offset:29696
    v_mfma_f32_16x16x32_bf16 v[100:103], a[144:147], v[72:75], v[100:103]
    ds_write_b64 v48, v[116:117] offset:8
    v_mfma_f32_16x16x32_bf16 v[104:107], a[148:151], v[72:75], v[104:107]
    v_permlane32_swap_b32 v112, v114
    v_mfma_f32_16x16x32_bf16 v[108:111], v[72:75], a[152:155], v[108:111]
    s_waitcnt lgkmcnt(6)
    v_permlane32_swap_b32 v113, v115
    v_mfma_f32_16x16x32_bf16 v[100:103], a[156:159], v[76:79], v[100:103]
    v_mov_b32_dpp v117, v117 row_ror:8 row_mask:0xf bank_mask:0xf
    v_cndmask_b32 v112, v112, v114, s[28:29]
    v_mfma_f32_16x16x32_bf16 v[104:107], a[160:163], v[76:79], v[104:107]
    v_cndmask_b32 v113, v113, v115, s[28:29]
    v_cndmask_b32 v114, v116, v117, s[30:31]
    v_mfma_f32_16x16x32_bf16 v[108:111], v[76:79], a[164:167], v[108:111]
    s_waitcnt lgkmcnt(5)
    v_mov_b32 v115, s33
    v_mfma_f32_16x16x32_bf16 v[100:103], a[168:171], v[80:83], v[100:103]
    s_bitcmp1_b32 s58, 0
    s_cbranch_scc0 Lnx232
    buffer_store_dwordx4 v[112:115], v46, s[16:19], s59 offen offset:1024 sc1
Lnx232:
    v_mfma_f32_16x16x32_bf16 v[104:107], a[172:175], v[80:83], v[104:107]
    s_cmp_lg_u32 s43, 0
    s_subb_u32 s77, s42, 0
    v_mfma_f32_16x16x32_bf16 v[108:111], v[80:83], a[176:179], v[108:111]
    s_waitcnt lgkmcnt(3)
    s_cmp_eq_u32 s44, 0
    s_cselect_b32 s78, 18, 2
    v_mfma_f32_16x16x32_bf16 v[100:103], a[180:183], v[84:87], v[100:103]
    s_sub_u32 s78, s86, s78
    ds_read2_b32 v[124:125], v49 offset0:0 offset1:96
    v_mfma_f32_16x16x32_bf16 v[104:107], a[184:187], v[84:87], v[104:107]
    ds_read_b128 v[126:129], v50 offset:0
    v_mfma_f32_16x16x32_bf16 v[108:111], v[84:87], a[188:191], v[108:111]
    s_waitcnt lgkmcnt(4)
    ds_read_b128 v[130:133], v50 offset:384
    v_mfma_f32_16x16x32_bf16 v[100:103], a[192:195], v[88:91], v[100:103]
    v_mfma_f32_16x16x32_bf16 v[104:107], a[196:199], v[88:91], v[104:107]
    v_mfma_f32_16x16x32_bf16 v[108:111], v[88:91], a[200:203], v[108:111]
    s_waitcnt lgkmcnt(4)
    v_mfma_f32_16x16x32_bf16 v[100:103], a[204:207], v[92:95], v[100:103]
    v_mfma_f32_16x16x32_bf16 v[104:107], a[208:211], v[92:95], v[104:107]
    v_mfma_f32_16x16x32_bf16 v[108:111], v[92:95], a[212:215], v[108:111]
    s_waitcnt vmcnt(0)
    v_cmp_eq_u32 s[74:75], s46, v99
    v_readlane_b32 s81, v98, s77
    s_nop 0
    s_and_b32 s82, s81, 0x7ff
    s_cmp_le_u32 s82, s78
    s_cselect_b32 s81, s81, 0
    s_max_u32 s80, s54, s81
    v_cmp_lt_u32_e64 vcc, s80, v98
    s_bitcmp1_b32 s74, s77
    s_cselect_b32 s81, s74, 0
    s_and_b32 s82, s81, vcc_lo
    s_cselect_b32 s83, 0, s74
    s_cmp_eq_u32 s83, -1
    s_cbranch_scc1 LS_early
LS_last:
    s_waitcnt lgkmcnt(2)
    v_pk_fma_f32 v[100:101], v[124:125], v[24:25], v[100:101] op_sel:[1,0,0] op_sel_hi:[1,1,1]
    v_pk_fma_f32 v[102:103], v[124:125], v[26:27], v[102:103] op_sel:[1,0,0] op_sel_hi:[1,1,1]
    v_pk_mul_f32 v[100:101], v[124:125], v[100:101] op_sel_hi:[0,1]
    v_pk_mul_f32 v[102:103], v[124:125], v[102:103] op_sel_hi:[0,1]
    v_cvt_pk_bf16_f32 v100, v100, v101
    v_cvt_pk_bf16_f32 v101, v102, v103
    ds_write_b64 v47, v[100:101] offset:0
    v_pk_fma_f32 v[104:105], v[124:125], v[28:29], v[104:105] op_sel:[1,0,0] op_sel_hi:[1,1,1]
    v_pk_fma_f32 v[106:107], v[124:125], v[30:31], v[106:107] op_sel:[1,0,0] op_sel_hi:[1,1,1]
    v_pk_mul_f32 v[104:105], v[124:125], v[104:105] op_sel_hi:[0,1]
    v_pk_mul_f32 v[106:107], v[124:125], v[106:107] op_sel_hi:[0,1]
    v_cvt_pk_bf16_f32 v102, v104, v105
    v_cvt_pk_bf16_f32 v103, v106, v107
    ds_write_b64 v47, v[102:103] offset:16128
    s_waitcnt lgkmcnt(2)
    s_nop 0
    v_pk_fma_f32 v[108:109], v[130:131], v[34:35], v[108:109] op_sel:[0,1,0]
    v_pk_fma_f32 v[110:111], v[132:133], v[34:35], v[110:111] op_sel:[0,1,0]
    v_pk_mul_f32 v[108:109], v[126:127], v[108:109]
    v_pk_mul_f32 v[110:111], v[128:129], v[110:111]
    v_cvt_pk_bf16_f32 v104, v108, v109
    v_cvt_pk_bf16_f32 v105, v110, v111
    ds_write_b64 v48, v[104:105] offset:0
    v_permlane32_swap_b32 v100, v102
    v_permlane32_swap_b32 v101, v103
    v_mov_b32_dpp v105, v105 row_ror:8 row_mask:0xf bank_mask:0xf
    v_cndmask_b32 v100, v100, v102, s[28:29]
    v_cndmask_b32 v101, v101, v103, s[28:29]
    v_cndmask_b32 v102, v104, v105, s[30:31]
    v_mov_b32_e64 v103, s33
    s_bitcmp1_b32 s58, 0
    s_cbranch_scc0 Lnx243
    buffer_store_dwordx4 v[100:103], v46, s[16:19], s59 offen offset:0 sc1
Lnx243:
    s_cmp_eq_u32 s82, 0
    s_cbranch_scc1 LS_decide
LS_free:
    s_bitcmp1_b32 s58, 1
    s_cbranch_scc0 Lni244
    buffer_load_dwordx4 v[120:123], v46, s[16:19], s59 offen offset:2048 sc1
    buffer_load_dwordx4 v[124:127], v46, s[16:19], s59 offen offset:1024 sc1
Lni244:
    s_waitcnt lgkmcnt(0)
    s_barrier
    ds_read_b64 v[92:93], v51 offset:29568
    ds_read_b32 v94, v52 offset:29568
    ds_read_b64 v[100:101], v51 offset:13440
    ds_read_b32 v102, v52 offset:13440
    ds_read_b64 v[88:89], v51 offset:26880
    ds_read_b32 v90, v52 offset:26880
    ds_read_b64 v[96:97], v51 offset:10752
    ds_read_b32 v98, v52 offset:10752
    ds_read_b64 v[84:85], v51 offset:24192
    ds_read_b32 v86, v52 offset:24192
    v_mov_b32 v87, 0
    v_mov_b32 v91, 0
    v_mov_b32 v95, 0
    v_mov_b32 v99, 0
    v_mov_b32_e64 v103, 0
    s_waitcnt lgkmcnt(6)
    s_nop 0
    v_mfma_f32_16x16x32_bf16 v[108:111], v[92:95], v[100:103], v[40:43]
    s_waitcnt lgkmcnt(4)
    ds_read_b64 v[78:79], v54 offset:24
    v_mfma_f32_16x16x32_bf16 v[116:119], v[88:91], v[100:103], v[40:43]
    s_waitcnt lgkmcnt(3)
    ds_read_b128 v[80:83], v54 offset:32
    v_mfma_f32_16x16x32_bf16 v[104:107], v[88:91], v[96:99], v[40:43]
    s_waitcnt lgkmcnt(2)
    ds_read_b64 v[72:73], v53 offset:24
    v_mfma_f32_16x16x32_bf16 v[112:115], v[84:87], v[96:99], v[40:43]
    ds_read_b128 v[74:77], v53 offset:32
    v_cndmask_b32 v108, v116, v108, s[66:67]
    v_cndmask_b32 v109, v117, v109, s[68:69]
    v_cndmask_b32 v110, v118, v110, s[70:71]
    v_cndmask_b32 v111, v119, v111, s[72:73]
    s_nop 2
    v_cndmask_b32 v104, v112, v104, s[66:67]
    v_cndmask_b32 v105, v113, v105, s[68:69]
    v_cndmask_b32 v106, v114, v106, s[70:71]
    v_cndmask_b32 v107, v115, v107, s[72:73]
    v_max3_f32 v145, v108, v109, v110
    v_max3_f32 v144, v104, v105, v106
    v_max_f32 v145, v145, v111
    v_max_f32 v144, v144, v107
    s_nop 1
    v_permlane32_swap_b32 v144, v145
    v_max_f32 v144, v144, v145
    v_mov_b32 v145, v144
    s_nop 1
    v_permlane16_swap_b32 v144, v145
    v_max_f32 v144, v144, v145
    v_mul_f32 v145, s85, v144
    v_mul_f32 v144, s85, v144
    s_nop 1
    v_permlane32_swap_b32_e64 v144, v145
    v_pk_fma_f32 v[104:105], v[104:105], s[84:85], v[144:145] op_sel:[0,1,0] op_sel_hi:[1,1,0] neg_lo:[0,0,1] neg_hi:[0,0,1]
    v_pk_fma_f32 v[106:107], v[106:107], s[84:85], v[144:145] op_sel:[0,1,0] op_sel_hi:[1,1,0] neg_lo:[0,0,1] neg_hi:[0,0,1]
    v_pk_fma_f32 v[108:109], v[108:109], s[84:85], v[144:145] op_sel:[0,1,1] op_sel_hi:[1,1,1] neg_lo:[0,0,1] neg_hi:[0,0,1]
    v_pk_fma_f32 v[110:111], v[110:111], s[84:85], v[144:145] op_sel:[0,1,1] op_sel_hi:[1,1,1] neg_lo:[0,0,1] neg_hi:[0,0,1]
    s_bitcmp1_b32 s58, 1
    s_cbranch_scc0 Lnp245
    s_waitcnt vmcnt(1)
    v_xor_b32 v123, s33, v123
    s_waitcnt vmcnt(0)
    v_xor_b32 v127, s33, v127
    v_or_b32 v123, v123, v127
    v_cmp_lt_u32 vcc, 1, v123
    ds_write_b64 v63, v[120:121] offset:5376
    ds_write_b32 v64, v122 offset:16
    ds_write_b64 v63, v[124:125] offset:2688
    ds_write_b32 v64, v126 offset:8
    s_cmp_lg_u64 vcc, 0
    s_cbranch_scc1 Lre248
Lok246:
Lnp245:
    s_bitcmp1_b32 s58, 1
    s_cbranch_scc0 Lni249
    buffer_load_dwordx4 v[148:151], v46, s[16:19], s59 offen offset:0 sc1
Lni249:
    ds_read_b64 v[100:101], v51 offset:8064
    ds_read_b32 v102, v52 offset:8064
    ds_read_b64 v[92:93], v51 offset:21504
    ds_read_b32 v94, v52 offset:21504
    ds_read_b64 v[96:97], v51 offset:5376
    ds_read_b32 v98, v52 offset:5376
    ds_read_b64 v[88:89], v51 offset:18816
    ds_read_b32 v90, v52 offset:18816
    v_exp_f32 v104, v104
    v_exp_f32 v105, v105
    v_exp_f32 v106, v106
    v_exp_f32 v107, v107
    v_exp_f32 v108, v108
    v_exp_f32 v109, v109
    v_exp_f32 v110, v110
    v_exp_f32 v111, v111
    s_waitcnt lgkmcnt(6)
    v_mfma_f32_16x16x32_bf16 v[124:127], v[84:87], v[100:103], v[40:43]
    s_waitcnt lgkmcnt(4)
    v_cvt_pk_bf16_f32 v138, v104, v105
    v_cvt_pk_bf16_f32 v139, v106, v107
    v_mfma_f32_16x16x32_bf16 v[132:135], v[92:95], v[100:103], v[40:43]
    s_waitcnt lgkmcnt(2)
    v_bfi_b32 v136, v44, 0, v138
    v_bfi_b32 v137, v45, 0, v139
    v_mfma_f32_16x16x32_bf16 v[120:123], v[92:95], v[96:99], v[40:43]
    s_waitcnt lgkmcnt(0)
    v_and_b32 v138, v44, v138
    v_and_b32 v139, v45, v139
    v_mfma_f32_16x16x32_bf16 v[128:131], v[88:91], v[96:99], v[40:43]
    s_add_u32 s76, s47, 140288
    v_cvt_pk_bf16_f32 v142, v108, v109
    v_cvt_pk_bf16_f32 v143, v110, v111
    v_mfma_f32_16x16x32_bf16 v[112:115], v[78:81], v[136:139], 0
    s_add_u32 s77, s47, 146432
    v_bfi_b32 v140, v44, 0, v142
    v_bfi_b32 v141, v45, 0, v143
    v_mfma_f32_16x16x32_bf16 v[104:107], v[72:75], v[136:139], 0
    v_and_b32_e64 v142, v44, v142
    v_and_b32 v143, v45, v143
    s_nop 1
    v_mfma_f32_16x16x32_bf16 v[116:119], v[80:83], v[140:143], 0
    v_cndmask_b32 v124, v132, v124, s[66:67]
    v_cndmask_b32 v125, v133, v125, s[68:69]
    v_mfma_f32_16x16x32_bf16 v[108:111], v[74:77], v[140:143], 0
    v_cndmask_b32 v126, v134, v126, s[70:71]
    v_cndmask_b32 v127, v135, v127, s[72:73]
    v_cndmask_b32 v120, v128, v120, s[66:67]
    v_cndmask_b32 v121, v129, v121, s[68:69]
    v_cndmask_b32 v122, v130, v122, s[70:71]
    v_cndmask_b32 v123, v131, v123, s[72:73]
    v_rcp_f32 v114, v114
    v_rcp_f32 v118, v118
    v_pk_mul_f32 v[104:105], v[104:105], v[114:115] op_sel_hi:[1,0]
    v_pk_mul_f32 v[106:107], v[106:107], v[114:115] op_sel_hi:[1,0]
    v_pk_mul_f32 v[112:113], v[112:113], v[114:115] op_sel_hi:[1,0]
    v_cvt_pk_bf16_f32 v104, v104, v105
    v_cvt_pk_bf16_f32 v105, v106, v107
    v_cvt_pk_bf16_f32 v112, v112, v113
    v_pk_mul_f32 v[108:109], v[108:109], v[118:119] op_sel_hi:[1,0]
    v_pk_mul_f32 v[110:111], v[110:111], v[118:119] op_sel_hi:[1,0]
    v_pk_mul_f32 v[116:117], v[116:117], v[118:119] op_sel_hi:[1,0]
    v_cvt_pk_bf16_f32 v108, v108, v109
    v_cvt_pk_bf16_f32 v109, v110, v111
    v_cvt_pk_bf16_f32 v116, v116, v117
    buffer_store_dwordx2 v[104:105], v55, s[16:19], s76 offen sc1
    buffer_store_dwordx2 v[108:109], v55, s[16:19], s77 offen sc1
    v_mov_b32_dpp v112, v116 quad_perm:[0,1,2,3] row_mask:0x2 bank_mask:0xf
    buffer_store_dword v112, v56, s[16:19], s76 offen sc1
    v_max3_f32 v145, v124, v125, v126
    v_max3_f32 v144, v120, v121, v122
    v_max_f32 v145, v145, v127
    v_max_f32 v144, v144, v123
    ds_read_b64 v[78:79], v54 offset:8
    ds_read_b128 v[80:83], v54 offset:16
    v_permlane32_swap_b32 v144, v145
    v_max_f32 v144, v144, v145
    v_mov_b32_e64 v145, v144
    ds_read_b64 v[72:73], v53 offset:8
    ds_read_b128 v[74:77], v53 offset:16
    v_permlane16_swap_b32 v144, v145
    v_max_f32 v144, v144, v145
    v_mul_f32 v145, s85, v144
    v_mul_f32 v144, s85, v144
    s_cmp_eq_u32 s43, 0
    s_cselect_b32 s81, s84, 0
    v_permlane32_swap_b32 v144, v145
    v_min_f32 v116, s81, v40
    v_min_f32 v117, s81, v41
    v_min_f32 v118, s81, v42
    v_min_f32 v119, s81, v43
    v_mov_b32 v112, s84
    v_mov_b32 v113, s84
    v_mov_b32 v114, s84
    v_mov_b32_e64 v115, s84
    v_pk_fma_f32 v[120:121], v[120:121], s[84:85], v[144:145] op_sel:[0,1,0] op_sel_hi:[1,1,0] neg_lo:[0,0,1] neg_hi:[0,0,1]
    v_pk_fma_f32 v[122:123], v[122:123], s[84:85], v[144:145] op_sel:[0,1,0] op_sel_hi:[1,1,0] neg_lo:[0,0,1] neg_hi:[0,0,1]
    v_pk_fma_f32 v[124:125], v[124:125], s[84:85], v[144:145] op_sel:[0,1,1] op_sel_hi:[1,1,1] neg_lo:[0,0,1] neg_hi:[0,0,1]
    v_pk_fma_f32 v[126:127], v[126:127], s[84:85], v[144:145] op_sel:[0,1,1] op_sel_hi:[1,1,1] neg_lo:[0,0,1] neg_hi:[0,0,1]
    s_bitcmp1_b32 s58, 1
    s_cbranch_scc0 Lnp250
    s_waitcnt vmcnt(3)
    v_xor_b32 v151, s33, v151
    v_cmp_lt_u32_e64 vcc, 1, v151
    ds_write_b64 v63, v[148:149] offset:0
    ds_write_b32 v64, v150 offset:0
    s_cmp_lg_u64 vcc, 0
    s_cbranch_scc1 Lre253
Lok251:
Lnp250:
    ds_read_b64 v[100:101], v51 offset:2688
    ds_read_b32 v102, v52 offset:2688
    ds_read_b64 v[84:85], v51 offset:16128
    ds_read_b32 v86, v52 offset:16128
    ds_read_b64 v[96:97], v51 offset:0
    ds_read_b32 v98, v52 offset:0
    v_exp_f32 v120, v120
    v_exp_f32 v121, v121
    v_exp_f32 v122, v122
    v_exp_f32 v123, v123
    v_exp_f32 v124, v124
    v_exp_f32 v125, v125
    v_exp_f32_e64 v126, v126
    v_exp_f32 v127, v127
    s_waitcnt vmcnt(0)
    buffer_store_dword v68, v57, s[16:19], s47 offen offset:480 sc1
    s_waitcnt lgkmcnt(4)
    v_mfma_f32_16x16x32_bf16 v[108:111], v[88:91], v[100:103], v[40:43]
    s_waitcnt lgkmcnt(2)
    v_cvt_pk_bf16_f32 v138, v120, v121
    v_cvt_pk_bf16_f32 v139, v122, v123
    v_mfma_f32_16x16x32_bf16 v[116:119], v[84:87], v[100:103], v[116:119]
    s_waitcnt lgkmcnt(0)
    v_bfi_b32 v136, v44, 0, v138
    v_bfi_b32 v137, v45, 0, v139
    v_mfma_f32_16x16x32_bf16 v[104:107], v[84:87], v[96:99], v[40:43]
    s_add_u32 s76, s47, 66560
    s_add_u32 s77, s47, 72704
    v_and_b32 v138, v44, v138
    v_and_b32 v139, v45, v139
    s_nop 1
    v_mfma_f32_16x16x32_bf16 v[128:131], v[78:81], v[136:139], 0
    v_cvt_pk_bf16_f32 v142, v124, v125
    v_cvt_pk_bf16_f32 v143, v126, v127
    v_mfma_f32_16x16x32_bf16 v[120:123], v[72:75], v[136:139], 0
    v_bfi_b32 v140, v44, 0, v142
    v_bfi_b32 v141, v45, 0, v143
    v_and_b32_e64 v142, v44, v142
    v_and_b32 v143, v45, v143
    s_nop 1
    v_mfma_f32_16x16x32_bf16 v[132:135], v[80:83], v[140:143], 0
    v_cndmask_b32 v108, v116, v108, s[66:67]
    v_cndmask_b32 v109, v117, v109, s[68:69]
    v_mfma_f32_16x16x32_bf16 v[124:127], v[74:77], v[140:143], 0
    v_cndmask_b32 v110, v118, v110, s[70:71]
    v_cndmask_b32 v111, v119, v111, s[72:73]
    v_cndmask_b32 v104, v112, v104, s[66:67]
    v_cndmask_b32 v105, v113, v105, s[68:69]
    v_cndmask_b32 v106, v114, v106, s[70:71]
    v_cndmask_b32 v107, v115, v107, s[72:73]
    v_rcp_f32 v130, v130
    v_rcp_f32 v134, v134
    v_pk_mul_f32 v[120:121], v[120:121], v[130:131] op_sel_hi:[1,0]
    v_pk_mul_f32 v[122:123], v[122:123], v[130:131] op_sel_hi:[1,0]
    v_pk_mul_f32 v[128:129], v[128:129], v[130:131] op_sel_hi:[1,0]
    v_cvt_pk_bf16_f32 v120, v120, v121
    v_cvt_pk_bf16_f32 v121, v122, v123
    v_cvt_pk_bf16_f32 v128, v128, v129
    v_pk_mul_f32 v[124:125], v[124:125], v[134:135] op_sel_hi:[1,0]
    v_pk_mul_f32 v[126:127], v[126:127], v[134:135] op_sel_hi:[1,0]
    v_pk_mul_f32 v[132:133], v[132:133], v[134:135] op_sel_hi:[1,0]
    v_cvt_pk_bf16_f32 v124, v124, v125
    v_cvt_pk_bf16_f32 v125, v126, v127
    v_cvt_pk_bf16_f32 v132, v132, v133
    buffer_store_dwordx2 v[120:121], v55, s[16:19], s76 offen sc1
    buffer_store_dwordx2 v[124:125], v55, s[16:19], s77 offen sc1
    v_mov_b32_dpp v128, v132 quad_perm:[0,1,2,3] row_mask:0x2 bank_mask:0xf
    buffer_store_dword v128, v56, s[16:19], s76 offen sc1
    buffer_load_dword v146, v58, s[16:19], s47 offen offset:480 sc1
    v_max3_f32 v145, v108, v109, v110
    v_max3_f32 v144, v104, v105, v106
    v_max_f32 v145, v145, v111
    v_max_f32 v144, v144, v107
    ds_read_b128 v[80:83], v54 offset:0
    ds_read_b128 v[74:77], v53 offset:0
    v_permlane32_swap_b32 v144, v145
    v_max_f32 v144, v144, v145
    v_mov_b32 v145, v144
    v_mov_b32 v78, 0
    v_mov_b32 v79, 0
    v_permlane16_swap_b32 v144, v145
    v_max_f32 v144, v144, v145
    v_mul_f32 v145, s85, v144
    v_mul_f32 v144, s85, v144
    v_mov_b32 v72, 0
    v_mov_b32 v73, 0
    v_permlane32_swap_b32 v144, v145
    v_pk_fma_f32 v[104:105], v[104:105], s[84:85], v[144:145] op_sel:[0,1,0] op_sel_hi:[1,1,0] neg_lo:[0,0,1] neg_hi:[0,0,1]
    v_pk_fma_f32 v[106:107], v[106:107], s[84:85], v[144:145] op_sel:[0,1,0] op_sel_hi:[1,1,0] neg_lo:[0,0,1] neg_hi:[0,0,1]
    v_pk_fma_f32 v[108:109], v[108:109], s[84:85], v[144:145] op_sel:[0,1,1] op_sel_hi:[1,1,1] neg_lo:[0,0,1] neg_hi:[0,0,1]
    v_pk_fma_f32 v[110:111], v[110:111], s[84:85], v[144:145] op_sel:[0,1,1] op_sel_hi:[1,1,1] neg_lo:[0,0,1] neg_hi:[0,0,1]
    v_exp_f32 v104, v104
    v_exp_f32 v105, v105
    v_exp_f32 v106, v106
    v_exp_f32 v107, v107
    v_exp_f32 v108, v108
    v_exp_f32 v109, v109
    v_exp_f32 v110, v110
    v_exp_f32 v111, v111
    s_waitcnt vmcnt(0)
    v_cmp_ne_u32 s[34:35], s46, v146
    buffer_store_dword v68, v57, s[16:19], s47 offen offset:640 sc1
    s_add_u32 s78, s87, s47
    s_add_u32 m0, s87, 0
    s_add_u32 s78, s78, 140288
    s_cmp_lg_u64 s[34:35], 0
    s_cbranch_scc1 Lre256
Lok254:
    buffer_inv sc1
    s_waitcnt vmcnt(0)
    buffer_load_dwordx4 v46, s[16:19], s78 offen offset:0 sc1 lds
    buffer_load_dwordx4 v46, s[16:19], s78 offen offset:1024 sc1 lds
    v_cvt_pk_bf16_f32 v138, v104, v105
    v_cvt_pk_bf16_f32 v139, v106, v107
    v_bfi_b32 v136, v44, 0, v138
    v_bfi_b32 v137, v45, 0, v139
    v_and_b32_e64 v138, v44, v138
    v_and_b32 v139, v45, v139
    s_waitcnt lgkmcnt(1)
    s_nop 0
    v_mfma_f32_16x16x32_bf16 v[112:115], v[78:81], v[136:139], 0
    s_waitcnt lgkmcnt(0)
    v_cvt_pk_bf16_f32 v142, v108, v109
    v_cvt_pk_bf16_f32 v143, v110, v111
    v_mfma_f32_16x16x32_bf16 v[104:107], v[72:75], v[136:139], 0
    s_add_u32 s76, s47, 103424
    s_add_u32 s77, s47, 109568
    v_bfi_b32 v140, v44, 0, v142
    v_bfi_b32 v141, v45, 0, v143
    v_and_b32_e64 v142, v44, v142
    v_and_b32 v143, v45, v143
    s_nop 1
    v_mfma_f32_16x16x32_bf16 v[116:119], v[80:83], v[140:143], 0
    v_rcp_f32 v114, v114
    v_mfma_f32_16x16x32_bf16 v[108:111], v[74:77], v[140:143], 0
    buffer_load_dwordx4 v46, s[16:19], s78 offen offset:2048 sc1 lds
    s_add_u32 s78, s87, s47
    s_add_u32 m0, s87, 12288
    s_add_u32 s78, s78, 152576
    buffer_load_dwordx4 v46, s[16:19], s78 offen offset:0 sc1 lds
    v_rcp_f32_e64 v118, v118
    v_pk_mul_f32 v[104:105], v[104:105], v[114:115] op_sel_hi:[1,0]
    v_pk_mul_f32 v[106:107], v[106:107], v[114:115] op_sel_hi:[1,0]
    v_pk_mul_f32 v[112:113], v[112:113], v[114:115] op_sel_hi:[1,0]
    v_cvt_pk_bf16_f32 v104, v104, v105
    v_cvt_pk_bf16_f32 v105, v106, v107
    v_cvt_pk_bf16_f32 v112, v112, v113
    v_pk_mul_f32 v[108:109], v[108:109], v[118:119] op_sel_hi:[1,0]
    v_pk_mul_f32 v[110:111], v[110:111], v[118:119] op_sel_hi:[1,0]
    v_pk_mul_f32 v[116:117], v[116:117], v[118:119] op_sel_hi:[1,0]
    v_cvt_pk_bf16_f32 v108, v108, v109
    v_cvt_pk_bf16_f32 v109, v110, v111
    v_cvt_pk_bf16_f32 v116, v116, v117
    buffer_store_dwordx2 v[104:105], v55, s[16:19], s76 offen sc1
    buffer_store_dwordx2 v[108:109], v55, s[16:19], s77 offen sc1
    v_mov_b32_dpp v112, v116 quad_perm:[0,1,2,3] row_mask:0x2 bank_mask:0xf
    buffer_store_dword v112, v56, s[16:19], s76 offen sc1
    buffer_load_dword v146, v58, s[16:19], s47 offen offset:640 sc1
    s_mul_i32 s81, s53, 6144
    v_add_u32 v96, s81, v46
    v_add_u32 v97, 36864, v96
    s_lshl_b32 s81, s53, 6
    s_add_u32 s81, s81, 768
    v_add_u32 v99, s81, v49
    buffer_load_dwordx4 v46, s[16:19], s78 offen offset:1024 sc1 lds
    buffer_load_dwordx4 v46, s[16:19], s78 offen offset:2048 sc1 lds
    s_add_u32 s78, s87, s47
    s_add_u32 m0, s87, 24576
    s_add_u32 s78, s78, 164864
    buffer_load_dwordx4 v46, s[16:19], s78 offen offset:0 sc1 lds
    s_waitcnt vmcnt(8) lgkmcnt(0)
    s_barrier
    ds_read_b128 v[72:75], v96 offset:0
    ds_read_b128 v[76:79], v96 offset:1024
    ds_read_b128 v[80:83], v96 offset:2048
    ds_read_b128 v[84:87], v96 offset:3072
    ds_read_b128 v[88:91], v96 offset:4096
    ds_read_b128 v[92:95], v96 offset:5120
    s_waitcnt lgkmcnt(5)
    v_mfma_f32_16x16x32_bf16 v[0:3], a[216:219], v[72:75], v[0:3]
    s_waitcnt vmcnt(3)
    ds_read2_b32 v[130:131], v99 offset0:32 offset1:128
    v_cmp_ne_u32 s[34:35], s46, v146
    v_mfma_f32_16x16x32_bf16 v[4:7], a[220:223], v[72:75], v[4:7]
    s_waitcnt lgkmcnt(0)
    ds_read2_b32 v[132:133], v99 offset0:0 offset1:96
    v_add_f32 v130, 1.0, v130
    v_mfma_f32_16x16x32_bf16 v[0:3], a[224:227], v[76:79], v[0:3]
    v_fma_f32 v8, v8, v130, v131
    v_fma_f32 v9, v9, v130, v131
    buffer_load_dwordx4 v46, s[16:19], s78 offen offset:1024 sc1 lds
    buffer_load_dwordx4 v46, s[16:19], s78 offen offset:2048 sc1 lds
    v_mfma_f32_16x16x32_bf16 v[4:7], a[228:231], v[76:79], v[4:7]
    s_cmp_lg_u64 s[34:35], 0
    s_cbranch_scc1 Lre259
Lok257:
    buffer_inv sc1
    s_waitcnt vmcnt(0)
    v_mfma_f32_16x16x32_bf16 v[0:3], a[232:235], v[80:83], v[0:3]
    buffer_store_dword v68, v57, s[16:19], s47 offen offset:800 sc1
    s_add_u32 s78, s87, s47
    v_mfma_f32_16x16x32_bf16 v[4:7], a[236:239], v[80:83], v[4:7]
    s_add_u32 m0, s87, 36864
    s_add_u32 s78, s78, 66560
    v_fma_f32 v10, v10, v130, v131
    v_mfma_f32_16x16x32_bf16 v[0:3], a[240:243], v[84:87], v[0:3]
    s_barrier
    v_fma_f32 v11, v11, v130, v131
    v_mfma_f32_16x16x32_bf16 v[4:7], a[244:247], v[84:87], v[4:7]
    s_nop 0
    ds_read_b128 v[72:75], v96 offset:12288
    v_fma_f32 v12, v12, v130, v131
    v_mfma_f32_16x16x32_bf16 v[0:3], a[248:251], v[88:91], v[0:3]
    ds_read_b128 v[76:79], v96 offset:13312
    v_fma_f32 v13, v13, v130, v131
    v_mfma_f32_16x16x32_bf16 v[4:7], a[252:255], v[88:91], v[4:7]
    ds_read_b128 v[80:83], v96 offset:14336
    v_fma_f32 v14, v14, v130, v131
    v_mfma_f32_16x16x32_bf16 v[0:3], v[152:155], v[92:95], v[0:3]
    ds_read_b128 v[84:87], v96 offset:15360
    v_fma_f32 v15, v15, v130, v131
    v_mfma_f32_16x16x32_bf16 v[4:7], v[156:159], v[92:95], v[4:7]
    s_waitcnt lgkmcnt(3)
    ds_read_b128 v[88:91], v96 offset:16384
    v_add_f32_e64 v132, 1.0, v132
    v_mfma_f32_16x16x32_bf16 v[0:3], v[160:163], v[72:75], v[0:3]
    buffer_load_dwordx4 v46, s[16:19], s78 offen offset:0 sc1 lds
    ds_read_b128 v[92:95], v96 offset:17408
    v_mfma_f32_16x16x32_bf16 v[4:7], v[164:167], v[72:75], v[4:7]
    s_waitcnt lgkmcnt(4)
    v_fma_f32 v16, v16, v132, v133
    v_fma_f32 v17, v17, v132, v133
    v_mfma_f32_16x16x32_bf16 v[0:3], v[168:171], v[76:79], v[0:3]
    v_fma_f32 v18, v18, v132, v133
    v_fma_f32 v19, v19, v132, v133
    buffer_load_dwordx4 v46, s[16:19], s78 offen offset:1024 sc1 lds
    buffer_load_dwordx4 v46, s[16:19], s78 offen offset:2048 sc1 lds
    v_mfma_f32_16x16x32_bf16 v[4:7], v[172:175], v[76:79], v[4:7]
    s_waitcnt lgkmcnt(3)
    s_add_u32 s78, s87, s47
    v_fma_f32 v20, v20, v132, v133
    v_mfma_f32_16x16x32_bf16 v[0:3], v[176:179], v[80:83], v[0:3]
    s_add_u32 m0, s87, 49152
    s_add_u32 s78, s78, 78848
    v_fma_f32 v21, v21, v132, v133
    v_mfma_f32_16x16x32_bf16 v[4:7], v[180:183], v[80:83], v[4:7]
    s_waitcnt lgkmcnt(2)
    v_fma_f32 v22, v22, v132, v133
    v_fma_f32 v23, v23, v132, v133
    v_mfma_f32_16x16x32_bf16 v[0:3], v[184:187], v[84:87], v[0:3]
    s_barrier
    v_mfma_f32_16x16x32_bf16 v[4:7], v[188:191], v[84:87], v[4:7]
    s_waitcnt lgkmcnt(1)
    ds_read_b128 v[72:75], v96 offset:24576
    v_mfma_f32_16x16x32_bf16 v[0:3], v[192:195], v[88:91], v[0:3]
    buffer_load_dword v98, v58, s[16:19], s47 offen offset:800 sc1
    ds_read_b128 v[76:79], v96 offset:25600
    v_mfma_f32_16x16x32_bf16 v[4:7], v[196:199], v[88:91], v[4:7]
    s_waitcnt lgkmcnt(2)
    ds_read_b128 v[80:83], v96 offset:26624
    v_mfma_f32_16x16x32_bf16 v[0:3], v[200:203], v[92:95], v[0:3]
    buffer_load_dwordx4 v46, s[16:19], s78 offen offset:0 sc1 lds
    ds_read_b128 v[84:87], v96 offset:27648
    v_mfma_f32_16x16x32_bf16 v[4:7], v[204:207], v[92:95], v[4:7]
    s_waitcnt lgkmcnt(3)
    ds_read_b128 v[88:91], v96 offset:28672
    v_mfma_f32_16x16x32_bf16 v[0:3], v[208:211], v[72:75], v[0:3]
    buffer_load_dwordx4 v46, s[16:19], s78 offen offset:1024 sc1 lds
    ds_read_b128 v[92:95], v96 offset:29696
    v_mfma_f32_16x16x32_bf16 v[4:7], v[212:215], v[72:75], v[4:7]
    s_waitcnt lgkmcnt(4)
    v_mfma_f32_16x16x32_bf16 v[0:3], v[216:219], v[76:79], v[0:3]
    buffer_load_dwordx4 v46, s[16:19], s78 offen offset:2048 sc1 lds
    v_mfma_f32_16x16x32_bf16 v[4:7], v[220:223], v[76:79], v[4:7]
    s_waitcnt lgkmcnt(3)
    s_add_u32 s78, s87, s47
    v_mfma_f32_16x16x32_bf16 v[0:3], v[224:227], v[80:83], v[0:3]
    s_add_u32 m0, s87, 61440
    s_add_u32 s78, s78, 91136
    v_mfma_f32_16x16x32_bf16 v[4:7], v[228:231], v[80:83], v[4:7]
    s_waitcnt lgkmcnt(2)
    v_mfma_f32_16x16x32_bf16 v[0:3], v[232:235], v[84:87], v[0:3]
    s_waitcnt vmcnt(4)
    s_barrier
    v_mfma_f32_16x16x32_bf16 v[4:7], v[236:239], v[84:87], v[4:7]
    s_waitcnt lgkmcnt(1)
    ds_read_b128 v[72:75], v97 offset:0
    v_mfma_f32_16x16x32_bf16 v[0:3], v[240:243], v[88:91], v[0:3]
    buffer_load_dwordx4 v46, s[16:19], s78 offen offset:0 sc1 lds
    ds_read_b128 v[76:79], v97 offset:1024
    v_mfma_f32_16x16x32_bf16 v[4:7], v[244:247], v[88:91], v[4:7]
    s_waitcnt lgkmcnt(2)
    ds_read_b128 v[80:83], v97 offset:2048
    v_mfma_f32_16x16x32_bf16 v[0:3], v[248:251], v[92:95], v[0:3]
    s_waitcnt vmcnt(4)
    ds_read_b128 v[84:87], v97 offset:3072
    v_cmp_ne_u32 s[34:35], s46, v98
    v_mfma_f32_16x16x32_bf16 v[4:7], v[252:255], v[92:95], v[4:7]
    s_waitcnt lgkmcnt(3)
    ds_read_b128 v[88:91], v97 offset:4096
    v_mfma_f32_16x16x32_bf16 v[8:11], a[216:219], v[72:75], v[8:11]
    buffer_load_dwordx4 v46, s[16:19], s78 offen offset:1024 sc1 lds
    ds_read_b128 v[92:95], v97 offset:5120
    v_mfma_f32_16x16x32_bf16 v[12:15], a[220:223], v[72:75], v[12:15]
    s_waitcnt lgkmcnt(4)
    v_cvt_pk_bf16_f32 v140, v0, v1
    v_cvt_pk_bf16_f32 v141, v2, v3
    v_mfma_f32_16x16x32_bf16 v[8:11], a[224:227], v[76:79], v[8:11]
    s_cmp_lg_u64 s[34:35], 0
    s_cbranch_scc1 Lre263
Lok261:
    buffer_inv sc1
    s_waitcnt vmcnt(0)
    buffer_load_dwordx4 v46, s[16:19], s78 offen offset:2048 sc1 lds
    v_mfma_f32_16x16x32_bf16 v[12:15], a[228:231], v[76:79], v[12:15]
    s_waitcnt lgkmcnt(3)
    s_add_u32 s78, s87, s47
    v_cvt_pk_bf16_f32 v142, v4, v5
    v_mfma_f32_16x16x32_bf16 v[8:11], a[232:235], v[80:83], v[8:11]
    s_add_u32 m0, s87, 73728
    s_add_u32 s78, s78, 103424
    v_cvt_pk_bf16_f32 v143, v6, v7
    v_mfma_f32_16x16x32_bf16 v[12:15], a[236:239], v[80:83], v[12:15]
    s_waitcnt lgkmcnt(2)
    s_or_b32 s79, s46, 5
    v_mfma_f32_16x16x32_bf16 v[100:103], v[140:143], v[140:143], 0
    v_mfma_f32_16x16x32_bf16 v[146:149], v[36:39], v[140:143], 0
    s_nop 3
    v_cndmask_b32 v100, v100, v101, s[60:61]
    v_cndmask_b32 v102, v102, v103, s[60:61]
    s_nop 1
    v_mov_b32 v149, s79
    v_cndmask_b32 v148, v100, v102, s[62:63]
    v_mfma_f32_16x16x32_bf16 v[8:11], a[240:243], v[84:87], v[8:11]
    s_barrier
    v_mfma_f32_16x16x32_bf16 v[12:15], a[244:247], v[84:87], v[12:15]
    s_waitcnt lgkmcnt(1)
    ds_read_b128 v[72:75], v97 offset:12288
    v_mfma_f32_16x16x32_bf16 v[8:11], a[248:251], v[88:91], v[8:11]
    buffer_store_dwordx4 v[146:149], v60, s[16:19], s47 offen offset:3072 sc1
    ds_read_b128 v[76:79], v97 offset:13312
    ds_read_b128 v[80:83], v97 offset:14336
    ds_read_b128 v[84:87], v97 offset:15360
    v_mfma_f32_16x16x32_bf16 v[12:15], a[252:255], v[88:91], v[12:15]
    s_waitcnt lgkmcnt(4)
    ds_read_b128 v[88:91], v97 offset:16384
    v_mfma_f32_16x16x32_bf16 v[8:11], v[152:155], v[92:95], v[8:11]
    buffer_load_dwordx4 v46, s[16:19], s78 offen offset:0 sc1 lds
    v_mfma_f32_16x16x32_bf16 v[12:15], v[156:159], v[92:95], v[12:15]
    s_waitcnt lgkmcnt(4)
    ds_read_b128 v[92:95], v97 offset:17408
    v_mfma_f32_16x16x32_bf16 v[8:11], v[160:163], v[72:75], v[8:11]
    v_mfma_f32_16x16x32_bf16 v[12:15], v[164:167], v[72:75], v[12:15]
    s_waitcnt lgkmcnt(4)
    buffer_load_dwordx4 v46, s[16:19], s78 offen offset:1024 sc1 lds
    v_mfma_f32_16x16x32_bf16 v[8:11], v[168:171], v[76:79], v[8:11]
    buffer_load_dwordx4 v46, s[16:19], s78 offen offset:2048 sc1 lds
    v_mfma_f32_16x16x32_bf16 v[12:15], v[172:175], v[76:79], v[12:15]
    s_waitcnt lgkmcnt(3)
    s_add_u32 s78, s87, s47
    v_mfma_f32_16x16x32_bf16 v[8:11], v[176:179], v[80:83], v[8:11]
    s_add_u32 m0, s87, 86016
    s_add_u32 s78, s78, 115712
    v_mfma_f32_16x16x32_bf16 v[12:15], v[180:183], v[80:83], v[12:15]
    s_waitcnt lgkmcnt(2)
    v_mfma_f32_16x16x32_bf16 v[8:11], v[184:187], v[84:87], v[8:11]
    s_waitcnt vmcnt(4)
    s_barrier
    v_mfma_f32_16x16x32_bf16 v[12:15], v[188:191], v[84:87], v[12:15]
    s_waitcnt lgkmcnt(1)
    ds_read_b128 v[72:75], v97 offset:24576
    v_mfma_f32_16x16x32_bf16 v[8:11], v[192:195], v[88:91], v[8:11]
    ds_read_b128 v[76:79], v97 offset:25600
    v_mfma_f32_16x16x32_bf16 v[12:15], v[196:199], v[88:91], v[12:15]
    s_waitcnt lgkmcnt(2)
    ds_read_b128 v[80:83], v97 offset:26624
    v_mfma_f32_16x16x32_bf16 v[8:11], v[200:203], v[92:95], v[8:11]
    buffer_load_dwordx4 v46, s[16:19], s78 offen offset:0 sc1 lds
    ds_read_b128 v[84:87], v97 offset:27648
    v_mfma_f32_16x16x32_bf16 v[12:15], v[204:207], v[92:95], v[12:15]
    s_waitcnt lgkmcnt(3)
    ds_read_b128 v[88:91], v97 offset:28672
    v_mfma_f32_16x16x32_bf16 v[8:11], v[208:211], v[72:75], v[8:11]
    ds_read_b128 v[92:95], v97 offset:29696
    v_mfma_f32_16x16x32_bf16 v[12:15], v[212:215], v[72:75], v[12:15]
    s_waitcnt lgkmcnt(4)
    buffer_load_dwordx4 v46, s[16:19], s78 offen offset:1024 sc1 lds
    v_mfma_f32_16x16x32_bf16 v[8:11], v[216:219], v[76:79], v[8:11]
    buffer_load_dwordx4 v46, s[16:19], s78 offen offset:2048 sc1 lds
    v_mfma_f32_16x16x32_bf16 v[12:15], v[220:223], v[76:79], v[12:15]
    s_waitcnt lgkmcnt(3)
    s_add_u32 s78, s87, s47
    v_mfma_f32_16x16x32_bf16 v[8:11], v[224:227], v[80:83], v[8:11]
    s_add_u32 m0, s87, 98304
    s_add_u32 s78, s78, 128000
    v_mfma_f32_16x16x32_bf16 v[12:15], v[228:231], v[80:83], v[12:15]
    s_waitcnt lgkmcnt(2)
    v_mfma_f32_16x16x32_bf16 v[8:11], v[232:235], v[84:87], v[8:11]
    s_waitcnt vmcnt(3)
    s_barrier
    v_mfma_f32_16x16x32_bf16 v[12:15], v[236:239], v[84:87], v[12:15]
    s_waitcnt lgkmcnt(1)
    v_add_u32 v96, 73728, v96
    v_mfma_f32_16x16x32_bf16 v[8:11], v[240:243], v[88:91], v[8:11]
    buffer_load_dwordx4 v46, s[16:19], s78 offen offset:0 sc1 lds
    ds_read_b128 v[72:75], v96 offset:0
    v_mfma_f32_16x16x32_bf16 v[12:15], v[244:247], v[88:91], v[12:15]
    s_waitcnt lgkmcnt(1)
    ds_read_b128 v[76:79], v96 offset:1024
    v_mfma_f32_16x16x32_bf16 v[8:11], v[248:251], v[92:95], v[8:11]
    buffer_load_dwordx4 v46, s[16:19], s78 offen offset:1024 sc1 lds
    ds_read_b128 v[80:83], v96 offset:2048
    v_mfma_f32_16x16x32_bf16 v[12:15], v[252:255], v[92:95], v[12:15]
    s_waitcnt lgkmcnt(2)
    ds_read_b128 v[84:87], v96 offset:3072
    v_mfma_f32_16x16x32_bf16 v[16:19], a[216:219], v[72:75], v[16:19]
    ds_read_b128 v[88:91], v96 offset:4096
    v_mfma_f32_16x16x32_bf16 v[20:23], a[220:223], v[72:75], v[20:23]
    s_waitcnt lgkmcnt(3)
    ds_read_b128 v[92:95], v96 offset:5120
    v_cvt_pk_bf16_f32 v116, v8, v9
    v_mfma_f32_16x16x32_bf16 v[16:19], a[224:227], v[76:79], v[16:19]
    buffer_load_dwordx4 v46, s[16:19], s78 offen offset:2048 sc1 lds
    v_cvt_pk_bf16_f32 v117, v10, v11
    v_mfma_f32_16x16x32_bf16 v[20:23], a[228:231], v[76:79], v[20:23]
    s_waitcnt lgkmcnt(3)
    v_cvt_pk_bf16_f32 v118, v12, v13
    v_cvt_pk_bf16_f32 v119, v14, v15
    v_mfma_f32_16x16x32_bf16 v[16:19], a[232:235], v[80:83], v[16:19]
    s_or_b32 s79, s46, 5
    v_mfma_f32_16x16x32_bf16 v[100:103], v[116:119], v[116:119], 0
    v_mfma_f32_16x16x32_bf16 v[104:107], v[36:39], v[116:119], 0
    s_nop 3
    v_cndmask_b32 v100, v100, v101, s[60:61]
    v_cndmask_b32 v102, v102, v103, s[60:61]
    s_nop 1
    v_mov_b32 v107, s79
    v_cndmask_b32 v106, v100, v102, s[62:63]
    v_mfma_f32_16x16x32_bf16 v[20:23], a[236:239], v[80:83], v[20:23]
    s_waitcnt lgkmcnt(2)
    v_mfma_f32_16x16x32_bf16 v[16:19], a[240:243], v[84:87], v[16:19]
    buffer_store_dwordx4 v[104:107], v60, s[16:19], s47 offen offset:2560 sc1
    s_waitcnt vmcnt(4)
    s_barrier
    v_mfma_f32_16x16x32_bf16 v[20:23], a[244:247], v[84:87], v[20:23]
    s_waitcnt lgkmcnt(1)
    ds_read_b128 v[72:75], v96 offset:12288
    v_mfma_f32_16x16x32_bf16 v[16:19], a[248:251], v[88:91], v[16:19]
    buffer_load_dwordx4 v[112:115], v61, s[16:19], s47 offen offset:3072 sc1
    ds_read_b128 v[76:79], v96 offset:13312
    v_mfma_f32_16x16x32_bf16 v[20:23], a[252:255], v[88:91], v[20:23]
    s_waitcnt lgkmcnt(2)
    ds_read_b128 v[80:83], v96 offset:14336
    v_mfma_f32_16x16x32_bf16 v[16:19], v[152:155], v[92:95], v[16:19]
    ds_read_b128 v[84:87], v96 offset:15360
    v_mfma_f32_16x16x32_bf16 v[20:23], v[156:159], v[92:95], v[20:23]
    s_waitcnt lgkmcnt(3)
    ds_read_b128 v[88:91], v96 offset:16384
    v_mfma_f32_16x16x32_bf16 v[16:19], v[160:163], v[72:75], v[16:19]
    ds_read_b128 v[92:95], v96 offset:17408
    v_mfma_f32_16x16x32_bf16 v[20:23], v[164:167], v[72:75], v[20:23]
    s_waitcnt lgkmcnt(4)
    v_mfma_f32_16x16x32_bf16 v[16:19], v[168:171], v[76:79], v[16:19]
    s_add_u32 s81, s47, 12288
    buffer_load_dwordx4 v[116:119], v61, s[16:19], s81 offen offset:3072 sc1
    v_mfma_f32_16x16x32_bf16 v[20:23], v[172:175], v[76:79], v[20:23]
    s_waitcnt lgkmcnt(3)
    v_mfma_f32_16x16x32_bf16 v[16:19], v[176:179], v[80:83], v[16:19]
    s_add_u32 s81, s47, 24576
    buffer_load_dwordx4 v[120:123], v69, s[16:19], s81 offen offset:3072 sc1
    v_mfma_f32_16x16x32_bf16 v[20:23], v[180:183], v[80:83], v[20:23]
    s_waitcnt lgkmcnt(2)
    v_mfma_f32_16x16x32_bf16 v[16:19], v[184:187], v[84:87], v[16:19]
    s_waitcnt vmcnt(4)
    s_barrier
    v_mfma_f32_16x16x32_bf16 v[20:23], v[188:191], v[84:87], v[20:23]
    s_waitcnt lgkmcnt(1)
    ds_read_b128 v[72:75], v96 offset:24576
    v_mfma_f32_16x16x32_bf16 v[16:19], v[192:195], v[88:91], v[16:19]
    buffer_load_dwordx4 v[128:131], v61, s[16:19], s47 offen offset:2560 sc1
    ds_read_b128 v[76:79], v96 offset:25600
    v_mfma_f32_16x16x32_bf16 v[20:23], v[196:199], v[88:91], v[20:23]
    s_waitcnt lgkmcnt(2)
    ds_read_b128 v[80:83], v96 offset:26624
    v_mfma_f32_16x16x32_bf16 v[16:19], v[200:203], v[92:95], v[16:19]
    ds_read_b128 v[84:87], v96 offset:27648
    v_mfma_f32_16x16x32_bf16 v[20:23], v[204:207], v[92:95], v[20:23]
    s_waitcnt lgkmcnt(3)
    ds_read_b128 v[88:91], v96 offset:28672
    v_mfma_f32_16x16x32_bf16 v[16:19], v[208:211], v[72:75], v[16:19]
    ds_read_b128 v[92:95], v96 offset:29696
    v_mfma_f32_16x16x32_bf16 v[20:23], v[212:215], v[72:75], v[20:23]
    s_waitcnt lgkmcnt(4)
    v_mfma_f32_16x16x32_bf16 v[16:19], v[216:219], v[76:79], v[16:19]
    s_add_u32 s81, s47, 12288
    buffer_load_dwordx4 v[132:135], v61, s[16:19], s81 offen offset:2560 sc1
    v_mfma_f32_16x16x32_bf16 v[20:23], v[220:223], v[76:79], v[20:23]
    s_waitcnt lgkmcnt(3)
    v_mfma_f32_16x16x32_bf16 v[16:19], v[224:227], v[80:83], v[16:19]
    s_add_u32 s81, s47, 24576
    buffer_load_dwordx4 v[136:139], v69, s[16:19], s81 offen offset:2560 sc1
    v_mfma_f32_16x16x32_bf16 v[20:23], v[228:231], v[80:83], v[20:23]
    s_waitcnt vmcnt(4) lgkmcnt(2)
    v_cmp_ne_u32 s[74:75], s79, v115
    v_cmp_ne_u32 s[92:93], s79, v119
    v_mfma_f32_16x16x32_bf16 v[16:19], v[232:235], v[84:87], v[16:19]
    s_waitcnt vmcnt(3)
    v_cmp_ne_u32 vcc, s79, v123
    s_or_b64 s[74:75], s[74:75], s[92:93]
    v_mfma_f32_16x16x32_bf16 v[20:23], v[236:239], v[84:87], v[20:23]
    s_waitcnt lgkmcnt(1)
    s_and_b32 s92, vcc_lo, 0xffff
    s_or_b32 s74, s74, s75
    v_mfma_f32_16x16x32_bf16 v[16:19], v[240:243], v[88:91], v[16:19]
    s_or_b32 s74, s74, s92
    s_cbranch_scc1 Lre267
Lok265:
    v_add_f32 v112, v112, v116
    v_mfma_f32_16x16x32_bf16 v[20:23], v[244:247], v[88:91], v[20:23]
    s_waitcnt lgkmcnt(0)
    v_add_f32 v113, v113, v117
    v_add_f32 v114, v114, v118
    v_mfma_f32_16x16x32_bf16 v[16:19], v[248:251], v[92:95], v[16:19]
    v_add_f32 v124, v112, v120
    v_add_f32 v125, v113, v121
    v_mfma_f32_16x16x32_bf16 v[20:23], v[252:255], v[92:95], v[20:23]
    v_add_f32_e64 v126, v114, v122
    s_nop 2
    v_cvt_pk_bf16_f32 v112, v16, v17
    v_cvt_pk_bf16_f32 v113, v18, v19
    s_nop 1
    v_cvt_pk_bf16_f32 v114, v20, v21
    v_cvt_pk_bf16_f32 v115, v22, v23
    s_or_b32 s79, s46, 5
    s_nop 0
    v_mfma_f32_16x16x32_bf16 v[100:103], v[112:115], v[112:115], 0
    v_mfma_f32_16x16x32_bf16 v[120:123], v[36:39], v[112:115], 0
    s_nop 3
    v_cndmask_b32 v100, v100, v101, s[60:61]
    v_cndmask_b32 v102, v102, v103, s[60:61]
    s_nop 1
    v_mov_b32_e64 v123, s79
    v_cndmask_b32 v122, v100, v102, s[62:63]
    buffer_store_dwordx4 v[120:123], v60, s[16:19], s47 offen offset:2048 sc1
    s_waitcnt vmcnt(3)
    v_cmp_ne_u32 s[74:75], s79, v131
    s_waitcnt vmcnt(2)
    v_cmp_ne_u32 s[92:93], s79, v135
    s_waitcnt vmcnt(1)
    v_cmp_ne_u32 vcc, s79, v139
    s_or_b64 s[74:75], s[74:75], s[92:93]
    s_and_b32 s92, vcc_lo, 0xffff
    s_or_b32 s74, s74, s75
    s_or_b32 s74, s74, s92
    s_cbranch_scc1 Lre270
Lok268:
    v_add_f32 v128, v128, v132
    v_add_f32 v129, v129, v133
    v_add_f32 v130, v130, v134
    v_add_f32 v128, v128, v136
    v_add_f32 v129, v129, v137
    v_add_f32 v130, v130, v138
    v_permlane32_swap_b32 v124, v128
    v_permlane32_swap_b32 v125, v129
    v_permlane32_swap_b32 v126, v130
    v_add_f32 v124, v124, v128
    v_add_f32 v125, v125, v129
    v_add_f32 v126, v126, v130
    buffer_load_dwordx4 v[112:115], v61, s[16:19], s47 offen offset:2048 sc1
    s_add_u32 s81, s47, 12288
    buffer_load_dwordx4 v[116:119], v61, s[16:19], s81 offen offset:2048 sc1
    s_add_u32 s81, s47, 24576
    buffer_load_dwordx4 v[120:123], v69, s[16:19], s81 offen offset:2048 sc1
    s_waitcnt vmcnt(2)
    v_cmp_ne_u32 s[74:75], s79, v115
    s_waitcnt vmcnt(1)
    v_cmp_ne_u32 s[92:93], s79, v119
    s_waitcnt vmcnt(0)
    v_cmp_ne_u32 vcc, s79, v123
    s_or_b64 s[74:75], s[74:75], s[92:93]
    s_and_b32 s92, vcc_lo, 0xffff
    s_or_b32 s74, s74, s75
    s_or_b32 s74, s74, s92
    s_cbranch_scc1 Lre273
Lok271:
    v_add_f32 v112, v112, v116
    v_add_f32 v113, v113, v117
    v_add_f32 v114, v114, v118
    v_add_f32 v112, v112, v120
    v_add_f32 v113, v113, v121
    v_add_f32 v114, v114, v122
    v_mov_b32 v116, v112
    v_mov_b32 v117, v113
    v_mov_b32 v118, v114
    v_permlane32_swap_b32 v112, v116
    v_permlane32_swap_b32 v113, v117
    v_permlane32_swap_b32 v114, v118
    v_add_f32 v112, v112, v116
    v_add_f32 v113, v113, v117
    v_add_f32 v114, v114, v118
    v_permlane16_swap_b32 v124, v112
    v_permlane16_swap_b32 v125, v113
    v_permlane16_swap_b32 v126, v114
    v_add_f32 v124, v124, v112
    v_add_f32 v125, v125, v113
    v_add_f32_e64 v126, v126, v114
    v_add_f32_dpp v124, v124, v124 row_ror:8 row_mask:0xf bank_mask:0xf
    v_add_f32_dpp v125, v125, v125 row_ror:8 row_mask:0xf bank_mask:0xf
    v_add_f32_dpp v126, v126, v126 row_ror:8 row_mask:0xf bank_mask:0xf
    v_mul_f32 v124, 0xbae38e39, v124
    v_mul_f32 v126, 0x3ae38e39, v126
    v_fma_f32 v126, -v124, v124, v126
    v_max_f32_e64 v126, 0, v126
    v_add_f32 v112, 0x3727c5ac, v126
    v_rsq_f32 v112, v112
    v_fmac_f32 v125, s50, v124
    v_mov_b32 v127, 162820
    v_mul_f32 v125, v125, v112
    v_mul_f32 v113, v124, v112
    v_ashrrev_i32_e64 v114, 31, v125
    v_or_b32 v114, 0x80000000, v114
    v_xor_b32_e64 v125, v125, v114
    v_and_b32 v125, 0xfffff800, v125
    v_or_b32_e64 v125, v125, v67
    v_cndmask_b32 v125, 0, v125, s[88:89]
    ds_write_b32 v66, v112 offset:768
    ds_write_b32 v66, v113 offset:1152
    v_max_u32_dpp v125, v125, v125 row_ror:1 row_mask:0xf bank_mask:0xf
    s_nop 1
    v_max_u32_dpp v125, v125, v125 row_ror:2 row_mask:0xf bank_mask:0xf
    s_nop 1
    v_max_u32_dpp v125, v125, v125 row_ror:4 row_mask:0xf bank_mask:0xf
    s_mov_b32 exec_lo, 0x10001
    s_mov_b32 exec_hi, 1
    ds_max_u32 v127, v125
    s_mov_b64 exec, -1
    s_lshl_b32 s81, s53, 6
    s_add_u32 s81, s81, 768
    v_add_u32 v99, s81, v49
    s_waitcnt lgkmcnt(0)
    s_barrier
    ds_read_b32 v98, v127
    ds_read2_b32 v[124:125], v99 offset0:64 offset1:160
    ds_read2_b32 v[126:127], v99 offset0:32 offset1:128
    ds_read2_b32 v[128:129], v99 offset0:0 offset1:96
    s_mul_i32 s82, s42, 512
    s_add_u32 s82, s82, 917504
    s_or_b32 s81, s41, s40
    s_cselect_b32 s82, 1073741824, s82
    v_mov_b32_e64 v99, s46
    s_mov_b64 exec, 1
    s_waitcnt lgkmcnt(3)
    buffer_store_dwordx2 v[98:99], v46, s[16:19], s82 offen sc1
    s_mov_b64 exec, -1
    v_readfirstlane_b32 s54, v98
    s_mul_i32 s80, s42, 2304
    s_add_u32 s80, s80, 98304
    s_and_b32 s55, s54, 0x7ff
    s_sub_u32 s55, s86, s55
    s_lshr_b32 s55, s55, 1
    s_bfe_u32 s82, s55, 0x10004
    s_waitcnt lgkmcnt(0)
    v_mov_b32_e64 v130, v128
    s_cmp_eq_u32 s82, s53
    s_cbranch_scc0 Lnc274
    s_and_b32 s81, s55, 15
    s_lshl_b32 s74, 0x10001, s81
    s_mov_b32 s75, s74
    s_and_b32 s81, s81, 14
    s_lshl_b32 s92, 0x30003, s81
    s_mov_b32 s93, s92
    s_lshr_b32 s81, s55, 5
    s_cmp_eq_u32 s81, 1
    s_cbranch_scc1 Lsa275
    s_cmp_eq_u32 s81, 0
    s_cbranch_scc1 Lsb276
    v_fma_f32 v130, v0, v124, v125
    v_fma_f32 v131, v1, v124, v125
    v_fma_f32 v132, v2, v124, v125
    v_fma_f32 v133, v3, v124, v125
    v_fma_f32 v134, v4, v124, v125
    v_fma_f32 v135, v5, v124, v125
    v_fma_f32 v136, v6, v124, v125
    v_fma_f32 v137, v7, v124, v125
    s_branch Lsj277
Lsa275:
    v_fma_f32 v130, v8, v126, v127
    v_fma_f32 v131, v9, v126, v127
    v_fma_f32 v132, v10, v126, v127
    v_fma_f32 v133, v11, v126, v127
    v_fma_f32 v134, v12, v126, v127
    v_fma_f32 v135, v13, v126, v127
    v_fma_f32 v136, v14, v126, v127
    v_fma_f32 v137, v15, v126, v127
    s_branch Lsj277
Lsb276:
    v_fma_f32 v130, v16, v128, v129
    v_fma_f32 v131, v17, v128, v129
    v_fma_f32 v132, v18, v128, v129
    v_fma_f32 v133, v19, v128, v129
    v_fma_f32 v134, v20, v128, v129
    v_fma_f32 v135, v21, v128, v129
    v_fma_f32 v136, v22, v128, v129
    v_fma_f32 v137, v23, v128, v129
Lsj277:
    v_cvt_pk_bf16_f32 v130, v130, v131
    v_cvt_pk_bf16_f32 v131, v132, v133
    v_cvt_pk_bf16_f32 v132, v134, v135
    v_cvt_pk_bf16_f32 v133, v136, v137
    s_mov_b64 vcc, s[74:75]
    s_lshl1_add_u32 s82, s41, s52
    s_lshl_b32 s82, s82, 7
    s_add_u32 s82, s82, s80
    v_or_b32 v134, 16, v65
    v_cndmask_b32 v134, v134, v65, vcc
    v_cndmask_b32_dpp v130, v132, v130, vcc quad_perm:[1,0,3,2] row_mask:0xf bank_mask:0xf
    v_cndmask_b32_dpp v131, v133, v131, vcc quad_perm:[1,0,3,2] row_mask:0xf bank_mask:0xf
    v_mov_b32_e64 v132, s54
    v_mov_b32 v133, s46
    s_mov_b64 exec, s[92:93]
    buffer_store_dwordx4 v[130:133], v134, s[16:19], s82 offen sc1
    s_mov_b64 exec, -1
Lnc274:
    v_mul_u32_u24 v32, 32, v46
    v_min_u32 v32, 11776, v32
    v_add_f32_e64 v124, 1.0, v124
    v_pk_fma_f32 v[0:1], v[0:1], v[124:125], v[124:125] op_sel:[0,0,1] op_sel_hi:[1,0,1]
    v_pk_fma_f32 v[2:3], v[2:3], v[124:125], v[124:125] op_sel:[0,0,1] op_sel_hi:[1,0,1]
    v_pk_fma_f32 v[4:5], v[4:5], v[124:125], v[124:125] op_sel:[0,0,1] op_sel_hi:[1,0,1]
    v_pk_fma_f32 v[6:7], v[6:7], v[124:125], v[124:125] op_sel:[0,0,1] op_sel_hi:[1,0,1]
    v_cvt_pk_bf16_f32 v72, v0, v1
    v_cvt_pk_bf16_f32 v73, v2, v3
    v_cvt_pk_bf16_f32 v74, v4, v5
    v_cvt_pk_bf16_f32 v75, v6, v7
    v_add_u32 v33, 147456, v62
    buffer_store_dwordx4 v[72:75], v33, s[20:23], 0 offen sc0 sc1
    v_add_f32_e64 v126, 1.0, v126
    v_pk_fma_f32 v[8:9], v[8:9], v[126:127], v[126:127] op_sel:[0,0,1] op_sel_hi:[1,0,1]
    v_pk_fma_f32 v[10:11], v[10:11], v[126:127], v[126:127] op_sel:[0,0,1] op_sel_hi:[1,0,1]
    v_pk_fma_f32 v[12:13], v[12:13], v[126:127], v[126:127] op_sel:[0,0,1] op_sel_hi:[1,0,1]
    v_pk_fma_f32 v[14:15], v[14:15], v[126:127], v[126:127] op_sel:[0,0,1] op_sel_hi:[1,0,1]
    v_cvt_pk_bf16_f32 v76, v8, v9
    v_cvt_pk_bf16_f32 v77, v10, v11
    v_cvt_pk_bf16_f32 v78, v12, v13
    v_cvt_pk_bf16_f32 v79, v14, v15
    v_add_u32 v34, 73728, v62
    buffer_store_dwordx4 v[76:79], v34, s[20:23], 0 offen sc0 sc1
    v_add_f32_e64 v128, 1.0, v128
    v_pk_fma_f32 v[16:17], v[16:17], v[128:129], v[128:129] op_sel:[0,0,1] op_sel_hi:[1,0,1]
    v_pk_fma_f32 v[18:19], v[18:19], v[128:129], v[128:129] op_sel:[0,0,1] op_sel_hi:[1,0,1]
    v_pk_fma_f32 v[20:21], v[20:21], v[128:129], v[128:129] op_sel:[0,0,1] op_sel_hi:[1,0,1]
    v_pk_fma_f32 v[22:23], v[22:23], v[128:129], v[128:129] op_sel:[0,0,1] op_sel_hi:[1,0,1]
    v_cvt_pk_bf16_f32 v80, v16, v17
    v_cvt_pk_bf16_f32 v81, v18, v19
    v_cvt_pk_bf16_f32 v82, v20, v21
    v_cvt_pk_bf16_f32 v83, v22, v23
    s_cmp_eq_u32 s44, 0
    s_cselect_b32 s81, 0, 0xff00ff00
    s_cmp_eq_u32 s53, 0
    s_cselect_b32 exec_lo, s81, -1
    s_mov_b32 exec_hi, exec_lo
    buffer_store_dwordx4 v[80:83], v62, s[20:23], 0 offen sc0 sc1
    s_mov_b64 exec, -1
    s_bfe_u32 s82, s55, 0x10004
    s_cmp_eq_u32 s82, s53
    s_cbranch_scc0 L_done
    s_mov_b32 s83, 0
Lspin280:
    s_mov_b32 s81, 917504
    buffer_load_dwordx2 v[108:109], v32, s[16:19], s81 offen sc1
    s_add_u32 s83, s83, 1
    s_cmp_gt_u32 s83, 100000
    s_cbranch_scc1 L_end
    s_waitcnt vmcnt(0)
    v_cmp_eq_u32 s[90:91], s46, v109
    v_cmp_lt_u32_e64 vcc, s54, v108
    s_nop 0
    s_and_b64 vcc, vcc, s[90:91]
    s_cbranch_scc1 L_done
    s_and_b32 s81, s90, 0xffffff
    s_bcnt1_i32_b32 s81, s81
    s_cmp_ge_u32 s81, 22
    s_cbranch_scc0 Lspin280
    s_and_b32 s81, s55, 15
    s_lshl_b32 s74, 0x10001, s81
    s_mov_b32 s75, s74
    s_and_b32 s81, s81, 14
    s_lshl_b32 s92, 0x30003, s81
    s_mov_b32 s93, s92
    s_lshr_b32 s81, s55, 5
    s_mov_b64 vcc, s[74:75]
    v_mov_b32 v112, 0
    v_mov_b32 v113, 0
    v_mov_b32 v114, 0
    v_mov_b32_e64 v115, 0
    s_cmp_eq_u32 s81, 1
    s_cbranch_scc1 Lsa281
    s_cmp_eq_u32 s81, 0
    s_cbranch_scc1 Lsb282
    v_cndmask_b32_dpp v120, v0, v0, vcc quad_perm:[1,0,3,2] row_mask:0xf bank_mask:0xf
    v_cndmask_b32_dpp v121, v1, v1, vcc quad_perm:[1,0,3,2] row_mask:0xf bank_mask:0xf
    v_cndmask_b32_dpp v122, v2, v2, vcc quad_perm:[1,0,3,2] row_mask:0xf bank_mask:0xf
    v_cndmask_b32_dpp v123, v3, v3, vcc quad_perm:[1,0,3,2] row_mask:0xf bank_mask:0xf
    v_cndmask_b32_dpp v124, v4, v4, vcc quad_perm:[1,0,3,2] row_mask:0xf bank_mask:0xf
    v_cndmask_b32_dpp v125, v5, v5, vcc quad_perm:[1,0,3,2] row_mask:0xf bank_mask:0xf
    v_cndmask_b32_dpp v126, v6, v6, vcc quad_perm:[1,0,3,2] row_mask:0xf bank_mask:0xf
    v_cndmask_b32_dpp v127, v7, v7, vcc quad_perm:[1,0,3,2] row_mask:0xf bank_mask:0xf
    s_branch Lsj283
Lsa281:
    v_cndmask_b32_dpp v120, v8, v8, vcc quad_perm:[1,0,3,2] row_mask:0xf bank_mask:0xf
    v_cndmask_b32_dpp v121, v9, v9, vcc quad_perm:[1,0,3,2] row_mask:0xf bank_mask:0xf
    v_cndmask_b32_dpp v122, v10, v10, vcc quad_perm:[1,0,3,2] row_mask:0xf bank_mask:0xf
    v_cndmask_b32_dpp v123, v11, v11, vcc quad_perm:[1,0,3,2] row_mask:0xf bank_mask:0xf
    v_cndmask_b32_dpp v124, v12, v12, vcc quad_perm:[1,0,3,2] row_mask:0xf bank_mask:0xf
    v_cndmask_b32_dpp v125, v13, v13, vcc quad_perm:[1,0,3,2] row_mask:0xf bank_mask:0xf
    v_cndmask_b32_dpp v126, v14, v14, vcc quad_perm:[1,0,3,2] row_mask:0xf bank_mask:0xf
    v_cndmask_b32_dpp v127, v15, v15, vcc quad_perm:[1,0,3,2] row_mask:0xf bank_mask:0xf
    s_branch Lsj283
Lsb282:
    v_cndmask_b32_dpp v120, v16, v16, vcc quad_perm:[1,0,3,2] row_mask:0xf bank_mask:0xf
    v_cndmask_b32_dpp v121, v17, v17, vcc quad_perm:[1,0,3,2] row_mask:0xf bank_mask:0xf
    v_cndmask_b32_dpp v122, v18, v18, vcc quad_perm:[1,0,3,2] row_mask:0xf bank_mask:0xf
    v_cndmask_b32_dpp v123, v19, v19, vcc quad_perm:[1,0,3,2] row_mask:0xf bank_mask:0xf
    v_cndmask_b32_dpp v124, v20, v20, vcc quad_perm:[1,0,3,2] row_mask:0xf bank_mask:0xf
    v_cndmask_b32_dpp v125, v21, v21, vcc quad_perm:[1,0,3,2] row_mask:0xf bank_mask:0xf
    v_cndmask_b32_dpp v126, v22, v22, vcc quad_perm:[1,0,3,2] row_mask:0xf bank_mask:0xf
    v_cndmask_b32_dpp v127, v23, v23, vcc quad_perm:[1,0,3,2] row_mask:0xf bank_mask:0xf
Lsj283:
    s_mov_b64 exec, s[92:93]
    v_cndmask_b32 v112, v120, v124, s[60:61]
    v_cndmask_b32 v113, v121, v125, s[60:61]
    v_cndmask_b32 v114, v122, v126, s[60:61]
    v_cndmask_b32 v115, v123, v127, s[60:61]
    s_mov_b64 exec, -1
    s_mul_i32 s78, s81, 73728
    v_cndmask_b32_dpp v33, v62, v62, vcc quad_perm:[1,0,3,2] row_mask:0xf bank_mask:0xf
    v_bfe_u32 v34, v46, 1, 4
    v_add3_u32 v33, v33, v34, s78
    v_cvt_pk_bf16_f32 v118, v112, v113
    v_cvt_pk_bf16_f32 v119, v114, v115
    v_bfe_u32 v85, v46, 5, 3
    v_mul_u32_u24 v85, 2304, v85
    v_and_b32 v84, 16, v46
    v_and_b32 v86, 0, v65
    v_add3_u32 v85, v85, v84, v86
    v_add_u32_e64 v85, v85, v65
    s_lshl1_add_u32 s76, s41, s52
    s_lshl_b32 s76, s76, 7
    s_add_u32 s76, s76, 335872
    s_not_b32 s77, s46
    v_mov_b32 v168, 0
    v_mov_b32 v169, 0
    v_mov_b32 v170, s54
    v_mov_b32 v171, s46
    v_mov_b32 v190, 0
    v_mov_b32 v191, 0
    v_mov_b32 v192, s54
    v_mov_b32 v193, s46
    v_mov_b32 v177, s77
    v_mov_b32 v195, s77
    v_mov_b32 v212, 0
    v_mov_b32 v213, 0
    v_mov_b32 v214, s54
    v_mov_b32 v215, s46
    v_mov_b32 v199, s77
    v_mov_b32_e64 v217, s77
    s_mov_b64 exec, 0
    s_branch Lpk287
Ldry284:
    s_mov_b64 exec, -1
    s_mov_b32 s83, 0
Lspin285:
    s_mov_b32 s81, 917504
    buffer_load_dwordx2 v[172:173], v32, s[16:19], s81 offen sc1
    buffer_load_dwordx4 v[152:155], v85, s[16:19], s76 offen sc1
    s_add_u32 s77, s76, 18432
    buffer_load_dwordx4 v[156:159], v85, s[16:19], s77 offen sc1
    s_add_u32 s77, s76, 36864
    buffer_load_dwordx4 v[160:163], v85, s[16:19], s77 offen sc1
    s_add_u32 s77, s76, 55296
    buffer_load_dwordx4 v[164:167], v85, s[16:19], s77 offen sc1
    s_add_u32 s77, s76, 73728
    s_mov_b32 exec_lo, 0x00ff00ff
    s_mov_b32 exec_hi, exec_lo
    buffer_load_dwordx4 v[168:171], v85, s[16:19], s77 offen sc1
    s_mov_b64 exec, -1
    s_waitcnt vmcnt(12)
    v_cmp_eq_u32 s[90:91], s46, v195
    v_cmp_lt_u32 vcc, s54, v194
    s_nop 0
    s_and_b64 vcc, vcc, s[90:91]
    s_cbranch_scc1 L_done
    v_xor_b32 v84, s54, v176
    v_xor_b32 v86, s46, v177
    v_or_b32 v84, v84, v86
    v_xor_b32 v86, s54, v180
    v_xor_b32 v87, s46, v181
    v_or3_b32 v84, v84, v86, v87
    v_xor_b32 v86, s54, v184
    v_xor_b32 v87, s46, v185
    v_or3_b32 v84, v84, v86, v87
    v_xor_b32 v86, s54, v188
    v_xor_b32 v87, s46, v189
    v_or3_b32 v84, v84, v86, v87
    v_xor_b32 v86, s54, v192
    v_xor_b32 v87, s46, v193
    v_or3_b32 v84, v84, v86, v87
    v_cmp_ne_u32 vcc, 0, v84
    s_cbranch_vccz Lpk288
    s_mov_b32 s81, 917504
    buffer_load_dwordx2 v[194:195], v32, s[16:19], s81 offen sc1
    buffer_load_dwordx4 v[174:177], v85, s[16:19], s76 offen sc1
    s_add_u32 s77, s76, 18432
    buffer_load_dwordx4 v[178:181], v85, s[16:19], s77 offen sc1
    s_add_u32 s77, s76, 36864
    buffer_load_dwordx4 v[182:185], v85, s[16:19], s77 offen sc1
    s_add_u32 s77, s76, 55296
    buffer_load_dwordx4 v[186:189], v85, s[16:19], s77 offen sc1
    s_add_u32 s77, s76, 73728
    s_mov_b32 exec_lo, 0x00ff00ff
    s_mov_b32 exec_hi, exec_lo
    buffer_load_dwordx4 v[190:193], v85, s[16:19], s77 offen sc1
    s_mov_b64 exec, -1
    s_waitcnt vmcnt(12)
    v_cmp_eq_u32 s[90:91], s46, v217
    v_cmp_lt_u32 vcc, s54, v216
    s_nop 0
    s_and_b64 vcc, vcc, s[90:91]
    s_cbranch_scc1 L_done
    v_xor_b32 v84, s54, v198
    v_xor_b32 v86, s46, v199
    v_or_b32 v84, v84, v86
    v_xor_b32 v86, s54, v202
    v_xor_b32 v87, s46, v203
    v_or3_b32 v84, v84, v86, v87
    v_xor_b32 v86, s54, v206
    v_xor_b32 v87, s46, v207
    v_or3_b32 v84, v84, v86, v87
    v_xor_b32 v86, s54, v210
    v_xor_b32 v87, s46, v211
    v_or3_b32 v84, v84, v86, v87
    v_xor_b32 v86, s54, v214
    v_xor_b32 v87, s46, v215
    v_or3_b32 v84, v84, v86, v87
    v_cmp_ne_u32 vcc, 0, v84
    s_cbranch_vccz Lpk289
    s_mov_b32 s81, 917504
    buffer_load_dwordx2 v[216:217], v32, s[16:19], s81 offen sc1
    buffer_load_dwordx4 v[196:199], v85, s[16:19], s76 offen sc1
    s_add_u32 s77, s76, 18432
    buffer_load_dwordx4 v[200:203], v85, s[16:19], s77 offen sc1
    s_add_u32 s77, s76, 36864
    buffer_load_dwordx4 v[204:207], v85, s[16:19], s77 offen sc1
    s_add_u32 s77, s76, 55296
    buffer_load_dwordx4 v[208:211], v85, s[16:19], s77 offen sc1
    s_add_u32 s77, s76, 73728
    s_mov_b32 exec_lo, 0x00ff00ff
    s_mov_b32 exec_hi, exec_lo
    buffer_load_dwordx4 v[212:215], v85, s[16:19], s77 offen sc1
    s_mov_b64 exec, -1
    s_waitcnt vmcnt(12)
    v_cmp_eq_u32 s[90:91], s46, v173
    v_cmp_lt_u32 vcc, s54, v172
    s_nop 0
    s_and_b64 vcc, vcc, s[90:91]
    s_cbranch_scc1 L_done
    v_xor_b32 v84, s54, v154
    v_xor_b32 v86, s46, v155
    v_or_b32 v84, v84, v86
    v_xor_b32 v86, s54, v158
    v_xor_b32 v87, s46, v159
    v_or3_b32 v84, v84, v86, v87
    v_xor_b32 v86, s54, v162
    v_xor_b32 v87, s46, v163
    v_or3_b32 v84, v84, v86, v87
    v_xor_b32 v86, s54, v166
    v_xor_b32 v87, s46, v167
    v_or3_b32 v84, v84, v86, v87
    v_xor_b32 v86, s54, v170
    v_xor_b32 v87, s46, v171
    v_or3_b32 v84, v84, v86, v87
    v_cmp_ne_u32_e64 vcc, 0, v84
    s_cbranch_vccz Lpk287
    s_add_u32 s83, s83, 1
    s_cmp_gt_u32 s83, 100000
    s_cbranch_scc0 Lspin285
    s_branch L_end
Lpk287:
    v_and_b32 v155, 0xffff0000, v153
    v_lshlrev_b32_e64 v154, 16, v153
    v_and_b32 v153, 0xffff0000, v152
    v_lshlrev_b32_e64 v152, 16, v152
    v_pk_add_f32 v[114:115], v[114:115], v[154:155]
    v_pk_add_f32 v[112:113], v[112:113], v[152:153]
    v_and_b32 v159, 0xffff0000, v157
    v_lshlrev_b32_e64 v158, 16, v157
    v_and_b32 v157, 0xffff0000, v156
    v_lshlrev_b32_e64 v156, 16, v156
    v_pk_add_f32 v[114:115], v[114:115], v[158:159]
    v_pk_add_f32 v[112:113], v[112:113], v[156:157]
    v_and_b32 v163, 0xffff0000, v161
    v_lshlrev_b32_e64 v162, 16, v161
    v_and_b32 v161, 0xffff0000, v160
    v_lshlrev_b32_e64 v160, 16, v160
    v_pk_add_f32 v[114:115], v[114:115], v[162:163]
    v_pk_add_f32 v[112:113], v[112:113], v[160:161]
    v_and_b32 v167, 0xffff0000, v165
    v_lshlrev_b32_e64 v166, 16, v165
    v_and_b32 v165, 0xffff0000, v164
    v_lshlrev_b32_e64 v164, 16, v164
    v_pk_add_f32 v[114:115], v[114:115], v[166:167]
    v_pk_add_f32 v[112:113], v[112:113], v[164:165]
    v_and_b32 v171, 0xffff0000, v169
    v_lshlrev_b32_e64 v170, 16, v169
    v_and_b32 v169, 0xffff0000, v168
    v_lshlrev_b32_e64 v168, 16, v168
    v_pk_add_f32 v[114:115], v[114:115], v[170:171]
    v_pk_add_f32 v[112:113], v[112:113], v[168:169]
    s_cbranch_execnz Lpj286
Lpk288:
    v_and_b32 v177, 0xffff0000, v175
    v_lshlrev_b32 v176, 16, v175
    v_and_b32 v175, 0xffff0000, v174
    v_lshlrev_b32_e64 v174, 16, v174
    v_pk_add_f32 v[114:115], v[114:115], v[176:177]
    v_pk_add_f32 v[112:113], v[112:113], v[174:175]
    v_and_b32 v181, 0xffff0000, v179
    v_lshlrev_b32_e64 v180, 16, v179
    v_and_b32 v179, 0xffff0000, v178
    v_lshlrev_b32_e64 v178, 16, v178
    v_pk_add_f32 v[114:115], v[114:115], v[180:181]
    v_pk_add_f32 v[112:113], v[112:113], v[178:179]
    v_and_b32 v185, 0xffff0000, v183
    v_lshlrev_b32_e64 v184, 16, v183
    v_and_b32 v183, 0xffff0000, v182
    v_lshlrev_b32_e64 v182, 16, v182
    v_pk_add_f32 v[114:115], v[114:115], v[184:185]
    v_pk_add_f32 v[112:113], v[112:113], v[182:183]
    v_and_b32 v189, 0xffff0000, v187
    v_lshlrev_b32_e64 v188, 16, v187
    v_and_b32 v187, 0xffff0000, v186
    v_lshlrev_b32_e64 v186, 16, v186
    v_pk_add_f32 v[114:115], v[114:115], v[188:189]
    v_pk_add_f32 v[112:113], v[112:113], v[186:187]
    v_and_b32 v193, 0xffff0000, v191
    v_lshlrev_b32_e64 v192, 16, v191
    v_and_b32 v191, 0xffff0000, v190
    v_lshlrev_b32_e64 v190, 16, v190
    v_pk_add_f32 v[114:115], v[114:115], v[192:193]
    v_pk_add_f32 v[112:113], v[112:113], v[190:191]
    s_cbranch_execnz Lpj286
Lpk289:
    v_and_b32 v199, 0xffff0000, v197
    v_lshlrev_b32 v198, 16, v197
    v_and_b32 v197, 0xffff0000, v196
    v_lshlrev_b32_e64 v196, 16, v196
    v_pk_add_f32 v[114:115], v[114:115], v[198:199]
    v_pk_add_f32 v[112:113], v[112:113], v[196:197]
    v_and_b32 v203, 0xffff0000, v201
    v_lshlrev_b32_e64 v202, 16, v201
    v_and_b32 v201, 0xffff0000, v200
    v_lshlrev_b32_e64 v200, 16, v200
    v_pk_add_f32 v[114:115], v[114:115], v[202:203]
    v_pk_add_f32 v[112:113], v[112:113], v[200:201]
    v_and_b32 v207, 0xffff0000, v205
    v_lshlrev_b32_e64 v206, 16, v205
    v_and_b32 v205, 0xffff0000, v204
    v_lshlrev_b32_e64 v204, 16, v204
    v_pk_add_f32 v[114:115], v[114:115], v[206:207]
    v_pk_add_f32 v[112:113], v[112:113], v[204:205]
    v_and_b32 v211, 0xffff0000, v209
    v_lshlrev_b32_e64 v210, 16, v209
    v_and_b32 v209, 0xffff0000, v208
    v_lshlrev_b32_e64 v208, 16, v208
    v_pk_add_f32 v[114:115], v[114:115], v[210:211]
    v_pk_add_f32 v[112:113], v[112:113], v[208:209]
    v_and_b32 v215, 0xffff0000, v213
    v_lshlrev_b32_e64 v214, 16, v213
    v_and_b32 v213, 0xffff0000, v212
    v_lshlrev_b32 v212, 16, v212
    v_pk_add_f32 v[114:115], v[114:115], v[214:215]
    v_pk_add_f32 v[112:113], v[112:113], v[212:213]
Lpj286:
    s_nop 1
    v_add_f32_dpp v112, v112, v112 row_ror:2 row_mask:0xf bank_mask:0xf
    v_add_f32_dpp v113, v113, v113 row_ror:2 row_mask:0xf bank_mask:0xf
    v_add_f32_dpp v114, v114, v114 row_ror:2 row_mask:0xf bank_mask:0xf
    v_add_f32_dpp v115, v115, v115 row_ror:2 row_mask:0xf bank_mask:0xf
    v_add_f32_dpp v112, v112, v112 row_ror:4 row_mask:0xf bank_mask:0xf
    v_add_f32_dpp v113, v113, v113 row_ror:4 row_mask:0xf bank_mask:0xf
    v_add_f32_dpp v114, v114, v114 row_ror:4 row_mask:0xf bank_mask:0xf
    v_add_f32_dpp v115, v115, v115 row_ror:4 row_mask:0xf bank_mask:0xf
    v_add_f32_dpp v112, v112, v112 row_ror:8 row_mask:0xf bank_mask:0xf
    v_add_f32_dpp v113, v113, v113 row_ror:8 row_mask:0xf bank_mask:0xf
    v_add_f32_dpp v114, v114, v114 row_ror:8 row_mask:0xf bank_mask:0xf
    v_add_f32_dpp v115, v115, v115 row_ror:8 row_mask:0xf bank_mask:0xf
    v_cvt_pk_bf16_f32 v116, v112, v113
    v_cvt_pk_bf16_f32 v117, v114, v115
    s_and_b64 exec, exec, s[92:93]
    buffer_store_dwordx2 v[116:117], v33, s[20:23], 0 offen sc0 sc1
    s_cbranch_execz Ldry284
    s_mov_b64 exec, -1
    s_cmp_eq_u32 s90, -1
    s_cbranch_scc1 L_done
    s_not_b32 s77, s46
    v_mov_b32 v243, s77
    v_mov_b32 v245, s77
    v_mov_b32 v247, s77
    s_mov_b32 s83, 0
Lspin291:
    s_mov_b32 s81, 917504
    buffer_load_dwordx2 v[240:241], v32, s[16:19], s81 offen sc1
    s_waitcnt vmcnt(3)
    v_cmp_eq_u32 s[90:91], s46, v243
    v_cmp_lt_u32 vcc, s54, v242
    s_nop 0
    s_and_b64 vcc, vcc, s[90:91]
    s_cbranch_scc1 Lback290
    s_cmp_eq_u32 s90, -1
    s_cbranch_scc1 L_done
    s_mov_b32 s81, 917504
    buffer_load_dwordx2 v[242:243], v32, s[16:19], s81 offen sc1
    s_waitcnt vmcnt(3)
    v_cmp_eq_u32 s[90:91], s46, v245
    v_cmp_lt_u32 vcc, s54, v244
    s_nop 0
    s_and_b64 vcc, vcc, s[90:91]
    s_cbranch_scc1 Lback290
    s_cmp_eq_u32 s90, -1
    s_cbranch_scc1 L_done
    s_mov_b32 s81, 917504
    buffer_load_dwordx2 v[244:245], v32, s[16:19], s81 offen sc1
    s_waitcnt vmcnt(3)
    v_cmp_eq_u32 s[90:91], s46, v247
    v_cmp_lt_u32 vcc, s54, v246
    s_nop 0
    s_and_b64 vcc, vcc, s[90:91]
    s_cbranch_scc1 Lback290
    s_cmp_eq_u32 s90, -1
    s_cbranch_scc1 L_done
    s_mov_b32 s81, 917504
    buffer_load_dwordx2 v[246:247], v32, s[16:19], s81 offen sc1
    s_waitcnt vmcnt(3)
    v_cmp_eq_u32 s[90:91], s46, v241
    v_cmp_lt_u32_e64 vcc, s54, v240
    s_nop 0
    s_and_b64 vcc, vcc, s[90:91]
    s_cbranch_scc1 Lback290
    s_cmp_eq_u32 s90, -1
    s_cbranch_scc1 L_done
    s_add_u32 s83, s83, 1
    s_cmp_gt_u32 s83, 100000
    s_cbranch_scc0 Lspin291
    s_branch L_end
Lpj292:
Lback290:
    s_mov_b64 exec, s[92:93]
    buffer_store_dwordx2 v[118:119], v33, s[20:23], 0 offen sc0 sc1
    s_branch L_done
Lre169:
    s_mov_b32 s83, 0
Lrt168:
    buffer_inv sc1
    s_waitcnt vmcnt(0)
    buffer_load_dwordx4 v[224:227], v46, s[16:19], s59 offen offset:3072 sc1
    buffer_load_dwordx4 v[228:231], v46, s[16:19], s32 offen offset:0 sc1
    buffer_load_dwordx4 v[232:235], v46, s[16:19], s32 offen offset:1024 sc1
    s_add_u32 s83, s83, 1
    s_cmp_gt_u32 s83, 100000
    s_cbranch_scc1 L_end
    s_waitcnt vmcnt(0)
    v_xor_b32 v227, s46, v227
    v_xor_b32 v231, s46, v231
    v_xor_b32 v235, s46, v235
    v_or3_b32 v227, v227, v231, v235
    v_cmp_lt_u32_e64 vcc, 0, v227
    ds_write_b64 v63, v[224:225] offset:8064
    ds_write_b32 v64, v226 offset:24
    ds_write_b64 v63, v[228:229] offset:10752
    ds_write_b32 v64, v230 offset:32
    ds_write_b64 v63, v[232:233] offset:13440
    ds_write_b32 v64, v234 offset:40
    s_cmp_lg_u64 vcc, 0
    s_cbranch_scc1 Lrt168
    s_branch Lok167
Lre174:
    s_mov_b32 s83, 0
Lrt173:
    buffer_inv sc1
    s_waitcnt vmcnt(0)
    buffer_load_dwordx4 v[184:187], v46, s[16:19], s59 offen offset:2048 sc1
    buffer_load_dwordx4 v[188:191], v46, s[16:19], s59 offen offset:1024 sc1
    buffer_load_dwordx4 v[192:195], v46, s[16:19], s59 offen offset:0 sc1
    s_add_u32 s83, s83, 1
    s_cmp_gt_u32 s83, 100000
    s_cbranch_scc1 L_end
    s_waitcnt vmcnt(0)
    v_xor_b32 v187, s46, v187
    v_xor_b32 v191, s46, v191
    v_xor_b32_e64 v195, s46, v195
    v_or3_b32 v187, v187, v191, v195
    v_cmp_lt_u32_e64 vcc, 0, v187
    ds_write_b64 v63, v[184:185] offset:5376
    ds_write_b32 v64, v186 offset:16
    ds_write_b64 v63, v[188:189] offset:2688
    ds_write_b32 v64, v190 offset:8
    ds_write_b64 v63, v[192:193] offset:0
    ds_write_b32 v64, v194 offset:0
    s_cmp_lg_u64 vcc, 0
    s_cbranch_scc1 Lrt173
    s_branch Lok172
Lre177:
    s_mov_b32 s83, 0
Lrt176:
    buffer_load_dword v146, v58, s[16:19], s47 offen offset:0 sc1
    s_add_u32 s83, s83, 1
    s_nop 0
    s_cmp_gt_u32 s83, 100000
    s_cbranch_scc1 L_end
    s_waitcnt vmcnt(0)
    v_cmp_ne_u32 s[34:35], s46, v146
    s_nop 0
    s_cmp_lg_u64 s[34:35], 0
    s_cbranch_scc1 Lrt176
    s_branch Lok175
Lre180:
    s_mov_b32 s83, 0
Lrt179:
    buffer_load_dword v146, v58, s[16:19], s47 offen offset:160 sc1
    s_add_u32 s83, s83, 1
    s_cmp_gt_u32 s83, 100000
    s_cbranch_scc1 L_end
    s_waitcnt vmcnt(0)
    v_cmp_ne_u32 s[34:35], s46, v146
    s_nop 0
    s_cmp_lg_u64 s[34:35], 0
    s_cbranch_scc1 Lrt179
    s_branch Lok178
Lre184:
    s_mov_b32 s83, 0
Lrt183:
    buffer_load_dword v98, v58, s[16:19], s47 offen offset:320 sc1
    s_add_u32 s83, s83, 1
    s_cmp_gt_u32 s83, 100000
    s_cbranch_scc1 L_end
    s_waitcnt vmcnt(0)
    v_cmp_ne_u32 s[34:35], s46, v98
    s_nop 0
    s_cmp_lg_u64 s[34:35], 0
    s_cbranch_scc1 Lrt183
    s_branch Lok182
Lre191:
    s_mov_b32 s83, 0
Lrt190:
    buffer_load_dword v98, v59, s[16:19], s47 offen offset:960 sc1
    s_add_u32 s83, s83, 1
    s_cmp_gt_u32 s83, 100000
    s_cbranch_scc1 L_end
    s_waitcnt vmcnt(0)
    v_cmp_ne_u32 s[34:35], s46, v98
    s_nop 0
    s_cmp_lg_u64 s[34:35], 0
    s_cbranch_scc1 Lrt190
    s_branch Lok189
Lre198:
    s_mov_b32 s83, 0
Lrt197:
    buffer_load_dword v33, v59, s[16:19], s47 offen offset:1120 sc1
    s_add_u32 s83, s83, 1
    s_cmp_gt_u32 s83, 100000
    s_cbranch_scc1 L_end
    s_waitcnt vmcnt(0)
    v_cmp_ne_u32 s[34:35], s46, v33
    s_nop 0
    s_cmp_lg_u64 s[34:35], 0
    s_cbranch_scc1 Lrt197
    s_branch Lok196
Lre205:
    s_mov_b32 s83, 0
Lrt204:
    buffer_load_dword v33, v59, s[16:19], s47 offen offset:1280 sc1
    s_add_u32 s83, s83, 1
    s_cmp_gt_u32 s83, 100000
    s_cbranch_scc1 L_end
    s_waitcnt vmcnt(0)
    v_cmp_ne_u32 s[34:35], s46, v33
    s_nop 0
    s_cmp_lg_u64 s[34:35], 0
    s_cbranch_scc1 Lrt204
    s_branch Lok203
Lre209:
    s_mov_b32 s83, 0
Lrt208:
    buffer_load_dword v34, v59, s[16:19], s94 offen offset:1120 sc1
    s_add_u32 s83, s83, 1
    s_cmp_gt_u32 s83, 100000
    s_cbranch_scc1 L_end
    s_waitcnt vmcnt(0)
    v_cmp_ne_u32 s[34:35], s46, v34
    s_nop 0
    s_cmp_lg_u64 s[34:35], 0
    s_cbranch_scc1 Lrt208
    s_branch Lok207
Lre213:
    s_mov_b32 s83, 0
Lrt212:
    buffer_inv sc1
    s_waitcnt vmcnt(0)
    buffer_load_dwordx4 v[128:131], v61, s[16:19], s47 offen offset:3072 sc1
    s_add_u32 s81, s47, 12288
    buffer_load_dwordx4 v[132:135], v61, s[16:19], s81 offen offset:3072 sc1
    s_add_u32 s81, s47, 24576
    buffer_load_dwordx4 v[136:139], v69, s[16:19], s81 offen offset:3072 sc1
    s_add_u32 s83, s83, 1
    s_cmp_gt_u32 s83, 100000
    s_cbranch_scc1 L_end
    s_waitcnt vmcnt(0)
    v_cmp_ne_u32 s[74:75], s79, v131
    v_cmp_ne_u32 s[92:93], s79, v135
    v_cmp_ne_u32 vcc, s79, v139
    s_or_b64 s[74:75], s[74:75], s[92:93]
    s_and_b32 s92, vcc_lo, 0xffff
    s_or_b32 s74, s74, s75
    s_or_b32 s74, s74, s92
    s_cbranch_scc1 Lrt212
    s_branch Lok211
Lre216:
    s_mov_b32 s83, 0
Lrt215:
    buffer_inv sc1
    s_waitcnt vmcnt(0)
    buffer_load_dwordx4 v[140:143], v61, s[16:19], s47 offen offset:2560 sc1
    s_add_u32 s81, s47, 12288
    buffer_load_dwordx4 v[144:147], v61, s[16:19], s81 offen offset:2560 sc1
    s_add_u32 s81, s47, 24576
    buffer_load_dwordx4 v[148:151], v69, s[16:19], s81 offen offset:2560 sc1
    s_add_u32 s83, s83, 1
    s_cmp_gt_u32 s83, 100000
    s_cbranch_scc1 L_end
    s_waitcnt vmcnt(0)
    v_cmp_ne_u32 s[74:75], s79, v143
    v_cmp_ne_u32 s[92:93], s79, v147
    v_cmp_ne_u32 vcc, s79, v151
    s_or_b64 s[74:75], s[74:75], s[92:93]
    s_and_b32 s92, vcc_lo, 0xffff
    s_or_b32 s74, s74, s75
    s_or_b32 s74, s74, s92
    s_cbranch_scc1 Lrt215
    s_branch Lok214
Lre219:
    s_mov_b32 s83, 0
Lrt218:
    buffer_inv sc1
    s_waitcnt vmcnt(0)
    buffer_load_dwordx4 v[128:131], v61, s[16:19], s47 offen offset:2048 sc1
    s_add_u32 s81, s47, 12288
    buffer_load_dwordx4 v[132:135], v61, s[16:19], s81 offen offset:2048 sc1
    s_add_u32 s81, s47, 24576
    buffer_load_dwordx4 v[136:139], v69, s[16:19], s81 offen offset:2048 sc1
    s_add_u32 s83, s83, 1
    s_cmp_gt_u32 s83, 100000
    s_cbranch_scc1 L_end
    s_waitcnt vmcnt(0)
    v_cmp_ne_u32 s[74:75], s79, v131
    v_cmp_ne_u32 s[92:93], s79, v135
    v_cmp_ne_u32_e64 vcc, s79, v139
    s_or_b64 s[74:75], s[74:75], s[92:93]
    s_and_b32 s92, vcc_lo, 0xffff
    s_or_b32 s74, s74, s75
    s_or_b32 s74, s74, s92
    s_cbranch_scc1 Lrt218
    s_branch Lok217
Lre230:
    s_mov_b32 s83, 0
Lrt229:
    buffer_inv sc1
    s_waitcnt vmcnt(0)
    buffer_load_dwordx4 v[140:143], v46, s[16:19], s32 offen offset:0 sc1
    buffer_load_dwordx4 v[144:147], v46, s[16:19], s32 offen offset:1024 sc1
    buffer_load_dwordx4 v[148:151], v46, s[16:19], s59 offen offset:3072 sc1
    s_add_u32 s83, s83, 1
    s_cmp_gt_u32 s83, 100000
    s_cbranch_scc1 L_end
    s_waitcnt vmcnt(0)
    v_xor_b32 v143, s33, v143
    v_xor_b32 v147, s33, v147
    v_xor_b32 v151, s33, v151
    v_or3_b32 v143, v143, v147, v151
    v_cmp_lt_u32_e64 vcc, 1, v143
    ds_write_b64 v63, v[140:141] offset:10752
    ds_write_b32 v64, v142 offset:32
    ds_write_b64 v63, v[144:145] offset:13440
    ds_write_b32 v64, v146 offset:40
    ds_write_b64 v63, v[148:149] offset:8064
    ds_write_b32 v64, v150 offset:24
    s_cmp_lg_u64 vcc, 0
    s_cbranch_scc1 Lrt229
    s_branch Lok228
Lre236:
    s_mov_b32 s83, 0
Lrt235:
    buffer_load_dword v33, v59, s[16:19], s47 offen offset:1440 sc1
    s_add_u32 s83, s83, 1
    s_cmp_gt_u32 s83, 100000
    s_cbranch_scc1 L_end
    s_waitcnt vmcnt(0)
    v_cmp_ne_u32 s[34:35], s46, v33
    s_nop 0
    s_cmp_lg_u64 s[34:35], 0
    s_cbranch_scc1 Lrt235
    s_branch Lok234
Lre241:
    s_mov_b32 s83, 0
Lrt240:
    buffer_inv sc1
    s_waitcnt vmcnt(0)
    s_add_u32 s77, s47, 217088
    buffer_load_dwordx3 v[32:34], v71, s[16:19], s77 offen sc1
    s_add_u32 s83, s83, 1
    s_cmp_gt_u32 s83, 100000
    s_cbranch_scc1 L_end
    s_waitcnt vmcnt(0)
    v_cmp_ne_u32 s[34:35], s79, v34
    s_nop 0
    s_and_b32 s77, s34, s76
    s_cbranch_scc1 Lrt240
    s_branch Lok239
LS_early:
    s_and_b32 s55, s80, 0x7ff
    s_sub_u32 s55, s86, s55
    s_lshr_b32 s55, s55, 1
    s_bfe_u32 s79, s55, 0x10004
    s_xor_b32 s79, s79, s53
    s_cmp_eq_u32 s44, 0
    s_cselect_b32 s95, 125952, s94
    s_xor_b32 s81, s80, s54
    s_cselect_b32 s95, s95, s47
    s_add_u32 s95, s95, 29696
    s_mov_b32 s54, s80
    s_or_b32 s81, s81, s79
    s_cbranch_scc1 LS_last
    v_bfe_u32 v73, v46, 5, 3
    v_mul_u32_u24 v73, 2304, v73
    v_and_b32 v72, 16, v46
    v_and_b32_e64 v74, 0, v65
    v_add3_u32 v73, v73, v72, v74
    v_add_u32_e64 v73, v73, v65
    s_lshl1_add_u32 s76, s41, s52
    s_lshl_b32 s76, s76, 7
    s_add_u32 s76, s76, 163840
    v_mov_b32 v92, 0
    v_mov_b32 v93, 0
    v_mov_b32 v94, s54
    v_mov_b32 v95, s46
    buffer_load_dwordx4 v[76:79], v73, s[16:19], s76 offen sc1
    s_add_u32 s77, s76, 18432
    buffer_load_dwordx4 v[80:83], v73, s[16:19], s77 offen sc1
    s_add_u32 s77, s76, 36864
    buffer_load_dwordx4 v[84:87], v73, s[16:19], s77 offen sc1
    s_add_u32 s77, s76, 55296
    buffer_load_dwordx4 v[88:91], v73, s[16:19], s77 offen sc1
    s_add_u32 s77, s76, 73728
    s_mov_b32 exec_lo, 0x00ff00ff
    s_mov_b32 exec_hi, exec_lo
    buffer_load_dwordx4 v[92:95], v73, s[16:19], s77 offen sc1
    s_mov_b64 exec, -1
    s_branch LS_last
LS_decide:
    s_cmp_eq_u32 s83, -1
    s_cbranch_scc1 Lgo295
    s_waitcnt vmcnt(0) lgkmcnt(0)
    s_mov_b32 s83, 0
Lspin296:
    s_mov_b32 s81, 786432
    buffer_load_dwordx2 v[98:99], v32, s[16:19], s81 offen sc1
    s_add_u32 s83, s83, 1
    s_cmp_gt_u32 s83, 100000
    s_cbranch_scc1 L_end
    s_waitcnt vmcnt(0)
    v_cmp_eq_u32 s[74:75], s46, v99
    v_readlane_b32 s81, v98, s77
    s_nop 0
    s_and_b32 s82, s81, 0x7ff
    s_cmp_le_u32 s82, s78
    s_cselect_b32 s81, s81, 0
    s_max_u32 s80, s54, s81
    v_cmp_lt_u32_e64 vcc, s80, v98
    s_bitcmp1_b32 s74, s77
    s_cselect_b32 s81, s74, 0
    s_and_b32 s82, s81, vcc_lo
    s_cbranch_scc1 LS_free
    s_cmp_eq_u32 s74, -1
    s_cbranch_scc0 Lspin296
    s_and_b32 s55, s80, 0x7ff
    s_sub_u32 s55, s86, s55
    s_lshr_b32 s55, s55, 1
    s_bfe_u32 s79, s55, 0x10004
    s_xor_b32 s79, s79, s53
    s_cmp_eq_u32 s44, 0
    s_cselect_b32 s95, 125952, s94
    s_xor_b32 s81, s80, s54
    s_cselect_b32 s95, s95, s47
    s_add_u32 s95, s95, 29696
    s_mov_b32 s54, s80
    s_or_b32 s81, s81, s79
    s_cbranch_scc1 Lgo295
    v_bfe_u32 v73, v46, 5, 3
    v_mul_u32_u24 v73, 2304, v73
    v_and_b32 v72, 16, v46
    v_and_b32_e64 v74, 0, v65
    v_add3_u32 v73, v73, v72, v74
    v_add_u32_e64 v73, v73, v65
    s_lshl1_add_u32 s76, s41, s52
    s_lshl_b32 s76, s76, 7
    s_add_u32 s76, s76, 163840
    v_mov_b32 v92, 0
    v_mov_b32 v93, 0
    v_mov_b32 v94, s54
    v_mov_b32 v95, s46
    buffer_load_dwordx4 v[76:79], v73, s[16:19], s76 offen sc1
    s_add_u32 s77, s76, 18432
    buffer_load_dwordx4 v[80:83], v73, s[16:19], s77 offen sc1
    s_add_u32 s77, s76, 36864
    buffer_load_dwordx4 v[84:87], v73, s[16:19], s77 offen sc1
    s_add_u32 s77, s76, 55296
    buffer_load_dwordx4 v[88:91], v73, s[16:19], s77 offen sc1
    s_add_u32 s77, s76, 73728
    s_mov_b32 exec_lo, 0x00ff00ff
    s_mov_b32 exec_hi, exec_lo
    buffer_load_dwordx4 v[92:95], v73, s[16:19], s77 offen sc1
    s_mov_b64 exec, -1
Lgo295:
    s_cmp_lg_u32 s81, 0
    s_cbranch_scc1 Lnotown293
    v_mov_b32 v116, 0
    v_mov_b32 v117, 0
    v_mov_b32 v118, s54
    v_mov_b32 v119, s46
    buffer_load_dwordx4 v[100:103], v73, s[16:19], s76 offen sc1
    s_add_u32 s77, s76, 18432
    buffer_load_dwordx4 v[104:107], v73, s[16:19], s77 offen sc1
    s_add_u32 s77, s76, 36864
    buffer_load_dwordx4 v[108:111], v73, s[16:19], s77 offen sc1
    s_add_u32 s77, s76, 55296
    buffer_load_dwordx4 v[112:115], v73, s[16:19], s77 offen sc1
    s_add_u32 s77, s76, 73728
    s_mov_b32 exec_lo, 0x00ff00ff
    s_mov_b32 exec_hi, exec_lo
    buffer_load_dwordx4 v[116:119], v73, s[16:19], s77 offen sc1
    s_mov_b64 exec, -1
Lnotown293:
    s_lshl_b32 s82, s53, 6
    s_add_u32 s82, s82, 768
    v_add_u32 v99, s82, v49
    ds_read2_b32 v[126:127], v99 offset0:32 offset1:128
    ds_read2_b32 v[128:129], v99 offset0:0 offset1:96
    s_waitcnt lgkmcnt(1)
    v_add_f32 v126, 1.0, v126
    v_pk_fma_f32 v[8:9], v[8:9], v[126:127], v[126:127] op_sel:[0,0,1] op_sel_hi:[1,0,1]
    v_pk_fma_f32 v[10:11], v[10:11], v[126:127], v[126:127] op_sel:[0,0,1] op_sel_hi:[1,0,1]
    v_pk_fma_f32 v[12:13], v[12:13], v[126:127], v[126:127] op_sel:[0,0,1] op_sel_hi:[1,0,1]
    v_pk_fma_f32 v[14:15], v[14:15], v[126:127], v[126:127] op_sel:[0,0,1] op_sel_hi:[1,0,1]
    s_waitcnt lgkmcnt(0)
    v_add_f32 v128, 1.0, v128
    v_pk_fma_f32 v[16:17], v[16:17], v[128:129], v[128:129] op_sel:[0,0,1] op_sel_hi:[1,0,1]
    v_pk_fma_f32 v[18:19], v[18:19], v[128:129], v[128:129] op_sel:[0,0,1] op_sel_hi:[1,0,1]
    v_pk_fma_f32 v[20:21], v[20:21], v[128:129], v[128:129] op_sel:[0,0,1] op_sel_hi:[1,0,1]
    v_pk_fma_f32 v[22:23], v[22:23], v[128:129], v[128:129] op_sel:[0,0,1] op_sel_hi:[1,0,1]
    v_mov_b32 v72, 0
    s_barrier
    ds_write2_b32 v99, v72, v72 offset0:0 offset1:96
    ds_write2_b32 v99, v72, v72 offset0:32 offset1:128
    s_lshr_b32 s82, s55, 5
    s_sub_u32 s82, 2, s82
    s_mul_i32 s78, s82, 36864
    s_bfe_u32 s82, s55, 0x10004
    s_mul_i32 s82, s82, 6144
    s_add_u32 s78, s78, s82
    v_lshrrev_b32 v140, 4, v46
    v_bfe_u32 v141, v140, 1, 2
    v_lshlrev_b32 v141, 8, v141
    v_and_b32 v142, 1, v140
    v_lshl_add_u32 v141, v142, 3, v141
    s_and_b32 s82, s55, 15
    s_lshl4_add_u32 s82, s82, s78
    v_add_u32_e64 v141, s82, v141
    v_bfe_u32 v144, v140, 3, 1
    v_lshrrev_b32 v140, 4, v140
    v_subrev_u32 v140, s45, v140
    v_add_u32 v96, s78, v46
    v_add_u32 v142, 0, v140
    v_add_u32 v143, 9, v140
    v_min_u32 v142, v142, v143
    v_lshlrev_b32_e64 v142, 2, v142
    v_lshrrev_b64 v[142:143], v142, s[90:91]
    v_and_b32_e64 v142, 15, v142
    v_lshl_add_u32 v142, v142, 1, v144
    v_mul_u32_u24 v143, 43, v142
    v_lshrrev_b32 v143, 8, v143
    v_mul_u32_u24 v143, 6144, v143
    v_lshl_add_u32 v142, v142, 10, v143
    v_add_u32 v148, v142, v141
    v_add_u32 v142, 3, v140
    v_add_u32 v143, 12, v140
    v_min_u32 v142, v142, v143
    v_lshlrev_b32_e64 v142, 2, v142
    v_lshrrev_b64 v[142:143], v142, s[90:91]
    v_and_b32_e64 v142, 15, v142
    v_lshl_add_u32 v142, v142, 1, v144
    v_mul_u32_u24 v143, 43, v142
    v_lshrrev_b32 v143, 8, v143
    v_mul_u32_u24 v143, 6144, v143
    v_lshl_add_u32 v142, v142, 10, v143
    v_add_u32 v149, v142, v141
    v_add_u32 v142, 6, v140
    v_add_u32 v143, 15, v140
    v_min_u32 v142, v142, v143
    v_lshlrev_b32_e64 v142, 2, v142
    v_lshrrev_b64 v[142:143], v142, s[90:91]
    v_and_b32_e64 v142, 15, v142
    v_lshl_add_u32 v142, v142, 1, v144
    v_mul_u32_u24 v143, 43, v142
    v_lshrrev_b32 v143, 8, v143
    v_mul_u32_u24 v143, 6144, v143
    v_lshl_add_u32 v142, v142, 10, v143
    v_add_u32_e64 v150, v142, v141
    s_cmp_eq_u32 s44, 2
    s_cselect_b32 s80, s55, 0
    s_cmp_ge_u32 s80, 80
    s_cselect_b32 s80, 155648, 2.0
    s_mov_b32 s79, s81
    s_and_b32 s81, s55, 15
    s_lshl_b32 s74, 0x10001, s81
    s_mov_b32 s75, s74
    s_and_b32 s81, s81, 14
    s_lshl_b32 s92, 0x30003, s81
    s_mov_b32 s93, s92
    s_lshr_b32 s81, s55, 5
    s_mov_b64 vcc, s[74:75]
    v_mov_b32 v140, 0
    v_mov_b32 v141, 0
    v_mov_b32 v142, 0
    v_mov_b32_e64 v143, 0
    s_cmp_eq_u32 s81, 1
    s_cbranch_scc1 Lsa297
    s_cmp_eq_u32 s81, 0
    s_cbranch_scc1 Lsb298
    v_cndmask_b32_dpp v120, v0, v0, vcc quad_perm:[1,0,3,2] row_mask:0xf bank_mask:0xf
    v_cndmask_b32_dpp v121, v1, v1, vcc quad_perm:[1,0,3,2] row_mask:0xf bank_mask:0xf
    v_cndmask_b32_dpp v122, v2, v2, vcc quad_perm:[1,0,3,2] row_mask:0xf bank_mask:0xf
    v_cndmask_b32_dpp v123, v3, v3, vcc quad_perm:[1,0,3,2] row_mask:0xf bank_mask:0xf
    v_cndmask_b32_dpp v124, v4, v4, vcc quad_perm:[1,0,3,2] row_mask:0xf bank_mask:0xf
    v_cndmask_b32_dpp v125, v5, v5, vcc quad_perm:[1,0,3,2] row_mask:0xf bank_mask:0xf
    v_cndmask_b32_dpp v126, v6, v6, vcc quad_perm:[1,0,3,2] row_mask:0xf bank_mask:0xf
    v_cndmask_b32_dpp v127, v7, v7, vcc quad_perm:[1,0,3,2] row_mask:0xf bank_mask:0xf
    s_branch Lsj299
Lsa297:
    v_cndmask_b32_dpp v120, v8, v8, vcc quad_perm:[1,0,3,2] row_mask:0xf bank_mask:0xf
    v_cndmask_b32_dpp v121, v9, v9, vcc quad_perm:[1,0,3,2] row_mask:0xf bank_mask:0xf
    v_cndmask_b32_dpp v122, v10, v10, vcc quad_perm:[1,0,3,2] row_mask:0xf bank_mask:0xf
    v_cndmask_b32_dpp v123, v11, v11, vcc quad_perm:[1,0,3,2] row_mask:0xf bank_mask:0xf
    v_cndmask_b32_dpp v124, v12, v12, vcc quad_perm:[1,0,3,2] row_mask:0xf bank_mask:0xf
    v_cndmask_b32_dpp v125, v13, v13, vcc quad_perm:[1,0,3,2] row_mask:0xf bank_mask:0xf
    v_cndmask_b32_dpp v126, v14, v14, vcc quad_perm:[1,0,3,2] row_mask:0xf bank_mask:0xf
    v_cndmask_b32_dpp v127, v15, v15, vcc quad_perm:[1,0,3,2] row_mask:0xf bank_mask:0xf
    s_branch Lsj299
Lsb298:
    v_cndmask_b32_dpp v120, v16, v16, vcc quad_perm:[1,0,3,2] row_mask:0xf bank_mask:0xf
    v_cndmask_b32_dpp v121, v17, v17, vcc quad_perm:[1,0,3,2] row_mask:0xf bank_mask:0xf
    v_cndmask_b32_dpp v122, v18, v18, vcc quad_perm:[1,0,3,2] row_mask:0xf bank_mask:0xf
    v_cndmask_b32_dpp v123, v19, v19, vcc quad_perm:[1,0,3,2] row_mask:0xf bank_mask:0xf
    v_cndmask_b32_dpp v124, v20, v20, vcc quad_perm:[1,0,3,2] row_mask:0xf bank_mask:0xf
    v_cndmask_b32_dpp v125, v21, v21, vcc quad_perm:[1,0,3,2] row_mask:0xf bank_mask:0xf
    v_cndmask_b32_dpp v126, v22, v22, vcc quad_perm:[1,0,3,2] row_mask:0xf bank_mask:0xf
    v_cndmask_b32_dpp v127, v23, v23, vcc quad_perm:[1,0,3,2] row_mask:0xf bank_mask:0xf
Lsj299:
    s_mov_b64 exec, s[92:93]
    s_nop 0
    v_cndmask_b32 v140, v120, v124, s[60:61]
    v_cndmask_b32 v141, v121, v125, s[60:61]
    v_cndmask_b32 v142, v122, v126, s[60:61]
    v_cndmask_b32 v143, v123, v127, s[60:61]
    s_mov_b64 exec, -1
    s_lshl1_add_u32 s82, s41, s52
    s_lshl_b32 s82, s82, 7
    s_add_u32 s78, s82, s95
    s_add_u32 s82, s82, 155648
    v_and_or_b32 v151, v46, 16, v65
    v_mov_b32 v146, s54
    v_mov_b32 v147, s46
    v_mov_b32 v136, 0
    v_mov_b32 v137, 0
    v_mov_b32 v138, s54
    v_mov_b32 v139, s46
    s_cmp_lg_u32 s79, 0
    s_cselect_b64 exec, 0, -1
    s_cbranch_scc1 Lpk302
    s_mov_b32 s83, 0
Lspin300:
    buffer_load_dwordx4 v[120:123], v73, s[16:19], s76 offen sc1
    s_add_u32 s77, s76, 18432
    buffer_load_dwordx4 v[124:127], v73, s[16:19], s77 offen sc1
    s_add_u32 s77, s76, 36864
    buffer_load_dwordx4 v[128:131], v73, s[16:19], s77 offen sc1
    s_add_u32 s77, s76, 55296
    buffer_load_dwordx4 v[132:135], v73, s[16:19], s77 offen sc1
    s_add_u32 s77, s76, 73728
    s_mov_b32 exec_lo, 0x00ff00ff
    s_mov_b32 exec_hi, exec_lo
    buffer_load_dwordx4 v[136:139], v73, s[16:19], s77 offen sc1
    s_mov_b64 exec, -1
    s_waitcnt vmcnt(10)
    v_xor_b32 v72, s54, v78
    v_xor_b32 v74, s46, v79
    v_or_b32 v72, v72, v74
    v_xor_b32 v74, s54, v82
    v_xor_b32 v75, s46, v83
    v_or3_b32 v72, v72, v74, v75
    v_xor_b32 v74, s54, v86
    v_xor_b32 v75, s46, v87
    v_or3_b32 v72, v72, v74, v75
    v_xor_b32 v74, s54, v90
    v_xor_b32 v75, s46, v91
    v_or3_b32 v72, v72, v74, v75
    v_xor_b32 v74, s54, v94
    v_xor_b32 v75, s46, v95
    v_or3_b32 v72, v72, v74, v75
    v_cmp_ne_u32 vcc, 0, v72
    s_cbranch_vccz Lpk302
    buffer_load_dwordx4 v[76:79], v73, s[16:19], s76 offen sc1
    s_add_u32 s77, s76, 18432
    buffer_load_dwordx4 v[80:83], v73, s[16:19], s77 offen sc1
    s_add_u32 s77, s76, 36864
    buffer_load_dwordx4 v[84:87], v73, s[16:19], s77 offen sc1
    s_add_u32 s77, s76, 55296
    buffer_load_dwordx4 v[88:91], v73, s[16:19], s77 offen sc1
    s_add_u32 s77, s76, 73728
    s_mov_b32 exec_lo, 0x00ff00ff
    s_mov_b32 exec_hi, exec_lo
    buffer_load_dwordx4 v[92:95], v73, s[16:19], s77 offen sc1
    s_mov_b64 exec, -1
    s_waitcnt vmcnt(10)
    v_xor_b32 v72, s54, v102
    v_xor_b32 v74, s46, v103
    v_or_b32 v72, v72, v74
    v_xor_b32 v74, s54, v106
    v_xor_b32 v75, s46, v107
    v_or3_b32 v72, v72, v74, v75
    v_xor_b32 v74, s54, v110
    v_xor_b32 v75, s46, v111
    v_or3_b32 v72, v72, v74, v75
    v_xor_b32 v74, s54, v114
    v_xor_b32 v75, s46, v115
    v_or3_b32 v72, v72, v74, v75
    v_xor_b32 v74, s54, v118
    v_xor_b32 v75, s46, v119
    v_or3_b32 v72, v72, v74, v75
    v_cmp_ne_u32 vcc, 0, v72
    s_cbranch_vccz Lpk303
    buffer_load_dwordx4 v[100:103], v73, s[16:19], s76 offen sc1
    s_add_u32 s77, s76, 18432
    buffer_load_dwordx4 v[104:107], v73, s[16:19], s77 offen sc1
    s_add_u32 s77, s76, 36864
    buffer_load_dwordx4 v[108:111], v73, s[16:19], s77 offen sc1
    s_add_u32 s77, s76, 55296
    buffer_load_dwordx4 v[112:115], v73, s[16:19], s77 offen sc1
    s_add_u32 s77, s76, 73728
    s_mov_b32 exec_lo, 0x00ff00ff
    s_mov_b32 exec_hi, exec_lo
    buffer_load_dwordx4 v[116:119], v73, s[16:19], s77 offen sc1
    s_mov_b64 exec, -1
    s_waitcnt vmcnt(10)
    v_xor_b32 v72, s54, v122
    v_xor_b32 v74, s46, v123
    v_or_b32 v72, v72, v74
    v_xor_b32 v74, s54, v126
    v_xor_b32 v75, s46, v127
    v_or3_b32 v72, v72, v74, v75
    v_xor_b32 v74, s54, v130
    v_xor_b32 v75, s46, v131
    v_or3_b32 v72, v72, v74, v75
    v_xor_b32 v74, s54, v134
    v_xor_b32 v75, s46, v135
    v_or3_b32 v72, v72, v74, v75
    v_xor_b32 v74, s54, v138
    v_xor_b32 v75, s46, v139
    v_or3_b32 v72, v72, v74, v75
    v_cmp_ne_u32_e64 vcc, 0, v72
    s_cbranch_vccz Lpk304
    s_add_u32 s83, s83, 1
    s_cmp_gt_u32 s83, 100000
    s_cbranch_scc0 Lspin300
    s_branch L_end
Lpk302:
    v_and_b32 v79, 0xffff0000, v77
    v_lshlrev_b32_e64 v78, 16, v77
    v_and_b32 v77, 0xffff0000, v76
    v_lshlrev_b32_e64 v76, 16, v76
    v_pk_add_f32 v[142:143], v[142:143], v[78:79]
    v_pk_add_f32 v[140:141], v[140:141], v[76:77]
    v_and_b32 v83, 0xffff0000, v81
    v_lshlrev_b32_e64 v82, 16, v81
    v_and_b32 v81, 0xffff0000, v80
    v_lshlrev_b32_e64 v80, 16, v80
    v_pk_add_f32 v[142:143], v[142:143], v[82:83]
    v_pk_add_f32 v[140:141], v[140:141], v[80:81]
    v_and_b32 v87, 0xffff0000, v85
    v_lshlrev_b32_e64 v86, 16, v85
    v_and_b32 v85, 0xffff0000, v84
    v_lshlrev_b32_e64 v84, 16, v84
    v_pk_add_f32 v[142:143], v[142:143], v[86:87]
    v_pk_add_f32 v[140:141], v[140:141], v[84:85]
    v_and_b32 v91, 0xffff0000, v89
    v_lshlrev_b32_e64 v90, 16, v89
    v_and_b32 v89, 0xffff0000, v88
    v_lshlrev_b32_e64 v88, 16, v88
    v_pk_add_f32 v[142:143], v[142:143], v[90:91]
    v_pk_add_f32 v[140:141], v[140:141], v[88:89]
    v_and_b32 v95, 0xffff0000, v93
    v_lshlrev_b32_e64 v94, 16, v93
    v_and_b32 v93, 0xffff0000, v92
    v_lshlrev_b32_e64 v92, 16, v92
    v_pk_add_f32 v[142:143], v[142:143], v[94:95]
    v_pk_add_f32 v[140:141], v[140:141], v[92:93]
    s_cbranch_execnz Lpj301
Lpk303:
    v_and_b32 v103, 0xffff0000, v101
    v_lshlrev_b32 v102, 16, v101
    v_and_b32 v101, 0xffff0000, v100
    v_lshlrev_b32_e64 v100, 16, v100
    v_pk_add_f32 v[142:143], v[142:143], v[102:103]
    v_pk_add_f32 v[140:141], v[140:141], v[100:101]
    v_and_b32 v107, 0xffff0000, v105
    v_lshlrev_b32_e64 v106, 16, v105
    v_and_b32 v105, 0xffff0000, v104
    v_lshlrev_b32_e64 v104, 16, v104
    v_pk_add_f32 v[142:143], v[142:143], v[106:107]
    v_pk_add_f32 v[140:141], v[140:141], v[104:105]
    v_and_b32 v111, 0xffff0000, v109
    v_lshlrev_b32_e64 v110, 16, v109
    v_and_b32 v109, 0xffff0000, v108
    v_lshlrev_b32_e64 v108, 16, v108
    v_pk_add_f32 v[142:143], v[142:143], v[110:111]
    v_pk_add_f32 v[140:141], v[140:141], v[108:109]
    v_and_b32 v115, 0xffff0000, v113
    v_lshlrev_b32_e64 v114, 16, v113
    v_and_b32 v113, 0xffff0000, v112
    v_lshlrev_b32_e64 v112, 16, v112
    v_pk_add_f32 v[142:143], v[142:143], v[114:115]
    v_pk_add_f32 v[140:141], v[140:141], v[112:113]
    v_and_b32 v119, 0xffff0000, v117
    v_lshlrev_b32_e64 v118, 16, v117
    v_and_b32 v117, 0xffff0000, v116
    v_lshlrev_b32_e64 v116, 16, v116
    v_pk_add_f32 v[142:143], v[142:143], v[118:119]
    v_pk_add_f32 v[140:141], v[140:141], v[116:117]
    s_cbranch_execnz Lpj301
Lpk304:
    v_and_b32 v123, 0xffff0000, v121
    v_lshlrev_b32 v122, 16, v121
    v_and_b32 v121, 0xffff0000, v120
    v_lshlrev_b32_e64 v120, 16, v120
    v_pk_add_f32 v[142:143], v[142:143], v[122:123]
    v_pk_add_f32 v[140:141], v[140:141], v[120:121]
    v_and_b32 v127, 0xffff0000, v125
    v_lshlrev_b32_e64 v126, 16, v125
    v_and_b32 v125, 0xffff0000, v124
    v_lshlrev_b32_e64 v124, 16, v124
    v_pk_add_f32 v[142:143], v[142:143], v[126:127]
    v_pk_add_f32 v[140:141], v[140:141], v[124:125]
    v_and_b32 v131, 0xffff0000, v129
    v_lshlrev_b32_e64 v130, 16, v129
    v_and_b32 v129, 0xffff0000, v128
    v_lshlrev_b32_e64 v128, 16, v128
    v_pk_add_f32 v[142:143], v[142:143], v[130:131]
    v_pk_add_f32 v[140:141], v[140:141], v[128:129]
    v_and_b32 v135, 0xffff0000, v133
    v_lshlrev_b32_e64 v134, 16, v133
    v_and_b32 v133, 0xffff0000, v132
    v_lshlrev_b32_e64 v132, 16, v132
    v_pk_add_f32 v[142:143], v[142:143], v[134:135]
    v_pk_add_f32 v[140:141], v[140:141], v[132:133]
    v_and_b32 v139, 0xffff0000, v137
    v_lshlrev_b32_e64 v138, 16, v137
    v_and_b32 v137, 0xffff0000, v136
    v_lshlrev_b32 v136, 16, v136
    v_pk_add_f32 v[142:143], v[142:143], v[138:139]
    v_pk_add_f32 v[140:141], v[140:141], v[136:137]
Lpj301:
    s_nop 1
    v_add_f32_dpp v140, v140, v140 row_ror:2 row_mask:0xf bank_mask:0xf
    v_add_f32_dpp v141, v141, v141 row_ror:2 row_mask:0xf bank_mask:0xf
    v_add_f32_dpp v142, v142, v142 row_ror:2 row_mask:0xf bank_mask:0xf
    v_add_f32_dpp v143, v143, v143 row_ror:2 row_mask:0xf bank_mask:0xf
    v_add_f32_dpp v140, v140, v140 row_ror:4 row_mask:0xf bank_mask:0xf
    v_add_f32_dpp v141, v141, v141 row_ror:4 row_mask:0xf bank_mask:0xf
    v_add_f32_dpp v142, v142, v142 row_ror:4 row_mask:0xf bank_mask:0xf
    v_add_f32_dpp v143, v143, v143 row_ror:4 row_mask:0xf bank_mask:0xf
    v_add_f32_dpp v140, v140, v140 row_ror:8 row_mask:0xf bank_mask:0xf
    v_add_f32_dpp v141, v141, v141 row_ror:8 row_mask:0xf bank_mask:0xf
    v_add_f32_dpp v142, v142, v142 row_ror:8 row_mask:0xf bank_mask:0xf
    v_add_f32_dpp v143, v143, v143 row_ror:8 row_mask:0xf bank_mask:0xf
    v_cvt_pk_bf16_f32 v144, v140, v141
    v_cvt_pk_bf16_f32 v145, v142, v143
    s_and_saveexec_b64 s[34:35], s[92:93]
    s_nop 0
    buffer_store_dwordx4 v[144:147], v151, s[16:19], s82 offen sc1
    s_mov_b64 exec, s[34:35]
    s_not_b64 vcc, s[74:75]
    s_cmp_eq_u32 s81, 1
    s_cbranch_scc1 Lsa305
    s_cmp_eq_u32 s81, 0
    s_cbranch_scc1 Lsb306
    v_cndmask_b32_dpp v0, v140, v0, vcc quad_perm:[0,0,2,2] row_mask:0xf bank_mask:0xf
    v_cndmask_b32_dpp v1, v141, v1, vcc quad_perm:[0,0,2,2] row_mask:0xf bank_mask:0xf
    v_cndmask_b32_dpp v2, v142, v2, vcc quad_perm:[0,0,2,2] row_mask:0xf bank_mask:0xf
    v_cndmask_b32_dpp v3, v143, v3, vcc quad_perm:[0,0,2,2] row_mask:0xf bank_mask:0xf
    v_cndmask_b32_dpp v4, v140, v4, vcc quad_perm:[1,1,3,3] row_mask:0xf bank_mask:0xf
    v_cndmask_b32_dpp v5, v141, v5, vcc quad_perm:[1,1,3,3] row_mask:0xf bank_mask:0xf
    v_cndmask_b32_dpp v6, v142, v6, vcc quad_perm:[1,1,3,3] row_mask:0xf bank_mask:0xf
    v_cndmask_b32_dpp v7, v143, v7, vcc quad_perm:[1,1,3,3] row_mask:0xf bank_mask:0xf
    s_branch Lsj307
Lsa305:
    v_cndmask_b32_dpp v8, v140, v8, vcc quad_perm:[0,0,2,2] row_mask:0xf bank_mask:0xf
    v_cndmask_b32_dpp v9, v141, v9, vcc quad_perm:[0,0,2,2] row_mask:0xf bank_mask:0xf
    v_cndmask_b32_dpp v10, v142, v10, vcc quad_perm:[0,0,2,2] row_mask:0xf bank_mask:0xf
    v_cndmask_b32_dpp v11, v143, v11, vcc quad_perm:[0,0,2,2] row_mask:0xf bank_mask:0xf
    v_cndmask_b32_dpp v12, v140, v12, vcc quad_perm:[1,1,3,3] row_mask:0xf bank_mask:0xf
    v_cndmask_b32_dpp v13, v141, v13, vcc quad_perm:[1,1,3,3] row_mask:0xf bank_mask:0xf
    v_cndmask_b32_dpp v14, v142, v14, vcc quad_perm:[1,1,3,3] row_mask:0xf bank_mask:0xf
    v_cndmask_b32_dpp v15, v143, v15, vcc quad_perm:[1,1,3,3] row_mask:0xf bank_mask:0xf
    s_branch Lsj307
Lsb306:
    v_cndmask_b32_dpp v16, v140, v16, vcc quad_perm:[0,0,2,2] row_mask:0xf bank_mask:0xf
    v_cndmask_b32_dpp v17, v141, v17, vcc quad_perm:[0,0,2,2] row_mask:0xf bank_mask:0xf
    v_cndmask_b32_dpp v18, v142, v18, vcc quad_perm:[0,0,2,2] row_mask:0xf bank_mask:0xf
    v_cndmask_b32_dpp v19, v143, v19, vcc quad_perm:[0,0,2,2] row_mask:0xf bank_mask:0xf
    v_cndmask_b32_dpp v20, v140, v20, vcc quad_perm:[1,1,3,3] row_mask:0xf bank_mask:0xf
    v_cndmask_b32_dpp v21, v141, v21, vcc quad_perm:[1,1,3,3] row_mask:0xf bank_mask:0xf
    v_cndmask_b32_dpp v22, v142, v22, vcc quad_perm:[1,1,3,3] row_mask:0xf bank_mask:0xf
    v_cndmask_b32_dpp v23, v143, v23, vcc quad_perm:[1,1,3,3] row_mask:0xf bank_mask:0xf
Lsj307:
    s_mov_b64 exec, -1
    s_waitcnt vmcnt(1)
    s_mov_b32 s76, 155648
    v_mov_b32 v140, 0
    v_mov_b32 v142, 0
    v_mov_b32 v141, 0x3f803f80
    s_mov_b32 exec_hi, 0xffff
    s_mov_b32 s83, 0
Lspin308:
    buffer_load_dwordx4 v[112:115], v46, s[16:19], s76 offen offset:0 sc1
    buffer_load_dwordx4 v[116:119], v46, s[16:19], s76 offen offset:768 sc1
    buffer_load_dwordx4 v[120:123], v46, s[16:19], s76 offen offset:1536 sc1
    s_add_u32 s83, s83, 1
    s_cmp_gt_u32 s83, 100000
    s_cbranch_scc1 L_end
    s_waitcnt vmcnt(2)
    v_xor_b32 v72, s46, v115
    s_waitcnt vmcnt(1)
    v_xor_b32 v73, s46, v119
    s_waitcnt vmcnt(0)
    v_xor_b32_e64 v74, s46, v123
    v_or3_b32 v72, v72, v73, v74
    v_cmp_ne_u32_e64 vcc, 0, v72
    s_cbranch_vccnz Lspin308
    ds_write_b64 v148, v[112:113]
    ds_write_b64 v149, v[116:117]
    ds_write_b64 v150, v[120:121]
    v_dot2c_f32_bf16 v140, v112, v141
    v_dot2c_f32_bf16 v142, v112, v112
    v_dot2c_f32_bf16 v140, v113, v141
    v_dot2c_f32_bf16 v142, v113, v113
    v_dot2c_f32_bf16 v140, v116, v141
    v_dot2c_f32_bf16 v142, v116, v116
    v_dot2c_f32_bf16 v140, v117, v141
    v_dot2c_f32_bf16 v142, v117, v117
    v_dot2c_f32_bf16 v140, v120, v141
    v_dot2c_f32_bf16 v142, v120, v120
    v_dot2c_f32_bf16 v140, v121, v141
    v_dot2c_f32_bf16 v142, v121, v121
    s_mov_b64 exec, -1
    ds_read_b128 v[72:75], v96 offset:0
    ds_read_b128 v[76:79], v96 offset:1024
    ds_read_b128 v[80:83], v96 offset:2048
    ds_read_b128 v[84:87], v96 offset:3072
    ds_read_b128 v[88:91], v96 offset:4096
    ds_read_b128 v[92:95], v96 offset:5120
    v_add_f32_dpp v140, v140, v140 row_ror:1 row_mask:0xf bank_mask:0xf
    v_add_f32_dpp v142, v142, v142 row_ror:1 row_mask:0xf bank_mask:0xf
    s_nop 0
    v_add_f32_dpp v140, v140, v140 row_ror:2 row_mask:0xf bank_mask:0xf
    v_add_f32_dpp v142, v142, v142 row_ror:2 row_mask:0xf bank_mask:0xf
    s_nop 0
    v_add_f32_dpp v140, v140, v140 row_ror:4 row_mask:0xf bank_mask:0xf
    v_add_f32_dpp v142, v142, v142 row_ror:4 row_mask:0xf bank_mask:0xf
    s_nop 0
    v_add_f32_dpp v140, v140, v140 row_ror:8 row_mask:0xf bank_mask:0xf
    v_add_f32_dpp v142, v142, v142 row_ror:8 row_mask:0xf bank_mask:0xf
    s_waitcnt lgkmcnt(5)
    v_mfma_f32_16x16x32_bf16 v[100:103], a[0:3], v[72:75], 0
    v_mov_b32 v141, v140
    v_mov_b32 v143, v142
    v_mfma_f32_16x16x32_bf16 v[104:107], a[4:7], v[72:75], 0
    v_permlane16_swap_b32 v140, v141
    v_mfma_f32_16x16x32_bf16 v[108:111], v[72:75], a[8:11], 0
    s_waitcnt lgkmcnt(4)
    ds_read_b128 v[72:75], v96 offset:12288
    v_mfma_f32_16x16x32_bf16 v[100:103], a[12:15], v[76:79], v[100:103]
    v_permlane16_swap_b32 v142, v143
    v_mfma_f32_16x16x32_bf16 v[104:107], a[16:19], v[76:79], v[104:107]
    v_add_f32 v140, v140, v141
    v_add_f32 v142, v142, v143
    v_mfma_f32_16x16x32_bf16 v[108:111], v[76:79], a[20:23], v[108:111]
    s_waitcnt lgkmcnt(4)
    ds_read_b128 v[76:79], v96 offset:13312
    v_mov_b32 v141, v140
    v_mfma_f32_16x16x32_bf16 v[100:103], a[24:27], v[80:83], v[100:103]
    v_mov_b32 v143, v142
    v_mfma_f32_16x16x32_bf16 v[104:107], a[28:31], v[80:83], v[104:107]
    v_permlane32_swap_b32 v140, v141
    v_mfma_f32_16x16x32_bf16 v[108:111], v[80:83], a[32:35], v[108:111]
    s_waitcnt lgkmcnt(4)
    ds_read_b128 v[80:83], v96 offset:14336
    v_mfma_f32_16x16x32_bf16 v[100:103], a[36:39], v[84:87], v[100:103]
    v_permlane32_swap_b32 v142, v143
    v_mfma_f32_16x16x32_bf16 v[104:107], a[40:43], v[84:87], v[104:107]
    v_add_f32 v140, v140, v141
    v_add_f32 v142, v142, v143
    v_mfma_f32_16x16x32_bf16 v[108:111], v[84:87], a[44:47], v[108:111]
    s_waitcnt lgkmcnt(4)
    ds_read_b128 v[84:87], v96 offset:15360
    v_mul_f32 v140, 0xbae38e39, v140
    v_mfma_f32_16x16x32_bf16 v[100:103], a[48:51], v[88:91], v[100:103]
    v_mul_f32 v142, 0x3ae38e39, v142
    v_fma_f32 v142, -v140, v140, v142
    v_mfma_f32_16x16x32_bf16 v[104:107], a[52:55], v[88:91], v[104:107]
    v_max_f32 v142, 0, v142
    v_add_f32 v141, 0x3727c5ac, v142
    v_mfma_f32_16x16x32_bf16 v[108:111], v[88:91], a[56:59], v[108:111]
    s_waitcnt lgkmcnt(4)
    ds_read_b128 v[88:91], v96 offset:16384
    v_mfma_f32_16x16x32_bf16 v[100:103], a[60:63], v[92:95], v[100:103]
    v_rsq_f32 v141, v141
    v_mfma_f32_16x16x32_bf16 v[104:107], a[64:67], v[92:95], v[104:107]
    s_lshl_b32 s76, s55, 2
    s_add_u32 s76, s76, 159744
    v_mov_b32_e64 v142, s76
    v_mfma_f32_16x16x32_bf16 v[108:111], v[92:95], a[68:71], v[108:111]
    s_waitcnt lgkmcnt(4)
    ds_read_b128 v[92:95], v96 offset:17408
    s_lshr_b32 s81, s55, 4
    v_mfma_f32_16x16x32_bf16 v[100:103], a[72:75], v[72:75], v[100:103]
    v_lshl_add_u32 v114, s81, 6, v49
    v_lshl_add_u32 v115, s81, 6, v50
    v_mfma_f32_16x16x32_bf16 v[104:107], a[76:79], v[72:75], v[104:107]
    ds_write2_b32 v142, v141, v140 offset1:96
    v_mfma_f32_16x16x32_bf16 v[108:111], v[72:75], a[80:83], v[108:111]
    s_waitcnt lgkmcnt(5)
    ds_read_b128 v[72:75], v96 offset:24576
    v_mfma_f32_16x16x32_bf16 v[100:103], a[84:87], v[76:79], v[100:103]
    ds_read2_b32 v[124:125], v114 offset0:0 offset1:96
    v_mfma_f32_16x16x32_bf16 v[104:107], a[88:91], v[76:79], v[104:107]
    ds_read_b128 v[126:129], v115 offset:0
    v_mfma_f32_16x16x32_bf16 v[108:111], v[76:79], a[92:95], v[108:111]
    s_waitcnt lgkmcnt(7)
    ds_read_b128 v[76:79], v96 offset:25600
    v_mfma_f32_16x16x32_bf16 v[100:103], a[96:99], v[80:83], v[100:103]
    ds_read_b128 v[130:133], v115 offset:384
    s_mul_i32 s82, s81, 2688
    v_mfma_f32_16x16x32_bf16 v[104:107], a[100:103], v[80:83], v[104:107]
    v_add_u32_e64 v112, s82, v47
    v_add_u32 v116, s82, v63
    v_mfma_f32_16x16x32_bf16 v[108:111], v[80:83], a[104:107], v[108:111]
    s_waitcnt lgkmcnt(8)
    ds_read_b128 v[80:83], v96 offset:26624
    v_lshl_add_u32 v113, s81, 3, v48
    v_mfma_f32_16x16x32_bf16 v[100:103], a[108:111], v[84:87], v[100:103]
    v_lshl_add_u32 v117, s81, 3, v64
    s_lshl_b32 s76, s81, 10
    v_mfma_f32_16x16x32_bf16 v[104:107], a[112:115], v[84:87], v[104:107]
    s_add_u32 s76, s76, s59
    v_mfma_f32_16x16x32_bf16 v[108:111], v[84:87], a[116:119], v[108:111]
    s_waitcnt lgkmcnt(8)
    ds_read_b128 v[84:87], v96 offset:27648
    v_mfma_f32_16x16x32_bf16 v[100:103], a[120:123], v[88:91], v[100:103]
    v_mfma_f32_16x16x32_bf16 v[104:107], a[124:127], v[88:91], v[104:107]
    v_mfma_f32_16x16x32_bf16 v[108:111], v[88:91], a[128:131], v[108:111]
    s_waitcnt lgkmcnt(8)
    ds_read_b128 v[88:91], v96 offset:28672
    v_mfma_f32_16x16x32_bf16 v[100:103], a[132:135], v[92:95], v[100:103]
    v_mfma_f32_16x16x32_bf16 v[104:107], a[136:139], v[92:95], v[104:107]
    v_mfma_f32_16x16x32_bf16 v[108:111], v[92:95], a[140:143], v[108:111]
    s_waitcnt lgkmcnt(7)
    ds_read_b128 v[92:95], v96 offset:29696
    v_mfma_f32_16x16x32_bf16 v[100:103], a[144:147], v[72:75], v[100:103]
    v_mfma_f32_16x16x32_bf16 v[104:107], a[148:151], v[72:75], v[104:107]
    v_mfma_f32_16x16x32_bf16 v[108:111], v[72:75], a[152:155], v[108:111]
    s_waitcnt lgkmcnt(5)
    v_mfma_f32_16x16x32_bf16 v[100:103], a[156:159], v[76:79], v[100:103]
    v_mfma_f32_16x16x32_bf16 v[104:107], a[160:163], v[76:79], v[104:107]
    v_mfma_f32_16x16x32_bf16 v[108:111], v[76:79], a[164:167], v[108:111]
    s_waitcnt lgkmcnt(3)
    v_mfma_f32_16x16x32_bf16 v[100:103], a[168:171], v[80:83], v[100:103]
    v_mfma_f32_16x16x32_bf16 v[104:107], a[172:175], v[80:83], v[104:107]
    v_mfma_f32_16x16x32_bf16 v[108:111], v[80:83], a[176:179], v[108:111]
    s_waitcnt lgkmcnt(2)
    v_mfma_f32_16x16x32_bf16 v[100:103], a[180:183], v[84:87], v[100:103]
    v_mfma_f32_16x16x32_bf16 v[104:107], a[184:187], v[84:87], v[104:107]
    v_mfma_f32_16x16x32_bf16 v[108:111], v[84:87], a[188:191], v[108:111]
    s_waitcnt lgkmcnt(1)
    v_mfma_f32_16x16x32_bf16 v[100:103], a[192:195], v[88:91], v[100:103]
    v_mfma_f32_16x16x32_bf16 v[104:107], a[196:199], v[88:91], v[104:107]
    v_mfma_f32_16x16x32_bf16 v[108:111], v[88:91], a[200:203], v[108:111]
    s_waitcnt lgkmcnt(0)
    v_mfma_f32_16x16x32_bf16 v[100:103], a[204:207], v[92:95], v[100:103]
    v_mfma_f32_16x16x32_bf16 v[104:107], a[208:211], v[92:95], v[104:107]
    v_mfma_f32_16x16x32_bf16 v[108:111], v[92:95], a[212:215], v[108:111]
    v_pk_fma_f32 v[100:101], v[124:125], v[24:25], v[100:101] op_sel:[1,0,0] op_sel_hi:[1,1,1]
    v_pk_fma_f32 v[102:103], v[124:125], v[26:27], v[102:103] op_sel:[1,0,0] op_sel_hi:[1,1,1]
    v_pk_mul_f32 v[100:101], v[124:125], v[100:101] op_sel_hi:[0,1]
    v_pk_mul_f32 v[102:103], v[124:125], v[102:103] op_sel_hi:[0,1]
    v_cvt_pk_bf16_f32 v134, v100, v101
    v_cvt_pk_bf16_f32 v135, v102, v103
    ds_write_b64 v112, v[134:135] offset:0
    v_pk_fma_f32 v[104:105], v[124:125], v[28:29], v[104:105] op_sel:[1,0,0] op_sel_hi:[1,1,1]
    v_pk_fma_f32 v[106:107], v[124:125], v[30:31], v[106:107] op_sel:[1,0,0] op_sel_hi:[1,1,1]
    v_pk_mul_f32 v[104:105], v[124:125], v[104:105] op_sel_hi:[0,1]
    v_pk_mul_f32 v[106:107], v[124:125], v[106:107] op_sel_hi:[0,1]
    v_cvt_pk_bf16_f32 v136, v104, v105
    v_cvt_pk_bf16_f32 v137, v106, v107
    ds_write_b64 v112, v[136:137] offset:16128
    v_pk_fma_f32 v[108:109], v[130:131], v[34:35], v[108:109] op_sel:[0,1,0]
    v_pk_fma_f32 v[110:111], v[132:133], v[34:35], v[110:111] op_sel:[0,1,0]
    v_pk_mul_f32 v[108:109], v[126:127], v[108:109]
    v_pk_mul_f32 v[110:111], v[128:129], v[110:111]
    v_cvt_pk_bf16_f32 v138, v108, v109
    v_cvt_pk_bf16_f32 v139, v110, v111
    ds_write_b64 v113, v[138:139] offset:0
    s_or_b32 s94, s46, 3
    v_permlane32_swap_b32 v134, v136
    v_permlane32_swap_b32_e64 v135, v137
    v_mov_b32_dpp v139, v139 row_ror:8 row_mask:0xf bank_mask:0xf
    v_cndmask_b32 v134, v134, v136, s[28:29]
    v_cndmask_b32 v135, v135, v137, s[28:29]
    v_cndmask_b32 v136, v138, v139, s[30:31]
    v_mov_b32_e64 v137, s94
    s_bitcmp1_b32 s58, 0
    s_cbranch_scc0 Lnx309
    buffer_store_dwordx4 v[134:137], v46, s[16:19], s76 offen offset:0 sc1
Lnx309:
    v_mov_b32 v143, s46
    s_bitcmp1_b32 s58, 1
    s_cbranch_scc0 Lnp310
    v_xor_b32 v143, s94, v143
    v_cmp_lt_u32_e64 vcc, 0, v143
    ds_write_b64 v116, v[140:141] offset:0
    ds_write_b32 v117, v142 offset:0
    s_cmp_lg_u64 vcc, 0
    s_cbranch_scc1 Lre313
Lok311:
Lnp310:
    s_waitcnt vmcnt(0) lgkmcnt(0)
    s_branch LS_free
Lre248:
    s_mov_b32 s83, 0
Lrt247:
    buffer_inv sc1
    s_waitcnt vmcnt(0)
    buffer_load_dwordx4 v[120:123], v46, s[16:19], s59 offen offset:2048 sc1
    buffer_load_dwordx4 v[124:127], v46, s[16:19], s59 offen offset:1024 sc1
    s_add_u32 s83, s83, 1
    s_cmp_gt_u32 s83, 100000
    s_cbranch_scc1 L_end
    s_waitcnt vmcnt(0)
    v_xor_b32 v123, s33, v123
    v_xor_b32 v127, s33, v127
    v_or_b32 v123, v123, v127
    v_cmp_lt_u32_e64 vcc, 1, v123
    ds_write_b64 v63, v[120:121] offset:5376
    ds_write_b32 v64, v122 offset:16
    ds_write_b64 v63, v[124:125] offset:2688
    ds_write_b32 v64, v126 offset:8
    s_cmp_lg_u64 vcc, 0
    s_cbranch_scc1 Lrt247
    s_branch Lok246
Lre253:
    s_mov_b32 s83, 0
Lrt252:
    buffer_inv sc1
    s_waitcnt vmcnt(0)
    buffer_load_dwordx4 v[148:151], v46, s[16:19], s59 offen offset:0 sc1
    s_add_u32 s83, s83, 1
    s_cmp_gt_u32 s83, 100000
    s_cbranch_scc1 L_end
    s_waitcnt vmcnt(0)
    v_xor_b32_e64 v151, s33, v151
    v_cmp_lt_u32 vcc, 1, v151
    ds_write_b64 v63, v[148:149] offset:0
    ds_write_b32 v64, v150 offset:0
    s_cmp_lg_u64 vcc, 0
    s_cbranch_scc1 Lrt252
    s_branch Lok251
Lre256:
    s_mov_b32 s83, 0
Lrt255:
    buffer_load_dword v146, v58, s[16:19], s47 offen offset:480 sc1
    s_add_u32 s83, s83, 1
    s_cmp_gt_u32 s83, 100000
    s_cbranch_scc1 L_end
    s_waitcnt vmcnt(0)
    v_cmp_ne_u32 s[34:35], s46, v146
    s_nop 0
    s_cmp_lg_u64 s[34:35], 0
    s_cbranch_scc1 Lrt255
    s_branch Lok254
Lre259:
    s_mov_b32 s83, 0
Lrt258:
    buffer_load_dword v146, v58, s[16:19], s47 offen offset:640 sc1
    s_add_u32 s83, s83, 1
    s_cmp_gt_u32 s83, 100000
    s_cbranch_scc1 L_end
    s_waitcnt vmcnt(0)
    v_cmp_ne_u32 s[34:35], s46, v146
    s_nop 0
    s_cmp_lg_u64 s[34:35], 0
    s_cbranch_scc1 Lrt258
    s_branch Lok257
Lre263:
    s_mov_b32 s83, 0
Lrt262:
    buffer_load_dword v98, v58, s[16:19], s47 offen offset:800 sc1
    s_add_u32 s83, s83, 1
    s_cmp_gt_u32 s83, 100000
    s_cbranch_scc1 L_end
    s_waitcnt vmcnt(0)
    v_cmp_ne_u32 s[34:35], s46, v98
    s_nop 0
    s_cmp_lg_u64 s[34:35], 0
    s_cbranch_scc1 Lrt262
    s_branch Lok261
Lre267:
    s_mov_b32 s83, 0
Lrt266:
    buffer_inv sc1
    s_waitcnt vmcnt(0)
    buffer_load_dwordx4 v[112:115], v61, s[16:19], s47 offen offset:3072 sc1
    s_add_u32 s81, s47, 12288
    buffer_load_dwordx4 v[116:119], v61, s[16:19], s81 offen offset:3072 sc1
    s_add_u32 s81, s47, 24576
    buffer_load_dwordx4 v[120:123], v69, s[16:19], s81 offen offset:3072 sc1
    s_add_u32 s83, s83, 1
    s_cmp_gt_u32 s83, 100000
    s_cbranch_scc1 L_end
    s_waitcnt vmcnt(0)
    v_cmp_ne_u32 s[74:75], s79, v115
    v_cmp_ne_u32 s[92:93], s79, v119
    v_cmp_ne_u32 vcc, s79, v123
    s_or_b64 s[74:75], s[74:75], s[92:93]
    s_and_b32 s92, vcc_lo, 0xffff
    s_or_b32 s74, s74, s75
    s_or_b32 s74, s74, s92
    s_cbranch_scc1 Lrt266
    s_branch Lok265
Lre270:
    s_mov_b32 s83, 0
Lrt269:
    buffer_inv sc1
    s_waitcnt vmcnt(0)
    buffer_load_dwordx4 v[128:131], v61, s[16:19], s47 offen offset:2560 sc1
    s_add_u32 s81, s47, 12288
    buffer_load_dwordx4 v[132:135], v61, s[16:19], s81 offen offset:2560 sc1
    s_add_u32 s81, s47, 24576
    buffer_load_dwordx4 v[136:139], v69, s[16:19], s81 offen offset:2560 sc1
    s_add_u32 s83, s83, 1
    s_cmp_gt_u32 s83, 100000
    s_cbranch_scc1 L_end
    s_waitcnt vmcnt(0)
    v_cmp_ne_u32 s[74:75], s79, v131
    v_cmp_ne_u32 s[92:93], s79, v135
    v_cmp_ne_u32 vcc, s79, v139
    s_or_b64 s[74:75], s[74:75], s[92:93]
    s_and_b32 s92, vcc_lo, 0xffff
    s_or_b32 s74, s74, s75
    s_or_b32 s74, s74, s92
    s_cbranch_scc1 Lrt269
    s_branch Lok268
Lre273:
    s_mov_b32 s83, 0
Lrt272:
    buffer_inv sc1
    s_waitcnt vmcnt(0)
    buffer_load_dwordx4 v[112:115], v61, s[16:19], s47 offen offset:2048 sc1
    s_add_u32 s81, s47, 12288
    buffer_load_dwordx4 v[116:119], v61, s[16:19], s81 offen offset:2048 sc1
    s_add_u32 s81, s47, 24576
    buffer_load_dwordx4 v[120:123], v69, s[16:19], s81 offen offset:2048 sc1
    s_add_u32 s83, s83, 1
    s_cmp_gt_u32 s83, 100000
    s_cbranch_scc1 L_end
    s_waitcnt vmcnt(0)
    v_cmp_ne_u32 s[74:75], s79, v115
    v_cmp_ne_u32 s[92:93], s79, v119
    v_cmp_ne_u32 vcc, s79, v123
    s_or_b64 s[74:75], s[74:75], s[92:93]
    s_and_b32 s92, vcc_lo, 0xffff
    s_or_b32 s74, s74, s75
    s_or_b32 s74, s74, s92
    s_cbranch_scc1 Lrt272
    s_branch Lok271
Lre313:
    s_mov_b32 s83, 0
Lrt312:
    buffer_inv sc1
    s_waitcnt vmcnt(0)
    buffer_load_dwordx4 v[140:143], v46, s[16:19], s76 offen offset:0 sc1
    s_add_u32 s83, s83, 1
    s_cmp_gt_u32 s83, 100000
    s_cbranch_scc1 L_end
    s_waitcnt vmcnt(0)
    v_xor_b32 v143, s94, v143
    v_cmp_lt_u32 vcc, 0, v143
    ds_write_b64 v116, v[140:141] offset:0
    ds_write_b32 v117, v142 offset:0
    s_cmp_lg_u64 vcc, 0
    s_cbranch_scc1 Lrt312
    s_branch Lok311
    s_endpgm
.section .rodata,"a"
.p2align 6
.amdhsa_kernel interleave_layers__sliding_local_dilated__moe_arch_mod__prompt_kernel
  .amdhsa_next_free_vgpr 512
  .amdhsa_next_free_sgpr 102
  .amdhsa_accum_offset 256
  .amdhsa_group_segment_fixed_size 0
  .amdhsa_kernarg_size 88
  .amdhsa_user_sgpr_count 2
  .amdhsa_user_sgpr_kernarg_segment_ptr 1
  .amdhsa_system_sgpr_workgroup_id_x 1
.end_amdhsa_kernel
```
